```python
import torch

def _softmax(x, axis=-1):
    return torch.softmax(x, dim=axis)
def _gelu(x):
    return torch.nn.functional.gelu(x, approximate="tanh")
def _silu(x):
    return torch.nn.functional.silu(x)
def _sigmoid(x):
    return torch.sigmoid(x)
def _layernorm(x, axis=-1, eps=1e-5):
    m = x.mean(dim=axis, keepdim=True)
    v = x.var(dim=axis, keepdim=True, unbiased=False)
    return (x - m) / torch.sqrt(v + eps)
def _scatter_add(tgt, idx, src, axis=0):
    return tgt.clone().index_add_(axis, idx, src)
def _segment_sum(src, seg, n):
    out = torch.zeros((n,) + src.shape[1:], dtype=src.dtype)
    return out.index_add_(0, seg, src)
def _pad(x, pw):
    flat = tuple(v for pair in reversed(pw) for v in pair)
    return torch.nn.functional.pad(x, flat)

kernel_name = 'concat_heads__mha_block_cached__gqa_block_cached__near_ridge'

def setup_inputs():

    _w = (lambda a: (lambda t: t.to(torch.bfloat16) if t.is_floating_point() else t)(torch.as_tensor(a)))
    def _A_setup():
        B, Sq, D = 8, 192, 448
        H, Sk, Dh = 16, 1024, 256
        return {
            "x": _w((lambda *s: torch.randn(*s, dtype=torch.bfloat16) * 0.8)(B, Sq, D)),
            "k_cache": _w((lambda *s: torch.randn(*s, dtype=torch.bfloat16) * 0.8)(B, H, Sk, Dh)),
            "v_cache": _w((lambda *s: torch.randn(*s, dtype=torch.bfloat16) * 0.05)(B, H, Sk, Dh)),
            "wq": _w((lambda *s: torch.randn(*s, dtype=torch.bfloat16) * 0.8)(D, H * Dh) * (D ** -0.5)),
            "wo": _w((lambda *s: torch.randn(*s, dtype=torch.bfloat16) * 0.05)(H * Dh, D) * ((H * Dh) ** -0.5)),
        }
    _A_in = _A_setup()

    def _B_setup():
        B, Sq, D = 8, 192, 448
        Hq, Hkv, Sk, Dh = 16, 16, 1024, 256
        assert Hq % Hkv == 0, (Hq, Hkv)
        return {
            "x": _w((lambda *s: torch.randn(*s, dtype=torch.bfloat16) * 0.8)(B, Sq, D)),
            "k_cache": _w((lambda *s: torch.randn(*s, dtype=torch.bfloat16) * 0.8)(B, Hkv, Sk, Dh)),
            "v_cache": _w((lambda *s: torch.randn(*s, dtype=torch.bfloat16) * 0.05)(B, Hkv, Sk, Dh)),
            "wq": _w((lambda *s: torch.randn(*s, dtype=torch.bfloat16) * 0.8)(D, Hq * Dh) * (D ** -0.5)),
            "wo": _w((lambda *s: torch.randn(*s, dtype=torch.bfloat16) * 0.05)(Hq * Dh, D) * ((Hq * Dh) ** -0.5)),
        }
    _B_in = _B_setup()

    return {
        "A_x": _A_in["x"],
        "A_k_cache": _A_in["k_cache"],
        "A_v_cache": _A_in["v_cache"],
        "A_wq": _A_in["wq"],
        "A_wo": _A_in["wo"],
        "B_x": _B_in["x"],
        "B_k_cache": _B_in["k_cache"],
        "B_v_cache": _B_in["v_cache"],
        "B_wq": _B_in["wq"],
        "B_wo": _B_in["wo"],
    }

def reference(A_x, A_k_cache, A_v_cache, A_wq, A_wo, B_x, B_k_cache, B_v_cache, B_wq, B_wo):
    def _A_ref(x, k_cache, v_cache, wq, wo):
        B, Sq, D = x.shape
        H, Dh = 16, 256
        q = (lambda x, *d: x.permute(*d))((x @ wq).reshape(B, Sq, H, Dh), 0, 2, 1, 3)
        scores = torch.einsum("bhqd,bhkd->bhqk", q, k_cache) * (Dh ** -0.5)
        p = _softmax(scores, axis=-1)
        o = torch.einsum("bhqk,bhkd->bhqd", p, v_cache)
        return (lambda x, *d: x.permute(*d))(o, 0, 2, 1, 3).reshape(B, Sq, H * Dh) @ wo

    def _B_ref(x, k_cache, v_cache, wq, wo):
        B, Sq, D = x.shape
        Hq, Dh = 16, 256
        Hkv = k_cache.shape[1]
        rep = Hq // Hkv
        q = (lambda x, *d: x.permute(*d))((x @ wq).reshape(B, Sq, Hq, Dh), 0, 2, 1, 3)
        k = (lambda x, n, axis: torch.repeat_interleave(x, n, dim=axis))(k_cache, rep, axis=1)
        v = (lambda x, n, axis: torch.repeat_interleave(x, n, dim=axis))(v_cache, rep, axis=1)
        scores = torch.einsum("bhqd,bhkd->bhqk", q, k) * (Dh ** -0.5)
        p = _softmax(scores, axis=-1)
        o = torch.einsum("bhqk,bhkd->bhqd", p, v)
        return (lambda x, *d: x.permute(*d))(o, 0, 2, 1, 3).reshape(B, Sq, Hq * Dh) @ wo

    a = _A_ref(A_x, A_k_cache, A_v_cache, A_wq, A_wo)
    b = _B_ref(B_x, B_k_cache, B_v_cache, B_wq, B_wo)
    return torch.concatenate([a, b], axis=-1)
```

```asm
; @launch grid=(256,1,1) block=(256,1,1) lds=163840
.amdgcn_target "amdgcn-amd-amdhsa--gfx950"
.text
.globl concat_heads__mha_block_cached__gqa_block_cached__near_ridge_kernel
.p2align 12
.p2align 8
.type concat_heads__mha_block_cached__gqa_block_cached__near_ridge_kernel,@function
concat_heads__mha_block_cached__gqa_block_cached__near_ridge_kernel:
    s_cmp_ge_u32 s2, 256
    s_cbranch_scc1 L_end
    s_load_dwordx16 s[44:59], s[0:1], 0
    s_load_dwordx4 s[60:63], s[0:1], 64
    s_load_dwordx4 s[88:91], s[0:1], 80
    s_load_dwordx2 s[64:65], s[0:1], 96
    v_lshrrev_b32 v1, 6, v0
    v_and_b32 v2, 63, v0
    v_readfirstlane_b32 s3, v1
    s_and_b32 s4, s2, 7
    s_lshr_b32 s92, s2, 3
    s_lshr_b32 s6, s4, 2
    s_and_b32 s4, s4, 3
    s_lshl_b32 s4, s4, 2
    s_lshr_b32 s93, s92, 3
    s_add_u32 s4, s4, s93
    s_and_b32 s7, s92, 7
    s_lshl_b32 s32, s3, 12
    v_lshrrev_b32 v3, 5, v2
    v_and_b32 v4, 31, v2
    v_and_b32 v5, 1, v1
    v_lshlrev_b32 v5, 3, v5
    v_lshl_or_b32 v5, v3, 1, v5
    v_xor_b32 v6, v4, v5
    v_xor_b32 v7, 4, v6
    v_lshl_add_u32 v8, v1, 3, v3
    v_lshlrev_b32 v9, 13, v8
    v_lshlrev_b32 v12, 2, v3
    v_xor_b32 v12, v12, v4
    v_xor_b32 v13, 8, v12
    v_lshl_add_u32 v208, v12, 4, v9
    v_lshl_add_u32 v209, v13, 4, v9
    s_mul_i32 s37, s3, 4104
    v_add_u32 v209, 14336, v209
    v_and_b32 v10, 15, v2
    v_lshrrev_b32 v11, 4, v2
    v_lshrrev_b32 v19, 2, v2
    v_and_b32 v20, 3, v2
    v_mul_u32_u24 v12, 48, v1
    v_add_u32 v12, v12, v19
    v_mul_u32_u24 v12, 896, v12
    v_sub_u32 v13, 0, v11
    v_xor_b32 v13, v13, v20
    v_and_b32 v13, 3, v13
    v_lshl_add_u32 v228, v13, 4, v12
    v_add_u32 v229, 13312, v228
    v_add_u32 v230, 26624, v228
    s_getpc_b64 s[94:95]
L_pc:
    s_lshl_b32 s93, s92, 2
    s_add_u32 s93, s93, s3
    s_lshl_b32 s93, s93, 9
    v_lshl_add_u32 v13, v20, 7, s93
    v_min_u32 v13, L_last-L_page0, v13
    v_add_u32 v13, L_page0-L_pc, v13
    v_mov_b32 v15, s95
    v_add_co_u32 v14, vcc, s94, v13
    s_nop 1
    v_addc_co_u32 v15, vcc, 0, v15, vcc
    global_load_dword v231, v[14:15], off
    s_lshl_b32 s94, s7, 2
    s_add_u32 s94, s94, s3
    s_lshl_b32 s94, s94, 13
    v_lshl_add_u32 v13, v19, 18, s94
    v_lshl_add_u32 v13, v20, 7, v13
    v_cmp_gt_u32 vcc, 16, v2
    v_mov_b32 v16, 0x40000000
    s_and_b32 s94, s4, 3
    s_lshl_b32 s94, s94, 2
    v_cndmask_b32 v232, v16, v13, vcc
    s_add_u32 s94, s94, s3
    s_mul_i32 s94, s94, 10752
    v_mul_u32_u24 v13, 43, v2
    v_lshrrev_b32 v13, 9, v13
    v_mul_u32_u24 v14, 12, v13
    v_sub_u32 v14, v2, v14
    v_mul_u32_u24 v14, 896, v14
    v_lshl_add_u32 v13, v13, 7, v14
    v_cmp_gt_u32 vcc, 24, v2
    v_add_u32 v13, s94, v13
    s_nop 0
    v_cndmask_b32 v233, v16, v13, vcc
    v_and_b32 v9, 1, v1
    v_lshlrev_b32 v9, 12, v9
    v_lshrrev_b32 v12, 1, v1
    v_lshl_add_u32 v9, v12, 13, v9
    v_lshl_add_u32 v9, v3, 9, v9
    v_lshl_add_u32 v206, v6, 4, v9
    v_lshl_add_u32 v207, v7, 4, v9
    v_lshl_or_b32 v12, v1, 2, v3
    v_xor_b32 v12, v4, v12
    v_xor_b32 v13, 2, v12
    v_lshl_add_u32 v204, v12, 4, v9
    v_lshl_add_u32 v205, v13, 4, v9
    v_add_u32 v205, 30720, v205
    v_add_u32 v207, 30720, v207
    v_mul_u32_u24 v13, 3072, v1
    v_lshl_add_u32 v212, v2, 4, v13
    s_getreg_b32 s97, hwreg(HW_REG_XCC_ID, 0, 4)
    v_mov_b32 v213, 0
    v_mov_b32 v21, s97
    v_lshlrev_b32 v22, 12, v2
    v_lshlrev_b32 v23, 12, v0
    v_lshl_add_u32 v13, v1, 6, v19
    v_mul_u32_u24 v13, 896, v13
    v_and_b32 v14, 1, v11
    v_lshlrev_b32 v14, 1, v14
    v_xor_b32 v15, v14, v20
    v_lshl_add_u32 v13, v15, 4, v13
    v_add_u32 v210, 4096, v13
    v_add_u32 v211, 30720, v13
    v_lshrrev_b32 v15, 1, v20
    v_or_b32 v15, v15, v14
    v_lshlrev_b32 v15, 4, v15
    v_lshl_add_u32 v15, v19, 6, v15
    v_and_b32 v14, 1, v2
    v_lshl_add_u32 v255, v14, 3, v15
    v_lshrrev_b32 v13, 1, v10
    v_and_b32 v14, 1, v10
    v_lshl_add_u32 v13, v13, 2, v14
    v_lshlrev_b32 v13, 9, v13
    v_and_b32 v14, 1, v11
    v_xor_b32 v15, v11, v10
    v_lshl_add_u32 v13, v15, 4, v13
    v_add_u32 v192, 0, v13
    v_xor_b32 v193, 64, v192
    v_xor_b32 v194, 128, v192
    v_xor_b32 v195, 192, v192
    v_bfe_u32 v13, v2, 3, 1
    v_bfe_u32 v15, v2, 2, 1
    v_lshlrev_b32 v16, 3, v11
    v_lshl_add_u32 v16, v13, 2, v16
    v_add_u32 v16, v16, v15
    v_lshlrev_b32 v16, 9, v16
    v_lshlrev_b32 v17, 3, v14
    v_lshl_or_b32 v17, v13, 2, v17
    v_lshl_or_b32 v17, v15, 1, v17
    v_bfe_u32 v18, v2, 1, 1
    v_or_b32 v17, v17, v18
    v_lshl_add_u32 v16, v17, 4, v16
    v_and_b32 v18, 1, v2
    v_lshl_add_u32 v16, v18, 3, v16
    v_add_u32 v196, 0x10000, v16
    v_mul_u32_u24 v16, 4104, v11
    v_lshl_add_u32 v16, v13, 11, v16
    v_lshl_add_u32 v16, v15, 9, v16
    v_add_u32 v16, 16320, v16
    v_lshl_add_u32 v236, v10, 4, v16
    v_xor_b32 v17, 4, v10
    v_lshl_add_u32 v237, v17, 4, v16
    v_xor_b32 v17, 8, v10
    v_lshl_add_u32 v238, v17, 4, v16
    v_xor_b32 v17, 12, v10
    v_lshl_add_u32 v239, v17, 4, v16
    v_lshrrev_b32 v13, 2, v10
    v_sub_u32 v13, 0, v13
    v_xor_b32 v13, v13, v11
    v_and_b32 v13, 3, v13
    v_lshlrev_b32 v13, 4, v13
    v_lshl_add_u32 v13, v10, 6, v13
    v_lshl_add_u32 v240, v1, 12, v13
    v_mov_b32 v216, 1
    v_xor_b32 v197, 32, v196
    v_xor_b32 v198, 64, v196
    v_xor_b32 v199, 96, v196
    v_xor_b32 v200, 128, v196
    v_xor_b32 v201, 160, v196
    v_xor_b32 v202, 192, v196
    v_xor_b32 v203, 224, v196
    v_add_u32 v241, 0x10000, v236
    v_add_u32 v242, 0x10000, v237
    v_add_u32 v243, 0x10000, v238
    v_add_u32 v244, 0x10000, v239
    v_add_u32 v245, 0x10000, v240
    v_add_u32 v246, 0x10000, v241
    v_add_u32 v247, 0x10000, v242
    v_add_u32 v248, 0x10000, v243
    v_add_u32 v249, 0x10000, v244
    v_add_u32 v250, 0x10000, v245
    v_min_u32 v215, 55, v2
    v_lshlrev_b32 v215, 7, v215
    v_min_u32 v254, 4480, v215
    s_waitcnt lgkmcnt(0)
    s_cmp_eq_u32 s6, 0
    s_cselect_b64 s[8:9], s[44:45], s[54:55]
    s_cselect_b64 s[16:17], s[46:47], s[56:57]
    s_cselect_b64 s[20:21], s[48:49], s[58:59]
    s_cselect_b64 s[12:13], s[50:51], s[60:61]
    s_cselect_b64 s[24:25], s[52:53], s[62:63]
    s_mul_i32 s94, s7, 172032
    s_add_u32 s8, s8, s94
    s_addc_u32 s9, s9, 0
    s_mov_b32 s10, 172032
    s_mov_b32 s11, 0x20000
    s_lshl_b32 s94, s4, 9
    s_add_u32 s12, s12, s94
    s_addc_u32 s13, s13, 0
    s_mov_b32 s14, 3662336
    s_mov_b32 s15, 0x20000
    s_mov_b32 s5, 0
    s_mov_b32 s29, 64
    s_add_u32 m0, s32, 32768
    s_nop 0
    buffer_load_dwordx4 v228, s[8:11], s5 offen offset:0 lds
    s_add_u32 m0, s32, 65536
    s_nop 0
    buffer_load_dwordx4 v228, s[8:11], s29 offen offset:0 lds
    s_add_u32 m0, s32, 32768
    s_nop 0
    buffer_load_dwordx4 v229, s[8:11], s5 offen offset:1024 lds
    s_add_u32 m0, s32, 65536
    s_nop 0
    buffer_load_dwordx4 v229, s[8:11], s29 offen offset:1024 lds
    s_add_u32 m0, s32, 32768
    s_nop 0
    buffer_load_dwordx4 v230, s[8:11], s5 offen offset:2048 lds
    s_add_u32 m0, s32, 65536
    s_nop 0
    buffer_load_dwordx4 v230, s[8:11], s29 offen offset:2048 lds
    s_add_u32 m0, s37, 49088
    s_mov_b32 s35, 0
    s_mov_b32 s36, 31744
    buffer_load_dwordx4 v208, s[12:15], s35 offen offset:0 lds
    buffer_load_dwordx4 v209, s[12:15], s35 offen offset:2048 lds
    buffer_load_dwordx4 v208, s[12:15], s36 offen offset:1024 lds
    buffer_load_dwordx4 v209, s[12:15], s36 offen offset:3072 lds
    s_add_u32 m0, s37, 81856
    s_mov_b32 s35, 262144
    s_mov_b32 s36, 293888
    buffer_load_dwordx4 v208, s[12:15], s35 offen offset:0 lds
    buffer_load_dwordx4 v209, s[12:15], s35 offen offset:2048 lds
    buffer_load_dwordx4 v208, s[12:15], s36 offen offset:1024 lds
    buffer_load_dwordx4 v209, s[12:15], s36 offen offset:3072 lds
    s_lshl_b32 s94, s7, 4
    s_add_u32 s94, s94, s4
    s_lshl_b32 s95, s94, 19
    s_add_u32 s16, s16, s95
    s_addc_u32 s17, s17, 0
    s_mov_b32 s18, 0x80000
    s_mov_b32 s19, 0x20000
    s_add_u32 s20, s20, s95
    s_addc_u32 s21, s21, 0
    s_mov_b32 s22, 0x80000
    s_mov_b32 s23, 0x20000
    s_mov_b32 s33, 0
    s_mov_b32 s34, 0
    s_lshl_b32 s95, s6, 3
    s_add_u32 s95, s95, s7
    s_mul_i32 s93, s95, 3543040
    s_add_u32 s68, s64, s93
    s_addc_u32 s69, s65, 0
    s_mov_b32 s70, 3543040
    s_mov_b32 s71, 0x20000
    s_mul_i32 s93, s95, 4352
    s_add_u32 s93, s93, 56688640
    s_add_u32 s72, s64, s93
    s_addc_u32 s73, s65, 0
    s_mov_b32 s74, 4096
    s_mov_b32 s75, 0x20000
    s_lshl_b32 s30, s4, 5
    s_lshr_b32 s93, s4, 2
    s_lshl_b32 s31, s93, 7
    s_add_u32 s31, s31, 4
    s_mul_i32 s59, s93, 151552
    s_mul_i32 s56, s93, 606208
    s_lshl_b32 s93, s93, 7
    s_lshl_b32 s94, s3, 2
    s_add_u32 s93, s93, s94
    s_add_u32 s93, s93, 2048
    s_and_b32 s94, s4, 3
    s_lshl_b32 s94, s94, 4
    s_add_u32 s28, s93, s94
    s_xor_b32 s60, s28, 16
    s_xor_b32 s61, s28, 32
    buffer_store_dword v213, v23, s[72:75], s30 offen sc1
    buffer_store_dword v21, v23, s[72:75], s30 offen offset:4 sc1
    buffer_store_dword v213, v22, s[72:75], s28 offen sc1
    s_add_u32 s59, s59, 458752
    s_add_u32 s56, s56, 1114112
    s_and_b32 s52, s4, 3
    s_xor_b32 s53, s52, 1
    s_xor_b32 s54, s52, 3
    s_xor_b32 s55, s52, 2
    s_mul_i32 s63, s4, 28672
    s_mov_b32 s67, 0x40000
    s_lshl_b32 s93, s95, 4
    s_add_u32 s80, s90, s93
    s_addc_u32 s81, s91, 0
    s_mov_b32 s82, 4
    s_mov_b32 s83, 0x20000
    s_mul_i32 s93, s7, 344064
    s_mul_i32 s94, s6, 896
    s_add_u32 s93, s93, s94
    s_add_u32 s84, s88, s93
    s_addc_u32 s85, s89, 0
    s_mov_b32 s86, 343168
    s_mov_b32 s87, 0x20000
    s_lshl_b32 s66, s3, 4
    s_add_u32 s66, s66, s4
    s_lshr_b32 s93, s4, 2
    s_sub_u32 s93, s66, s93
    s_cmp_eq_u32 s3, 3
    s_cselect_b32 s66, s93, s66
    s_and_b32 s93, s4, s3
    s_add_u32 s94, s7, 60
    s_cmp_eq_u32 s93, 3
    s_cselect_b32 s66, s94, s66
    s_sub_u32 s94, s66, 24
    s_mul_i32 s93, s94, 5462
    s_lshr_b32 s93, s93, 16
    s_mul_i32 s93, s93, 36
    s_add_u32 s94, s94, s93
    s_add_u32 s93, s66, 144
    s_cmp_lt_u32 s66, 24
    s_cselect_b32 s93, s93, s94
    s_cselect_b32 s94, s66, s94
    s_cselect_b32 s95, 0, 458752
    s_mov_b32 s89, 12288
    s_cselect_b32 s89, 114688, s89
    s_mov_b32 s47, 151552
    s_cselect_b32 s47, 28672, s47
    s_lshl_b32 s94, s94, 10
    s_add_u32 s46, s94, s95
    s_mov_b32 s88, 0
    s_lshl_b32 s90, s89, 1
    s_add_u32 s91, s90, s89
    s_mul_i32 s94, s93, 5462
    s_lshr_b32 s94, s94, 16
    s_mul_i32 s95, s94, 12
    s_sub_u32 s95, s93, s95
    s_mul_i32 s95, s95, 28672
    s_lshl_b32 s94, s94, 6
    s_add_u32 s62, s94, s95
    s_mul_i32 s95, s4, 229376
    s_add_u32 s24, s24, s95
    s_addc_u32 s25, s25, 0
    s_sub_u32 s24, s24, 4096
    s_subb_u32 s25, s25, 0
    s_mov_b32 s26, 233472
    s_mov_b32 s27, 0x20000
    s_mov_b32 s43, 0x3db8aa3b
    s_lshl_b32 s93, s7, 2
    s_add_u32 s93, s93, s3
    s_mul_i32 s93, s93, 7168
    s_add_u32 s44, s93, 4096
    s_lshl_b32 s93, s52, 2
    s_add_u32 s93, s93, s3
    s_mul_i32 s93, s93, 9216
    s_add_u32 s45, s93, s56
    s_mov_b32 s35, 524288
    s_mov_b32 s36, 128
    buffer_load_dword v231, v232, s[12:15], s35 offen
    buffer_load_dword v231, v233, s[8:11], s36 offen
    s_branch L_page0
.p2align 12
L_page0:
    s_waitcnt vmcnt(9) lgkmcnt(0)
    s_barrier
    ds_read_b128 a[0:3], v240 offset:32768
    ds_read_b128 a[4:7], v240 offset:33792
    ds_read_b128 a[8:11], v240 offset:34816
    ds_read_b64_tr_b16 a[192:193], v236 offset:32768
    ds_read_b64_tr_b16 a[194:195], v236 offset:33792
    s_waitcnt lgkmcnt(0)
    v_mfma_f32_16x16x32_bf16 v[0:3], a[192:195], a[0:3], 0
    ds_read_b64_tr_b16 a[196:197], v236 offset:32776
    ds_read_b64_tr_b16 a[198:199], v236 offset:33800
    s_waitcnt lgkmcnt(0)
    v_mfma_f32_16x16x32_bf16 v[4:7], a[196:199], a[0:3], 0
    ds_read_b64_tr_b16 a[200:201], v237 offset:32768
    ds_read_b64_tr_b16 a[202:203], v237 offset:33792
    v_mfma_f32_16x16x32_bf16 v[12:15], a[196:199], a[4:7], 0
    ds_read_b64_tr_b16 a[204:205], v237 offset:32776
    ds_read_b64_tr_b16 a[206:207], v237 offset:33800
    v_mfma_f32_16x16x32_bf16 v[8:11], a[192:195], a[4:7], 0
    ds_read_b64_tr_b16 a[208:209], v238 offset:32768
    ds_read_b64_tr_b16 a[210:211], v238 offset:33792
    v_mfma_f32_16x16x32_bf16 v[16:19], a[192:195], a[8:11], 0
    ds_read_b64_tr_b16 a[212:213], v238 offset:32776
    v_mfma_f32_16x16x32_bf16 v[20:23], a[196:199], a[8:11], 0
    s_waitcnt lgkmcnt(5)
    ds_read_b64_tr_b16 a[214:215], v238 offset:33800
    v_mfma_f32_16x16x32_bf16 v[40:43], a[200:203], a[8:11], 0
    s_waitcnt lgkmcnt(4)
    ds_read_b64_tr_b16 a[216:217], v239 offset:32768
    v_mfma_f32_16x16x32_bf16 v[44:47], a[204:207], a[8:11], 0
    ds_read_b64_tr_b16 a[218:219], v239 offset:33792
    v_mfma_f32_16x16x32_bf16 v[36:39], a[204:207], a[4:7], 0
    ds_read_b64_tr_b16 a[220:221], v239 offset:32776
    v_mfma_f32_16x16x32_bf16 v[32:35], a[200:203], a[4:7], 0
    ds_read_b64_tr_b16 a[222:223], v239 offset:33800
    v_mfma_f32_16x16x32_bf16 v[24:27], a[200:203], a[0:3], 0
    ds_read_b64_tr_b16 a[224:225], v236 offset:33024
    v_mfma_f32_16x16x32_bf16 v[28:31], a[204:207], a[0:3], 0
    s_waitcnt lgkmcnt(7)
    ds_read_b64_tr_b16 a[226:227], v236 offset:34048
    v_mfma_f32_16x16x32_bf16 v[48:51], a[208:211], a[0:3], 0
    s_waitcnt lgkmcnt(6)
    ds_read_b64_tr_b16 a[228:229], v236 offset:33032
    v_mfma_f32_16x16x32_bf16 v[52:55], a[212:215], a[0:3], 0
    ds_read_b64_tr_b16 a[230:231], v236 offset:34056
    v_mfma_f32_16x16x32_bf16 v[60:63], a[212:215], a[4:7], 0
    ds_read_b64_tr_b16 a[232:233], v237 offset:33024
    v_mfma_f32_16x16x32_bf16 v[56:59], a[208:211], a[4:7], 0
    ds_read_b64_tr_b16 a[234:235], v237 offset:34048
    v_mfma_f32_16x16x32_bf16 v[64:67], a[208:211], a[8:11], 0
    ds_read_b64_tr_b16 a[236:237], v237 offset:33032
    v_mfma_f32_16x16x32_bf16 v[68:71], a[212:215], a[8:11], 0
    s_waitcnt lgkmcnt(9)
    v_mfma_f32_16x16x32_bf16 v[88:91], a[216:219], a[8:11], 0
    s_waitcnt lgkmcnt(7)
    ds_read_b64_tr_b16 a[238:239], v237 offset:34056
    v_mfma_f32_16x16x32_bf16 v[92:95], a[220:223], a[8:11], 0
    ds_read_b64_tr_b16 a[240:241], v238 offset:33024
    v_mfma_f32_16x16x32_bf16 v[84:87], a[220:223], a[4:7], 0
    ds_read_b64_tr_b16 a[242:243], v238 offset:34048
    v_mfma_f32_16x16x32_bf16 v[80:83], a[216:219], a[4:7], 0
    v_mfma_f32_16x16x32_bf16 v[72:75], a[216:219], a[0:3], 0
    ds_read_b64_tr_b16 a[244:245], v238 offset:33032
    v_mfma_f32_16x16x32_bf16 v[76:79], a[220:223], a[0:3], 0
    s_waitcnt lgkmcnt(7)
    ds_read_b64_tr_b16 a[246:247], v238 offset:34056
    v_mfma_f32_16x16x32_bf16 v[96:99], a[224:227], a[0:3], 0
    ds_read_b64_tr_b16 a[248:249], v239 offset:33024
    v_mfma_f32_16x16x32_bf16 v[100:103], a[228:231], a[0:3], 0
    v_mfma_f32_16x16x32_bf16 v[108:111], a[228:231], a[4:7], 0
    ds_read_b64_tr_b16 a[250:251], v239 offset:34048
    v_mfma_f32_16x16x32_bf16 v[104:107], a[224:227], a[4:7], 0
    ds_read_b64_tr_b16 a[252:253], v239 offset:33032
    v_mfma_f32_16x16x32_bf16 v[112:115], a[224:227], a[8:11], 0
    ds_read_b64_tr_b16 a[254:255], v239 offset:34056
    v_mfma_f32_16x16x32_bf16 v[116:119], a[228:231], a[8:11], 0
    s_waitcnt lgkmcnt(7)
    v_mfma_f32_16x16x32_bf16 v[136:139], a[232:235], a[8:11], 0
    v_mfma_f32_16x16x32_bf16 v[140:143], a[236:239], a[8:11], 0
    v_mfma_f32_16x16x32_bf16 v[132:135], a[236:239], a[4:7], 0
    v_mfma_f32_16x16x32_bf16 v[128:131], a[232:235], a[4:7], 0
    v_mfma_f32_16x16x32_bf16 v[120:123], a[232:235], a[0:3], 0
    v_mfma_f32_16x16x32_bf16 v[124:127], a[236:239], a[0:3], 0
    s_waitcnt lgkmcnt(3)
    s_waitcnt vmcnt(5) lgkmcnt(0)
    s_barrier
    ds_read_b128 a[12:15], v245 offset:0
    v_mfma_f32_16x16x32_bf16 v[144:147], a[240:243], a[0:3], 0
    ds_read_b128 a[16:19], v245 offset:1024
    v_mfma_f32_16x16x32_bf16 v[148:151], a[244:247], a[0:3], 0
    ds_read_b128 a[20:23], v245 offset:2048
    v_mfma_f32_16x16x32_bf16 v[156:159], a[244:247], a[4:7], 0
    ds_read_b64_tr_b16 a[192:193], v241 offset:0
    v_mfma_f32_16x16x32_bf16 v[152:155], a[240:243], a[4:7], 0
    ds_read_b64_tr_b16 a[194:195], v241 offset:1024
    v_mfma_f32_16x16x32_bf16 v[160:163], a[240:243], a[8:11], 0
    ds_read_b64_tr_b16 a[196:197], v241 offset:8
    v_mfma_f32_16x16x32_bf16 v[164:167], a[244:247], a[8:11], 0
    ds_read_b64_tr_b16 a[198:199], v241 offset:1032
    v_mfma_f32_16x16x32_bf16 v[184:187], a[248:251], a[8:11], 0
    ds_read_b64_tr_b16 a[200:201], v242 offset:0
    v_mfma_f32_16x16x32_bf16 v[188:191], a[252:255], a[8:11], 0
    ds_read_b64_tr_b16 a[202:203], v242 offset:1024
    v_mfma_f32_16x16x32_bf16 v[180:183], a[252:255], a[4:7], 0
    ds_read_b64_tr_b16 a[204:205], v242 offset:8
    v_mfma_f32_16x16x32_bf16 v[176:179], a[248:251], a[4:7], 0
    ds_read_b64_tr_b16 a[206:207], v242 offset:1032
    v_mfma_f32_16x16x32_bf16 v[168:171], a[248:251], a[0:3], 0
    ds_read_b64_tr_b16 a[208:209], v243 offset:0
    v_mfma_f32_16x16x32_bf16 v[172:175], a[252:255], a[0:3], 0
    s_waitcnt lgkmcnt(7)
    ds_read_b64_tr_b16 a[210:211], v243 offset:1024
    v_mfma_f32_16x16x32_bf16 v[0:3], a[192:195], a[12:15], v[0:3]
    s_waitcnt lgkmcnt(6)
    v_mfma_f32_16x16x32_bf16 v[4:7], a[196:199], a[12:15], v[4:7]
    ds_read_b64_tr_b16 a[212:213], v243 offset:8
    v_mfma_f32_16x16x32_bf16 v[12:15], a[196:199], a[16:19], v[12:15]
    ds_read_b64_tr_b16 a[214:215], v243 offset:1032
    v_mfma_f32_16x16x32_bf16 v[8:11], a[192:195], a[16:19], v[8:11]
    ds_read_b64_tr_b16 a[216:217], v244 offset:0
    v_mfma_f32_16x16x32_bf16 v[16:19], a[192:195], a[20:23], v[16:19]
    v_mfma_f32_16x16x32_bf16 v[20:23], a[196:199], a[20:23], v[20:23]
    s_waitcnt lgkmcnt(7)
    ds_read_b64_tr_b16 a[218:219], v244 offset:1024
    v_mfma_f32_16x16x32_bf16 v[40:43], a[200:203], a[20:23], v[40:43]
    s_waitcnt lgkmcnt(6)
    ds_read_b64_tr_b16 a[220:221], v244 offset:8
    v_mfma_f32_16x16x32_bf16 v[44:47], a[204:207], a[20:23], v[44:47]
    ds_read_b64_tr_b16 a[222:223], v244 offset:1032
    v_mfma_f32_16x16x32_bf16 v[36:39], a[204:207], a[16:19], v[36:39]
    ds_read_b64_tr_b16 a[224:225], v241 offset:256
    v_mfma_f32_16x16x32_bf16 v[32:35], a[200:203], a[16:19], v[32:35]
    v_mfma_f32_16x16x32_bf16 v[24:27], a[200:203], a[12:15], v[24:27]
    ds_read_b64_tr_b16 a[226:227], v241 offset:1280
    v_mfma_f32_16x16x32_bf16 v[28:31], a[204:207], a[12:15], v[28:31]
    s_waitcnt lgkmcnt(7)
    ds_read_b64_tr_b16 a[228:229], v241 offset:264
    v_mfma_f32_16x16x32_bf16 v[48:51], a[208:211], a[12:15], v[48:51]
    s_waitcnt lgkmcnt(7)
    ds_read_b64_tr_b16 a[230:231], v241 offset:1288
    v_mfma_f32_16x16x32_bf16 v[52:55], a[212:215], a[12:15], v[52:55]
    v_mfma_f32_16x16x32_bf16 v[60:63], a[212:215], a[16:19], v[60:63]
    ds_read_b64_tr_b16 a[232:233], v242 offset:256
    v_mfma_f32_16x16x32_bf16 v[56:59], a[208:211], a[16:19], v[56:59]
    ds_read_b64_tr_b16 a[234:235], v242 offset:1280
    v_mfma_f32_16x16x32_bf16 v[64:67], a[208:211], a[20:23], v[64:67]
    ds_read_b64_tr_b16 a[236:237], v242 offset:264
    v_mfma_f32_16x16x32_bf16 v[68:71], a[212:215], a[20:23], v[68:71]
    s_waitcnt lgkmcnt(7)
    v_mfma_f32_16x16x32_bf16 v[88:91], a[216:219], a[20:23], v[88:91]
    s_mov_b32 s5, 128
    ds_read_b64_tr_b16 a[238:239], v242 offset:1288
    v_mfma_f32_16x16x32_bf16 v[92:95], a[220:223], a[20:23], v[92:95]
    s_mov_b32 s29, 192
    ds_read_b64_tr_b16 a[240:241], v243 offset:256
    v_mfma_f32_16x16x32_bf16 v[84:87], a[220:223], a[16:19], v[84:87]
    s_add_u32 m0, s32, 98304
    ds_read_b64_tr_b16 a[242:243], v243 offset:1280
    v_mfma_f32_16x16x32_bf16 v[80:83], a[216:219], a[16:19], v[80:83]
    buffer_load_dwordx4 v228, s[8:11], s5 offen offset:0 lds
    s_add_u32 m0, s32, 131072
    v_mfma_f32_16x16x32_bf16 v[72:75], a[216:219], a[12:15], v[72:75]
    ds_read_b64_tr_b16 a[244:245], v243 offset:264
    v_mfma_f32_16x16x32_bf16 v[76:79], a[220:223], a[12:15], v[76:79]
    s_waitcnt lgkmcnt(7)
    ds_read_b64_tr_b16 a[246:247], v243 offset:1288
    buffer_load_dwordx4 v228, s[8:11], s29 offen offset:0 lds
    v_mfma_f32_16x16x32_bf16 v[96:99], a[224:227], a[12:15], v[96:99]
    s_add_u32 m0, s32, 98304
    ds_read_b64_tr_b16 a[248:249], v244 offset:256
    buffer_load_dwordx4 v229, s[8:11], s5 offen offset:1024 lds
    v_mfma_f32_16x16x32_bf16 v[100:103], a[228:231], a[12:15], v[100:103]
    s_add_u32 m0, s32, 131072
    s_nop 0
    buffer_load_dwordx4 v229, s[8:11], s29 offen offset:1024 lds
    s_add_u32 m0, s32, 98304
    v_mfma_f32_16x16x32_bf16 v[108:111], a[228:231], a[16:19], v[108:111]
    ds_read_b64_tr_b16 a[250:251], v244 offset:1280
    buffer_load_dwordx4 v230, s[8:11], s5 offen offset:2048 lds
    v_mfma_f32_16x16x32_bf16 v[104:107], a[224:227], a[16:19], v[104:107]
    s_add_u32 m0, s32, 131072
    ds_read_b64_tr_b16 a[252:253], v244 offset:264
    buffer_load_dwordx4 v230, s[8:11], s29 offen offset:2048 lds
    v_mfma_f32_16x16x32_bf16 v[112:115], a[224:227], a[20:23], v[112:115]
    s_add_u32 m0, s37, 114624
    ds_read_b64_tr_b16 a[254:255], v244 offset:1288
    s_mov_b32 s35, 524288
    v_mfma_f32_16x16x32_bf16 v[116:119], a[228:231], a[20:23], v[116:119]
    s_waitcnt lgkmcnt(7)
    s_mov_b32 s36, 556032
    v_mfma_f32_16x16x32_bf16 v[136:139], a[232:235], a[20:23], v[136:139]
    buffer_load_dwordx4 v208, s[12:15], s35 offen offset:0 lds
    buffer_load_dwordx4 v209, s[12:15], s35 offen offset:2048 lds
    v_mfma_f32_16x16x32_bf16 v[140:143], a[236:239], a[20:23], v[140:143]
    buffer_load_dwordx4 v208, s[12:15], s36 offen offset:1024 lds
    buffer_load_dwordx4 v209, s[12:15], s36 offen offset:3072 lds
    v_mfma_f32_16x16x32_bf16 v[132:135], a[236:239], a[16:19], v[132:135]
    s_add_u32 m0, s37, 147392
    s_mov_b32 s35, 786432
    s_mov_b32 s36, 818176
    v_mfma_f32_16x16x32_bf16 v[128:131], a[232:235], a[16:19], v[128:131]
    buffer_load_dwordx4 v208, s[12:15], s35 offen offset:0 lds
    v_mfma_f32_16x16x32_bf16 v[120:123], a[232:235], a[12:15], v[120:123]
    buffer_load_dwordx4 v209, s[12:15], s35 offen offset:2048 lds
    v_mfma_f32_16x16x32_bf16 v[124:127], a[236:239], a[12:15], v[124:127]
    s_waitcnt lgkmcnt(3)
    buffer_load_dwordx4 v208, s[12:15], s36 offen offset:1024 lds
    buffer_load_dwordx4 v209, s[12:15], s36 offen offset:3072 lds
    v_mfma_f32_16x16x32_bf16 v[144:147], a[240:243], a[12:15], v[144:147]
    s_waitcnt vmcnt(4) lgkmcnt(0)
    s_barrier
    ds_read_b128 a[24:27], v245 offset:32768
    v_mfma_f32_16x16x32_bf16 v[148:151], a[244:247], a[12:15], v[148:151]
    s_mov_b32 s5, 256
    ds_read_b128 a[28:31], v245 offset:33792
    v_mfma_f32_16x16x32_bf16 v[156:159], a[244:247], a[16:19], v[156:159]
    s_mov_b32 s29, 320
    ds_read_b128 a[32:35], v245 offset:34816
    v_mfma_f32_16x16x32_bf16 v[152:155], a[240:243], a[16:19], v[152:155]
    s_add_u32 m0, s32, 0
    ds_read_b64_tr_b16 a[192:193], v241 offset:32768
    v_mfma_f32_16x16x32_bf16 v[160:163], a[240:243], a[20:23], v[160:163]
    ds_read_b64_tr_b16 a[194:195], v241 offset:33792
    v_mfma_f32_16x16x32_bf16 v[164:167], a[244:247], a[20:23], v[164:167]
    ds_read_b64_tr_b16 a[196:197], v241 offset:32776
    v_mfma_f32_16x16x32_bf16 v[184:187], a[248:251], a[20:23], v[184:187]
    ds_read_b64_tr_b16 a[198:199], v241 offset:33800
    v_mfma_f32_16x16x32_bf16 v[188:191], a[252:255], a[20:23], v[188:191]
    ds_read_b64_tr_b16 a[200:201], v242 offset:32768
    v_mfma_f32_16x16x32_bf16 v[180:183], a[252:255], a[16:19], v[180:183]
    ds_read_b64_tr_b16 a[202:203], v242 offset:33792
    buffer_load_dwordx4 v228, s[8:11], s5 offen offset:0 lds
    v_mfma_f32_16x16x32_bf16 v[176:179], a[248:251], a[16:19], v[176:179]
    s_add_u32 m0, s32, 32768
    ds_read_b64_tr_b16 a[204:205], v242 offset:32776
    v_mfma_f32_16x16x32_bf16 v[168:171], a[248:251], a[12:15], v[168:171]
    ds_read_b64_tr_b16 a[206:207], v242 offset:33800
    buffer_load_dwordx4 v228, s[8:11], s29 offen offset:0 lds
    v_mfma_f32_16x16x32_bf16 v[172:175], a[252:255], a[12:15], v[172:175]
    s_waitcnt lgkmcnt(6)
    ds_read_b64_tr_b16 a[208:209], v243 offset:32768
    s_add_u32 m0, s32, 0
    v_mfma_f32_16x16x32_bf16 v[0:3], a[192:195], a[24:27], v[0:3]
    s_waitcnt lgkmcnt(5)
    ds_read_b64_tr_b16 a[210:211], v243 offset:33792
    v_mfma_f32_16x16x32_bf16 v[4:7], a[196:199], a[24:27], v[4:7]
    ds_read_b64_tr_b16 a[212:213], v243 offset:32776
    buffer_load_dwordx4 v229, s[8:11], s5 offen offset:1024 lds
    v_mfma_f32_16x16x32_bf16 v[12:15], a[196:199], a[28:31], v[12:15]
    s_add_u32 m0, s32, 32768
    ds_read_b64_tr_b16 a[214:215], v243 offset:33800
    v_mfma_f32_16x16x32_bf16 v[8:11], a[192:195], a[28:31], v[8:11]
    ds_read_b64_tr_b16 a[216:217], v244 offset:32768
    v_mfma_f32_16x16x32_bf16 v[16:19], a[192:195], a[32:35], v[16:19]
    buffer_load_dwordx4 v229, s[8:11], s29 offen offset:1024 lds
    s_add_u32 m0, s32, 0
    v_mfma_f32_16x16x32_bf16 v[20:23], a[196:199], a[32:35], v[20:23]
    s_waitcnt lgkmcnt(7)
    ds_read_b64_tr_b16 a[218:219], v244 offset:33792
    v_mfma_f32_16x16x32_bf16 v[40:43], a[200:203], a[32:35], v[40:43]
    s_waitcnt lgkmcnt(6)
    ds_read_b64_tr_b16 a[220:221], v244 offset:32776
    v_mfma_f32_16x16x32_bf16 v[44:47], a[204:207], a[32:35], v[44:47]
    ds_read_b64_tr_b16 a[222:223], v244 offset:33800
    buffer_load_dwordx4 v230, s[8:11], s5 offen offset:2048 lds
    v_mfma_f32_16x16x32_bf16 v[36:39], a[204:207], a[28:31], v[36:39]
    s_add_u32 m0, s32, 32768
    ds_read_b64_tr_b16 a[224:225], v241 offset:33024
    v_mfma_f32_16x16x32_bf16 v[32:35], a[200:203], a[28:31], v[32:35]
    buffer_load_dwordx4 v230, s[8:11], s29 offen offset:2048 lds
    v_mfma_f32_16x16x32_bf16 v[24:27], a[200:203], a[24:27], v[24:27]
    s_add_u32 m0, s37, 16320
    ds_read_b64_tr_b16 a[226:227], v241 offset:34048
    v_mfma_f32_16x16x32_bf16 v[28:31], a[204:207], a[24:27], v[28:31]
    s_waitcnt lgkmcnt(7)
    ds_read_b64_tr_b16 a[228:229], v241 offset:33032
    s_mov_b32 s35, 1048576
    v_mfma_f32_16x16x32_bf16 v[48:51], a[208:211], a[24:27], v[48:51]
    s_waitcnt lgkmcnt(7)
    ds_read_b64_tr_b16 a[230:231], v241 offset:34056
    v_mfma_f32_16x16x32_bf16 v[52:55], a[212:215], a[24:27], v[52:55]
    s_mov_b32 s36, 1080320
    buffer_load_dwordx4 v208, s[12:15], s35 offen offset:0 lds
    v_mfma_f32_16x16x32_bf16 v[60:63], a[212:215], a[28:31], v[60:63]
    ds_read_b64_tr_b16 a[232:233], v242 offset:33024
    v_mfma_f32_16x16x32_bf16 v[56:59], a[208:211], a[28:31], v[56:59]
    ds_read_b64_tr_b16 a[234:235], v242 offset:34048
    v_mfma_f32_16x16x32_bf16 v[64:67], a[208:211], a[32:35], v[64:67]
    ds_read_b64_tr_b16 a[236:237], v242 offset:33032
    buffer_load_dwordx4 v209, s[12:15], s35 offen offset:2048 lds
    v_mfma_f32_16x16x32_bf16 v[68:71], a[212:215], a[32:35], v[68:71]
    s_waitcnt lgkmcnt(7)
    buffer_load_dwordx4 v208, s[12:15], s36 offen offset:1024 lds
    v_mfma_f32_16x16x32_bf16 v[88:91], a[216:219], a[32:35], v[88:91]
    ds_read_b64_tr_b16 a[238:239], v242 offset:34056
    v_mfma_f32_16x16x32_bf16 v[92:95], a[220:223], a[32:35], v[92:95]
    ds_read_b64_tr_b16 a[240:241], v243 offset:33024
    buffer_load_dwordx4 v209, s[12:15], s36 offen offset:3072 lds
    v_mfma_f32_16x16x32_bf16 v[84:87], a[220:223], a[28:31], v[84:87]
    s_add_u32 m0, s37, 49088
    ds_read_b64_tr_b16 a[242:243], v243 offset:34048
    v_mfma_f32_16x16x32_bf16 v[80:83], a[216:219], a[28:31], v[80:83]
    s_mov_b32 s35, 1310720
    v_mfma_f32_16x16x32_bf16 v[72:75], a[216:219], a[24:27], v[72:75]
    s_mov_b32 s36, 1342464
    ds_read_b64_tr_b16 a[244:245], v243 offset:33032
    v_mfma_f32_16x16x32_bf16 v[76:79], a[220:223], a[24:27], v[76:79]
    s_waitcnt lgkmcnt(7)
    ds_read_b64_tr_b16 a[246:247], v243 offset:34056
    v_mfma_f32_16x16x32_bf16 v[96:99], a[224:227], a[24:27], v[96:99]
    ds_read_b64_tr_b16 a[248:249], v244 offset:33024
    v_mfma_f32_16x16x32_bf16 v[100:103], a[228:231], a[24:27], v[100:103]
    buffer_load_dwordx4 v208, s[12:15], s35 offen offset:0 lds
    v_mfma_f32_16x16x32_bf16 v[108:111], a[228:231], a[28:31], v[108:111]
    ds_read_b64_tr_b16 a[250:251], v244 offset:34048
    buffer_load_dwordx4 v209, s[12:15], s35 offen offset:2048 lds
    v_mfma_f32_16x16x32_bf16 v[104:107], a[224:227], a[28:31], v[104:107]
    ds_read_b64_tr_b16 a[252:253], v244 offset:33032
    buffer_load_dwordx4 v208, s[12:15], s36 offen offset:1024 lds
    v_mfma_f32_16x16x32_bf16 v[112:115], a[224:227], a[32:35], v[112:115]
    ds_read_b64_tr_b16 a[254:255], v244 offset:34056
    v_mfma_f32_16x16x32_bf16 v[116:119], a[228:231], a[32:35], v[116:119]
    s_waitcnt lgkmcnt(7)
    buffer_load_dwordx4 v209, s[12:15], s36 offen offset:3072 lds
    s_mov_b32 s35, 1572864
    v_mfma_f32_16x16x32_bf16 v[136:139], a[232:235], a[32:35], v[136:139]
    s_mov_b32 s36, 384
    buffer_load_dword v231, v232, s[12:15], s35 offen
    v_mfma_f32_16x16x32_bf16 v[140:143], a[236:239], a[32:35], v[140:143]
    buffer_load_dword v231, v233, s[8:11], s36 offen
    v_mfma_f32_16x16x32_bf16 v[132:135], a[236:239], a[28:31], v[132:135]
    v_mfma_f32_16x16x32_bf16 v[128:131], a[232:235], a[28:31], v[128:131]
    v_mfma_f32_16x16x32_bf16 v[120:123], a[232:235], a[24:27], v[120:123]
    v_mfma_f32_16x16x32_bf16 v[124:127], a[236:239], a[24:27], v[124:127]
    s_waitcnt lgkmcnt(3)
    s_mov_b64 exec, 0
    s_cmp_eq_u32 s3, 0
    s_cbranch_scc1 L_hop0_0
    s_cmp_eq_u32 s3, 1
    s_cbranch_scc1 L_hop0_1
    s_cmp_eq_u32 s3, 2
    s_cbranch_scc1 L_hop0_2
    s_branch L_hop0_3
L_hopped0:
    s_mov_b64 exec, -1
    s_waitcnt vmcnt(16) lgkmcnt(0)
    s_barrier
    ds_read_b128 a[36:39], v250 offset:0
    v_mfma_f32_16x16x32_bf16 v[144:147], a[240:243], a[24:27], v[144:147]
    ds_read_b128 a[40:43], v250 offset:1024
    v_mfma_f32_16x16x32_bf16 v[148:151], a[244:247], a[24:27], v[148:151]
    ds_read_b128 a[44:47], v250 offset:2048
    v_mfma_f32_16x16x32_bf16 v[156:159], a[244:247], a[28:31], v[156:159]
    ds_read_b64_tr_b16 a[192:193], v246 offset:0
    v_mfma_f32_16x16x32_bf16 v[152:155], a[240:243], a[28:31], v[152:155]
    ds_read_b64_tr_b16 a[194:195], v246 offset:1024
    v_mfma_f32_16x16x32_bf16 v[160:163], a[240:243], a[32:35], v[160:163]
    ds_read_b64_tr_b16 a[196:197], v246 offset:8
    v_mfma_f32_16x16x32_bf16 v[164:167], a[244:247], a[32:35], v[164:167]
    ds_read_b64_tr_b16 a[198:199], v246 offset:1032
    v_mfma_f32_16x16x32_bf16 v[184:187], a[248:251], a[32:35], v[184:187]
    ds_read_b64_tr_b16 a[200:201], v247 offset:0
    v_mfma_f32_16x16x32_bf16 v[188:191], a[252:255], a[32:35], v[188:191]
    ds_read_b64_tr_b16 a[202:203], v247 offset:1024
    v_mfma_f32_16x16x32_bf16 v[180:183], a[252:255], a[28:31], v[180:183]
    ds_read_b64_tr_b16 a[204:205], v247 offset:8
    v_mfma_f32_16x16x32_bf16 v[176:179], a[248:251], a[28:31], v[176:179]
    ds_read_b64_tr_b16 a[206:207], v247 offset:1032
    v_mfma_f32_16x16x32_bf16 v[168:171], a[248:251], a[24:27], v[168:171]
    ds_read_b64_tr_b16 a[208:209], v248 offset:0
    v_mfma_f32_16x16x32_bf16 v[172:175], a[252:255], a[24:27], v[172:175]
    s_waitcnt lgkmcnt(7)
    ds_read_b64_tr_b16 a[210:211], v248 offset:1024
    v_mfma_f32_16x16x32_bf16 v[0:3], a[192:195], a[36:39], v[0:3]
    s_waitcnt lgkmcnt(6)
    v_mfma_f32_16x16x32_bf16 v[4:7], a[196:199], a[36:39], v[4:7]
    ds_read_b64_tr_b16 a[212:213], v248 offset:8
    v_mfma_f32_16x16x32_bf16 v[12:15], a[196:199], a[40:43], v[12:15]
    ds_read_b64_tr_b16 a[214:215], v248 offset:1032
    v_mfma_f32_16x16x32_bf16 v[8:11], a[192:195], a[40:43], v[8:11]
    ds_read_b64_tr_b16 a[216:217], v249 offset:0
    v_mfma_f32_16x16x32_bf16 v[16:19], a[192:195], a[44:47], v[16:19]
    v_mfma_f32_16x16x32_bf16 v[20:23], a[196:199], a[44:47], v[20:23]
    s_waitcnt lgkmcnt(7)
    ds_read_b64_tr_b16 a[218:219], v249 offset:1024
    v_mfma_f32_16x16x32_bf16 v[40:43], a[200:203], a[44:47], v[40:43]
    s_waitcnt lgkmcnt(6)
    ds_read_b64_tr_b16 a[220:221], v249 offset:8
    v_mfma_f32_16x16x32_bf16 v[44:47], a[204:207], a[44:47], v[44:47]
    ds_read_b64_tr_b16 a[222:223], v249 offset:1032
    v_mfma_f32_16x16x32_bf16 v[36:39], a[204:207], a[40:43], v[36:39]
    ds_read_b64_tr_b16 a[224:225], v246 offset:256
    v_mfma_f32_16x16x32_bf16 v[32:35], a[200:203], a[40:43], v[32:35]
    v_mfma_f32_16x16x32_bf16 v[24:27], a[200:203], a[36:39], v[24:27]
    ds_read_b64_tr_b16 a[226:227], v246 offset:1280
    v_mfma_f32_16x16x32_bf16 v[28:31], a[204:207], a[36:39], v[28:31]
    s_waitcnt lgkmcnt(7)
    ds_read_b64_tr_b16 a[228:229], v246 offset:264
    v_mfma_f32_16x16x32_bf16 v[48:51], a[208:211], a[36:39], v[48:51]
    s_waitcnt lgkmcnt(7)
    ds_read_b64_tr_b16 a[230:231], v246 offset:1288
    v_mfma_f32_16x16x32_bf16 v[52:55], a[212:215], a[36:39], v[52:55]
    v_mfma_f32_16x16x32_bf16 v[60:63], a[212:215], a[40:43], v[60:63]
    ds_read_b64_tr_b16 a[232:233], v247 offset:256
    v_mfma_f32_16x16x32_bf16 v[56:59], a[208:211], a[40:43], v[56:59]
    ds_read_b64_tr_b16 a[234:235], v247 offset:1280
    v_mfma_f32_16x16x32_bf16 v[64:67], a[208:211], a[44:47], v[64:67]
    ds_read_b64_tr_b16 a[236:237], v247 offset:264
    v_mfma_f32_16x16x32_bf16 v[68:71], a[212:215], a[44:47], v[68:71]
    s_waitcnt lgkmcnt(7)
    v_mfma_f32_16x16x32_bf16 v[88:91], a[216:219], a[44:47], v[88:91]
    ds_read_b64_tr_b16 a[238:239], v247 offset:1288
    v_mfma_f32_16x16x32_bf16 v[92:95], a[220:223], a[44:47], v[92:95]
    ds_read_b64_tr_b16 a[240:241], v248 offset:256
    v_mfma_f32_16x16x32_bf16 v[84:87], a[220:223], a[40:43], v[84:87]
    ds_read_b64_tr_b16 a[242:243], v248 offset:1280
    v_mfma_f32_16x16x32_bf16 v[80:83], a[216:219], a[40:43], v[80:83]
    v_mfma_f32_16x16x32_bf16 v[72:75], a[216:219], a[36:39], v[72:75]
    ds_read_b64_tr_b16 a[244:245], v248 offset:264
    v_mfma_f32_16x16x32_bf16 v[76:79], a[220:223], a[36:39], v[76:79]
    s_waitcnt lgkmcnt(7)
    ds_read_b64_tr_b16 a[246:247], v248 offset:1288
    v_mfma_f32_16x16x32_bf16 v[96:99], a[224:227], a[36:39], v[96:99]
    ds_read_b64_tr_b16 a[248:249], v249 offset:256
    v_mfma_f32_16x16x32_bf16 v[100:103], a[228:231], a[36:39], v[100:103]
    v_mfma_f32_16x16x32_bf16 v[108:111], a[228:231], a[40:43], v[108:111]
    ds_read_b64_tr_b16 a[250:251], v249 offset:1280
    v_mfma_f32_16x16x32_bf16 v[104:107], a[224:227], a[40:43], v[104:107]
    ds_read_b64_tr_b16 a[252:253], v249 offset:264
    v_mfma_f32_16x16x32_bf16 v[112:115], a[224:227], a[44:47], v[112:115]
    ds_read_b64_tr_b16 a[254:255], v249 offset:1288
    v_mfma_f32_16x16x32_bf16 v[116:119], a[228:231], a[44:47], v[116:119]
    s_waitcnt lgkmcnt(7)
    v_mfma_f32_16x16x32_bf16 v[136:139], a[232:235], a[44:47], v[136:139]
    v_mfma_f32_16x16x32_bf16 v[140:143], a[236:239], a[44:47], v[140:143]
    v_mfma_f32_16x16x32_bf16 v[132:135], a[236:239], a[40:43], v[132:135]
    v_mfma_f32_16x16x32_bf16 v[128:131], a[232:235], a[40:43], v[128:131]
    v_mfma_f32_16x16x32_bf16 v[120:123], a[232:235], a[36:39], v[120:123]
    v_mfma_f32_16x16x32_bf16 v[124:127], a[236:239], a[36:39], v[124:127]
    s_waitcnt lgkmcnt(3)
    s_waitcnt vmcnt(2) lgkmcnt(0)
    s_barrier
    ds_read_b128 a[0:3], v240 offset:0
    v_mfma_f32_16x16x32_bf16 v[144:147], a[240:243], a[36:39], v[144:147]
    s_mov_b32 s5, 384
    ds_read_b128 a[4:7], v240 offset:1024
    v_mfma_f32_16x16x32_bf16 v[148:151], a[244:247], a[36:39], v[148:151]
    ds_read_b128 a[8:11], v240 offset:2048
    v_mfma_f32_16x16x32_bf16 v[156:159], a[244:247], a[40:43], v[156:159]
    ds_read_b64_tr_b16 a[192:193], v236 offset:0
    v_mfma_f32_16x16x32_bf16 v[152:155], a[240:243], a[40:43], v[152:155]
    s_mov_b32 s29, 448
    ds_read_b64_tr_b16 a[194:195], v236 offset:1024
    v_mfma_f32_16x16x32_bf16 v[160:163], a[240:243], a[44:47], v[160:163]
    ds_read_b128 a[12:15], v240 offset:32768
    v_mfma_f32_16x16x32_bf16 v[164:167], a[244:247], a[44:47], v[164:167]
    ds_read_b128 a[16:19], v240 offset:33792
    v_mfma_f32_16x16x32_bf16 v[184:187], a[248:251], a[44:47], v[184:187]
    s_add_u32 m0, s32, 65536
    ds_read_b128 a[20:23], v240 offset:34816
    v_mfma_f32_16x16x32_bf16 v[188:191], a[252:255], a[44:47], v[188:191]
    ds_read_b64_tr_b16 a[196:197], v236 offset:32768
    v_mfma_f32_16x16x32_bf16 v[180:183], a[252:255], a[40:43], v[180:183]
    ds_read_b64_tr_b16 a[198:199], v236 offset:33792
    ds_read_b64_tr_b16 a[200:201], v236 offset:8
    v_mfma_f32_16x16x32_bf16 v[176:179], a[248:251], a[40:43], v[176:179]
    ds_read_b64_tr_b16 a[202:203], v236 offset:1032
    v_mfma_f32_16x16x32_bf16 v[168:171], a[248:251], a[36:39], v[168:171]
    ds_read_b64_tr_b16 a[204:205], v236 offset:32776
    v_mfma_f32_16x16x32_bf16 v[172:175], a[252:255], a[36:39], v[172:175]
    s_waitcnt lgkmcnt(8)
    ds_read_b64_tr_b16 a[206:207], v236 offset:33800
    buffer_load_dwordx4 v228, s[8:11], s5 offen offset:0 lds
    v_mfma_f32_16x16x32_bf16 v[0:3], a[192:195], a[0:3], v[0:3]
    s_waitcnt lgkmcnt(4)
    ds_read_b64_tr_b16 a[208:209], v237 offset:0
    v_mfma_f32_16x16x32_bf16 v[0:3], a[196:199], a[12:15], v[0:3]
    s_add_u32 m0, s32, 98304
    ds_read_b64_tr_b16 a[210:211], v237 offset:1024
    v_mfma_f32_16x16x32_bf16 v[8:11], a[196:199], a[16:19], v[8:11]
    ds_read_b64_tr_b16 a[212:213], v237 offset:32768
    v_mfma_f32_16x16x32_bf16 v[8:11], a[192:195], a[4:7], v[8:11]
    ds_read_b64_tr_b16 a[214:215], v237 offset:33792
    v_mfma_f32_16x16x32_bf16 v[16:19], a[192:195], a[8:11], v[16:19]
    ds_read_b64_tr_b16 a[216:217], v237 offset:8
    buffer_load_dwordx4 v228, s[8:11], s29 offen offset:0 lds
    v_mfma_f32_16x16x32_bf16 v[16:19], a[196:199], a[20:23], v[16:19]
    s_waitcnt lgkmcnt(7)
    v_mfma_f32_16x16x32_bf16 v[20:23], a[200:203], a[8:11], v[20:23]
    s_waitcnt lgkmcnt(5)
    ds_read_b64_tr_b16 a[218:219], v237 offset:1032
    s_add_u32 m0, s32, 65536
    v_mfma_f32_16x16x32_bf16 v[20:23], a[204:207], a[20:23], v[20:23]
    ds_read_b64_tr_b16 a[220:221], v237 offset:32776
    v_mfma_f32_16x16x32_bf16 v[12:15], a[204:207], a[16:19], v[12:15]
    buffer_load_dwordx4 v229, s[8:11], s5 offen offset:1024 lds
    v_mfma_f32_16x16x32_bf16 v[12:15], a[200:203], a[4:7], v[12:15]
    s_add_u32 m0, s32, 98304
    ds_read_b64_tr_b16 a[222:223], v237 offset:33800
    v_mfma_f32_16x16x32_bf16 v[4:7], a[200:203], a[0:3], v[4:7]
    ds_read_b64_tr_b16 a[224:225], v238 offset:0
    v_mfma_f32_16x16x32_bf16 v[4:7], a[204:207], a[12:15], v[4:7]
    s_waitcnt lgkmcnt(7)
    ds_read_b64_tr_b16 a[226:227], v238 offset:1024
    v_mfma_f32_16x16x32_bf16 v[24:27], a[208:211], a[0:3], v[24:27]
    s_waitcnt lgkmcnt(6)
    buffer_load_dwordx4 v229, s[8:11], s29 offen offset:1024 lds
    v_mfma_f32_16x16x32_bf16 v[24:27], a[212:215], a[12:15], v[24:27]
    ds_read_b64_tr_b16 a[228:229], v238 offset:32768
    v_mfma_f32_16x16x32_bf16 v[32:35], a[212:215], a[16:19], v[32:35]
    s_add_u32 m0, s32, 65536
    ds_read_b64_tr_b16 a[230:231], v238 offset:33792
    v_mfma_f32_16x16x32_bf16 v[32:35], a[208:211], a[4:7], v[32:35]
    v_mfma_f32_16x16x32_bf16 v[40:43], a[208:211], a[8:11], v[40:43]
    ds_read_b64_tr_b16 a[232:233], v238 offset:8
    v_mfma_f32_16x16x32_bf16 v[40:43], a[212:215], a[20:23], v[40:43]
    s_waitcnt lgkmcnt(6)
    ds_read_b64_tr_b16 a[234:235], v238 offset:1032
    v_mfma_f32_16x16x32_bf16 v[44:47], a[216:219], a[8:11], v[44:47]
    s_waitcnt lgkmcnt(6)
    ds_read_b64_tr_b16 a[236:237], v238 offset:32776
    v_mfma_f32_16x16x32_bf16 v[44:47], a[220:223], a[20:23], v[44:47]
    buffer_load_dwordx4 v230, s[8:11], s5 offen offset:2048 lds
    v_mfma_f32_16x16x32_bf16 v[36:39], a[220:223], a[16:19], v[36:39]
    s_add_u32 m0, s32, 98304
    ds_read_b64_tr_b16 a[238:239], v238 offset:33800
    v_mfma_f32_16x16x32_bf16 v[36:39], a[216:219], a[4:7], v[36:39]
    ds_read_b64_tr_b16 a[240:241], v239 offset:0
    v_mfma_f32_16x16x32_bf16 v[28:31], a[216:219], a[0:3], v[28:31]
    buffer_load_dwordx4 v230, s[8:11], s29 offen offset:2048 lds
    v_mfma_f32_16x16x32_bf16 v[28:31], a[220:223], a[12:15], v[28:31]
    s_waitcnt lgkmcnt(6)
    ds_read_b64_tr_b16 a[242:243], v239 offset:1024
    v_mfma_f32_16x16x32_bf16 v[48:51], a[224:227], a[0:3], v[48:51]
    s_waitcnt lgkmcnt(6)
    ds_read_b64_tr_b16 a[244:245], v239 offset:32768
    v_mfma_f32_16x16x32_bf16 v[48:51], a[228:231], a[12:15], v[48:51]
    s_add_u32 m0, s37, 81856
    ds_read_b64_tr_b16 a[246:247], v239 offset:33792
    v_mfma_f32_16x16x32_bf16 v[56:59], a[228:231], a[16:19], v[56:59]
    s_mov_b32 s35, 1572864
    v_mfma_f32_16x16x32_bf16 v[56:59], a[224:227], a[4:7], v[56:59]
    ds_read_b64_tr_b16 a[248:249], v239 offset:8
    v_mfma_f32_16x16x32_bf16 v[64:67], a[224:227], a[8:11], v[64:67]
    ds_read_b64_tr_b16 a[250:251], v239 offset:1032
    v_mfma_f32_16x16x32_bf16 v[64:67], a[228:231], a[20:23], v[64:67]
    s_waitcnt lgkmcnt(7)
    v_mfma_f32_16x16x32_bf16 v[68:71], a[232:235], a[8:11], v[68:71]
    s_waitcnt lgkmcnt(6)
    ds_read_b64_tr_b16 a[252:253], v239 offset:32776
    v_mfma_f32_16x16x32_bf16 v[68:71], a[236:239], a[20:23], v[68:71]
    s_mov_b32 s36, 1604608
    ds_read_b64_tr_b16 a[254:255], v239 offset:33800
    v_mfma_f32_16x16x32_bf16 v[60:63], a[236:239], a[16:19], v[60:63]
L_hop0_0:
L_pad0:
    s_cbranch_execz L_pad4
    ds_read_b64_tr_b16 a[192:193], v236 offset:256
    v_mfma_f32_16x16x32_bf16 v[60:63], a[232:235], a[4:7], v[60:63]
    buffer_load_dwordx4 v208, s[12:15], s35 offen offset:0 lds
    v_mfma_f32_16x16x32_bf16 v[52:55], a[232:235], a[0:3], v[52:55]
    ds_read_b64_tr_b16 a[194:195], v236 offset:1280
    v_mfma_f32_16x16x32_bf16 v[52:55], a[236:239], a[12:15], v[52:55]
    s_waitcnt lgkmcnt(6)
    ds_read_b64_tr_b16 a[196:197], v236 offset:33024
    v_mfma_f32_16x16x32_bf16 v[72:75], a[240:243], a[0:3], v[72:75]
    buffer_load_dwordx4 v209, s[12:15], s35 offen offset:2048 lds
    v_mfma_f32_16x16x32_bf16 v[72:75], a[244:247], a[12:15], v[72:75]
    ds_read_b64_tr_b16 a[198:199], v236 offset:34048
    v_mfma_f32_16x16x32_bf16 v[80:83], a[244:247], a[16:19], v[80:83]
    ds_read_b64_tr_b16 a[200:201], v236 offset:264
    v_mfma_f32_16x16x32_bf16 v[80:83], a[240:243], a[4:7], v[80:83]
    buffer_load_dwordx4 v208, s[12:15], s36 offen offset:1024 lds
    v_mfma_f32_16x16x32_bf16 v[88:91], a[240:243], a[8:11], v[88:91]
    ds_read_b64_tr_b16 a[202:203], v236 offset:1288
    v_mfma_f32_16x16x32_bf16 v[88:91], a[244:247], a[20:23], v[88:91]
    s_waitcnt lgkmcnt(6)
    ds_read_b64_tr_b16 a[204:205], v236 offset:33032
    v_mfma_f32_16x16x32_bf16 v[92:95], a[248:251], a[8:11], v[92:95]
    ds_read_b64_tr_b16 a[206:207], v236 offset:34056
    buffer_load_dwordx4 v209, s[12:15], s36 offen offset:3072 lds
    v_mfma_f32_16x16x32_bf16 v[92:95], a[252:255], a[20:23], v[92:95]
    s_add_u32 m0, s37, 114624
    v_mfma_f32_16x16x32_bf16 v[84:87], a[252:255], a[16:19], v[84:87]
    s_mov_b32 s35, 1835008
    ds_read_b64_tr_b16 a[208:209], v237 offset:256
    v_mfma_f32_16x16x32_bf16 v[84:87], a[248:251], a[4:7], v[84:87]
    ds_read_b64_tr_b16 a[210:211], v237 offset:1280
    v_mfma_f32_16x16x32_bf16 v[76:79], a[248:251], a[0:3], v[76:79]
    v_mfma_f32_16x16x32_bf16 v[76:79], a[252:255], a[12:15], v[76:79]
    s_waitcnt lgkmcnt(6)
    ds_read_b64_tr_b16 a[212:213], v237 offset:33024
    v_mfma_f32_16x16x32_bf16 v[96:99], a[192:195], a[0:3], v[96:99]
    s_mov_b32 s36, 1866752
    ds_read_b64_tr_b16 a[214:215], v237 offset:34048
    v_mfma_f32_16x16x32_bf16 v[96:99], a[196:199], a[12:15], v[96:99]
    ds_read_b64_tr_b16 a[216:217], v237 offset:264
    v_mfma_f32_16x16x32_bf16 v[104:107], a[196:199], a[16:19], v[104:107]
    buffer_load_dwordx4 v208, s[12:15], s35 offen offset:0 lds
    v_mfma_f32_16x16x32_bf16 v[104:107], a[192:195], a[4:7], v[104:107]
    ds_read_b64_tr_b16 a[218:219], v237 offset:1288
    v_mfma_f32_16x16x32_bf16 v[112:115], a[192:195], a[8:11], v[112:115]
    ds_read_b64_tr_b16 a[220:221], v237 offset:33032
    v_mfma_f32_16x16x32_bf16 v[112:115], a[196:199], a[20:23], v[112:115]
    s_waitcnt lgkmcnt(7)
    buffer_load_dwordx4 v209, s[12:15], s35 offen offset:2048 lds
    v_mfma_f32_16x16x32_bf16 v[116:119], a[200:203], a[8:11], v[116:119]
    ds_read_b64_tr_b16 a[222:223], v237 offset:34056
    v_mfma_f32_16x16x32_bf16 v[116:119], a[204:207], a[20:23], v[116:119]
    ds_read_b64_tr_b16 a[224:225], v238 offset:256
    v_mfma_f32_16x16x32_bf16 v[108:111], a[204:207], a[16:19], v[108:111]
    ds_read_b64_tr_b16 a[226:227], v238 offset:1280
    v_mfma_f32_16x16x32_bf16 v[108:111], a[200:203], a[4:7], v[108:111]
    buffer_load_dwordx4 v208, s[12:15], s36 offen offset:1024 lds
    v_mfma_f32_16x16x32_bf16 v[100:103], a[200:203], a[0:3], v[100:103]
    ds_read_b64_tr_b16 a[228:229], v238 offset:33024
    v_mfma_f32_16x16x32_bf16 v[100:103], a[204:207], a[12:15], v[100:103]
    s_waitcnt lgkmcnt(6)
    ds_read_b64_tr_b16 a[230:231], v238 offset:34048
    v_mfma_f32_16x16x32_bf16 v[120:123], a[208:211], a[0:3], v[120:123]
    buffer_load_dwordx4 v209, s[12:15], s36 offen offset:3072 lds
    v_mfma_f32_16x16x32_bf16 v[120:123], a[212:215], a[12:15], v[120:123]
    s_add_u32 m0, s37, 147392
    ds_read_b64_tr_b16 a[232:233], v238 offset:264
    v_mfma_f32_16x16x32_bf16 v[128:131], a[212:215], a[16:19], v[128:131]
    s_mov_b32 s35, 2097152
    ds_read_b64_tr_b16 a[234:235], v238 offset:1288
    v_mfma_f32_16x16x32_bf16 v[128:131], a[208:211], a[4:7], v[128:131]
    ds_read_b64_tr_b16 a[236:237], v238 offset:33032
    v_mfma_f32_16x16x32_bf16 v[136:139], a[208:211], a[8:11], v[136:139]
    s_mov_b32 s36, 2128896
    v_mfma_f32_16x16x32_bf16 v[136:139], a[212:215], a[20:23], v[136:139]
    s_waitcnt lgkmcnt(6)
    ds_read_b64_tr_b16 a[238:239], v238 offset:34056
    v_mfma_f32_16x16x32_bf16 v[140:143], a[216:219], a[8:11], v[140:143]
    ds_read_b64_tr_b16 a[240:241], v239 offset:256
    v_mfma_f32_16x16x32_bf16 v[140:143], a[220:223], a[20:23], v[140:143]
    buffer_load_dwordx4 v208, s[12:15], s35 offen offset:0 lds
    v_mfma_f32_16x16x32_bf16 v[132:135], a[220:223], a[16:19], v[132:135]
    ds_read_b64_tr_b16 a[242:243], v239 offset:1280
    v_mfma_f32_16x16x32_bf16 v[132:135], a[216:219], a[4:7], v[132:135]
    ds_read_b64_tr_b16 a[244:245], v239 offset:33024
    v_mfma_f32_16x16x32_bf16 v[124:127], a[216:219], a[0:3], v[124:127]
    ds_read_b64_tr_b16 a[246:247], v239 offset:34048
    v_mfma_f32_16x16x32_bf16 v[124:127], a[220:223], a[12:15], v[124:127]
    s_waitcnt lgkmcnt(7)
    buffer_load_dwordx4 v209, s[12:15], s35 offen offset:2048 lds
    v_mfma_f32_16x16x32_bf16 v[144:147], a[224:227], a[0:3], v[144:147]
    ds_read_b64_tr_b16 a[248:249], v239 offset:264
    v_mfma_f32_16x16x32_bf16 v[144:147], a[228:231], a[12:15], v[144:147]
    ds_read_b64_tr_b16 a[250:251], v239 offset:1288
    v_mfma_f32_16x16x32_bf16 v[152:155], a[228:231], a[16:19], v[152:155]
    buffer_load_dwordx4 v208, s[12:15], s36 offen offset:1024 lds
    v_mfma_f32_16x16x32_bf16 v[152:155], a[224:227], a[4:7], v[152:155]
    ds_read_b64_tr_b16 a[252:253], v239 offset:33032
    v_mfma_f32_16x16x32_bf16 v[160:163], a[224:227], a[8:11], v[160:163]
    ds_read_b64_tr_b16 a[254:255], v239 offset:34056
    v_mfma_f32_16x16x32_bf16 v[160:163], a[228:231], a[20:23], v[160:163]
    s_waitcnt lgkmcnt(7)
    buffer_load_dwordx4 v209, s[12:15], s36 offen offset:3072 lds
    v_mfma_f32_16x16x32_bf16 v[164:167], a[232:235], a[8:11], v[164:167]
    v_mfma_f32_16x16x32_bf16 v[164:167], a[236:239], a[20:23], v[164:167]
    v_mfma_f32_16x16x32_bf16 v[156:159], a[236:239], a[16:19], v[156:159]
    v_mfma_f32_16x16x32_bf16 v[156:159], a[232:235], a[4:7], v[156:159]
    v_mfma_f32_16x16x32_bf16 v[148:151], a[232:235], a[0:3], v[148:151]
    v_mfma_f32_16x16x32_bf16 v[148:151], a[236:239], a[12:15], v[148:151]
    s_waitcnt lgkmcnt(2)
    s_waitcnt vmcnt(4) lgkmcnt(0)
    s_barrier
    ds_read_b128 a[24:27], v245 offset:0
    v_accvgpr_write_b32 a168, 0
    v_mfma_f32_16x16x32_bf16 v[168:171], a[240:243], a[0:3], v[168:171]
    s_mov_b32 s5, 512
    ds_read_b128 a[28:31], v245 offset:1024
    v_accvgpr_write_b32 a169, 0
    v_mfma_f32_16x16x32_bf16 v[168:171], a[244:247], a[12:15], v[168:171]
    ds_read_b128 a[32:35], v245 offset:2048
    v_mfma_f32_16x16x32_bf16 v[176:179], a[244:247], a[16:19], v[176:179]
    s_mov_b32 s29, 576
    ds_read_b64_tr_b16 a[192:193], v241 offset:0
    v_mfma_f32_16x16x32_bf16 v[176:179], a[240:243], a[4:7], v[176:179]
    ds_read_b64_tr_b16 a[194:195], v241 offset:1024
    v_mfma_f32_16x16x32_bf16 v[184:187], a[240:243], a[8:11], v[184:187]
    s_add_u32 m0, s32, 131072
    ds_read_b128 a[36:39], v245 offset:32768
    v_accvgpr_write_b32 a170, 0
    v_mfma_f32_16x16x32_bf16 v[184:187], a[244:247], a[20:23], v[184:187]
    ds_read_b128 a[40:43], v245 offset:33792
    v_mfma_f32_16x16x32_bf16 v[188:191], a[248:251], a[8:11], v[188:191]
    ds_read_b128 a[44:47], v245 offset:34816
    v_mfma_f32_16x16x32_bf16 v[188:191], a[252:255], a[20:23], v[188:191]
    ds_read_b64_tr_b16 a[196:197], v241 offset:32768
    v_accvgpr_write_b32 a171, 0
    v_mfma_f32_16x16x32_bf16 v[180:183], a[252:255], a[16:19], v[180:183]
    ds_read_b64_tr_b16 a[198:199], v241 offset:33792
    ds_read_b64_tr_b16 a[200:201], v241 offset:8
    v_mfma_f32_16x16x32_bf16 v[180:183], a[248:251], a[4:7], v[180:183]
    ds_read_b64_tr_b16 a[202:203], v241 offset:1032
    buffer_load_dwordx4 v228, s[8:11], s5 offen offset:0 lds
    v_mfma_f32_16x16x32_bf16 v[172:175], a[248:251], a[0:3], v[172:175]
    s_add_u32 m0, s32, 0
    ds_read_b64_tr_b16 a[204:205], v241 offset:32776
    v_mfma_f32_16x16x32_bf16 v[172:175], a[252:255], a[12:15], v[172:175]
    s_waitcnt lgkmcnt(8)
    ds_read_b64_tr_b16 a[206:207], v241 offset:33800
    v_accvgpr_write_b32 a172, 0
    v_mfma_f32_16x16x32_bf16 v[0:3], a[192:195], a[24:27], v[0:3]
    s_waitcnt lgkmcnt(4)
    ds_read_b64_tr_b16 a[208:209], v242 offset:0
    v_mfma_f32_16x16x32_bf16 v[0:3], a[196:199], a[36:39], v[0:3]
    ds_read_b64_tr_b16 a[210:211], v242 offset:1024
    buffer_load_dwordx4 v228, s[8:11], s29 offen offset:0 lds
    v_mfma_f32_16x16x32_bf16 v[8:11], a[196:199], a[40:43], v[8:11]
    s_add_u32 m0, s32, 131072
    ds_read_b64_tr_b16 a[212:213], v242 offset:32768
    v_mfma_f32_16x16x32_bf16 v[8:11], a[192:195], a[28:31], v[8:11]
    ds_read_b64_tr_b16 a[214:215], v242 offset:33792
    v_accvgpr_write_b32 a173, 0
    v_mfma_f32_16x16x32_bf16 v[16:19], a[192:195], a[32:35], v[16:19]
    ds_read_b64_tr_b16 a[216:217], v242 offset:8
    v_mfma_f32_16x16x32_bf16 v[16:19], a[196:199], a[44:47], v[16:19]
    s_waitcnt lgkmcnt(7)
    buffer_load_dwordx4 v229, s[8:11], s5 offen offset:1024 lds
    v_mfma_f32_16x16x32_bf16 v[20:23], a[200:203], a[32:35], v[20:23]
    s_waitcnt lgkmcnt(5)
    ds_read_b64_tr_b16 a[218:219], v242 offset:1032
    s_add_u32 m0, s32, 0
    v_mfma_f32_16x16x32_bf16 v[20:23], a[204:207], a[44:47], v[20:23]
    ds_read_b64_tr_b16 a[220:221], v242 offset:32776
    v_accvgpr_write_b32 a174, 0
    v_mfma_f32_16x16x32_bf16 v[12:15], a[204:207], a[40:43], v[12:15]
    buffer_load_dwordx4 v229, s[8:11], s29 offen offset:1024 lds
    v_mfma_f32_16x16x32_bf16 v[12:15], a[200:203], a[28:31], v[12:15]
    s_add_u32 m0, s32, 131072
    ds_read_b64_tr_b16 a[222:223], v242 offset:33800
    v_mfma_f32_16x16x32_bf16 v[4:7], a[200:203], a[24:27], v[4:7]
    ds_read_b64_tr_b16 a[224:225], v243 offset:0
    v_accvgpr_write_b32 a175, 0
    v_mfma_f32_16x16x32_bf16 v[4:7], a[204:207], a[36:39], v[4:7]
    s_waitcnt lgkmcnt(7)
    ds_read_b64_tr_b16 a[226:227], v243 offset:1024
    v_mfma_f32_16x16x32_bf16 v[24:27], a[208:211], a[24:27], v[24:27]
    s_waitcnt lgkmcnt(6)
    buffer_load_dwordx4 v230, s[8:11], s5 offen offset:2048 lds
    v_mfma_f32_16x16x32_bf16 v[24:27], a[212:215], a[36:39], v[24:27]
    s_add_u32 m0, s32, 0
    ds_read_b64_tr_b16 a[228:229], v243 offset:32768
    v_accvgpr_write_b32 a176, 0
    v_mfma_f32_16x16x32_bf16 v[32:35], a[212:215], a[40:43], v[32:35]
    ds_read_b64_tr_b16 a[230:231], v243 offset:33792
    v_mfma_f32_16x16x32_bf16 v[32:35], a[208:211], a[28:31], v[32:35]
    buffer_load_dwordx4 v230, s[8:11], s29 offen offset:2048 lds
    v_mfma_f32_16x16x32_bf16 v[40:43], a[208:211], a[32:35], v[40:43]
    s_add_u32 m0, s37, 16320
    ds_read_b64_tr_b16 a[232:233], v243 offset:8
    v_mfma_f32_16x16x32_bf16 v[40:43], a[212:215], a[44:47], v[40:43]
    s_waitcnt lgkmcnt(6)
    ds_read_b64_tr_b16 a[234:235], v243 offset:1032
    v_accvgpr_write_b32 a177, 0
    v_mfma_f32_16x16x32_bf16 v[44:47], a[216:219], a[32:35], v[44:47]
    s_waitcnt lgkmcnt(6)
    ds_read_b64_tr_b16 a[236:237], v243 offset:32776
    v_mfma_f32_16x16x32_bf16 v[44:47], a[220:223], a[44:47], v[44:47]
    s_mov_b32 s35, 2359296
    v_mfma_f32_16x16x32_bf16 v[36:39], a[220:223], a[40:43], v[36:39]
    s_mov_b32 s36, 2391040
    ds_read_b64_tr_b16 a[238:239], v243 offset:33800
    v_mfma_f32_16x16x32_bf16 v[36:39], a[216:219], a[28:31], v[36:39]
    ds_read_b64_tr_b16 a[240:241], v244 offset:0
    v_accvgpr_write_b32 a178, 0
    v_mfma_f32_16x16x32_bf16 v[28:31], a[216:219], a[24:27], v[28:31]
    buffer_load_dwordx4 v208, s[12:15], s35 offen offset:0 lds
    v_mfma_f32_16x16x32_bf16 v[28:31], a[220:223], a[36:39], v[28:31]
    s_waitcnt lgkmcnt(6)
    ds_read_b64_tr_b16 a[242:243], v244 offset:1024
    v_mfma_f32_16x16x32_bf16 v[48:51], a[224:227], a[24:27], v[48:51]
    s_waitcnt lgkmcnt(6)
    ds_read_b64_tr_b16 a[244:245], v244 offset:32768
    v_accvgpr_write_b32 a179, 0
    v_mfma_f32_16x16x32_bf16 v[48:51], a[228:231], a[36:39], v[48:51]
    ds_read_b64_tr_b16 a[246:247], v244 offset:33792
    v_mfma_f32_16x16x32_bf16 v[56:59], a[228:231], a[40:43], v[56:59]
    buffer_load_dwordx4 v209, s[12:15], s35 offen offset:2048 lds
    v_mfma_f32_16x16x32_bf16 v[56:59], a[224:227], a[28:31], v[56:59]
    ds_read_b64_tr_b16 a[248:249], v244 offset:8
    v_mfma_f32_16x16x32_bf16 v[64:67], a[224:227], a[32:35], v[64:67]
    ds_read_b64_tr_b16 a[250:251], v244 offset:1032
    v_accvgpr_write_b32 a180, 0
    v_mfma_f32_16x16x32_bf16 v[64:67], a[228:231], a[44:47], v[64:67]
    s_waitcnt lgkmcnt(7)
    buffer_load_dwordx4 v208, s[12:15], s36 offen offset:1024 lds
    v_mfma_f32_16x16x32_bf16 v[68:71], a[232:235], a[32:35], v[68:71]
    s_waitcnt lgkmcnt(6)
    ds_read_b64_tr_b16 a[252:253], v244 offset:32776
    v_mfma_f32_16x16x32_bf16 v[68:71], a[236:239], a[44:47], v[68:71]
    ds_read_b64_tr_b16 a[254:255], v244 offset:33800
    buffer_load_dwordx4 v209, s[12:15], s36 offen offset:3072 lds
    v_mfma_f32_16x16x32_bf16 v[60:63], a[236:239], a[40:43], v[60:63]
    s_mov_b32 s35, 2621440
    ds_read_b64_tr_b16 a[192:193], v241 offset:256
    v_accvgpr_write_b32 a181, 0
    v_mfma_f32_16x16x32_bf16 v[60:63], a[232:235], a[28:31], v[60:63]
    s_mov_b32 s36, 640
    v_mfma_f32_16x16x32_bf16 v[52:55], a[232:235], a[24:27], v[52:55]
    ds_read_b64_tr_b16 a[194:195], v241 offset:1280
    v_mfma_f32_16x16x32_bf16 v[52:55], a[236:239], a[36:39], v[52:55]
    s_waitcnt lgkmcnt(6)
    ds_read_b64_tr_b16 a[196:197], v241 offset:33024
    v_accvgpr_write_b32 a182, 0
    v_mfma_f32_16x16x32_bf16 v[72:75], a[240:243], a[24:27], v[72:75]
    buffer_load_dword v231, v232, s[12:15], s35 offen
    v_mfma_f32_16x16x32_bf16 v[72:75], a[244:247], a[36:39], v[72:75]
    ds_read_b64_tr_b16 a[198:199], v241 offset:34048
    v_mfma_f32_16x16x32_bf16 v[80:83], a[244:247], a[40:43], v[80:83]
    ds_read_b64_tr_b16 a[200:201], v241 offset:264
    v_mfma_f32_16x16x32_bf16 v[80:83], a[240:243], a[28:31], v[80:83]
    buffer_load_dword v231, v233, s[8:11], s36 offen
    v_accvgpr_write_b32 a183, 0
    v_mfma_f32_16x16x32_bf16 v[88:91], a[240:243], a[32:35], v[88:91]
    ds_read_b64_tr_b16 a[202:203], v241 offset:1288
    v_mfma_f32_16x16x32_bf16 v[88:91], a[244:247], a[44:47], v[88:91]
    s_waitcnt lgkmcnt(6)
    ds_read_b64_tr_b16 a[204:205], v241 offset:33032
    v_mfma_f32_16x16x32_bf16 v[92:95], a[248:251], a[32:35], v[92:95]
    ds_read_b64_tr_b16 a[206:207], v241 offset:34056
    v_accvgpr_write_b32 a184, 0
    v_mfma_f32_16x16x32_bf16 v[92:95], a[252:255], a[44:47], v[92:95]
    v_mfma_f32_16x16x32_bf16 v[84:87], a[252:255], a[40:43], v[84:87]
    ds_read_b64_tr_b16 a[208:209], v242 offset:256
    v_mfma_f32_16x16x32_bf16 v[84:87], a[248:251], a[28:31], v[84:87]
    ds_read_b64_tr_b16 a[210:211], v242 offset:1280
    v_mfma_f32_16x16x32_bf16 v[76:79], a[248:251], a[24:27], v[76:79]
    v_mfma_f32_16x16x32_bf16 v[76:79], a[252:255], a[36:39], v[76:79]
    s_waitcnt lgkmcnt(6)
    ds_read_b64_tr_b16 a[212:213], v242 offset:33024
    v_accvgpr_write_b32 a185, 0
    v_mfma_f32_16x16x32_bf16 v[96:99], a[192:195], a[24:27], v[96:99]
    ds_read_b64_tr_b16 a[214:215], v242 offset:34048
    v_mfma_f32_16x16x32_bf16 v[96:99], a[196:199], a[36:39], v[96:99]
    ds_read_b64_tr_b16 a[216:217], v242 offset:264
    v_mfma_f32_16x16x32_bf16 v[104:107], a[196:199], a[40:43], v[104:107]
    v_mfma_f32_16x16x32_bf16 v[104:107], a[192:195], a[28:31], v[104:107]
    ds_read_b64_tr_b16 a[218:219], v242 offset:1288
    v_accvgpr_write_b32 a186, 0
    v_mfma_f32_16x16x32_bf16 v[112:115], a[192:195], a[32:35], v[112:115]
    ds_read_b64_tr_b16 a[220:221], v242 offset:33032
    v_mfma_f32_16x16x32_bf16 v[112:115], a[196:199], a[44:47], v[112:115]
    s_waitcnt lgkmcnt(7)
    v_mfma_f32_16x16x32_bf16 v[116:119], a[200:203], a[32:35], v[116:119]
    ds_read_b64_tr_b16 a[222:223], v242 offset:34056
    v_accvgpr_write_b32 a187, 0
    v_mfma_f32_16x16x32_bf16 v[116:119], a[204:207], a[44:47], v[116:119]
    ds_read_b64_tr_b16 a[224:225], v243 offset:256
    v_mfma_f32_16x16x32_bf16 v[108:111], a[204:207], a[40:43], v[108:111]
    ds_read_b64_tr_b16 a[226:227], v243 offset:1280
    v_mfma_f32_16x16x32_bf16 v[108:111], a[200:203], a[28:31], v[108:111]
    v_mfma_f32_16x16x32_bf16 v[100:103], a[200:203], a[24:27], v[100:103]
    ds_read_b64_tr_b16 a[228:229], v243 offset:33024
    v_accvgpr_write_b32 a188, 0
    v_mfma_f32_16x16x32_bf16 v[100:103], a[204:207], a[36:39], v[100:103]
    s_waitcnt lgkmcnt(6)
    ds_read_b64_tr_b16 a[230:231], v243 offset:34048
    v_mfma_f32_16x16x32_bf16 v[120:123], a[208:211], a[24:27], v[120:123]
    v_mfma_f32_16x16x32_bf16 v[120:123], a[212:215], a[36:39], v[120:123]
    ds_read_b64_tr_b16 a[232:233], v243 offset:264
    v_accvgpr_write_b32 a189, 0
    v_mfma_f32_16x16x32_bf16 v[128:131], a[212:215], a[40:43], v[128:131]
    ds_read_b64_tr_b16 a[234:235], v243 offset:1288
    v_mfma_f32_16x16x32_bf16 v[128:131], a[208:211], a[28:31], v[128:131]
    ds_read_b64_tr_b16 a[236:237], v243 offset:33032
    v_mfma_f32_16x16x32_bf16 v[136:139], a[208:211], a[32:35], v[136:139]
    v_mfma_f32_16x16x32_bf16 v[136:139], a[212:215], a[44:47], v[136:139]
    s_waitcnt lgkmcnt(6)
    ds_read_b64_tr_b16 a[238:239], v243 offset:34056
    v_accvgpr_write_b32 a190, 0
    v_mfma_f32_16x16x32_bf16 v[140:143], a[216:219], a[32:35], v[140:143]
    ds_read_b64_tr_b16 a[240:241], v244 offset:256
    v_mfma_f32_16x16x32_bf16 v[140:143], a[220:223], a[44:47], v[140:143]
    v_mfma_f32_16x16x32_bf16 v[132:135], a[220:223], a[40:43], v[132:135]
    ds_read_b64_tr_b16 a[242:243], v244 offset:1280
    v_accvgpr_write_b32 a191, 0
    v_mfma_f32_16x16x32_bf16 v[132:135], a[216:219], a[28:31], v[132:135]
    ds_read_b64_tr_b16 a[244:245], v244 offset:33024
    v_mfma_f32_16x16x32_bf16 v[124:127], a[216:219], a[24:27], v[124:127]
    ds_read_b64_tr_b16 a[246:247], v244 offset:34048
    v_mfma_f32_16x16x32_bf16 v[124:127], a[220:223], a[36:39], v[124:127]
    s_waitcnt lgkmcnt(7)
    v_mfma_f32_16x16x32_bf16 v[144:147], a[224:227], a[24:27], v[144:147]
    ds_read_b64_tr_b16 a[248:249], v244 offset:264
    v_mfma_f32_16x16x32_bf16 v[144:147], a[228:231], a[36:39], v[144:147]
    ds_read_b64_tr_b16 a[250:251], v244 offset:1288
    v_mfma_f32_16x16x32_bf16 v[152:155], a[228:231], a[40:43], v[152:155]
    v_mfma_f32_16x16x32_bf16 v[152:155], a[224:227], a[28:31], v[152:155]
    ds_read_b64_tr_b16 a[252:253], v244 offset:33032
    v_mfma_f32_16x16x32_bf16 v[160:163], a[224:227], a[32:35], v[160:163]
    ds_read_b64_tr_b16 a[254:255], v244 offset:34056
    v_mfma_f32_16x16x32_bf16 v[160:163], a[228:231], a[44:47], v[160:163]
    s_waitcnt lgkmcnt(7)
    v_mfma_f32_16x16x32_bf16 v[164:167], a[232:235], a[32:35], v[164:167]
    v_mfma_f32_16x16x32_bf16 v[164:167], a[236:239], a[44:47], v[164:167]
    v_mfma_f32_16x16x32_bf16 v[156:159], a[236:239], a[40:43], v[156:159]
    v_mfma_f32_16x16x32_bf16 v[156:159], a[232:235], a[28:31], v[156:159]
    v_mfma_f32_16x16x32_bf16 v[148:151], a[232:235], a[24:27], v[148:151]
    v_mfma_f32_16x16x32_bf16 v[148:151], a[236:239], a[36:39], v[148:151]
    s_waitcnt lgkmcnt(2)
    s_waitcnt vmcnt(2) lgkmcnt(0)
    s_barrier
    ds_read_b128 a[0:3], v250 offset:0
    v_mfma_f32_16x16x32_bf16 v[168:171], a[240:243], a[24:27], v[168:171]
    s_mov_b32 s5, 640
    ds_read_b128 a[4:7], v250 offset:1024
    v_mfma_f32_16x16x32_bf16 v[168:171], a[244:247], a[36:39], v[168:171]
    ds_read_b128 a[8:11], v250 offset:2048
    v_mfma_f32_16x16x32_bf16 v[176:179], a[244:247], a[40:43], v[176:179]
    ds_read_b64_tr_b16 a[192:193], v246 offset:0
    v_mfma_f32_16x16x32_bf16 v[176:179], a[240:243], a[28:31], v[176:179]
    s_mov_b32 s29, 704
    ds_read_b64_tr_b16 a[194:195], v246 offset:1024
    v_mfma_f32_16x16x32_bf16 v[184:187], a[240:243], a[32:35], v[184:187]
    ds_read_b128 a[12:15], v240 offset:0
    v_mfma_f32_16x16x32_bf16 v[184:187], a[244:247], a[44:47], v[184:187]
    ds_read_b128 a[16:19], v240 offset:1024
    v_mfma_f32_16x16x32_bf16 v[188:191], a[248:251], a[32:35], v[188:191]
    s_add_u32 m0, s32, 32768
    ds_read_b128 a[20:23], v240 offset:2048
    v_mfma_f32_16x16x32_bf16 v[188:191], a[252:255], a[44:47], v[188:191]
    ds_read_b64_tr_b16 a[196:197], v236 offset:0
    v_mfma_f32_16x16x32_bf16 v[180:183], a[252:255], a[40:43], v[180:183]
    ds_read_b64_tr_b16 a[198:199], v236 offset:1024
    ds_read_b64_tr_b16 a[200:201], v246 offset:8
    v_mfma_f32_16x16x32_bf16 v[180:183], a[248:251], a[28:31], v[180:183]
    ds_read_b64_tr_b16 a[202:203], v246 offset:1032
    v_mfma_f32_16x16x32_bf16 v[172:175], a[248:251], a[24:27], v[172:175]
    ds_read_b64_tr_b16 a[204:205], v236 offset:8
    v_mfma_f32_16x16x32_bf16 v[172:175], a[252:255], a[36:39], v[172:175]
    s_waitcnt lgkmcnt(8)
    ds_read_b64_tr_b16 a[206:207], v236 offset:1032
    buffer_load_dwordx4 v228, s[8:11], s5 offen offset:0 lds
    v_mfma_f32_16x16x32_bf16 v[0:3], a[192:195], a[0:3], v[0:3]
    s_waitcnt lgkmcnt(4)
    ds_read_b64_tr_b16 a[208:209], v247 offset:0
    v_mfma_f32_16x16x32_bf16 v[0:3], a[196:199], a[12:15], v[0:3]
    s_add_u32 m0, s32, 65536
    ds_read_b64_tr_b16 a[210:211], v247 offset:1024
    v_mfma_f32_16x16x32_bf16 v[8:11], a[196:199], a[16:19], v[8:11]
    ds_read_b64_tr_b16 a[212:213], v237 offset:0
    v_mfma_f32_16x16x32_bf16 v[8:11], a[192:195], a[4:7], v[8:11]
    ds_read_b64_tr_b16 a[214:215], v237 offset:1024
    v_mfma_f32_16x16x32_bf16 v[16:19], a[192:195], a[8:11], v[16:19]
    ds_read_b64_tr_b16 a[216:217], v247 offset:8
    buffer_load_dwordx4 v228, s[8:11], s29 offen offset:0 lds
    v_mfma_f32_16x16x32_bf16 v[16:19], a[196:199], a[20:23], v[16:19]
    s_waitcnt lgkmcnt(7)
    v_mfma_f32_16x16x32_bf16 v[20:23], a[200:203], a[8:11], v[20:23]
    s_waitcnt lgkmcnt(5)
    ds_read_b64_tr_b16 a[218:219], v247 offset:1032
    s_add_u32 m0, s32, 32768
    v_mfma_f32_16x16x32_bf16 v[20:23], a[204:207], a[20:23], v[20:23]
    ds_read_b64_tr_b16 a[220:221], v237 offset:8
    v_mfma_f32_16x16x32_bf16 v[12:15], a[204:207], a[16:19], v[12:15]
    buffer_load_dwordx4 v229, s[8:11], s5 offen offset:1024 lds
    v_mfma_f32_16x16x32_bf16 v[12:15], a[200:203], a[4:7], v[12:15]
    s_add_u32 m0, s32, 65536
    ds_read_b64_tr_b16 a[222:223], v237 offset:1032
    v_mfma_f32_16x16x32_bf16 v[4:7], a[200:203], a[0:3], v[4:7]
    ds_read_b64_tr_b16 a[224:225], v248 offset:0
    v_mfma_f32_16x16x32_bf16 v[4:7], a[204:207], a[12:15], v[4:7]
    s_waitcnt lgkmcnt(7)
    ds_read_b64_tr_b16 a[226:227], v248 offset:1024
    v_mfma_f32_16x16x32_bf16 v[24:27], a[208:211], a[0:3], v[24:27]
    s_waitcnt lgkmcnt(6)
    buffer_load_dwordx4 v229, s[8:11], s29 offen offset:1024 lds
    v_mfma_f32_16x16x32_bf16 v[24:27], a[212:215], a[12:15], v[24:27]
    ds_read_b64_tr_b16 a[228:229], v238 offset:0
    v_mfma_f32_16x16x32_bf16 v[32:35], a[212:215], a[16:19], v[32:35]
    s_add_u32 m0, s32, 32768
    ds_read_b64_tr_b16 a[230:231], v238 offset:1024
    v_mfma_f32_16x16x32_bf16 v[32:35], a[208:211], a[4:7], v[32:35]
    v_mfma_f32_16x16x32_bf16 v[40:43], a[208:211], a[8:11], v[40:43]
    ds_read_b64_tr_b16 a[232:233], v248 offset:8
    v_mfma_f32_16x16x32_bf16 v[40:43], a[212:215], a[20:23], v[40:43]
    s_waitcnt lgkmcnt(6)
    ds_read_b64_tr_b16 a[234:235], v248 offset:1032
    v_mfma_f32_16x16x32_bf16 v[44:47], a[216:219], a[8:11], v[44:47]
    s_waitcnt lgkmcnt(6)
    ds_read_b64_tr_b16 a[236:237], v238 offset:8
    v_mfma_f32_16x16x32_bf16 v[44:47], a[220:223], a[20:23], v[44:47]
    buffer_load_dwordx4 v230, s[8:11], s5 offen offset:2048 lds
    v_mfma_f32_16x16x32_bf16 v[36:39], a[220:223], a[16:19], v[36:39]
    s_add_u32 m0, s32, 65536
    ds_read_b64_tr_b16 a[238:239], v238 offset:1032
    v_mfma_f32_16x16x32_bf16 v[36:39], a[216:219], a[4:7], v[36:39]
    ds_read_b64_tr_b16 a[240:241], v249 offset:0
    v_mfma_f32_16x16x32_bf16 v[28:31], a[216:219], a[0:3], v[28:31]
    buffer_load_dwordx4 v230, s[8:11], s29 offen offset:2048 lds
    v_mfma_f32_16x16x32_bf16 v[28:31], a[220:223], a[12:15], v[28:31]
    s_waitcnt lgkmcnt(6)
    ds_read_b64_tr_b16 a[242:243], v249 offset:1024
    v_mfma_f32_16x16x32_bf16 v[48:51], a[224:227], a[0:3], v[48:51]
    s_waitcnt lgkmcnt(6)
    ds_read_b64_tr_b16 a[244:245], v239 offset:0
    v_mfma_f32_16x16x32_bf16 v[48:51], a[228:231], a[12:15], v[48:51]
    s_add_u32 m0, s37, 49088
    ds_read_b64_tr_b16 a[246:247], v239 offset:1024
    v_mfma_f32_16x16x32_bf16 v[56:59], a[228:231], a[16:19], v[56:59]
    s_mov_b32 s35, 2621440
    v_mfma_f32_16x16x32_bf16 v[56:59], a[224:227], a[4:7], v[56:59]
    ds_read_b64_tr_b16 a[248:249], v249 offset:8
    v_mfma_f32_16x16x32_bf16 v[64:67], a[224:227], a[8:11], v[64:67]
    ds_read_b64_tr_b16 a[250:251], v249 offset:1032
    v_mfma_f32_16x16x32_bf16 v[64:67], a[228:231], a[20:23], v[64:67]
    s_waitcnt lgkmcnt(7)
    v_mfma_f32_16x16x32_bf16 v[68:71], a[232:235], a[8:11], v[68:71]
    s_waitcnt lgkmcnt(6)
    ds_read_b64_tr_b16 a[252:253], v239 offset:8
    v_mfma_f32_16x16x32_bf16 v[68:71], a[236:239], a[20:23], v[68:71]
    s_mov_b32 s36, 2653184
    ds_read_b64_tr_b16 a[254:255], v239 offset:1032
    v_mfma_f32_16x16x32_bf16 v[60:63], a[236:239], a[16:19], v[60:63]
    ds_read_b64_tr_b16 a[192:193], v246 offset:256
    v_mfma_f32_16x16x32_bf16 v[60:63], a[232:235], a[4:7], v[60:63]
    buffer_load_dwordx4 v208, s[12:15], s35 offen offset:0 lds
    v_mfma_f32_16x16x32_bf16 v[52:55], a[232:235], a[0:3], v[52:55]
    ds_read_b64_tr_b16 a[194:195], v246 offset:1280
    v_mfma_f32_16x16x32_bf16 v[52:55], a[236:239], a[12:15], v[52:55]
    s_waitcnt lgkmcnt(6)
    ds_read_b64_tr_b16 a[196:197], v236 offset:256
    v_mfma_f32_16x16x32_bf16 v[72:75], a[240:243], a[0:3], v[72:75]
    buffer_load_dwordx4 v209, s[12:15], s35 offen offset:2048 lds
    v_mfma_f32_16x16x32_bf16 v[72:75], a[244:247], a[12:15], v[72:75]
    ds_read_b64_tr_b16 a[198:199], v236 offset:1280
    v_mfma_f32_16x16x32_bf16 v[80:83], a[244:247], a[16:19], v[80:83]
    ds_read_b64_tr_b16 a[200:201], v246 offset:264
    v_mfma_f32_16x16x32_bf16 v[80:83], a[240:243], a[4:7], v[80:83]
    buffer_load_dwordx4 v208, s[12:15], s36 offen offset:1024 lds
    v_mfma_f32_16x16x32_bf16 v[88:91], a[240:243], a[8:11], v[88:91]
    ds_read_b64_tr_b16 a[202:203], v246 offset:1288
    v_mfma_f32_16x16x32_bf16 v[88:91], a[244:247], a[20:23], v[88:91]
    s_waitcnt lgkmcnt(6)
    ds_read_b64_tr_b16 a[204:205], v236 offset:264
    v_mfma_f32_16x16x32_bf16 v[92:95], a[248:251], a[8:11], v[92:95]
    ds_read_b64_tr_b16 a[206:207], v236 offset:1288
    buffer_load_dwordx4 v209, s[12:15], s36 offen offset:3072 lds
    v_mfma_f32_16x16x32_bf16 v[92:95], a[252:255], a[20:23], v[92:95]
    s_add_u32 m0, s37, 81856
    v_mfma_f32_16x16x32_bf16 v[84:87], a[252:255], a[16:19], v[84:87]
    s_mov_b32 s35, 2883584
    ds_read_b64_tr_b16 a[208:209], v247 offset:256
    v_mfma_f32_16x16x32_bf16 v[84:87], a[248:251], a[4:7], v[84:87]
    ds_read_b64_tr_b16 a[210:211], v247 offset:1280
    v_mfma_f32_16x16x32_bf16 v[76:79], a[248:251], a[0:3], v[76:79]
    v_mfma_f32_16x16x32_bf16 v[76:79], a[252:255], a[12:15], v[76:79]
    s_waitcnt lgkmcnt(6)
    ds_read_b64_tr_b16 a[212:213], v237 offset:256
    v_mfma_f32_16x16x32_bf16 v[96:99], a[192:195], a[0:3], v[96:99]
    s_mov_b32 s36, 2915328
    ds_read_b64_tr_b16 a[214:215], v237 offset:1280
    v_mfma_f32_16x16x32_bf16 v[96:99], a[196:199], a[12:15], v[96:99]
    ds_read_b64_tr_b16 a[216:217], v247 offset:264
    v_mfma_f32_16x16x32_bf16 v[104:107], a[196:199], a[16:19], v[104:107]
    buffer_load_dwordx4 v208, s[12:15], s35 offen offset:0 lds
    v_mfma_f32_16x16x32_bf16 v[104:107], a[192:195], a[4:7], v[104:107]
    ds_read_b64_tr_b16 a[218:219], v247 offset:1288
    v_mfma_f32_16x16x32_bf16 v[112:115], a[192:195], a[8:11], v[112:115]
    ds_read_b64_tr_b16 a[220:221], v237 offset:264
    v_mfma_f32_16x16x32_bf16 v[112:115], a[196:199], a[20:23], v[112:115]
    s_waitcnt lgkmcnt(7)
    buffer_load_dwordx4 v209, s[12:15], s35 offen offset:2048 lds
    v_mfma_f32_16x16x32_bf16 v[116:119], a[200:203], a[8:11], v[116:119]
    ds_read_b64_tr_b16 a[222:223], v237 offset:1288
    v_mfma_f32_16x16x32_bf16 v[116:119], a[204:207], a[20:23], v[116:119]
    ds_read_b64_tr_b16 a[224:225], v248 offset:256
    v_mfma_f32_16x16x32_bf16 v[108:111], a[204:207], a[16:19], v[108:111]
    ds_read_b64_tr_b16 a[226:227], v248 offset:1280
    v_mfma_f32_16x16x32_bf16 v[108:111], a[200:203], a[4:7], v[108:111]
    buffer_load_dwordx4 v208, s[12:15], s36 offen offset:1024 lds
    v_mfma_f32_16x16x32_bf16 v[100:103], a[200:203], a[0:3], v[100:103]
    ds_read_b64_tr_b16 a[228:229], v238 offset:256
    v_mfma_f32_16x16x32_bf16 v[100:103], a[204:207], a[12:15], v[100:103]
    s_waitcnt lgkmcnt(6)
    ds_read_b64_tr_b16 a[230:231], v238 offset:1280
    v_mfma_f32_16x16x32_bf16 v[120:123], a[208:211], a[0:3], v[120:123]
    buffer_load_dwordx4 v209, s[12:15], s36 offen offset:3072 lds
    v_mfma_f32_16x16x32_bf16 v[120:123], a[212:215], a[12:15], v[120:123]
    s_add_u32 m0, s37, 114624
    ds_read_b64_tr_b16 a[232:233], v248 offset:264
    v_mfma_f32_16x16x32_bf16 v[128:131], a[212:215], a[16:19], v[128:131]
    s_mov_b32 s35, 3145728
    ds_read_b64_tr_b16 a[234:235], v248 offset:1288
    v_mfma_f32_16x16x32_bf16 v[128:131], a[208:211], a[4:7], v[128:131]
    ds_read_b64_tr_b16 a[236:237], v238 offset:264
    v_mfma_f32_16x16x32_bf16 v[136:139], a[208:211], a[8:11], v[136:139]
    s_mov_b32 s36, 3177472
    v_mfma_f32_16x16x32_bf16 v[136:139], a[212:215], a[20:23], v[136:139]
    s_waitcnt lgkmcnt(6)
    ds_read_b64_tr_b16 a[238:239], v238 offset:1288
    v_mfma_f32_16x16x32_bf16 v[140:143], a[216:219], a[8:11], v[140:143]
L_hop0_1:
L_pad1:
    s_cbranch_execz L_hopped0
    ds_read_b64_tr_b16 a[240:241], v249 offset:256
    v_mfma_f32_16x16x32_bf16 v[140:143], a[220:223], a[20:23], v[140:143]
    buffer_load_dwordx4 v208, s[12:15], s35 offen offset:0 lds
    v_mfma_f32_16x16x32_bf16 v[132:135], a[220:223], a[16:19], v[132:135]
    ds_read_b64_tr_b16 a[242:243], v249 offset:1280
    v_mfma_f32_16x16x32_bf16 v[132:135], a[216:219], a[4:7], v[132:135]
    ds_read_b64_tr_b16 a[244:245], v239 offset:256
    v_mfma_f32_16x16x32_bf16 v[124:127], a[216:219], a[0:3], v[124:127]
    ds_read_b64_tr_b16 a[246:247], v239 offset:1280
    v_mfma_f32_16x16x32_bf16 v[124:127], a[220:223], a[12:15], v[124:127]
    s_waitcnt lgkmcnt(7)
    buffer_load_dwordx4 v209, s[12:15], s35 offen offset:2048 lds
    v_mfma_f32_16x16x32_bf16 v[144:147], a[224:227], a[0:3], v[144:147]
    ds_read_b64_tr_b16 a[248:249], v249 offset:264
    v_mfma_f32_16x16x32_bf16 v[144:147], a[228:231], a[12:15], v[144:147]
    ds_read_b64_tr_b16 a[250:251], v249 offset:1288
    v_mfma_f32_16x16x32_bf16 v[152:155], a[228:231], a[16:19], v[152:155]
    buffer_load_dwordx4 v208, s[12:15], s36 offen offset:1024 lds
    v_mfma_f32_16x16x32_bf16 v[152:155], a[224:227], a[4:7], v[152:155]
    ds_read_b64_tr_b16 a[252:253], v239 offset:264
    v_mfma_f32_16x16x32_bf16 v[160:163], a[224:227], a[8:11], v[160:163]
    ds_read_b64_tr_b16 a[254:255], v239 offset:1288
    v_mfma_f32_16x16x32_bf16 v[160:163], a[228:231], a[20:23], v[160:163]
    s_waitcnt lgkmcnt(7)
    buffer_load_dwordx4 v209, s[12:15], s36 offen offset:3072 lds
    v_mfma_f32_16x16x32_bf16 v[164:167], a[232:235], a[8:11], v[164:167]
    v_mfma_f32_16x16x32_bf16 v[164:167], a[236:239], a[20:23], v[164:167]
    v_mfma_f32_16x16x32_bf16 v[156:159], a[236:239], a[16:19], v[156:159]
    v_mfma_f32_16x16x32_bf16 v[156:159], a[232:235], a[4:7], v[156:159]
    v_mfma_f32_16x16x32_bf16 v[148:151], a[232:235], a[0:3], v[148:151]
    v_mfma_f32_16x16x32_bf16 v[148:151], a[236:239], a[12:15], v[148:151]
    s_waitcnt lgkmcnt(2)
    s_waitcnt vmcnt(4) lgkmcnt(0)
    s_barrier
    ds_read_b128 a[24:27], v240 offset:32768
    v_mfma_f32_16x16x32_bf16 v[168:171], a[240:243], a[0:3], v[168:171]
    s_mov_b32 s5, 768
    ds_read_b128 a[28:31], v240 offset:33792
    v_mfma_f32_16x16x32_bf16 v[168:171], a[244:247], a[12:15], v[168:171]
    ds_read_b128 a[32:35], v240 offset:34816
    v_mfma_f32_16x16x32_bf16 v[176:179], a[244:247], a[16:19], v[176:179]
    ds_read_b64_tr_b16 a[192:193], v236 offset:32768
    v_mfma_f32_16x16x32_bf16 v[176:179], a[240:243], a[4:7], v[176:179]
    s_mov_b32 s29, 832
    ds_read_b64_tr_b16 a[194:195], v236 offset:33792
    v_mfma_f32_16x16x32_bf16 v[184:187], a[240:243], a[8:11], v[184:187]
    ds_read_b128 a[36:39], v245 offset:0
    v_mfma_f32_16x16x32_bf16 v[184:187], a[244:247], a[20:23], v[184:187]
    s_add_u32 m0, s32, 98304
    ds_read_b128 a[40:43], v245 offset:1024
    v_mfma_f32_16x16x32_bf16 v[188:191], a[248:251], a[8:11], v[188:191]
    ds_read_b128 a[44:47], v245 offset:2048
    v_mfma_f32_16x16x32_bf16 v[188:191], a[252:255], a[20:23], v[188:191]
    ds_read_b64_tr_b16 a[196:197], v241 offset:0
    v_mfma_f32_16x16x32_bf16 v[180:183], a[252:255], a[16:19], v[180:183]
    ds_read_b64_tr_b16 a[198:199], v241 offset:1024
    ds_read_b64_tr_b16 a[200:201], v236 offset:32776
    v_mfma_f32_16x16x32_bf16 v[180:183], a[248:251], a[4:7], v[180:183]
    ds_read_b64_tr_b16 a[202:203], v236 offset:33800
    v_mfma_f32_16x16x32_bf16 v[172:175], a[248:251], a[0:3], v[172:175]
    ds_read_b64_tr_b16 a[204:205], v241 offset:8
    v_mfma_f32_16x16x32_bf16 v[172:175], a[252:255], a[12:15], v[172:175]
    s_waitcnt lgkmcnt(8)
    ds_read_b64_tr_b16 a[206:207], v241 offset:1032
    buffer_load_dwordx4 v228, s[8:11], s5 offen offset:0 lds
    v_mfma_f32_16x16x32_bf16 v[0:3], a[192:195], a[24:27], v[0:3]
    s_waitcnt lgkmcnt(4)
    ds_read_b64_tr_b16 a[208:209], v237 offset:32768
    s_add_u32 m0, s32, 131072
    v_mfma_f32_16x16x32_bf16 v[0:3], a[196:199], a[36:39], v[0:3]
    ds_read_b64_tr_b16 a[210:211], v237 offset:33792
    v_mfma_f32_16x16x32_bf16 v[8:11], a[196:199], a[40:43], v[8:11]
    ds_read_b64_tr_b16 a[212:213], v242 offset:0
    v_mfma_f32_16x16x32_bf16 v[8:11], a[192:195], a[28:31], v[8:11]
    ds_read_b64_tr_b16 a[214:215], v242 offset:1024
    v_mfma_f32_16x16x32_bf16 v[16:19], a[192:195], a[32:35], v[16:19]
    ds_read_b64_tr_b16 a[216:217], v237 offset:32776
    buffer_load_dwordx4 v228, s[8:11], s29 offen offset:0 lds
    v_mfma_f32_16x16x32_bf16 v[16:19], a[196:199], a[44:47], v[16:19]
    s_waitcnt lgkmcnt(7)
    s_add_u32 m0, s32, 98304
    v_mfma_f32_16x16x32_bf16 v[20:23], a[200:203], a[32:35], v[20:23]
    s_waitcnt lgkmcnt(5)
    ds_read_b64_tr_b16 a[218:219], v237 offset:33800
    v_mfma_f32_16x16x32_bf16 v[20:23], a[204:207], a[44:47], v[20:23]
    ds_read_b64_tr_b16 a[220:221], v242 offset:8
    v_mfma_f32_16x16x32_bf16 v[12:15], a[204:207], a[40:43], v[12:15]
    buffer_load_dwordx4 v229, s[8:11], s5 offen offset:1024 lds
    v_mfma_f32_16x16x32_bf16 v[12:15], a[200:203], a[28:31], v[12:15]
    s_add_u32 m0, s32, 131072
    ds_read_b64_tr_b16 a[222:223], v242 offset:1032
    v_mfma_f32_16x16x32_bf16 v[4:7], a[200:203], a[24:27], v[4:7]
    ds_read_b64_tr_b16 a[224:225], v238 offset:32768
    v_mfma_f32_16x16x32_bf16 v[4:7], a[204:207], a[36:39], v[4:7]
    s_waitcnt lgkmcnt(7)
    ds_read_b64_tr_b16 a[226:227], v238 offset:33792
    v_mfma_f32_16x16x32_bf16 v[24:27], a[208:211], a[24:27], v[24:27]
    s_waitcnt lgkmcnt(6)
    buffer_load_dwordx4 v229, s[8:11], s29 offen offset:1024 lds
    v_mfma_f32_16x16x32_bf16 v[24:27], a[212:215], a[36:39], v[24:27]
    s_add_u32 m0, s32, 98304
    ds_read_b64_tr_b16 a[228:229], v243 offset:0
    v_mfma_f32_16x16x32_bf16 v[32:35], a[212:215], a[40:43], v[32:35]
    ds_read_b64_tr_b16 a[230:231], v243 offset:1024
    v_mfma_f32_16x16x32_bf16 v[32:35], a[208:211], a[28:31], v[32:35]
    buffer_load_dwordx4 v230, s[8:11], s5 offen offset:2048 lds
    v_mfma_f32_16x16x32_bf16 v[40:43], a[208:211], a[32:35], v[40:43]
    ds_read_b64_tr_b16 a[232:233], v238 offset:32776
    v_mfma_f32_16x16x32_bf16 v[40:43], a[212:215], a[44:47], v[40:43]
    s_waitcnt lgkmcnt(6)
    ds_read_b64_tr_b16 a[234:235], v238 offset:33800
    v_mfma_f32_16x16x32_bf16 v[44:47], a[216:219], a[32:35], v[44:47]
    s_waitcnt lgkmcnt(6)
    ds_read_b64_tr_b16 a[236:237], v243 offset:8
    v_mfma_f32_16x16x32_bf16 v[44:47], a[220:223], a[44:47], v[44:47]
    s_add_u32 m0, s32, 131072
    v_mfma_f32_16x16x32_bf16 v[36:39], a[220:223], a[40:43], v[36:39]
    ds_read_b64_tr_b16 a[238:239], v243 offset:1032
    v_mfma_f32_16x16x32_bf16 v[36:39], a[216:219], a[28:31], v[36:39]
    ds_read_b64_tr_b16 a[240:241], v239 offset:32768
    v_mfma_f32_16x16x32_bf16 v[28:31], a[216:219], a[24:27], v[28:31]
    buffer_load_dwordx4 v230, s[8:11], s29 offen offset:2048 lds
    v_mfma_f32_16x16x32_bf16 v[28:31], a[220:223], a[36:39], v[28:31]
    s_waitcnt lgkmcnt(6)
    ds_read_b64_tr_b16 a[242:243], v239 offset:33792
    v_mfma_f32_16x16x32_bf16 v[48:51], a[224:227], a[24:27], v[48:51]
    s_waitcnt lgkmcnt(6)
    ds_read_b64_tr_b16 a[244:245], v244 offset:0
    v_mfma_f32_16x16x32_bf16 v[48:51], a[228:231], a[36:39], v[48:51]
    s_add_u32 m0, s37, 147392
    ds_read_b64_tr_b16 a[246:247], v244 offset:1024
    v_mfma_f32_16x16x32_bf16 v[56:59], a[228:231], a[40:43], v[56:59]
    s_mov_b32 s35, 3407872
    v_mfma_f32_16x16x32_bf16 v[56:59], a[224:227], a[28:31], v[56:59]
    ds_read_b64_tr_b16 a[248:249], v239 offset:32776
    v_mfma_f32_16x16x32_bf16 v[64:67], a[224:227], a[32:35], v[64:67]
    s_mov_b32 s36, 3439616
    ds_read_b64_tr_b16 a[250:251], v239 offset:33800
    v_mfma_f32_16x16x32_bf16 v[64:67], a[228:231], a[44:47], v[64:67]
    s_waitcnt lgkmcnt(7)
    v_mfma_f32_16x16x32_bf16 v[68:71], a[232:235], a[32:35], v[68:71]
    s_waitcnt lgkmcnt(6)
    ds_read_b64_tr_b16 a[252:253], v244 offset:8
    v_mfma_f32_16x16x32_bf16 v[68:71], a[236:239], a[44:47], v[68:71]
    ds_read_b64_tr_b16 a[254:255], v244 offset:1032
    v_mfma_f32_16x16x32_bf16 v[60:63], a[236:239], a[40:43], v[60:63]
    ds_read_b64_tr_b16 a[192:193], v236 offset:33024
    v_mfma_f32_16x16x32_bf16 v[60:63], a[232:235], a[28:31], v[60:63]
    buffer_load_dwordx4 v208, s[12:15], s35 offen offset:0 lds
    v_mfma_f32_16x16x32_bf16 v[52:55], a[232:235], a[24:27], v[52:55]
    ds_read_b64_tr_b16 a[194:195], v236 offset:34048
    v_mfma_f32_16x16x32_bf16 v[52:55], a[236:239], a[36:39], v[52:55]
    s_waitcnt lgkmcnt(6)
    ds_read_b64_tr_b16 a[196:197], v241 offset:256
    v_mfma_f32_16x16x32_bf16 v[72:75], a[240:243], a[24:27], v[72:75]
    buffer_load_dwordx4 v209, s[12:15], s35 offen offset:2048 lds
    v_mfma_f32_16x16x32_bf16 v[72:75], a[244:247], a[36:39], v[72:75]
    ds_read_b64_tr_b16 a[198:199], v241 offset:1280
    v_mfma_f32_16x16x32_bf16 v[80:83], a[244:247], a[40:43], v[80:83]
    ds_read_b64_tr_b16 a[200:201], v236 offset:33032
    buffer_load_dwordx4 v208, s[12:15], s36 offen offset:1024 lds
    v_mfma_f32_16x16x32_bf16 v[80:83], a[240:243], a[28:31], v[80:83]
    buffer_load_dwordx4 v209, s[12:15], s36 offen offset:3072 lds
    v_mfma_f32_16x16x32_bf16 v[88:91], a[240:243], a[32:35], v[88:91]
    s_add_u32 m0, s32, 0
    ds_read_b64_tr_b16 a[202:203], v236 offset:34056
    v_mfma_f32_16x16x32_bf16 v[88:91], a[244:247], a[44:47], v[88:91]
    s_waitcnt lgkmcnt(6)
    ds_read_b64_tr_b16 a[204:205], v241 offset:264
    v_mfma_f32_16x16x32_bf16 v[92:95], a[248:251], a[32:35], v[92:95]
    ds_read_b64_tr_b16 a[206:207], v241 offset:1288
    v_mfma_f32_16x16x32_bf16 v[92:95], a[252:255], a[44:47], v[92:95]
    buffer_load_dwordx4 v204, s[16:19], s33 offen offset:0 nt lds
    v_mfma_f32_16x16x32_bf16 v[84:87], a[252:255], a[40:43], v[84:87]
    ds_read_b64_tr_b16 a[208:209], v237 offset:33024
    v_mfma_f32_16x16x32_bf16 v[84:87], a[248:251], a[28:31], v[84:87]
    ds_read_b64_tr_b16 a[210:211], v237 offset:34048
    v_mfma_f32_16x16x32_bf16 v[76:79], a[248:251], a[24:27], v[76:79]
    buffer_load_dwordx4 v205, s[16:19], s33 offen offset:2048 nt lds
    v_mfma_f32_16x16x32_bf16 v[76:79], a[252:255], a[36:39], v[76:79]
    s_waitcnt lgkmcnt(6)
    ds_read_b64_tr_b16 a[212:213], v242 offset:256
    v_mfma_f32_16x16x32_bf16 v[96:99], a[192:195], a[24:27], v[96:99]
    ds_read_b64_tr_b16 a[214:215], v242 offset:1280
    v_mfma_f32_16x16x32_bf16 v[96:99], a[196:199], a[36:39], v[96:99]
    ds_read_b64_tr_b16 a[216:217], v237 offset:33032
    v_mfma_f32_16x16x32_bf16 v[104:107], a[196:199], a[40:43], v[104:107]
    buffer_load_dwordx4 v204, s[16:19], s33 offen offset:1024 nt lds
    v_mfma_f32_16x16x32_bf16 v[104:107], a[192:195], a[28:31], v[104:107]
    ds_read_b64_tr_b16 a[218:219], v237 offset:34056
    v_mfma_f32_16x16x32_bf16 v[112:115], a[192:195], a[32:35], v[112:115]
    ds_read_b64_tr_b16 a[220:221], v242 offset:264
    v_mfma_f32_16x16x32_bf16 v[112:115], a[196:199], a[44:47], v[112:115]
    s_waitcnt lgkmcnt(7)
    buffer_load_dwordx4 v205, s[16:19], s33 offen offset:3072 nt lds
    v_mfma_f32_16x16x32_bf16 v[116:119], a[200:203], a[32:35], v[116:119]
    s_add_u32 s33, s33, 0xb800
    ds_read_b64_tr_b16 a[222:223], v242 offset:1288
    v_mfma_f32_16x16x32_bf16 v[116:119], a[204:207], a[44:47], v[116:119]
    s_andn2_b32 s33, s33, 0xb000
    ds_read_b64_tr_b16 a[224:225], v238 offset:33024
    v_mfma_f32_16x16x32_bf16 v[108:111], a[204:207], a[40:43], v[108:111]
    ds_read_b64_tr_b16 a[226:227], v238 offset:34048
    v_mfma_f32_16x16x32_bf16 v[108:111], a[200:203], a[28:31], v[108:111]
    s_add_u32 m0, s32, 16384
    v_mfma_f32_16x16x32_bf16 v[100:103], a[200:203], a[24:27], v[100:103]
    ds_read_b64_tr_b16 a[228:229], v243 offset:256
    v_mfma_f32_16x16x32_bf16 v[100:103], a[204:207], a[36:39], v[100:103]
    s_waitcnt lgkmcnt(6)
    ds_read_b64_tr_b16 a[230:231], v243 offset:1280
    v_mfma_f32_16x16x32_bf16 v[120:123], a[208:211], a[24:27], v[120:123]
    buffer_load_dwordx4 v204, s[16:19], s33 offen offset:0 nt lds
    v_mfma_f32_16x16x32_bf16 v[120:123], a[212:215], a[36:39], v[120:123]
    ds_read_b64_tr_b16 a[232:233], v238 offset:33032
    v_mfma_f32_16x16x32_bf16 v[128:131], a[212:215], a[40:43], v[128:131]
    ds_read_b64_tr_b16 a[234:235], v238 offset:34056
    v_mfma_f32_16x16x32_bf16 v[128:131], a[208:211], a[28:31], v[128:131]
    ds_read_b64_tr_b16 a[236:237], v243 offset:264
    v_mfma_f32_16x16x32_bf16 v[136:139], a[208:211], a[32:35], v[136:139]
    buffer_load_dwordx4 v205, s[16:19], s33 offen offset:2048 nt lds
    v_mfma_f32_16x16x32_bf16 v[136:139], a[212:215], a[44:47], v[136:139]
    s_waitcnt lgkmcnt(6)
    ds_read_b64_tr_b16 a[238:239], v243 offset:1288
    v_mfma_f32_16x16x32_bf16 v[140:143], a[216:219], a[32:35], v[140:143]
    ds_read_b64_tr_b16 a[240:241], v239 offset:33024
    v_mfma_f32_16x16x32_bf16 v[140:143], a[220:223], a[44:47], v[140:143]
    buffer_load_dwordx4 v204, s[16:19], s33 offen offset:1024 nt lds
    v_mfma_f32_16x16x32_bf16 v[132:135], a[220:223], a[40:43], v[132:135]
    ds_read_b64_tr_b16 a[242:243], v239 offset:34048
    v_mfma_f32_16x16x32_bf16 v[132:135], a[216:219], a[28:31], v[132:135]
    ds_read_b64_tr_b16 a[244:245], v244 offset:256
    v_mfma_f32_16x16x32_bf16 v[124:127], a[216:219], a[24:27], v[124:127]
    ds_read_b64_tr_b16 a[246:247], v244 offset:1280
    buffer_load_dwordx4 v205, s[16:19], s33 offen offset:3072 nt lds
    v_mfma_f32_16x16x32_bf16 v[124:127], a[220:223], a[36:39], v[124:127]
    s_waitcnt lgkmcnt(7)
    s_add_u32 s33, s33, 0xb800
    v_mfma_f32_16x16x32_bf16 v[144:147], a[224:227], a[24:27], v[144:147]
    s_andn2_b32 s33, s33, 0xb000
    ds_read_b64_tr_b16 a[248:249], v239 offset:33032
    v_mfma_f32_16x16x32_bf16 v[144:147], a[228:231], a[36:39], v[144:147]
    ds_read_b64_tr_b16 a[250:251], v239 offset:34056
    v_mfma_f32_16x16x32_bf16 v[152:155], a[228:231], a[40:43], v[152:155]
    buffer_atomic_add v216, v212, s[80:83], 0 offen sc1
    v_mfma_f32_16x16x32_bf16 v[152:155], a[224:227], a[28:31], v[152:155]
    ds_read_b64_tr_b16 a[252:253], v244 offset:264
    v_mfma_f32_16x16x32_bf16 v[160:163], a[224:227], a[32:35], v[160:163]
    ds_read_b64_tr_b16 a[254:255], v244 offset:1288
    v_mfma_f32_16x16x32_bf16 v[160:163], a[228:231], a[44:47], v[160:163]
    s_waitcnt lgkmcnt(7)
    v_mfma_f32_16x16x32_bf16 v[164:167], a[232:235], a[32:35], v[164:167]
    v_mfma_f32_16x16x32_bf16 v[164:167], a[236:239], a[44:47], v[164:167]
    v_mfma_f32_16x16x32_bf16 v[156:159], a[236:239], a[40:43], v[156:159]
    v_mfma_f32_16x16x32_bf16 v[156:159], a[232:235], a[28:31], v[156:159]
    v_mfma_f32_16x16x32_bf16 v[148:151], a[232:235], a[24:27], v[148:151]
    v_mfma_f32_16x16x32_bf16 v[148:151], a[236:239], a[36:39], v[148:151]
    s_waitcnt lgkmcnt(2)
    s_waitcnt vmcnt(9) lgkmcnt(0)
    s_barrier
    ds_read_b128 a[0:3], v245 offset:32768
    v_and_b32 v228, 0xf0, v212
    v_mfma_f32_16x16x32_bf16 v[168:171], a[240:243], a[24:27], v[168:171]
    ds_read_b128 a[4:7], v245 offset:33792
    v_mfma_f32_16x16x32_bf16 v[168:171], a[244:247], a[36:39], v[168:171]
    ds_read_b128 a[8:11], v245 offset:34816
    v_mfma_f32_16x16x32_bf16 v[176:179], a[244:247], a[40:43], v[176:179]
    ds_read_b64_tr_b16 a[192:193], v241 offset:32768
    v_mfma_f32_16x16x32_bf16 v[176:179], a[240:243], a[28:31], v[176:179]
    ds_read_b64_tr_b16 a[194:195], v241 offset:33792
    v_mfma_f32_16x16x32_bf16 v[184:187], a[240:243], a[32:35], v[184:187]
    ds_read_b128 a[12:15], v250 offset:0
    v_mfma_f32_16x16x32_bf16 v[184:187], a[244:247], a[44:47], v[184:187]
    ds_read_b128 a[16:19], v250 offset:1024
    v_mfma_f32_16x16x32_bf16 v[188:191], a[248:251], a[32:35], v[188:191]
    ds_read_b128 a[20:23], v250 offset:2048
    v_mfma_f32_16x16x32_bf16 v[188:191], a[252:255], a[44:47], v[188:191]
    ds_read_b64_tr_b16 a[196:197], v246 offset:0
    v_mfma_f32_16x16x32_bf16 v[180:183], a[252:255], a[40:43], v[180:183]
    ds_read_b64_tr_b16 a[198:199], v246 offset:1024
    ds_read_b64_tr_b16 a[200:201], v241 offset:32776
    v_mfma_f32_16x16x32_bf16 v[180:183], a[248:251], a[28:31], v[180:183]
    ds_read_b64_tr_b16 a[202:203], v241 offset:33800
    v_mfma_f32_16x16x32_bf16 v[172:175], a[248:251], a[24:27], v[172:175]
    ds_read_b64_tr_b16 a[204:205], v246 offset:8
    v_cmp_eq_u32 vcc, 0, v228
    v_mfma_f32_16x16x32_bf16 v[172:175], a[252:255], a[36:39], v[172:175]
    s_waitcnt lgkmcnt(8)
    ds_read_b64_tr_b16 a[206:207], v246 offset:1032
    v_mfma_f32_16x16x32_bf16 v[0:3], a[192:195], a[0:3], v[0:3]
    s_waitcnt lgkmcnt(4)
    ds_read_b64_tr_b16 a[208:209], v242 offset:32768
    v_mfma_f32_16x16x32_bf16 v[0:3], a[196:199], a[12:15], v[0:3]
    ds_read_b64_tr_b16 a[210:211], v242 offset:33792
    v_mfma_f32_16x16x32_bf16 v[8:11], a[196:199], a[16:19], v[8:11]
    ds_read_b64_tr_b16 a[212:213], v247 offset:0
    v_mfma_f32_16x16x32_bf16 v[8:11], a[192:195], a[4:7], v[8:11]
    ds_read_b64_tr_b16 a[214:215], v247 offset:1024
    v_mfma_f32_16x16x32_bf16 v[16:19], a[192:195], a[8:11], v[16:19]
    ds_read_b64_tr_b16 a[216:217], v242 offset:32776
    v_mfma_f32_16x16x32_bf16 v[16:19], a[196:199], a[20:23], v[16:19]
    s_waitcnt lgkmcnt(7)
    v_mfma_f32_16x16x32_bf16 v[20:23], a[200:203], a[8:11], v[20:23]
    s_waitcnt lgkmcnt(5)
    ds_read_b64_tr_b16 a[218:219], v242 offset:33800
    v_mfma_f32_16x16x32_bf16 v[20:23], a[204:207], a[20:23], v[20:23]
    ds_read_b64_tr_b16 a[220:221], v247 offset:8
    v_mfma_f32_16x16x32_bf16 v[12:15], a[204:207], a[16:19], v[12:15]
    v_mfma_f32_16x16x32_bf16 v[12:15], a[200:203], a[4:7], v[12:15]
    ds_read_b64_tr_b16 a[222:223], v247 offset:1032
    v_mfma_f32_16x16x32_bf16 v[4:7], a[200:203], a[0:3], v[4:7]
    ds_read_b64_tr_b16 a[224:225], v243 offset:32768
    v_mov_b32 v229, 0x3f803f80
    v_mfma_f32_16x16x32_bf16 v[4:7], a[204:207], a[12:15], v[4:7]
    s_waitcnt lgkmcnt(7)
    ds_read_b64_tr_b16 a[226:227], v243 offset:33792
    v_mul_f32 v0, s43, v0
    v_mfma_f32_16x16x32_bf16 v[24:27], a[208:211], a[0:3], v[24:27]
    s_waitcnt lgkmcnt(6)
    v_mfma_f32_16x16x32_bf16 v[24:27], a[212:215], a[12:15], v[24:27]
    ds_read_b64_tr_b16 a[228:229], v248 offset:0
    v_mul_f32 v1, s43, v1
    v_mfma_f32_16x16x32_bf16 v[32:35], a[212:215], a[16:19], v[32:35]
    ds_read_b64_tr_b16 a[230:231], v248 offset:1024
    v_mul_f32 v2, s43, v2
    v_mfma_f32_16x16x32_bf16 v[32:35], a[208:211], a[4:7], v[32:35]
    v_mul_f32 v3, s43, v3
    v_mul_f32 v4, s43, v4
    v_mfma_f32_16x16x32_bf16 v[40:43], a[208:211], a[8:11], v[40:43]
    ds_read_b64_tr_b16 a[232:233], v243 offset:32776
    v_mul_f32 v5, s43, v5
    v_mfma_f32_16x16x32_bf16 v[40:43], a[212:215], a[20:23], v[40:43]
    s_waitcnt lgkmcnt(6)
    ds_read_b64_tr_b16 a[234:235], v243 offset:33800
    v_mul_f32 v6, s43, v6
    v_mfma_f32_16x16x32_bf16 v[44:47], a[216:219], a[8:11], v[44:47]
    s_waitcnt lgkmcnt(6)
    ds_read_b64_tr_b16 a[236:237], v248 offset:8
    v_mul_f32 v7, s43, v7
    v_mfma_f32_16x16x32_bf16 v[44:47], a[220:223], a[20:23], v[44:47]
    v_cvt_pk_bf16_f32 v0, v0, v1
    v_cvt_pk_bf16_f32 v1, v2, v3
    v_mfma_f32_16x16x32_bf16 v[36:39], a[220:223], a[16:19], v[36:39]
    ds_read_b64_tr_b16 a[238:239], v248 offset:1032
    v_cvt_pk_bf16_f32 v2, v4, v5
    v_mfma_f32_16x16x32_bf16 v[36:39], a[216:219], a[4:7], v[36:39]
    ds_read_b64_tr_b16 a[240:241], v244 offset:32768
    v_cvt_pk_bf16_f32 v3, v6, v7
    v_mfma_f32_16x16x32_bf16 v[28:31], a[216:219], a[0:3], v[28:31]
    v_mul_f32 v8, s43, v8
    v_mul_f32 v9, s43, v9
    v_mfma_f32_16x16x32_bf16 v[28:31], a[220:223], a[12:15], v[28:31]
    s_waitcnt lgkmcnt(6)
    ds_read_b64_tr_b16 a[242:243], v244 offset:33792
    v_mul_f32 v10, s43, v10
    v_mfma_f32_16x16x32_bf16 v[48:51], a[224:227], a[0:3], v[48:51]
    s_waitcnt lgkmcnt(6)
    ds_read_b64_tr_b16 a[244:245], v249 offset:0
    v_mul_f32 v11, s43, v11
    v_mfma_f32_16x16x32_bf16 v[48:51], a[228:231], a[12:15], v[48:51]
    s_nop 0
    ds_read_b64_tr_b16 a[246:247], v249 offset:1024
    v_mul_f32 v12, s43, v12
    v_mfma_f32_16x16x32_bf16 v[56:59], a[228:231], a[16:19], v[56:59]
    v_mul_f32 v13, s43, v13
    v_mul_f32 v14, s43, v14
    v_mfma_f32_16x16x32_bf16 v[56:59], a[224:227], a[4:7], v[56:59]
    s_add_u32 m0, s32, 65536
    ds_read_b64_tr_b16 a[248:249], v244 offset:32776
    v_mul_f32 v15, s43, v15
    v_mfma_f32_16x16x32_bf16 v[64:67], a[224:227], a[8:11], v[64:67]
    ds_read_b64_tr_b16 a[250:251], v244 offset:33800
    v_cvt_pk_bf16_f32 v4, v8, v9
    v_mfma_f32_16x16x32_bf16 v[64:67], a[228:231], a[20:23], v[64:67]
    s_waitcnt lgkmcnt(7)
    v_cvt_pk_bf16_f32 v5, v10, v11
    v_cvt_pk_bf16_f32 v6, v12, v13
    v_mfma_f32_16x16x32_bf16 v[68:71], a[232:235], a[8:11], v[68:71]
    s_waitcnt lgkmcnt(6)
    ds_read_b64_tr_b16 a[252:253], v249 offset:8
    v_cvt_pk_bf16_f32 v7, v14, v15
    v_mfma_f32_16x16x32_bf16 v[68:71], a[236:239], a[20:23], v[68:71]
    ds_read_b64_tr_b16 a[254:255], v249 offset:1032
    v_mul_f32 v16, s43, v16
    v_mfma_f32_16x16x32_bf16 v[60:63], a[236:239], a[16:19], v[60:63]
    ds_read_b64_tr_b16 a[192:193], v241 offset:33024
    v_mul_f32 v17, s43, v17
    v_mfma_f32_16x16x32_bf16 v[60:63], a[232:235], a[4:7], v[60:63]
    v_mul_f32 v18, s43, v18
    v_mul_f32 v19, s43, v19
    v_mfma_f32_16x16x32_bf16 v[52:55], a[232:235], a[0:3], v[52:55]
    ds_read_b64_tr_b16 a[194:195], v241 offset:34048
    v_mul_f32 v20, s43, v20
    v_mfma_f32_16x16x32_bf16 v[52:55], a[236:239], a[12:15], v[52:55]
    s_waitcnt lgkmcnt(6)
    ds_read_b64_tr_b16 a[196:197], v246 offset:256
    v_mul_f32 v21, s43, v21
    v_mfma_f32_16x16x32_bf16 v[72:75], a[240:243], a[0:3], v[72:75]
    buffer_load_dwordx4 v206, s[20:23], s34 offen offset:0 nt lds
    v_mul_f32 v22, s43, v22
    v_mfma_f32_16x16x32_bf16 v[72:75], a[244:247], a[12:15], v[72:75]
    ds_read_b64_tr_b16 a[198:199], v246 offset:1280
    v_mul_f32 v23, s43, v23
    v_mfma_f32_16x16x32_bf16 v[80:83], a[244:247], a[16:19], v[80:83]
    ds_read_b64_tr_b16 a[200:201], v241 offset:33032
    v_cvt_pk_bf16_f32 v8, v16, v17
    v_mfma_f32_16x16x32_bf16 v[80:83], a[240:243], a[4:7], v[80:83]
    v_cvt_pk_bf16_f32 v9, v18, v19
    v_cvt_pk_bf16_f32 v10, v20, v21
    v_mfma_f32_16x16x32_bf16 v[88:91], a[240:243], a[8:11], v[88:91]
    ds_read_b64_tr_b16 a[202:203], v241 offset:34056
    v_cvt_pk_bf16_f32 v11, v22, v23
    v_mfma_f32_16x16x32_bf16 v[88:91], a[244:247], a[20:23], v[88:91]
    s_waitcnt lgkmcnt(6)
    ds_read_b64_tr_b16 a[204:205], v246 offset:264
    v_mul_f32 v24, s43, v24
    v_mfma_f32_16x16x32_bf16 v[92:95], a[248:251], a[8:11], v[92:95]
    ds_read_b64_tr_b16 a[206:207], v246 offset:1288
    v_mul_f32 v25, s43, v25
    v_mfma_f32_16x16x32_bf16 v[92:95], a[252:255], a[20:23], v[92:95]
    buffer_load_dwordx4 v207, s[20:23], s34 offen offset:2048 nt lds
    v_mul_f32 v26, s43, v26
    v_mfma_f32_16x16x32_bf16 v[84:87], a[252:255], a[16:19], v[84:87]
    ds_read_b64_tr_b16 a[208:209], v242 offset:33024
    v_mul_f32 v27, s43, v27
    v_mfma_f32_16x16x32_bf16 v[84:87], a[248:251], a[4:7], v[84:87]
    ds_read_b64_tr_b16 a[210:211], v242 offset:34048
    v_mul_f32 v28, s43, v28
    v_mfma_f32_16x16x32_bf16 v[76:79], a[248:251], a[0:3], v[76:79]
    v_mul_f32 v29, s43, v29
    v_mul_f32 v30, s43, v30
    v_mfma_f32_16x16x32_bf16 v[76:79], a[252:255], a[12:15], v[76:79]
    s_waitcnt lgkmcnt(6)
    ds_read_b64_tr_b16 a[212:213], v247 offset:256
    v_mul_f32 v31, s43, v31
    v_mfma_f32_16x16x32_bf16 v[96:99], a[192:195], a[0:3], v[96:99]
    ds_read_b64_tr_b16 a[214:215], v247 offset:1280
    v_cvt_pk_bf16_f32 v12, v24, v25
    v_mfma_f32_16x16x32_bf16 v[96:99], a[196:199], a[12:15], v[96:99]
    ds_read_b64_tr_b16 a[216:217], v242 offset:33032
    v_cvt_pk_bf16_f32 v13, v26, v27
    v_mfma_f32_16x16x32_bf16 v[104:107], a[196:199], a[16:19], v[104:107]
    buffer_load_dwordx4 v206, s[20:23], s34 offen offset:1024 nt lds
    v_cvt_pk_bf16_f32 v14, v28, v29
    v_mfma_f32_16x16x32_bf16 v[104:107], a[192:195], a[4:7], v[104:107]
    ds_read_b64_tr_b16 a[218:219], v242 offset:34056
    v_cvt_pk_bf16_f32 v15, v30, v31
    v_mfma_f32_16x16x32_bf16 v[112:115], a[192:195], a[8:11], v[112:115]
    ds_read_b64_tr_b16 a[220:221], v247 offset:264
    v_mul_f32 v32, s43, v32
    v_mfma_f32_16x16x32_bf16 v[112:115], a[196:199], a[20:23], v[112:115]
    s_waitcnt lgkmcnt(7)
    v_mul_f32 v33, s43, v33
    v_mul_f32 v34, s43, v34
    v_mfma_f32_16x16x32_bf16 v[116:119], a[200:203], a[8:11], v[116:119]
    ds_read_b64_tr_b16 a[222:223], v247 offset:1288
    v_mul_f32 v35, s43, v35
    v_mfma_f32_16x16x32_bf16 v[116:119], a[204:207], a[20:23], v[116:119]
    ds_read_b64_tr_b16 a[224:225], v243 offset:33024
    v_mul_f32 v36, s43, v36
    v_mfma_f32_16x16x32_bf16 v[108:111], a[204:207], a[16:19], v[108:111]
    ds_read_b64_tr_b16 a[226:227], v243 offset:34048
    v_mul_f32 v37, s43, v37
    v_mfma_f32_16x16x32_bf16 v[108:111], a[200:203], a[4:7], v[108:111]
    buffer_load_dwordx4 v207, s[20:23], s34 offen offset:3072 nt lds
    v_mul_f32 v38, s43, v38
    v_mfma_f32_16x16x32_bf16 v[100:103], a[200:203], a[0:3], v[100:103]
    ds_read_b64_tr_b16 a[228:229], v248 offset:256
    v_mul_f32 v39, s43, v39
    v_mfma_f32_16x16x32_bf16 v[100:103], a[204:207], a[12:15], v[100:103]
    s_waitcnt lgkmcnt(6)
    ds_read_b64_tr_b16 a[230:231], v248 offset:1280
    v_cvt_pk_bf16_f32 v16, v32, v33
    v_mfma_f32_16x16x32_bf16 v[120:123], a[208:211], a[0:3], v[120:123]
    v_cvt_pk_bf16_f32 v17, v34, v35
    v_cvt_pk_bf16_f32 v18, v36, v37
    v_mfma_f32_16x16x32_bf16 v[120:123], a[212:215], a[12:15], v[120:123]
    ds_read_b64_tr_b16 a[232:233], v243 offset:33032
    v_cvt_pk_bf16_f32 v19, v38, v39
    v_mfma_f32_16x16x32_bf16 v[128:131], a[212:215], a[16:19], v[128:131]
    ds_read_b64_tr_b16 a[234:235], v243 offset:34056
    v_mul_f32 v40, s43, v40
    v_mfma_f32_16x16x32_bf16 v[128:131], a[208:211], a[4:7], v[128:131]
    s_add_u32 s34, s34, 0xb800
    ds_read_b64_tr_b16 a[236:237], v248 offset:264
    v_mul_f32 v41, s43, v41
    v_mfma_f32_16x16x32_bf16 v[136:139], a[208:211], a[8:11], v[136:139]
    v_mul_f32 v42, s43, v42
    v_mul_f32 v43, s43, v43
    v_mfma_f32_16x16x32_bf16 v[136:139], a[212:215], a[20:23], v[136:139]
    s_waitcnt lgkmcnt(6)
    ds_read_b64_tr_b16 a[238:239], v248 offset:1288
    v_mul_f32 v44, s43, v44
    v_mfma_f32_16x16x32_bf16 v[140:143], a[216:219], a[8:11], v[140:143]
    ds_read_b64_tr_b16 a[240:241], v244 offset:33024
    v_mul_f32 v45, s43, v45
    v_mfma_f32_16x16x32_bf16 v[140:143], a[220:223], a[20:23], v[140:143]
    v_mul_f32 v46, s43, v46
    v_mul_f32 v47, s43, v47
    v_mfma_f32_16x16x32_bf16 v[132:135], a[220:223], a[16:19], v[132:135]
    ds_read_b64_tr_b16 a[242:243], v244 offset:34048
    v_cvt_pk_bf16_f32 v20, v40, v41
    v_mfma_f32_16x16x32_bf16 v[132:135], a[216:219], a[4:7], v[132:135]
    ds_read_b64_tr_b16 a[244:245], v249 offset:256
    v_cvt_pk_bf16_f32 v21, v42, v43
    v_mfma_f32_16x16x32_bf16 v[124:127], a[216:219], a[0:3], v[124:127]
    s_andn2_b32 s34, s34, 0xb000
    ds_read_b64_tr_b16 a[246:247], v249 offset:1280
    v_cvt_pk_bf16_f32 v22, v44, v45
    v_mfma_f32_16x16x32_bf16 v[124:127], a[220:223], a[12:15], v[124:127]
    s_waitcnt lgkmcnt(7)
    v_cvt_pk_bf16_f32 v23, v46, v47
    v_cndmask_b32 v228, 0, v229, vcc
    v_mfma_f32_16x16x32_bf16 v[144:147], a[224:227], a[0:3], v[144:147]
    ds_read_b64_tr_b16 a[248:249], v244 offset:33032
    v_mul_f32 v48, s43, v48
    v_mfma_f32_16x16x32_bf16 v[144:147], a[228:231], a[12:15], v[144:147]
    ds_read_b64_tr_b16 a[250:251], v244 offset:34056
    v_mul_f32 v49, s43, v49
    v_mfma_f32_16x16x32_bf16 v[152:155], a[228:231], a[16:19], v[152:155]
    v_mul_f32 v50, s43, v50
    v_mul_f32 v51, s43, v51
    v_mfma_f32_16x16x32_bf16 v[152:155], a[224:227], a[4:7], v[152:155]
    ds_read_b64_tr_b16 a[252:253], v249 offset:264
    v_mul_f32 v52, s43, v52
    v_mfma_f32_16x16x32_bf16 v[160:163], a[224:227], a[8:11], v[160:163]
    ds_read_b64_tr_b16 a[254:255], v249 offset:1288
    v_mul_f32 v53, s43, v53
    v_mfma_f32_16x16x32_bf16 v[160:163], a[228:231], a[20:23], v[160:163]
    s_waitcnt lgkmcnt(7)
    v_mul_f32 v54, s43, v54
    v_mul_f32 v55, s43, v55
    v_mfma_f32_16x16x32_bf16 v[164:167], a[232:235], a[8:11], v[164:167]
    v_cvt_pk_bf16_f32 v48, v48, v49
    v_cvt_pk_bf16_f32 v49, v50, v51
    v_mfma_f32_16x16x32_bf16 v[164:167], a[236:239], a[20:23], v[164:167]
    v_cvt_pk_bf16_f32 v50, v52, v53
    v_cvt_pk_bf16_f32 v51, v54, v55
    v_mfma_f32_16x16x32_bf16 v[156:159], a[236:239], a[16:19], v[156:159]
    v_mul_f32 v56, s43, v56
    v_mul_f32 v57, s43, v57
    v_mfma_f32_16x16x32_bf16 v[156:159], a[232:235], a[4:7], v[156:159]
    v_mul_f32 v58, s43, v58
    v_mul_f32 v59, s43, v59
    v_mfma_f32_16x16x32_bf16 v[148:151], a[232:235], a[0:3], v[148:151]
    v_mul_f32 v60, s43, v60
    v_mul_f32 v61, s43, v61
    v_mfma_f32_16x16x32_bf16 v[148:151], a[236:239], a[12:15], v[148:151]
    s_waitcnt lgkmcnt(2)
    s_waitcnt vmcnt(5) lgkmcnt(0)
    s_barrier
    ds_read_b128 a[192:195], v192 offset:0
    ds_read_b128 a[196:199], v192 offset:1024
    v_mfma_f32_16x16x32_bf16 v[168:171], a[240:243], a[0:3], v[168:171]
    s_add_u32 m0, s32, 81920
    ds_read_b128 a[200:203], v193 offset:0
    ds_read_b128 a[204:207], v193 offset:1024
    v_mfma_f32_16x16x32_bf16 v[168:171], a[244:247], a[12:15], v[168:171]
    ds_read_b128 a[208:211], v194 offset:0
    ds_read_b128 a[212:215], v194 offset:1024
    v_mfma_f32_16x16x32_bf16 v[176:179], a[244:247], a[16:19], v[176:179]
    ds_read_b128 a[216:219], v195 offset:0
    v_mul_f32 v62, s43, v62
    v_mfma_f32_16x16x32_bf16 v[176:179], a[240:243], a[4:7], v[176:179]
    v_mul_f32 v63, s43, v63
    v_cvt_pk_bf16_f32 v52, v56, v57
    v_mfma_f32_16x16x32_bf16 v[184:187], a[240:243], a[8:11], v[184:187]
    ds_read_b128 a[220:223], v195 offset:1024
    v_cvt_pk_bf16_f32 v53, v58, v59
    v_mfma_f32_16x16x32_bf16 v[184:187], a[244:247], a[20:23], v[184:187]
L_hop0_2:
L_pad2:
    s_cbranch_execz L_hopped0
    v_cvt_pk_bf16_f32 v54, v60, v61
    v_cvt_pk_bf16_f32 v55, v62, v63
    v_mfma_f32_16x16x32_bf16 v[188:191], a[248:251], a[8:11], v[188:191]
    v_mul_f32 v64, s43, v64
    v_mul_f32 v65, s43, v65
    v_mfma_f32_16x16x32_bf16 v[188:191], a[252:255], a[20:23], v[188:191]
    ds_read_b128 a[224:227], v192 offset:256
    v_mul_f32 v66, s43, v66
    v_mfma_f32_16x16x32_bf16 v[180:183], a[252:255], a[16:19], v[180:183]
    buffer_load_dwordx4 v206, s[20:23], s34 offen offset:0 nt lds
    v_mul_f32 v67, s43, v67
    v_mfma_f32_16x16x32_bf16 v[180:183], a[248:251], a[4:7], v[180:183]
    v_mul_f32 v68, s43, v68
    v_mul_f32 v69, s43, v69
    v_mfma_f32_16x16x32_bf16 v[172:175], a[248:251], a[0:3], v[172:175]
    ds_read_b128 a[228:231], v192 offset:1280
    v_mul_f32 v70, s43, v70
    v_mfma_f32_16x16x32_bf16 v[172:175], a[252:255], a[12:15], v[172:175]
    s_waitcnt lgkmcnt(4)
    v_mul_f32 v71, s43, v71
    v_cvt_pk_bf16_f32 v56, v64, v65
    v_mfma_f32_16x16x32_bf16 v[24:27], a[192:195], v[0:3], 0
    v_cvt_pk_bf16_f32 v57, v66, v67
    v_cvt_pk_bf16_f32 v58, v68, v69
    v_mfma_f32_16x16x32_bf16 v[28:31], a[192:195], v[4:7], 0
    ds_read_b128 a[232:235], v193 offset:256
    v_cvt_pk_bf16_f32 v59, v70, v71
    v_mfma_f32_16x16x32_bf16 v[32:35], a[192:195], v[8:11], 0
    buffer_load_dwordx4 v207, s[20:23], s34 offen offset:2048 nt lds
    v_mov_b32 v229, v228
    v_mfma_f32_16x16x32_bf16 v[44:47], a[196:199], v[8:11], 0
    ds_read_b128 a[236:239], v193 offset:1280
    v_mul_f32 v72, s43, v72
    v_mfma_f32_16x16x32_bf16 v[40:43], a[196:199], v[4:7], 0
    v_mul_f32 v73, s43, v73
    v_mul_f32 v74, s43, v74
    v_mfma_f32_16x16x32_bf16 v[36:39], a[196:199], v[0:3], 0
    v_mul_f32 v75, s43, v75
    v_mul_f32 v76, s43, v76
    v_mfma_f32_16x16x32_bf16 v[24:27], a[200:203], v[12:15], v[24:27]
    ds_read_b128 a[240:243], v194 offset:256
    v_mul_f32 v77, s43, v77
    v_mfma_f32_16x16x32_bf16 v[28:31], a[200:203], v[16:19], v[28:31]
    v_mul_f32 v78, s43, v78
    v_mul_f32 v79, s43, v79
    v_mfma_f32_16x16x32_bf16 v[32:35], a[200:203], v[20:23], v[32:35]
    v_cvt_pk_bf16_f32 v60, v72, v73
    v_cvt_pk_bf16_f32 v61, v74, v75
    v_mfma_f32_16x16x32_bf16 v[44:47], a[204:207], v[20:23], v[44:47]
    ds_read_b128 a[244:247], v194 offset:1280
    v_cvt_pk_bf16_f32 v62, v76, v77
    v_mfma_f32_16x16x32_bf16 v[40:43], a[204:207], v[16:19], v[40:43]
    buffer_load_dwordx4 v206, s[20:23], s34 offen offset:1024 nt lds
    v_cvt_pk_bf16_f32 v63, v78, v79
    v_mfma_f32_16x16x32_bf16 v[36:39], a[204:207], v[12:15], v[36:39]
    v_mul_f32 v80, s43, v80
    v_mul_f32 v81, s43, v81
    v_mfma_f32_16x16x32_bf16 v[24:27], a[208:211], v[48:51], v[24:27]
    ds_read_b128 a[248:251], v195 offset:256
    v_mul_f32 v82, s43, v82
    v_mfma_f32_16x16x32_bf16 v[28:31], a[208:211], v[52:55], v[28:31]
    v_mul_f32 v83, s43, v83
    v_mul_f32 v84, s43, v84
    v_mfma_f32_16x16x32_bf16 v[32:35], a[208:211], v[56:59], v[32:35]
    v_mul_f32 v85, s43, v85
    v_mul_f32 v86, s43, v86
    v_mfma_f32_16x16x32_bf16 v[44:47], a[212:215], v[56:59], v[44:47]
    ds_read_b128 a[252:255], v195 offset:1280
    v_mul_f32 v87, s43, v87
    v_mfma_f32_16x16x32_bf16 v[40:43], a[212:215], v[52:55], v[40:43]
    buffer_load_dwordx4 v207, s[20:23], s34 offen offset:3072 nt lds
    v_cvt_pk_bf16_f32 v64, v80, v81
    v_mfma_f32_16x16x32_bf16 v[36:39], a[212:215], v[48:51], v[36:39]
    v_cvt_pk_bf16_f32 v65, v82, v83
    v_cvt_pk_bf16_f32 v66, v84, v85
    v_cvt_pk_bf16_f32 v67, v86, v87
    v_mul_f32 v88, s43, v88
    v_mul_f32 v89, s43, v89
    v_pk_mul_f32 v[90:91], v[90:91], s[42:43] op_sel:[0,1] op_sel_hi:[1,1]
    v_pk_mul_f32 v[92:93], v[92:93], s[42:43] op_sel:[0,1] op_sel_hi:[1,1]
    v_pk_mul_f32 v[94:95], v[94:95], s[42:43] op_sel:[0,1] op_sel_hi:[1,1]
    v_cvt_pk_bf16_f32 v68, v88, v89
    v_cvt_pk_bf16_f32 v69, v90, v91
    v_cvt_pk_bf16_f32 v70, v92, v93
    v_cvt_pk_bf16_f32 v71, v94, v95
    s_waitcnt lgkmcnt(3)
    v_mfma_f32_16x16x32_bf16 v[24:27], a[216:219], v[60:63], v[24:27]
    ds_read_b128 a[192:195], v192 offset:16384
    v_mov_b32 v230, v228
    v_mfma_f32_16x16x32_bf16 v[28:31], a[216:219], v[64:67], v[28:31]
    v_mul_f32 v96, s43, v96
    v_mul_f32 v97, s43, v97
    v_mfma_f32_16x16x32_bf16 v[32:35], a[216:219], v[68:71], v[32:35]
    v_mul_f32 v98, s43, v98
    v_mul_f32 v99, s43, v99
    v_mfma_f32_16x16x32_bf16 v[44:47], a[220:223], v[68:71], v[44:47]
    ds_read_b128 a[196:199], v193 offset:16384
    v_mul_f32 v100, s43, v100
    v_mfma_f32_16x16x32_bf16 v[40:43], a[220:223], v[64:67], v[40:43]
    v_mul_f32 v101, s43, v101
    v_mul_f32 v102, s43, v102
    v_mfma_f32_16x16x32_bf16 v[36:39], a[220:223], v[60:63], v[36:39]
    s_add_u32 s34, s34, 0xb800
    v_mul_f32 v103, s43, v103
    v_cvt_pk_bf16_f32 v96, v96, v97
    v_cvt_pk_bf16_f32 v97, v98, v99
    v_cvt_pk_bf16_f32 v98, v100, v101
    v_cvt_pk_bf16_f32 v99, v102, v103
    v_pk_mul_f32 v[104:105], v[104:105], s[42:43] op_sel:[0,1] op_sel_hi:[1,1]
    v_pk_mul_f32 v[106:107], v[106:107], s[42:43] op_sel:[0,1] op_sel_hi:[1,1]
    v_pk_mul_f32 v[108:109], v[108:109], s[42:43] op_sel:[0,1] op_sel_hi:[1,1]
    v_pk_mul_f32 v[110:111], v[110:111], s[42:43] op_sel:[0,1] op_sel_hi:[1,1]
    v_cvt_pk_bf16_f32 v100, v104, v105
    v_cvt_pk_bf16_f32 v101, v106, v107
    v_cvt_pk_bf16_f32 v102, v108, v109
    v_cvt_pk_bf16_f32 v103, v110, v111
    v_pk_mul_f32 v[112:113], v[112:113], s[42:43] op_sel:[0,1] op_sel_hi:[1,1]
    v_pk_mul_f32 v[114:115], v[114:115], s[42:43] op_sel:[0,1] op_sel_hi:[1,1]
    v_pk_mul_f32 v[116:117], v[116:117], s[42:43] op_sel:[0,1] op_sel_hi:[1,1]
    v_pk_mul_f32 v[118:119], v[118:119], s[42:43] op_sel:[0,1] op_sel_hi:[1,1]
    v_cvt_pk_bf16_f32 v104, v112, v113
    v_cvt_pk_bf16_f32 v105, v114, v115
    v_cvt_pk_bf16_f32 v106, v116, v117
    v_cvt_pk_bf16_f32 v107, v118, v119
    v_mfma_f32_16x16x32_bf16 v[24:27], a[224:227], v[96:99], v[24:27]
    ds_read_b128 a[200:203], v194 offset:16384
    v_mov_b32 v231, v228
    v_mfma_f32_16x16x32_bf16 v[28:31], a[224:227], v[100:103], v[28:31]
    v_mul_f32 v120, s43, v120
    v_mul_f32 v121, s43, v121
    v_mfma_f32_16x16x32_bf16 v[32:35], a[224:227], v[104:107], v[32:35]
    v_mul_f32 v122, s43, v122
    v_mul_f32 v123, s43, v123
    v_mfma_f32_16x16x32_bf16 v[44:47], a[228:231], v[104:107], v[44:47]
    ds_read_b128 a[204:207], v195 offset:16384
    v_mul_f32 v124, s43, v124
    v_mfma_f32_16x16x32_bf16 v[40:43], a[228:231], v[100:103], v[40:43]
    v_mul_f32 v125, s43, v125
    v_mul_f32 v126, s43, v126
    v_mfma_f32_16x16x32_bf16 v[36:39], a[228:231], v[96:99], v[36:39]
    v_mul_f32 v127, s43, v127
    v_cvt_pk_bf16_f32 v108, v120, v121
    v_cvt_pk_bf16_f32 v109, v122, v123
    v_cvt_pk_bf16_f32 v110, v124, v125
    v_cvt_pk_bf16_f32 v111, v126, v127
    v_pk_mul_f32 v[128:129], v[128:129], s[42:43] op_sel:[0,1] op_sel_hi:[1,1]
    v_pk_mul_f32 v[130:131], v[130:131], s[42:43] op_sel:[0,1] op_sel_hi:[1,1]
    v_pk_mul_f32 v[132:133], v[132:133], s[42:43] op_sel:[0,1] op_sel_hi:[1,1]
    v_pk_mul_f32 v[134:135], v[134:135], s[42:43] op_sel:[0,1] op_sel_hi:[1,1]
    v_cvt_pk_bf16_f32 v112, v128, v129
    v_cvt_pk_bf16_f32 v113, v130, v131
    v_cvt_pk_bf16_f32 v114, v132, v133
    v_cvt_pk_bf16_f32 v115, v134, v135
    v_pk_mul_f32 v[136:137], v[136:137], s[42:43] op_sel:[0,1] op_sel_hi:[1,1]
    v_pk_mul_f32 v[138:139], v[138:139], s[42:43] op_sel:[0,1] op_sel_hi:[1,1]
    v_pk_mul_f32 v[140:141], v[140:141], s[42:43] op_sel:[0,1] op_sel_hi:[1,1]
    v_pk_mul_f32 v[142:143], v[142:143], s[42:43] op_sel:[0,1] op_sel_hi:[1,1]
    v_cvt_pk_bf16_f32 v116, v136, v137
    v_cvt_pk_bf16_f32 v117, v138, v139
    v_cvt_pk_bf16_f32 v118, v140, v141
    v_cvt_pk_bf16_f32 v119, v142, v143
    v_mfma_f32_16x16x32_bf16 v[24:27], a[232:235], v[108:111], v[24:27]
    s_andn2_b32 s34, s34, 0xb000
    ds_read_b128 a[208:211], v192 offset:16640
    v_mul_f32 v144, s43, v144
    v_mfma_f32_16x16x32_bf16 v[28:31], a[232:235], v[112:115], v[28:31]
    v_mul_f32 v145, s43, v145
    v_mul_f32 v146, s43, v146
    v_mfma_f32_16x16x32_bf16 v[32:35], a[232:235], v[116:119], v[32:35]
    v_mul_f32 v147, s43, v147
    v_mul_f32 v148, s43, v148
    v_mfma_f32_16x16x32_bf16 v[44:47], a[236:239], v[116:119], v[44:47]
    ds_read_b128 a[212:215], v193 offset:16640
    v_mul_f32 v149, s43, v149
    v_mfma_f32_16x16x32_bf16 v[40:43], a[236:239], v[112:115], v[40:43]
    v_mul_f32 v150, s43, v150
    v_mul_f32 v151, s43, v151
    v_mfma_f32_16x16x32_bf16 v[36:39], a[236:239], v[108:111], v[36:39]
    ds_read_b128 a[216:219], v194 offset:16640
    v_cvt_pk_bf16_f32 v144, v144, v145
    v_cvt_pk_bf16_f32 v145, v146, v147
    v_cvt_pk_bf16_f32 v146, v148, v149
    v_cvt_pk_bf16_f32 v147, v150, v151
    v_pk_mul_f32 v[152:153], v[152:153], s[42:43] op_sel:[0,1] op_sel_hi:[1,1]
    v_pk_mul_f32 v[154:155], v[154:155], s[42:43] op_sel:[0,1] op_sel_hi:[1,1]
    v_pk_mul_f32 v[156:157], v[156:157], s[42:43] op_sel:[0,1] op_sel_hi:[1,1]
    v_pk_mul_f32 v[158:159], v[158:159], s[42:43] op_sel:[0,1] op_sel_hi:[1,1]
    v_cvt_pk_bf16_f32 v148, v152, v153
    v_cvt_pk_bf16_f32 v149, v154, v155
    v_cvt_pk_bf16_f32 v150, v156, v157
    v_cvt_pk_bf16_f32 v151, v158, v159
    v_pk_mul_f32 v[160:161], v[160:161], s[42:43] op_sel:[0,1] op_sel_hi:[1,1]
    v_pk_mul_f32 v[162:163], v[162:163], s[42:43] op_sel:[0,1] op_sel_hi:[1,1]
    v_pk_mul_f32 v[164:165], v[164:165], s[42:43] op_sel:[0,1] op_sel_hi:[1,1]
    v_pk_mul_f32 v[166:167], v[166:167], s[42:43] op_sel:[0,1] op_sel_hi:[1,1]
    v_cvt_pk_bf16_f32 v152, v160, v161
    v_cvt_pk_bf16_f32 v153, v162, v163
    v_cvt_pk_bf16_f32 v154, v164, v165
    v_cvt_pk_bf16_f32 v155, v166, v167
    v_mfma_f32_16x16x32_bf16 v[24:27], a[240:243], v[144:147], v[24:27]
    v_mul_f32 v168, s43, v168
    v_mul_f32 v169, s43, v169
    v_mfma_f32_16x16x32_bf16 v[28:31], a[240:243], v[148:151], v[28:31]
    s_add_u32 m0, s32, 32768
    v_mul_f32 v170, s43, v170
    v_mul_f32 v171, s43, v171
    v_mfma_f32_16x16x32_bf16 v[32:35], a[240:243], v[152:155], v[32:35]
    s_waitcnt lgkmcnt(3)
    ds_read_b128 a[220:223], v195 offset:16640
    v_mul_f32 v172, s43, v172
    v_mfma_f32_16x16x32_bf16 v[44:47], a[244:247], v[152:155], v[44:47]
    v_mul_f32 v173, s43, v173
    v_mul_f32 v174, s43, v174
    v_mfma_f32_16x16x32_bf16 v[40:43], a[244:247], v[148:151], v[40:43]
    v_mul_f32 v175, s43, v175
    v_cvt_pk_bf16_f32 v156, v168, v169
    v_mfma_f32_16x16x32_bf16 v[36:39], a[244:247], v[144:147], v[36:39]
    ds_read_b128 a[224:227], v192 offset:17408
    v_cvt_pk_bf16_f32 v157, v170, v171
    v_cvt_pk_bf16_f32 v158, v172, v173
    v_cvt_pk_bf16_f32 v159, v174, v175
    v_mul_f32 v176, s43, v176
    v_mul_f32 v177, s43, v177
    v_pk_mul_f32 v[178:179], v[178:179], s[42:43] op_sel:[0,1] op_sel_hi:[1,1]
    v_pk_mul_f32 v[180:181], v[180:181], s[42:43] op_sel:[0,1] op_sel_hi:[1,1]
    v_pk_mul_f32 v[182:183], v[182:183], s[42:43] op_sel:[0,1] op_sel_hi:[1,1]
    v_cvt_pk_bf16_f32 v160, v176, v177
    v_cvt_pk_bf16_f32 v161, v178, v179
    v_cvt_pk_bf16_f32 v162, v180, v181
    v_cvt_pk_bf16_f32 v163, v182, v183
    v_pk_mul_f32 v[184:185], v[184:185], s[42:43] op_sel:[0,1] op_sel_hi:[1,1]
    v_pk_mul_f32 v[186:187], v[186:187], s[42:43] op_sel:[0,1] op_sel_hi:[1,1]
    v_pk_mul_f32 v[188:189], v[188:189], s[42:43] op_sel:[0,1] op_sel_hi:[1,1]
    v_pk_mul_f32 v[190:191], v[190:191], s[42:43] op_sel:[0,1] op_sel_hi:[1,1]
    v_cvt_pk_bf16_f32 v164, v184, v185
    v_cvt_pk_bf16_f32 v165, v186, v187
    v_cvt_pk_bf16_f32 v166, v188, v189
    v_cvt_pk_bf16_f32 v167, v190, v191
    v_mfma_f32_16x16x32_bf16 v[24:27], a[248:251], v[156:159], v[24:27]
    v_mfma_f32_16x16x32_bf16 v[28:31], a[248:251], v[160:163], v[28:31]
    v_mfma_f32_16x16x32_bf16 v[32:35], a[248:251], v[164:167], v[32:35]
    ds_read_b128 a[228:231], v193 offset:17408
    v_mfma_f32_16x16x32_bf16 v[44:47], a[252:255], v[164:167], v[44:47]
    buffer_load_dwordx4 v204, s[16:19], s33 offen offset:0 nt lds
    v_mfma_f32_16x16x32_bf16 v[40:43], a[252:255], v[160:163], v[40:43]
    v_mfma_f32_16x16x32_bf16 v[36:39], a[252:255], v[156:159], v[36:39]
    ds_read_b128 a[232:235], v194 offset:17408
    v_max_f32 v233, v24, v25
    v_max_f32 v234, v28, v29
    v_max_f32 v235, v32, v33
    v_max3_f32 v233, v233, v26, v27
    v_max3_f32 v234, v234, v30, v31
    v_max3_f32 v235, v235, v34, v35
    s_nop 0
    v_max3_f32 v233, v233, v36, v37
    v_max3_f32 v234, v234, v40, v41
    v_max3_f32 v235, v235, v44, v45
    v_max3_f32 v233, v233, v38, v39
    v_max3_f32 v234, v234, v42, v43
    v_max3_f32 v235, v235, v46, v47
    v_mov_b32 v236, v233
    v_mov_b32 v237, v234
    v_mov_b32 v238, v235
    v_permlane16_swap_b32 v233, v236
    v_permlane16_swap_b32 v234, v237
    v_permlane16_swap_b32 v235, v238
    v_max_f32 v233, v233, v236
    v_max_f32 v234, v234, v237
    v_max_f32 v235, v235, v238
    v_mov_b32 v236, v233
    v_mov_b32 v237, v234
    v_mov_b32 v238, v235
    v_permlane32_swap_b32 v233, v236
    v_permlane32_swap_b32 v234, v237
    v_permlane32_swap_b32 v235, v238
    v_max_f32 v233, v233, v236
    v_max_f32 v234, v234, v237
    v_max_f32 v235, v235, v238
    v_add_f32 v233, 0x42100000, v233
    v_add_f32 v234, 0x42100000, v234
    v_add_f32 v235, 0x42100000, v235
    v_sub_f32 v240, 0, v233
    v_sub_f32 v241, 0, v233
    v_sub_f32 v242, 0, v233
    v_sub_f32 v243, 0, v233
    v_sub_f32 v244, 0, v234
    v_sub_f32 v245, 0, v234
    v_sub_f32 v246, 0, v234
    v_sub_f32 v247, 0, v234
    v_sub_f32 v248, 0, v235
    v_sub_f32 v249, 0, v235
    v_sub_f32 v250, 0, v235
    v_sub_f32 v251, 0, v235
    v_mfma_f32_16x16x32_bf16 v[72:75], a[192:195], v[0:3], v[240:243]
    v_sub_f32 v24, v24, v233
    v_sub_f32 v25, v25, v233
    v_mfma_f32_16x16x32_bf16 v[72:75], a[196:199], v[12:15], v[72:75]
    v_sub_f32 v26, v26, v233
    v_sub_f32 v27, v27, v233
    v_mfma_f32_16x16x32_bf16 v[72:75], a[200:203], v[48:51], v[72:75]
    ds_read_b128 a[236:239], v195 offset:17408
    v_sub_f32 v28, v28, v234
    v_mfma_f32_16x16x32_bf16 v[72:75], a[204:207], v[60:63], v[72:75]
    s_waitcnt lgkmcnt(3)
    buffer_load_dwordx4 v205, s[16:19], s33 offen offset:2048 nt lds
    v_sub_f32 v29, v29, v234
    v_mfma_f32_16x16x32_bf16 v[72:75], a[208:211], v[96:99], v[72:75]
    v_sub_f32 v30, v30, v234
    v_sub_f32 v31, v31, v234
    v_mfma_f32_16x16x32_bf16 v[72:75], a[212:215], v[108:111], v[72:75]
    ds_read_b128 a[240:243], v192 offset:17664
    v_sub_f32 v32, v32, v235
    v_mfma_f32_16x16x32_bf16 v[72:75], a[216:219], v[144:147], v[72:75]
    v_sub_f32 v33, v33, v235
    v_sub_f32 v34, v34, v235
    v_mfma_f32_16x16x32_bf16 v[72:75], a[220:223], v[156:159], v[72:75]
    v_sub_f32 v35, v35, v235
    v_sub_f32 v36, v36, v233
    v_mfma_f32_16x16x32_bf16 v[76:79], a[220:223], v[160:163], v[244:247]
    ds_read_b128 a[244:247], v193 offset:17664
    v_sub_f32 v37, v37, v233
    v_mfma_f32_16x16x32_bf16 v[76:79], a[216:219], v[148:151], v[76:79]
    v_sub_f32 v38, v38, v233
    v_sub_f32 v39, v39, v233
    v_mfma_f32_16x16x32_bf16 v[76:79], a[212:215], v[112:115], v[76:79]
    buffer_load_dwordx4 v204, s[16:19], s33 offen offset:1024 nt lds
    v_sub_f32 v40, v40, v234
    v_mfma_f32_16x16x32_bf16 v[76:79], a[208:211], v[100:103], v[76:79]
    ds_read_b128 a[248:251], v194 offset:17664
    v_sub_f32 v41, v41, v234
    v_mfma_f32_16x16x32_bf16 v[76:79], a[204:207], v[64:67], v[76:79]
    v_sub_f32 v42, v42, v234
    v_sub_f32 v43, v43, v234
    v_mfma_f32_16x16x32_bf16 v[76:79], a[200:203], v[52:55], v[76:79]
    v_sub_f32 v44, v44, v235
    v_sub_f32 v45, v45, v235
    v_mfma_f32_16x16x32_bf16 v[76:79], a[196:199], v[16:19], v[76:79]
    ds_read_b128 a[252:255], v195 offset:17664
    v_sub_f32 v46, v46, v235
    v_mfma_f32_16x16x32_bf16 v[76:79], a[192:195], v[4:7], v[76:79]
    v_sub_f32 v47, v47, v235
    v_mfma_f32_16x16x32_bf16 v[80:83], a[192:195], v[8:11], v[248:251]
    v_exp_f32 v220, v24
    v_mfma_f32_16x16x32_bf16 v[80:83], a[196:199], v[20:23], v[80:83]
    v_exp_f32 v221, v25
    v_mfma_f32_16x16x32_bf16 v[80:83], a[200:203], v[56:59], v[80:83]
    v_exp_f32 v222, v26
    v_mfma_f32_16x16x32_bf16 v[80:83], a[204:207], v[68:71], v[80:83]
    v_exp_f32 v223, v27
    v_mfma_f32_16x16x32_bf16 v[80:83], a[208:211], v[104:107], v[80:83]
    v_exp_f32 v224, v28
    v_mfma_f32_16x16x32_bf16 v[80:83], a[212:215], v[116:119], v[80:83]
    buffer_load_dwordx4 v205, s[16:19], s33 offen offset:3072 nt lds
    v_cvt_pk_bf16_f32 v120, v220, v221
    v_mfma_f32_16x16x32_bf16 v[80:83], a[216:219], v[152:155], v[80:83]
    v_cvt_pk_bf16_f32 v121, v222, v223
    v_mfma_f32_16x16x32_bf16 v[80:83], a[220:223], v[164:167], v[80:83]
    v_exp_f32 v225, v29
    v_mfma_f32_16x16x32_bf16 v[92:95], a[224:227], v[8:11], v[248:251]
    s_waitcnt lgkmcnt(0)
    v_exp_f32 v226, v30
    v_mfma_f32_16x16x32_bf16 v[92:95], a[228:231], v[20:23], v[92:95]
    s_add_u32 s33, s33, 0xb800
    v_or3_b32 v216, v120, v121, 0
    v_mfma_f32_16x16x32_bf16 v[92:95], a[232:235], v[56:59], v[92:95]
    v_exp_f32 v227, v31
    v_mfma_f32_16x16x32_bf16 v[92:95], a[236:239], v[68:71], v[92:95]
    v_exp_f32 v220, v32
    v_mfma_f32_16x16x32_bf16 v[92:95], a[240:243], v[104:107], v[92:95]
    v_cvt_pk_bf16_f32 v124, v224, v225
    v_cvt_pk_bf16_f32 v125, v226, v227
    v_mfma_f32_16x16x32_bf16 v[92:95], a[244:247], v[116:119], v[92:95]
    v_exp_f32 v221, v33
    v_mfma_f32_16x16x32_bf16 v[92:95], a[248:251], v[152:155], v[92:95]
    v_exp_f32 v222, v34
    v_mfma_f32_16x16x32_bf16 v[92:95], a[252:255], v[164:167], v[92:95]
    s_andn2_b32 s33, s33, 0xb000
    v_or3_b32 v216, v124, v125, v216
    v_mfma_f32_16x16x32_bf16 v[88:91], a[252:255], v[160:163], v[244:247]
    v_exp_f32 v223, v35
    v_mfma_f32_16x16x32_bf16 v[88:91], a[248:251], v[148:151], v[88:91]
    v_exp_f32 v224, v44
    v_mfma_f32_16x16x32_bf16 v[88:91], a[244:247], v[112:115], v[88:91]
    v_cvt_pk_bf16_f32 v128, v220, v221
    v_cvt_pk_bf16_f32 v129, v222, v223
    v_mfma_f32_16x16x32_bf16 v[88:91], a[240:243], v[100:103], v[88:91]
    v_exp_f32 v225, v45
    v_mfma_f32_16x16x32_bf16 v[88:91], a[236:239], v[64:67], v[88:91]
    v_exp_f32 v226, v46
    v_mfma_f32_16x16x32_bf16 v[88:91], a[232:235], v[52:55], v[88:91]
    v_or3_b32 v216, v128, v129, v216
    v_mfma_f32_16x16x32_bf16 v[88:91], a[228:231], v[16:19], v[88:91]
    v_exp_f32 v227, v47
    v_mfma_f32_16x16x32_bf16 v[88:91], a[224:227], v[4:7], v[88:91]
    v_exp_f32 v220, v40
    v_mfma_f32_16x16x32_bf16 v[84:87], a[224:227], v[0:3], v[240:243]
    v_cvt_pk_bf16_f32 v130, v224, v225
    v_cvt_pk_bf16_f32 v131, v226, v227
    v_mfma_f32_16x16x32_bf16 v[84:87], a[228:231], v[12:15], v[84:87]
    v_exp_f32 v221, v41
    v_mfma_f32_16x16x32_bf16 v[84:87], a[232:235], v[48:51], v[84:87]
    v_exp_f32 v222, v42
    v_mfma_f32_16x16x32_bf16 v[84:87], a[236:239], v[60:63], v[84:87]
    v_or3_b32 v216, v130, v131, v216
    v_mfma_f32_16x16x32_bf16 v[84:87], a[240:243], v[96:99], v[84:87]
    v_exp_f32 v223, v43
    v_mfma_f32_16x16x32_bf16 v[84:87], a[244:247], v[108:111], v[84:87]
    v_exp_f32 v224, v36
    v_mfma_f32_16x16x32_bf16 v[84:87], a[248:251], v[144:147], v[84:87]
    v_cvt_pk_bf16_f32 v126, v220, v221
    v_cvt_pk_bf16_f32 v127, v222, v223
    v_mfma_f32_16x16x32_bf16 v[84:87], a[252:255], v[156:159], v[84:87]
    v_exp_f32 v225, v37
    v_exp_f32 v226, v38
    s_waitcnt vmcnt(4) lgkmcnt(0)
    s_barrier
    ds_read_b64_tr_b16 a[192:193], v196 offset:0
    ds_read_b64_tr_b16 a[194:195], v196 offset:1024
    ds_read_b64_tr_b16 a[196:197], v197 offset:0
    ds_read_b64_tr_b16 a[198:199], v197 offset:1024
    ds_read_b64_tr_b16 a[200:201], v198 offset:0
    ds_read_b64_tr_b16 a[202:203], v198 offset:1024
    ds_read_b64_tr_b16 a[204:205], v199 offset:0
    ds_read_b64_tr_b16 a[206:207], v199 offset:1024
    ds_read_b64_tr_b16 a[208:209], v200 offset:0
    ds_read_b64_tr_b16 a[210:211], v200 offset:1024
    ds_read_b64_tr_b16 a[212:213], v201 offset:0
    ds_read_b64_tr_b16 a[214:215], v201 offset:1024
    v_or3_b32 v216, v126, v127, v216
    v_exp_f32 v227, v39
    v_exp_f32 v220, v72
    v_cvt_pk_bf16_f32 v122, v224, v225
    v_cvt_pk_bf16_f32 v123, v226, v227
    s_waitcnt lgkmcnt(10)
    s_nop 0
    v_mfma_f32_16x16x32_bf16 a[0:3], a[192:195], v[120:123], 0
    s_waitcnt lgkmcnt(8)
    v_exp_f32 v221, v73
    v_mfma_f32_16x16x32_bf16 a[12:15], a[196:199], v[120:123], 0
    v_exp_f32 v222, v74
    v_mfma_f32_16x16x32_bf16 a[16:19], a[196:199], v[124:127], 0
    buffer_load_dword v239, off, s[80:83], 0 sc1
    v_mbcnt_lo_u32_b32 v213, -1, 0
    v_mfma_f32_16x16x32_bf16 a[4:7], a[192:195], v[124:127], 0
    v_mbcnt_hi_u32_b32 v213, -1, v213
    v_or3_b32 v216, v122, v123, v216
    v_mfma_f32_16x16x32_bf16 a[8:11], a[192:195], v[128:131], 0
    v_exp_f32 v223, v75
    v_mfma_f32_16x16x32_bf16 a[20:23], a[196:199], v[128:131], 0
    s_waitcnt lgkmcnt(6)
    v_exp_f32 v224, v76
    v_mfma_f32_16x16x32_bf16 a[32:35], a[200:203], v[128:131], 0
    s_waitcnt lgkmcnt(4)
    ds_read_b64_tr_b16 a[216:217], v202 offset:0
    v_lshlrev_b32 v208, 12, v213
    v_mfma_f32_16x16x32_bf16 a[44:47], a[204:207], v[128:131], 0
    ds_read_b64_tr_b16 a[218:219], v202 offset:1024
    v_lshlrev_b32 v209, 12, v212
    v_mfma_f32_16x16x32_bf16 a[40:43], a[204:207], v[124:127], 0
    ds_read_b64_tr_b16 a[220:221], v203 offset:0
    v_and_b32 v214, 3, v213
    v_mfma_f32_16x16x32_bf16 a[28:31], a[200:203], v[124:127], 0
    ds_read_b64_tr_b16 a[222:223], v203 offset:1024
    v_lshlrev_b32 v214, 5, v214
    v_mfma_f32_16x16x32_bf16 a[24:27], a[200:203], v[120:123], 0
    ds_read_b64_tr_b16 a[224:225], v196 offset:256
    v_cvt_pk_bf16_f32 v132, v220, v221
    v_mfma_f32_16x16x32_bf16 a[36:39], a[204:207], v[120:123], 0
    s_waitcnt lgkmcnt(5)
    ds_read_b64_tr_b16 a[226:227], v196 offset:1280
    v_cvt_pk_bf16_f32 v133, v222, v223
    v_mfma_f32_16x16x32_bf16 a[48:51], a[208:211], v[120:123], 0
    v_exp_f32 v225, v77
    v_mfma_f32_16x16x32_bf16 a[60:63], a[212:215], v[120:123], 0
    v_exp_f32 v226, v78
    v_mfma_f32_16x16x32_bf16 a[64:67], a[212:215], v[124:127], 0
    ds_read_b64_tr_b16 a[228:229], v197 offset:256
    v_or3_b32 v216, v132, v133, v216
    v_mfma_f32_16x16x32_bf16 a[52:55], a[208:211], v[124:127], 0
    v_exp_f32 v227, v79
    v_mfma_f32_16x16x32_bf16 a[56:59], a[208:211], v[128:131], 0
    v_exp_f32 v220, v80
    v_mfma_f32_16x16x32_bf16 a[68:71], a[212:215], v[128:131], 0
    s_waitcnt lgkmcnt(5)
    ds_read_b64_tr_b16 a[230:231], v197 offset:1280
    v_cvt_pk_bf16_f32 v136, v224, v225
    v_mfma_f32_16x16x32_bf16 a[80:83], a[216:219], v[128:131], 0
    s_waitcnt lgkmcnt(4)
    ds_read_b64_tr_b16 a[232:233], v198 offset:256
    v_cvt_pk_bf16_f32 v137, v226, v227
    v_mfma_f32_16x16x32_bf16 a[92:95], a[220:223], v[128:131], 0
    s_add_u32 m0, s32, 49152
    v_exp_f32 v221, v81
    v_mfma_f32_16x16x32_bf16 a[88:91], a[220:223], v[124:127], 0
    v_exp_f32 v222, v82
    v_mfma_f32_16x16x32_bf16 a[76:79], a[216:219], v[124:127], 0
    ds_read_b64_tr_b16 a[234:235], v198 offset:1280
    buffer_load_dwordx4 v204, s[16:19], s33 offen offset:0 nt lds
    v_mfma_f32_16x16x32_bf16 a[72:75], a[216:219], v[120:123], 0
    ds_read_b64_tr_b16 a[236:237], v199 offset:256
    buffer_load_dwordx4 v205, s[16:19], s33 offen offset:2048 nt lds
    v_mfma_f32_16x16x32_bf16 a[84:87], a[220:223], v[120:123], 0
    s_waitcnt lgkmcnt(5)
    ds_read_b64_tr_b16 a[238:239], v199 offset:1280
    v_or3_b32 v216, v136, v137, v216
    v_mfma_f32_16x16x32_bf16 a[96:99], a[224:227], v[120:123], 0
    s_waitcnt lgkmcnt(4)
    v_exp_f32 v223, v83
    v_mfma_f32_16x16x32_bf16 a[108:111], a[228:231], v[120:123], 0
    v_exp_f32 v224, v92
    v_mfma_f32_16x16x32_bf16 a[112:115], a[228:231], v[124:127], 0
    ds_read_b64_tr_b16 a[240:241], v200 offset:256
    ds_read_b64_tr_b16 a[242:243], v200 offset:1280
    v_mfma_f32_16x16x32_bf16 a[100:103], a[224:227], v[124:127], 0
    ds_read_b64_tr_b16 a[244:245], v201 offset:256
    v_cvt_pk_bf16_f32 v140, v220, v221
    v_mfma_f32_16x16x32_bf16 a[104:107], a[224:227], v[128:131], 0
    ds_read_b64_tr_b16 a[246:247], v201 offset:1280
    v_cvt_pk_bf16_f32 v141, v222, v223
    v_mfma_f32_16x16x32_bf16 a[116:119], a[228:231], v[128:131], 0
    s_waitcnt lgkmcnt(6)
    v_exp_f32 v225, v93
    v_mfma_f32_16x16x32_bf16 a[128:131], a[232:235], v[128:131], 0
    s_waitcnt lgkmcnt(4)
    v_exp_f32 v226, v94
    v_mfma_f32_16x16x32_bf16 a[140:143], a[236:239], v[128:131], 0
    ds_read_b64_tr_b16 a[248:249], v196 offset:16384
    buffer_load_dwordx4 v204, s[16:19], s33 offen offset:1024 nt lds
    v_mfma_f32_16x16x32_bf16 a[136:139], a[236:239], v[124:127], 0
    ds_read_b64_tr_b16 a[250:251], v196 offset:17408
    buffer_load_dwordx4 v205, s[16:19], s33 offen offset:3072 nt lds
    v_mfma_f32_16x16x32_bf16 a[124:127], a[232:235], v[124:127], 0
    ds_read_b64_tr_b16 a[252:253], v197 offset:16384
    v_or3_b32 v216, v140, v141, v216
    v_mfma_f32_16x16x32_bf16 a[120:123], a[232:235], v[120:123], 0
    v_exp_f32 v227, v95
    v_mfma_f32_16x16x32_bf16 a[132:135], a[236:239], v[120:123], 0
    s_waitcnt lgkmcnt(5)
    v_exp_f32 v220, v88
    v_mfma_f32_16x16x32_bf16 a[144:147], a[240:243], v[120:123], 0
    s_waitcnt lgkmcnt(3)
    ds_read_b64_tr_b16 a[254:255], v197 offset:17408
    ds_read_b64_tr_b16 a[192:193], v198 offset:16384
    v_mfma_f32_16x16x32_bf16 a[156:159], a[244:247], v[120:123], 0
    ds_read_b64_tr_b16 a[194:195], v198 offset:17408
    v_cvt_pk_bf16_f32 v142, v224, v225
    v_mfma_f32_16x16x32_bf16 a[160:163], a[244:247], v[124:127], 0
    ds_read_b64_tr_b16 a[196:197], v199 offset:16384
    v_cvt_pk_bf16_f32 v143, v226, v227
    v_mfma_f32_16x16x32_bf16 a[148:151], a[240:243], v[124:127], 0
    v_exp_f32 v221, v89
    v_mfma_f32_16x16x32_bf16 a[152:155], a[240:243], v[128:131], 0
    v_exp_f32 v222, v90
    v_mfma_f32_16x16x32_bf16 a[164:167], a[244:247], v[128:131], 0
    ds_read_b64_tr_b16 a[198:199], v199 offset:17408
    ds_read_b64_tr_b16 a[200:201], v200 offset:16384
    v_or3_b32 v216, v142, v143, v216
    v_exp_f32 v223, v91
    v_exp_f32 v224, v84
    v_cvt_pk_bf16_f32 v138, v220, v221
    v_cvt_pk_bf16_f32 v139, v222, v223
    v_exp_f32 v225, v85
    v_exp_f32 v226, v86
    v_or3_b32 v216, v138, v139, v216
    v_exp_f32 v227, v87
    v_cvt_pk_bf16_f32 v134, v224, v225
    v_cvt_pk_bf16_f32 v135, v226, v227
    v_or3_b32 v216, v134, v135, v216
    v_and_b32 v232, 0x40004000, v216
    v_cmp_ne_u32 vcc, 0, v232
    s_cbranch_vccnz L_slow0
L_back0:
    s_waitcnt lgkmcnt(7)
    v_mfma_f32_16x16x32_bf16 a[8:11], a[248:251], v[140:143], a[8:11]
    s_waitcnt lgkmcnt(5)
    ds_read_b64_tr_b16 a[202:203], v200 offset:17408
    v_mfma_f32_16x16x32_bf16 a[20:23], a[252:255], v[140:143], a[20:23]
    ds_read_b64_tr_b16 a[204:205], v201 offset:16384
    v_mfma_f32_16x16x32_bf16 a[16:19], a[252:255], v[136:139], a[16:19]
    ds_read_b64_tr_b16 a[206:207], v201 offset:17408
    v_mfma_f32_16x16x32_bf16 a[4:7], a[248:251], v[136:139], a[4:7]
    ds_read_b64_tr_b16 a[208:209], v202 offset:16384
    v_mfma_f32_16x16x32_bf16 a[0:3], a[248:251], v[132:135], a[0:3]
    ds_read_b64_tr_b16 a[210:211], v202 offset:17408
    v_mfma_f32_16x16x32_bf16 a[12:15], a[252:255], v[132:135], a[12:15]
    ds_read_b64_tr_b16 a[212:213], v203 offset:16384
    v_mfma_f32_16x16x32_bf16 v[168:171], v[228:231], v[120:123], 0
    ds_read_b64_tr_b16 a[214:215], v203 offset:17408
    v_mfma_f32_16x16x32_bf16 v[168:171], v[228:231], v[132:135], v[168:171]
    ds_read_b64_tr_b16 a[216:217], v196 offset:16640
    v_mfma_f32_16x16x32_bf16 v[172:175], v[228:231], v[136:139], 0
    v_mfma_f32_16x16x32_bf16 v[172:175], v[228:231], v[124:127], v[172:175]
    s_add_u32 s33, s33, 0xb800
    ds_read_b64_tr_b16 a[218:219], v196 offset:17664
    v_mfma_f32_16x16x32_bf16 v[176:179], v[228:231], v[128:131], 0
    ds_read_b64_tr_b16 a[220:221], v197 offset:16640
    v_mfma_f32_16x16x32_bf16 v[176:179], v[228:231], v[140:143], v[176:179]
    s_waitcnt lgkmcnt(8)
    v_mfma_f32_16x16x32_bf16 a[24:27], a[192:195], v[132:135], a[24:27]
    s_andn2_b32 s33, s33, 0xb000
    ds_read_b64_tr_b16 a[222:223], v197 offset:17664
    v_mfma_f32_16x16x32_bf16 a[36:39], a[196:199], v[132:135], a[36:39]
    s_add_u32 m0, s32, 98304
    ds_read_b64_tr_b16 a[224:225], v198 offset:16640
    v_mfma_f32_16x16x32_bf16 a[40:43], a[196:199], v[136:139], a[40:43]
    ds_read_b64_tr_b16 a[226:227], v198 offset:17664
    v_mfma_f32_16x16x32_bf16 a[28:31], a[192:195], v[136:139], a[28:31]
    buffer_load_dwordx4 v206, s[20:23], s34 offen offset:0 nt lds
    v_mfma_f32_16x16x32_bf16 a[32:35], a[192:195], v[140:143], a[32:35]
    ds_read_b64_tr_b16 a[228:229], v199 offset:16640
    v_mfma_f32_16x16x32_bf16 a[44:47], a[196:199], v[140:143], a[44:47]
L_hop0_3:
L_pad3:
    s_cbranch_execz L_hopped0
    ds_read_b64_tr_b16 a[230:231], v199 offset:17664
    v_mfma_f32_16x16x32_bf16 a[56:59], a[200:203], v[140:143], a[56:59]
    s_waitcnt lgkmcnt(7)
    buffer_load_dwordx4 v207, s[20:23], s34 offen offset:2048 nt lds
    v_mfma_f32_16x16x32_bf16 a[68:71], a[204:207], v[140:143], a[68:71]
    ds_read_b64_tr_b16 a[232:233], v200 offset:16640
    v_mfma_f32_16x16x32_bf16 a[64:67], a[204:207], v[136:139], a[64:67]
    ds_read_b64_tr_b16 a[234:235], v200 offset:17664
    v_mfma_f32_16x16x32_bf16 a[52:55], a[200:203], v[136:139], a[52:55]
    ds_read_b64_tr_b16 a[236:237], v201 offset:16640
    v_mfma_f32_16x16x32_bf16 a[48:51], a[200:203], v[132:135], a[48:51]
    v_mfma_f32_16x16x32_bf16 a[60:63], a[204:207], v[132:135], a[60:63]
    ds_read_b64_tr_b16 a[238:239], v201 offset:17664
    v_mfma_f32_16x16x32_bf16 a[72:75], a[208:211], v[132:135], a[72:75]
    ds_read_b64_tr_b16 a[240:241], v202 offset:256
    v_mfma_f32_16x16x32_bf16 a[84:87], a[212:215], v[132:135], a[84:87]
    v_mfma_f32_16x16x32_bf16 a[88:91], a[212:215], v[136:139], a[88:91]
    ds_read_b64_tr_b16 a[242:243], v202 offset:1280
    v_mfma_f32_16x16x32_bf16 a[76:79], a[208:211], v[136:139], a[76:79]
    ds_read_b64_tr_b16 a[244:245], v202 offset:16640
    v_mfma_f32_16x16x32_bf16 a[80:83], a[208:211], v[140:143], a[80:83]
    ds_read_b64_tr_b16 a[246:247], v202 offset:17664
    v_mfma_f32_16x16x32_bf16 a[92:95], a[212:215], v[140:143], a[92:95]
    s_waitcnt lgkmcnt(7)
    v_mfma_f32_16x16x32_bf16 a[104:107], a[216:219], v[140:143], a[104:107]
    ds_read_b64_tr_b16 a[248:249], v203 offset:256
    v_mfma_f32_16x16x32_bf16 a[116:119], a[220:223], v[140:143], a[116:119]
    ds_read_b64_tr_b16 a[250:251], v203 offset:1280
    v_mfma_f32_16x16x32_bf16 a[112:115], a[220:223], v[136:139], a[112:115]
    v_mfma_f32_16x16x32_bf16 a[100:103], a[216:219], v[136:139], a[100:103]
    ds_read_b64_tr_b16 a[252:253], v203 offset:16640
    v_mfma_f32_16x16x32_bf16 a[96:99], a[216:219], v[132:135], a[96:99]
    ds_read_b64_tr_b16 a[254:255], v203 offset:17664
    v_mfma_f32_16x16x32_bf16 a[108:111], a[220:223], v[132:135], a[108:111]
    v_mfma_f32_16x16x32_bf16 a[120:123], a[224:227], v[132:135], a[120:123]
    v_mfma_f32_16x16x32_bf16 a[132:135], a[228:231], v[132:135], a[132:135]
    v_mfma_f32_16x16x32_bf16 a[136:139], a[228:231], v[136:139], a[136:139]
    v_mfma_f32_16x16x32_bf16 a[124:127], a[224:227], v[136:139], a[124:127]
    v_mfma_f32_16x16x32_bf16 a[128:131], a[224:227], v[140:143], a[128:131]
    v_mfma_f32_16x16x32_bf16 a[140:143], a[228:231], v[140:143], a[140:143]
    s_waitcnt lgkmcnt(2)
    v_mfma_f32_16x16x32_bf16 a[152:155], a[232:235], v[140:143], a[152:155]
    buffer_load_dwordx4 v206, s[20:23], s34 offen offset:1024 nt lds
    v_mfma_f32_16x16x32_bf16 a[164:167], a[236:239], v[140:143], a[164:167]
    buffer_load_dwordx4 v207, s[20:23], s34 offen offset:3072 nt lds
    v_mfma_f32_16x16x32_bf16 a[160:163], a[236:239], v[136:139], a[160:163]
    s_add_u32 s34, s34, 0xb800
    v_mfma_f32_16x16x32_bf16 a[148:151], a[232:235], v[136:139], a[148:151]
    s_andn2_b32 s34, s34, 0xb000
    s_mov_b32 s42, 7
    v_mfma_f32_16x16x32_bf16 a[144:147], a[232:235], v[132:135], a[144:147]
    v_mfma_f32_16x16x32_bf16 a[156:159], a[236:239], v[132:135], a[156:159]
    s_mov_b64 exec, 0
    s_cmp_eq_u32 s3, 0
    s_cbranch_scc1 L_hop1_0
    s_cmp_eq_u32 s3, 1
    s_cbranch_scc1 L_hop1_1
    s_cmp_eq_u32 s3, 2
    s_cbranch_scc1 L_hop1_2
    s_branch L_hop1_3
L_hopped1:
    s_mov_b64 exec, -1
.p2align 6
L_loop:
    s_waitcnt vmcnt(4) lgkmcnt(0)
    s_barrier
    ds_read_b128 a[192:195], v192 offset:32768
    ds_read_b128 a[196:199], v193 offset:32768
    v_mfma_f32_16x16x32_bf16 a[168:171], a[240:243], v[120:123], a[168:171]
    ds_read_b128 a[200:203], v194 offset:32768
    ds_read_b128 a[204:207], v195 offset:32768
    v_mfma_f32_16x16x32_bf16 a[168:171], a[244:247], v[132:135], a[168:171]
    ds_read_b128 a[208:211], v192 offset:33024
    ds_read_b128 a[212:215], v193 offset:33024
    v_mfma_f32_16x16x32_bf16 a[172:175], a[244:247], v[136:139], a[172:175]
    ds_read_b128 a[216:219], v194 offset:33024
    v_mfma_f32_16x16x32_bf16 a[172:175], a[240:243], v[124:127], a[172:175]
    v_mfma_f32_16x16x32_bf16 a[176:179], a[240:243], v[128:131], a[176:179]
    ds_read_b128 a[220:223], v195 offset:33024
    v_mfma_f32_16x16x32_bf16 a[176:179], a[244:247], v[140:143], a[176:179]
    v_mfma_f32_16x16x32_bf16 a[188:191], a[248:251], v[128:131], a[188:191]
    v_mfma_f32_16x16x32_bf16 a[188:191], a[252:255], v[140:143], a[188:191]
    ds_read_b128 a[224:227], v192 offset:33792
    v_mfma_f32_16x16x32_bf16 a[184:187], a[252:255], v[136:139], a[184:187]
    v_mfma_f32_16x16x32_bf16 a[184:187], a[248:251], v[124:127], a[184:187]
    v_mfma_f32_16x16x32_bf16 a[180:183], a[248:251], v[120:123], a[180:183]
    ds_read_b128 a[228:231], v193 offset:33792
    v_mfma_f32_16x16x32_bf16 a[180:183], a[252:255], v[132:135], a[180:183]
    s_waitcnt lgkmcnt(4)
    v_mfma_f32_16x16x32_bf16 v[24:27], a[192:195], v[0:3], v[240:243]
    v_mfma_f32_16x16x32_bf16 v[24:27], a[196:199], v[12:15], v[24:27]
    ds_read_b128 a[232:235], v194 offset:33792
    v_mfma_f32_16x16x32_bf16 v[24:27], a[200:203], v[48:51], v[24:27]
    v_mfma_f32_16x16x32_bf16 v[24:27], a[204:207], v[60:63], v[24:27]
    ds_read_b128 a[236:239], v195 offset:33792
    v_mfma_f32_16x16x32_bf16 v[24:27], a[208:211], v[96:99], v[24:27]
    v_mfma_f32_16x16x32_bf16 v[24:27], a[212:215], v[108:111], v[24:27]
    s_waitcnt lgkmcnt(3)
    v_mfma_f32_16x16x32_bf16 v[24:27], a[216:219], v[144:147], v[24:27]
    ds_read_b128 a[240:243], v192 offset:34048
    v_mfma_f32_16x16x32_bf16 v[24:27], a[220:223], v[156:159], v[24:27]
    v_mfma_f32_16x16x32_bf16 v[28:31], a[220:223], v[160:163], v[244:247]
    v_mfma_f32_16x16x32_bf16 v[28:31], a[216:219], v[148:151], v[28:31]
    ds_read_b128 a[244:247], v193 offset:34048
    v_mfma_f32_16x16x32_bf16 v[28:31], a[212:215], v[112:115], v[28:31]
    v_mfma_f32_16x16x32_bf16 v[28:31], a[208:211], v[100:103], v[28:31]
    s_nop 2
    v_exp_f32 v220, v24
    v_mfma_f32_16x16x32_bf16 v[28:31], a[204:207], v[64:67], v[28:31]
    v_exp_f32 v221, v25
    v_mfma_f32_16x16x32_bf16 v[28:31], a[200:203], v[52:55], v[28:31]
    v_exp_f32 v222, v26
    v_mfma_f32_16x16x32_bf16 v[28:31], a[196:199], v[16:19], v[28:31]
    s_add_u32 m0, s32, 114688
    v_exp_f32 v223, v27
    v_mfma_f32_16x16x32_bf16 v[28:31], a[192:195], v[4:7], v[28:31]
    ds_read_b128 a[248:251], v194 offset:34048
    v_mfma_f32_16x16x32_bf16 v[32:35], a[192:195], v[8:11], v[248:251]
    ds_read_b128 a[252:255], v195 offset:34048
    v_mfma_f32_16x16x32_bf16 v[32:35], a[196:199], v[20:23], v[32:35]
    buffer_load_dwordx4 v206, s[20:23], s34 offen offset:0 nt lds
    v_mfma_f32_16x16x32_bf16 v[32:35], a[200:203], v[56:59], v[32:35]
    ds_read_b128 a[192:195], v192 offset:49152
    v_mfma_f32_16x16x32_bf16 v[32:35], a[204:207], v[68:71], v[32:35]
    buffer_load_dwordx4 v207, s[20:23], s34 offen offset:2048 nt lds
    v_mfma_f32_16x16x32_bf16 v[32:35], a[208:211], v[104:107], v[32:35]
    v_exp_f32 v224, v28
    v_mfma_f32_16x16x32_bf16 v[32:35], a[212:215], v[116:119], v[32:35]
    ds_read_b128 a[196:199], v193 offset:49152
    v_cvt_pk_bf16_f32 v120, v220, v221
    v_mfma_f32_16x16x32_bf16 v[32:35], a[216:219], v[152:155], v[32:35]
    v_cvt_pk_bf16_f32 v121, v222, v223
    v_mfma_f32_16x16x32_bf16 v[32:35], a[220:223], v[164:167], v[32:35]
    v_exp_f32 v225, v29
    v_mfma_f32_16x16x32_bf16 v[44:47], a[224:227], v[8:11], v[248:251]
    s_waitcnt lgkmcnt(4)
    v_exp_f32 v226, v30
    v_mfma_f32_16x16x32_bf16 v[44:47], a[228:231], v[20:23], v[44:47]
    ds_read_b128 a[200:203], v194 offset:49152
    v_or3_b32 v216, v120, v121, 0
    v_mfma_f32_16x16x32_bf16 v[44:47], a[232:235], v[56:59], v[44:47]
    v_exp_f32 v227, v31
    v_mfma_f32_16x16x32_bf16 v[44:47], a[236:239], v[68:71], v[44:47]
    ds_read_b128 a[204:207], v195 offset:49152
    v_mfma_f32_16x16x32_bf16 v[44:47], a[240:243], v[104:107], v[44:47]
    buffer_load_dwordx4 v206, s[20:23], s34 offen offset:1024 nt lds
    v_mfma_f32_16x16x32_bf16 v[44:47], a[244:247], v[116:119], v[44:47]
    s_waitcnt lgkmcnt(3)
    buffer_load_dwordx4 v207, s[20:23], s34 offen offset:3072 nt lds
    v_mfma_f32_16x16x32_bf16 v[44:47], a[248:251], v[152:155], v[44:47]
    v_exp_f32 v220, v32
    v_mfma_f32_16x16x32_bf16 v[44:47], a[252:255], v[164:167], v[44:47]
    ds_read_b128 a[208:211], v192 offset:49408
    v_cvt_pk_bf16_f32 v124, v224, v225
    v_mfma_f32_16x16x32_bf16 v[40:43], a[252:255], v[160:163], v[244:247]
    v_cvt_pk_bf16_f32 v125, v226, v227
    v_mfma_f32_16x16x32_bf16 v[40:43], a[248:251], v[148:151], v[40:43]
    v_exp_f32 v221, v33
    v_mfma_f32_16x16x32_bf16 v[40:43], a[244:247], v[112:115], v[40:43]
    v_exp_f32 v222, v34
    v_mfma_f32_16x16x32_bf16 v[40:43], a[240:243], v[100:103], v[40:43]
    ds_read_b128 a[212:215], v193 offset:49408
    v_or3_b32 v216, v124, v125, v216
    v_mfma_f32_16x16x32_bf16 v[40:43], a[236:239], v[64:67], v[40:43]
    v_exp_f32 v223, v35
    v_mfma_f32_16x16x32_bf16 v[40:43], a[232:235], v[52:55], v[40:43]
    ds_read_b128 a[216:219], v194 offset:49408
    v_mfma_f32_16x16x32_bf16 v[40:43], a[228:231], v[16:19], v[40:43]
    v_exp_f32 v224, v44
    v_mfma_f32_16x16x32_bf16 v[40:43], a[224:227], v[4:7], v[40:43]
    ds_read_b128 a[220:223], v195 offset:49408
    v_cvt_pk_bf16_f32 v128, v220, v221
    v_mfma_f32_16x16x32_bf16 v[36:39], a[224:227], v[0:3], v[240:243]
    v_cvt_pk_bf16_f32 v129, v222, v223
    v_mfma_f32_16x16x32_bf16 v[36:39], a[228:231], v[12:15], v[36:39]
    v_exp_f32 v225, v45
    v_mfma_f32_16x16x32_bf16 v[36:39], a[232:235], v[48:51], v[36:39]
    v_exp_f32 v226, v46
    v_mfma_f32_16x16x32_bf16 v[36:39], a[236:239], v[60:63], v[36:39]
    ds_read_b128 a[224:227], v192 offset:50176
    v_or3_b32 v216, v128, v129, v216
    v_mfma_f32_16x16x32_bf16 v[36:39], a[240:243], v[96:99], v[36:39]
    v_exp_f32 v227, v47
    v_mfma_f32_16x16x32_bf16 v[36:39], a[244:247], v[108:111], v[36:39]
    v_exp_f32 v220, v40
    v_mfma_f32_16x16x32_bf16 v[36:39], a[248:251], v[144:147], v[36:39]
    ds_read_b128 a[228:231], v193 offset:50176
    v_cvt_pk_bf16_f32 v130, v224, v225
    v_mfma_f32_16x16x32_bf16 v[36:39], a[252:255], v[156:159], v[36:39]
    ds_read_b128 a[232:235], v194 offset:50176
    v_cvt_pk_bf16_f32 v131, v226, v227
    v_mfma_f32_16x16x32_bf16 v[72:75], a[192:195], v[0:3], v[240:243]
    s_waitcnt lgkmcnt(4)
    v_exp_f32 v221, v41
    v_mfma_f32_16x16x32_bf16 v[72:75], a[196:199], v[12:15], v[72:75]
    v_exp_f32 v222, v42
    v_mfma_f32_16x16x32_bf16 v[72:75], a[200:203], v[48:51], v[72:75]
    ds_read_b128 a[236:239], v195 offset:50176
    v_or3_b32 v216, v130, v131, v216
    v_mfma_f32_16x16x32_bf16 v[72:75], a[204:207], v[60:63], v[72:75]
    v_exp_f32 v223, v43
    v_mfma_f32_16x16x32_bf16 v[72:75], a[208:211], v[96:99], v[72:75]
    v_exp_f32 v224, v36
    v_mfma_f32_16x16x32_bf16 v[72:75], a[212:215], v[108:111], v[72:75]
    s_add_u32 s34, s34, 0xb800
    ds_read_b128 a[240:243], v192 offset:50432
    v_cvt_pk_bf16_f32 v126, v220, v221
    v_mfma_f32_16x16x32_bf16 v[72:75], a[216:219], v[144:147], v[72:75]
    s_waitcnt lgkmcnt(4)
    v_cvt_pk_bf16_f32 v127, v222, v223
    v_mfma_f32_16x16x32_bf16 v[72:75], a[220:223], v[156:159], v[72:75]
    s_andn2_b32 s34, s34, 0xb000
    v_exp_f32 v225, v37
    v_mfma_f32_16x16x32_bf16 v[76:79], a[220:223], v[160:163], v[244:247]
    s_add_u32 m0, s32, 0
    v_exp_f32 v226, v38
    v_mfma_f32_16x16x32_bf16 v[76:79], a[216:219], v[148:151], v[76:79]
    ds_read_b128 a[244:247], v193 offset:50432
    v_or3_b32 v216, v126, v127, v216
    v_mfma_f32_16x16x32_bf16 v[76:79], a[212:215], v[112:115], v[76:79]
    v_exp_f32 v227, v39
    v_mfma_f32_16x16x32_bf16 v[76:79], a[208:211], v[100:103], v[76:79]
    ds_read_b128 a[248:251], v194 offset:50432
    v_mfma_f32_16x16x32_bf16 v[76:79], a[204:207], v[64:67], v[76:79]
    buffer_load_dwordx4 v204, s[16:19], s33 offen offset:0 nt lds
    v_mfma_f32_16x16x32_bf16 v[76:79], a[200:203], v[52:55], v[76:79]
    buffer_load_dwordx4 v205, s[16:19], s33 offen offset:2048 nt lds
    v_mfma_f32_16x16x32_bf16 v[76:79], a[196:199], v[16:19], v[76:79]
    v_exp_f32 v220, v72
    v_mfma_f32_16x16x32_bf16 v[76:79], a[192:195], v[4:7], v[76:79]
    ds_read_b128 a[252:255], v195 offset:50432
    v_cvt_pk_bf16_f32 v122, v224, v225
    v_mfma_f32_16x16x32_bf16 v[80:83], a[192:195], v[8:11], v[248:251]
    v_cvt_pk_bf16_f32 v123, v226, v227
    v_mfma_f32_16x16x32_bf16 v[80:83], a[196:199], v[20:23], v[80:83]
    v_exp_f32 v221, v73
    v_mfma_f32_16x16x32_bf16 v[80:83], a[200:203], v[56:59], v[80:83]
    v_exp_f32 v222, v74
    v_mfma_f32_16x16x32_bf16 v[80:83], a[204:207], v[68:71], v[80:83]
    v_or3_b32 v216, v122, v123, v216
    v_mfma_f32_16x16x32_bf16 v[80:83], a[208:211], v[104:107], v[80:83]
    v_exp_f32 v223, v75
    v_mfma_f32_16x16x32_bf16 v[80:83], a[212:215], v[116:119], v[80:83]
    v_exp_f32 v224, v76
    v_mfma_f32_16x16x32_bf16 v[80:83], a[216:219], v[152:155], v[80:83]
    v_cvt_pk_bf16_f32 v132, v220, v221
    v_cvt_pk_bf16_f32 v133, v222, v223
    v_mfma_f32_16x16x32_bf16 v[80:83], a[220:223], v[164:167], v[80:83]
    v_exp_f32 v225, v77
    v_mfma_f32_16x16x32_bf16 v[92:95], a[224:227], v[8:11], v[248:251]
    s_waitcnt lgkmcnt(1)
    v_exp_f32 v226, v78
    v_mfma_f32_16x16x32_bf16 v[92:95], a[228:231], v[20:23], v[92:95]
    v_or3_b32 v216, v132, v133, v216
    v_mfma_f32_16x16x32_bf16 v[92:95], a[232:235], v[56:59], v[92:95]
    v_exp_f32 v227, v79
    v_mfma_f32_16x16x32_bf16 v[92:95], a[236:239], v[68:71], v[92:95]
    v_exp_f32 v220, v80
    v_mfma_f32_16x16x32_bf16 v[92:95], a[240:243], v[104:107], v[92:95]
    v_cvt_pk_bf16_f32 v136, v224, v225
    v_cvt_pk_bf16_f32 v137, v226, v227
    v_mfma_f32_16x16x32_bf16 v[92:95], a[244:247], v[116:119], v[92:95]
    v_exp_f32 v221, v81
    v_mfma_f32_16x16x32_bf16 v[92:95], a[248:251], v[152:155], v[92:95]
    s_waitcnt lgkmcnt(0)
    v_exp_f32 v222, v82
    v_mfma_f32_16x16x32_bf16 v[92:95], a[252:255], v[164:167], v[92:95]
    v_or3_b32 v216, v136, v137, v216
    v_mfma_f32_16x16x32_bf16 v[88:91], a[252:255], v[160:163], v[244:247]
    v_exp_f32 v223, v83
    v_mfma_f32_16x16x32_bf16 v[88:91], a[248:251], v[148:151], v[88:91]
    v_mfma_f32_16x16x32_bf16 v[88:91], a[244:247], v[112:115], v[88:91]
    v_mfma_f32_16x16x32_bf16 v[88:91], a[240:243], v[100:103], v[88:91]
    s_nop 1
    v_exp_f32 v224, v92
    v_mfma_f32_16x16x32_bf16 v[88:91], a[236:239], v[64:67], v[88:91]
    v_cvt_pk_bf16_f32 v140, v220, v221
    v_cvt_pk_bf16_f32 v141, v222, v223
    v_mfma_f32_16x16x32_bf16 v[88:91], a[232:235], v[52:55], v[88:91]
    v_exp_f32 v225, v93
    v_mfma_f32_16x16x32_bf16 v[88:91], a[228:231], v[16:19], v[88:91]
    v_exp_f32 v226, v94
    v_mfma_f32_16x16x32_bf16 v[88:91], a[224:227], v[4:7], v[88:91]
    v_or3_b32 v216, v140, v141, v216
    v_mfma_f32_16x16x32_bf16 v[84:87], a[224:227], v[0:3], v[240:243]
    v_exp_f32 v227, v95
    v_mfma_f32_16x16x32_bf16 v[84:87], a[228:231], v[12:15], v[84:87]
    v_mfma_f32_16x16x32_bf16 v[84:87], a[232:235], v[48:51], v[84:87]
    buffer_load_dwordx4 v204, s[16:19], s33 offen offset:1024 nt lds
    v_mfma_f32_16x16x32_bf16 v[84:87], a[236:239], v[60:63], v[84:87]
    buffer_load_dwordx4 v205, s[16:19], s33 offen offset:3072 nt lds
    v_mfma_f32_16x16x32_bf16 v[84:87], a[240:243], v[96:99], v[84:87]
    s_add_u32 s33, s33, 0xb800
    v_exp_f32 v220, v88
    v_mfma_f32_16x16x32_bf16 v[84:87], a[244:247], v[108:111], v[84:87]
    s_andn2_b32 s33, s33, 0xb000
    v_cvt_pk_bf16_f32 v142, v224, v225
    v_cvt_pk_bf16_f32 v143, v226, v227
    v_mfma_f32_16x16x32_bf16 v[84:87], a[248:251], v[144:147], v[84:87]
    v_exp_f32 v221, v89
    v_mfma_f32_16x16x32_bf16 v[84:87], a[252:255], v[156:159], v[84:87]
    v_exp_f32 v222, v90
    v_or3_b32 v216, v142, v143, v216
    v_exp_f32 v223, v91
    s_nop 4
    v_exp_f32 v224, v84
    v_cvt_pk_bf16_f32 v138, v220, v221
    v_cvt_pk_bf16_f32 v139, v222, v223
    v_exp_f32 v225, v85
    v_exp_f32 v226, v86
    v_or3_b32 v216, v138, v139, v216
    v_exp_f32 v227, v87
    v_cvt_pk_bf16_f32 v134, v224, v225
    s_waitcnt vmcnt(4) lgkmcnt(0)
    s_barrier
    ds_read_b64_tr_b16 a[192:193], v196 offset:32768
    ds_read_b64_tr_b16 a[194:195], v196 offset:33792
    ds_read_b64_tr_b16 a[196:197], v196 offset:49152
    ds_read_b64_tr_b16 a[198:199], v196 offset:50176
    ds_read_b64_tr_b16 a[200:201], v197 offset:32768
    ds_read_b64_tr_b16 a[202:203], v197 offset:33792
    ds_read_b64_tr_b16 a[204:205], v197 offset:49152
    ds_read_b64_tr_b16 a[206:207], v197 offset:50176
    ds_read_b64_tr_b16 a[208:209], v198 offset:32768
    ds_read_b64_tr_b16 a[210:211], v198 offset:33792
    ds_read_b64_tr_b16 a[212:213], v198 offset:49152
    ds_read_b64_tr_b16 a[214:215], v198 offset:50176
    v_cvt_pk_bf16_f32 v135, v226, v227
    v_or3_b32 v216, v134, v135, v216
    v_and_b32 v232, 0x40004000, v216
    v_cmp_ne_u32 vcc, 0, v232
    s_cbranch_vccnz L_slow1
L_back1:
    s_waitcnt lgkmcnt(10)
    v_mfma_f32_16x16x32_bf16 a[0:3], a[192:195], v[120:123], a[0:3]
    s_waitcnt lgkmcnt(8)
    v_mfma_f32_16x16x32_bf16 a[0:3], a[196:199], v[132:135], a[0:3]
    v_mfma_f32_16x16x32_bf16 a[4:7], a[196:199], v[136:139], a[4:7]
    v_mfma_f32_16x16x32_bf16 a[4:7], a[192:195], v[124:127], a[4:7]
    v_mfma_f32_16x16x32_bf16 a[8:11], a[192:195], v[128:131], a[8:11]
    ds_read_b64_tr_b16 a[216:217], v199 offset:32768
    v_mfma_f32_16x16x32_bf16 a[8:11], a[196:199], v[140:143], a[8:11]
    v_mfma_f32_16x16x32_bf16 v[168:171], v[228:231], v[120:123], v[168:171]
    ds_read_b64_tr_b16 a[218:219], v199 offset:33792
    v_mfma_f32_16x16x32_bf16 v[168:171], v[228:231], v[132:135], v[168:171]
    ds_read_b64_tr_b16 a[220:221], v199 offset:49152
    v_mfma_f32_16x16x32_bf16 v[172:175], v[228:231], v[136:139], v[172:175]
    v_mfma_f32_16x16x32_bf16 v[172:175], v[228:231], v[124:127], v[172:175]
    ds_read_b64_tr_b16 a[222:223], v199 offset:50176
    v_mfma_f32_16x16x32_bf16 v[176:179], v[228:231], v[128:131], v[176:179]
    ds_read_b64_tr_b16 a[224:225], v200 offset:32768
    v_mfma_f32_16x16x32_bf16 v[176:179], v[228:231], v[140:143], v[176:179]
    s_waitcnt lgkmcnt(5)
    ds_read_b64_tr_b16 a[226:227], v200 offset:33792
    v_mfma_f32_16x16x32_bf16 a[20:23], a[200:203], v[128:131], a[20:23]
    v_mfma_f32_16x16x32_bf16 a[20:23], a[204:207], v[140:143], a[20:23]
    ds_read_b64_tr_b16 a[228:229], v200 offset:49152
    v_mfma_f32_16x16x32_bf16 a[16:19], a[204:207], v[136:139], a[16:19]
    ds_read_b64_tr_b16 a[230:231], v200 offset:50176
    v_mfma_f32_16x16x32_bf16 a[16:19], a[200:203], v[124:127], a[16:19]
    v_mfma_f32_16x16x32_bf16 a[12:15], a[200:203], v[120:123], a[12:15]
    ds_read_b64_tr_b16 a[232:233], v201 offset:32768
    v_mfma_f32_16x16x32_bf16 a[12:15], a[204:207], v[132:135], a[12:15]
    s_add_u32 m0, s32, 16384
    ds_read_b64_tr_b16 a[234:235], v201 offset:33792
    v_mfma_f32_16x16x32_bf16 a[24:27], a[208:211], v[120:123], a[24:27]
    ds_read_b64_tr_b16 a[236:237], v201 offset:49152
    v_mfma_f32_16x16x32_bf16 a[24:27], a[212:215], v[132:135], a[24:27]
    buffer_load_dwordx4 v204, s[16:19], s33 offen offset:0 nt lds
    v_mfma_f32_16x16x32_bf16 a[28:31], a[212:215], v[136:139], a[28:31]
    ds_read_b64_tr_b16 a[238:239], v201 offset:50176
    v_mfma_f32_16x16x32_bf16 a[28:31], a[208:211], v[124:127], a[28:31]
    ds_read_b64_tr_b16 a[240:241], v202 offset:32768
    v_mfma_f32_16x16x32_bf16 a[32:35], a[208:211], v[128:131], a[32:35]
    buffer_load_dwordx4 v205, s[16:19], s33 offen offset:2048 nt lds
    v_mfma_f32_16x16x32_bf16 a[32:35], a[212:215], v[140:143], a[32:35]
    s_waitcnt lgkmcnt(6)
    ds_read_b64_tr_b16 a[242:243], v202 offset:33792
    v_mfma_f32_16x16x32_bf16 a[44:47], a[216:219], v[128:131], a[44:47]
    ds_read_b64_tr_b16 a[244:245], v202 offset:49152
    v_mfma_f32_16x16x32_bf16 a[44:47], a[220:223], v[140:143], a[44:47]
    ds_read_b64_tr_b16 a[246:247], v202 offset:50176
    v_mfma_f32_16x16x32_bf16 a[40:43], a[220:223], v[136:139], a[40:43]
    v_mfma_f32_16x16x32_bf16 a[40:43], a[216:219], v[124:127], a[40:43]
    ds_read_b64_tr_b16 a[248:249], v203 offset:32768
    v_mfma_f32_16x16x32_bf16 a[36:39], a[216:219], v[120:123], a[36:39]
    ds_read_b64_tr_b16 a[250:251], v203 offset:33792
    v_mfma_f32_16x16x32_bf16 a[36:39], a[220:223], v[132:135], a[36:39]
    buffer_load_dwordx4 v204, s[16:19], s33 offen offset:1024 nt lds
    v_mfma_f32_16x16x32_bf16 a[48:51], a[224:227], v[120:123], a[48:51]
    s_waitcnt lgkmcnt(6)
    ds_read_b64_tr_b16 a[252:253], v203 offset:49152
    v_mfma_f32_16x16x32_bf16 a[48:51], a[228:231], v[132:135], a[48:51]
    ds_read_b64_tr_b16 a[254:255], v203 offset:50176
    buffer_load_dwordx4 v205, s[16:19], s33 offen offset:3072 nt lds
    v_mfma_f32_16x16x32_bf16 a[52:55], a[228:231], v[136:139], a[52:55]
    ds_read_b64_tr_b16 a[192:193], v196 offset:33024
    v_mfma_f32_16x16x32_bf16 a[52:55], a[224:227], v[124:127], a[52:55]
    v_mfma_f32_16x16x32_bf16 a[56:59], a[224:227], v[128:131], a[56:59]
    ds_read_b64_tr_b16 a[194:195], v196 offset:34048
    v_mfma_f32_16x16x32_bf16 a[56:59], a[228:231], v[140:143], a[56:59]
    ds_read_b64_tr_b16 a[196:197], v196 offset:49408
    v_mfma_f32_16x16x32_bf16 a[68:71], a[232:235], v[128:131], a[68:71]
    v_mfma_f32_16x16x32_bf16 a[68:71], a[236:239], v[140:143], a[68:71]
    ds_read_b64_tr_b16 a[198:199], v196 offset:50432
    v_mfma_f32_16x16x32_bf16 a[64:67], a[236:239], v[136:139], a[64:67]
    ds_read_b64_tr_b16 a[200:201], v197 offset:33024
    v_mfma_f32_16x16x32_bf16 a[64:67], a[232:235], v[124:127], a[64:67]
    v_mfma_f32_16x16x32_bf16 a[60:63], a[232:235], v[120:123], a[60:63]
    ds_read_b64_tr_b16 a[202:203], v197 offset:34048
    v_mfma_f32_16x16x32_bf16 a[60:63], a[236:239], v[132:135], a[60:63]
    s_waitcnt lgkmcnt(6)
    ds_read_b64_tr_b16 a[204:205], v197 offset:49408
    v_mfma_f32_16x16x32_bf16 a[72:75], a[240:243], v[120:123], a[72:75]
    ds_read_b64_tr_b16 a[206:207], v197 offset:50432
    v_mfma_f32_16x16x32_bf16 a[72:75], a[244:247], v[132:135], a[72:75]
    v_mfma_f32_16x16x32_bf16 a[76:79], a[244:247], v[136:139], a[76:79]
    ds_read_b64_tr_b16 a[208:209], v198 offset:33024
    v_mfma_f32_16x16x32_bf16 a[76:79], a[240:243], v[124:127], a[76:79]
    ds_read_b64_tr_b16 a[210:211], v198 offset:34048
    v_mfma_f32_16x16x32_bf16 a[80:83], a[240:243], v[128:131], a[80:83]
    v_mfma_f32_16x16x32_bf16 a[80:83], a[244:247], v[140:143], a[80:83]
    ds_read_b64_tr_b16 a[212:213], v198 offset:49408
    v_mfma_f32_16x16x32_bf16 a[92:95], a[248:251], v[128:131], a[92:95]
    ds_read_b64_tr_b16 a[214:215], v198 offset:50432
    v_mfma_f32_16x16x32_bf16 a[92:95], a[252:255], v[140:143], a[92:95]
    ds_read_b64_tr_b16 a[216:217], v199 offset:33024
    v_mfma_f32_16x16x32_bf16 a[88:91], a[252:255], v[136:139], a[88:91]
    v_mfma_f32_16x16x32_bf16 a[88:91], a[248:251], v[124:127], a[88:91]
    s_add_u32 s33, s33, 0xb800
    ds_read_b64_tr_b16 a[218:219], v199 offset:34048
    v_mfma_f32_16x16x32_bf16 a[84:87], a[248:251], v[120:123], a[84:87]
    ds_read_b64_tr_b16 a[220:221], v199 offset:49408
    v_mfma_f32_16x16x32_bf16 a[84:87], a[252:255], v[132:135], a[84:87]
    s_waitcnt lgkmcnt(7)
    v_mfma_f32_16x16x32_bf16 a[96:99], a[192:195], v[120:123], a[96:99]
    s_andn2_b32 s33, s33, 0xb000
    ds_read_b64_tr_b16 a[222:223], v199 offset:50432
    v_mfma_f32_16x16x32_bf16 a[96:99], a[196:199], v[132:135], a[96:99]
    s_add_u32 m0, s32, 65536
    ds_read_b64_tr_b16 a[224:225], v200 offset:33024
    v_mfma_f32_16x16x32_bf16 a[100:103], a[196:199], v[136:139], a[100:103]
    ds_read_b64_tr_b16 a[226:227], v200 offset:34048
    v_mfma_f32_16x16x32_bf16 a[100:103], a[192:195], v[124:127], a[100:103]
    buffer_load_dwordx4 v206, s[20:23], s34 offen offset:0 nt lds
    v_mfma_f32_16x16x32_bf16 a[104:107], a[192:195], v[128:131], a[104:107]
    ds_read_b64_tr_b16 a[228:229], v200 offset:49408
    v_mfma_f32_16x16x32_bf16 a[104:107], a[196:199], v[140:143], a[104:107]
    ds_read_b64_tr_b16 a[230:231], v200 offset:50432
    v_mfma_f32_16x16x32_bf16 a[116:119], a[200:203], v[128:131], a[116:119]
    buffer_load_dwordx4 v207, s[20:23], s34 offen offset:2048 nt lds
    v_mfma_f32_16x16x32_bf16 a[116:119], a[204:207], v[140:143], a[116:119]
    ds_read_b64_tr_b16 a[232:233], v201 offset:33024
    v_mfma_f32_16x16x32_bf16 a[112:115], a[204:207], v[136:139], a[112:115]
    ds_read_b64_tr_b16 a[234:235], v201 offset:34048
    v_mfma_f32_16x16x32_bf16 a[112:115], a[200:203], v[124:127], a[112:115]
    ds_read_b64_tr_b16 a[236:237], v201 offset:49408
    v_mfma_f32_16x16x32_bf16 a[108:111], a[200:203], v[120:123], a[108:111]
    v_mfma_f32_16x16x32_bf16 a[108:111], a[204:207], v[132:135], a[108:111]
    s_waitcnt lgkmcnt(6)
    ds_read_b64_tr_b16 a[238:239], v201 offset:50432
    v_mfma_f32_16x16x32_bf16 a[120:123], a[208:211], v[120:123], a[120:123]
    ds_read_b64_tr_b16 a[240:241], v202 offset:33024
    v_mfma_f32_16x16x32_bf16 a[120:123], a[212:215], v[132:135], a[120:123]
    v_mfma_f32_16x16x32_bf16 a[124:127], a[212:215], v[136:139], a[124:127]
    ds_read_b64_tr_b16 a[242:243], v202 offset:34048
    v_mfma_f32_16x16x32_bf16 a[124:127], a[208:211], v[124:127], a[124:127]
    ds_read_b64_tr_b16 a[244:245], v202 offset:49408
    v_mfma_f32_16x16x32_bf16 a[128:131], a[208:211], v[128:131], a[128:131]
    ds_read_b64_tr_b16 a[246:247], v202 offset:50432
    v_mfma_f32_16x16x32_bf16 a[128:131], a[212:215], v[140:143], a[128:131]
    v_mfma_f32_16x16x32_bf16 a[140:143], a[216:219], v[128:131], a[140:143]
    ds_read_b64_tr_b16 a[248:249], v203 offset:33024
    v_mfma_f32_16x16x32_bf16 a[140:143], a[220:223], v[140:143], a[140:143]
    ds_read_b64_tr_b16 a[250:251], v203 offset:34048
    v_mfma_f32_16x16x32_bf16 a[136:139], a[220:223], v[136:139], a[136:139]
    v_mfma_f32_16x16x32_bf16 a[136:139], a[216:219], v[124:127], a[136:139]
    ds_read_b64_tr_b16 a[252:253], v203 offset:49408
    v_mfma_f32_16x16x32_bf16 a[132:135], a[216:219], v[120:123], a[132:135]
    ds_read_b64_tr_b16 a[254:255], v203 offset:50432
    v_mfma_f32_16x16x32_bf16 a[132:135], a[220:223], v[132:135], a[132:135]
    s_waitcnt lgkmcnt(7)
    v_mfma_f32_16x16x32_bf16 a[144:147], a[224:227], v[120:123], a[144:147]
    v_mfma_f32_16x16x32_bf16 a[144:147], a[228:231], v[132:135], a[144:147]
    v_mfma_f32_16x16x32_bf16 a[148:151], a[228:231], v[136:139], a[148:151]
    v_mfma_f32_16x16x32_bf16 a[148:151], a[224:227], v[124:127], a[148:151]
    v_mfma_f32_16x16x32_bf16 a[152:155], a[224:227], v[128:131], a[152:155]
    v_mfma_f32_16x16x32_bf16 a[152:155], a[228:231], v[140:143], a[152:155]
    v_mfma_f32_16x16x32_bf16 a[164:167], a[232:235], v[128:131], a[164:167]
    buffer_load_dwordx4 v206, s[20:23], s34 offen offset:1024 nt lds
    v_mfma_f32_16x16x32_bf16 a[164:167], a[236:239], v[140:143], a[164:167]
    buffer_load_dwordx4 v207, s[20:23], s34 offen offset:3072 nt lds
    v_mfma_f32_16x16x32_bf16 a[160:163], a[236:239], v[136:139], a[160:163]
    s_add_u32 s34, s34, 0xb800
    v_mfma_f32_16x16x32_bf16 a[160:163], a[232:235], v[124:127], a[160:163]
    s_andn2_b32 s34, s34, 0xb000
    v_mfma_f32_16x16x32_bf16 a[156:159], a[232:235], v[120:123], a[156:159]
    v_mfma_f32_16x16x32_bf16 a[156:159], a[236:239], v[132:135], a[156:159]
    s_waitcnt lgkmcnt(0)
    s_waitcnt vmcnt(4) lgkmcnt(0)
    s_barrier
    ds_read_b128 a[192:195], v192 offset:0
    ds_read_b128 a[196:199], v193 offset:0
    v_mfma_f32_16x16x32_bf16 a[168:171], a[240:243], v[120:123], a[168:171]
    ds_read_b128 a[200:203], v194 offset:0
    ds_read_b128 a[204:207], v195 offset:0
    v_mfma_f32_16x16x32_bf16 a[168:171], a[244:247], v[132:135], a[168:171]
    ds_read_b128 a[208:211], v192 offset:256
    ds_read_b128 a[212:215], v193 offset:256
    v_mfma_f32_16x16x32_bf16 a[172:175], a[244:247], v[136:139], a[172:175]
    ds_read_b128 a[216:219], v194 offset:256
    v_mfma_f32_16x16x32_bf16 a[172:175], a[240:243], v[124:127], a[172:175]
    v_mfma_f32_16x16x32_bf16 a[176:179], a[240:243], v[128:131], a[176:179]
    ds_read_b128 a[220:223], v195 offset:256
    v_mfma_f32_16x16x32_bf16 a[176:179], a[244:247], v[140:143], a[176:179]
    v_mfma_f32_16x16x32_bf16 a[188:191], a[248:251], v[128:131], a[188:191]
    v_mfma_f32_16x16x32_bf16 a[188:191], a[252:255], v[140:143], a[188:191]
    ds_read_b128 a[224:227], v192 offset:1024
    v_mfma_f32_16x16x32_bf16 a[184:187], a[252:255], v[136:139], a[184:187]
    v_mfma_f32_16x16x32_bf16 a[184:187], a[248:251], v[124:127], a[184:187]
    v_mfma_f32_16x16x32_bf16 a[180:183], a[248:251], v[120:123], a[180:183]
    ds_read_b128 a[228:231], v193 offset:1024
    v_mfma_f32_16x16x32_bf16 a[180:183], a[252:255], v[132:135], a[180:183]
    s_waitcnt lgkmcnt(4)
    v_mfma_f32_16x16x32_bf16 v[24:27], a[192:195], v[0:3], v[240:243]
    v_mfma_f32_16x16x32_bf16 v[24:27], a[196:199], v[12:15], v[24:27]
    ds_read_b128 a[232:235], v194 offset:1024
    v_mfma_f32_16x16x32_bf16 v[24:27], a[200:203], v[48:51], v[24:27]
    v_mfma_f32_16x16x32_bf16 v[24:27], a[204:207], v[60:63], v[24:27]
    ds_read_b128 a[236:239], v195 offset:1024
    v_mfma_f32_16x16x32_bf16 v[24:27], a[208:211], v[96:99], v[24:27]
    v_mfma_f32_16x16x32_bf16 v[24:27], a[212:215], v[108:111], v[24:27]
    s_waitcnt lgkmcnt(3)
    v_mfma_f32_16x16x32_bf16 v[24:27], a[216:219], v[144:147], v[24:27]
    ds_read_b128 a[240:243], v192 offset:1280
    v_mfma_f32_16x16x32_bf16 v[24:27], a[220:223], v[156:159], v[24:27]
    v_mfma_f32_16x16x32_bf16 v[28:31], a[220:223], v[160:163], v[244:247]
    v_mfma_f32_16x16x32_bf16 v[28:31], a[216:219], v[148:151], v[28:31]
    ds_read_b128 a[244:247], v193 offset:1280
    v_mfma_f32_16x16x32_bf16 v[28:31], a[212:215], v[112:115], v[28:31]
    v_mfma_f32_16x16x32_bf16 v[28:31], a[208:211], v[100:103], v[28:31]
    s_nop 2
    v_exp_f32 v220, v24
    v_mfma_f32_16x16x32_bf16 v[28:31], a[204:207], v[64:67], v[28:31]
    v_exp_f32 v221, v25
    v_mfma_f32_16x16x32_bf16 v[28:31], a[200:203], v[52:55], v[28:31]
    v_exp_f32 v222, v26
    v_mfma_f32_16x16x32_bf16 v[28:31], a[196:199], v[16:19], v[28:31]
    s_add_u32 m0, s32, 81920
    v_exp_f32 v223, v27
    v_mfma_f32_16x16x32_bf16 v[28:31], a[192:195], v[4:7], v[28:31]
    ds_read_b128 a[248:251], v194 offset:1280
    v_mfma_f32_16x16x32_bf16 v[32:35], a[192:195], v[8:11], v[248:251]
    ds_read_b128 a[252:255], v195 offset:1280
    v_mfma_f32_16x16x32_bf16 v[32:35], a[196:199], v[20:23], v[32:35]
    buffer_load_dwordx4 v206, s[20:23], s34 offen offset:0 nt lds
    v_mfma_f32_16x16x32_bf16 v[32:35], a[200:203], v[56:59], v[32:35]
    ds_read_b128 a[192:195], v192 offset:16384
    v_mfma_f32_16x16x32_bf16 v[32:35], a[204:207], v[68:71], v[32:35]
    buffer_load_dwordx4 v207, s[20:23], s34 offen offset:2048 nt lds
    v_mfma_f32_16x16x32_bf16 v[32:35], a[208:211], v[104:107], v[32:35]
    v_exp_f32 v224, v28
    v_mfma_f32_16x16x32_bf16 v[32:35], a[212:215], v[116:119], v[32:35]
    ds_read_b128 a[196:199], v193 offset:16384
    v_cvt_pk_bf16_f32 v120, v220, v221
    v_mfma_f32_16x16x32_bf16 v[32:35], a[216:219], v[152:155], v[32:35]
L_pad4:
    s_cbranch_execz L_hopped0
    v_cvt_pk_bf16_f32 v121, v222, v223
    v_mfma_f32_16x16x32_bf16 v[32:35], a[220:223], v[164:167], v[32:35]
    v_exp_f32 v225, v29
    v_mfma_f32_16x16x32_bf16 v[44:47], a[224:227], v[8:11], v[248:251]
    s_waitcnt lgkmcnt(4)
    v_exp_f32 v226, v30
    v_mfma_f32_16x16x32_bf16 v[44:47], a[228:231], v[20:23], v[44:47]
    ds_read_b128 a[200:203], v194 offset:16384
    v_or3_b32 v216, v120, v121, 0
    v_mfma_f32_16x16x32_bf16 v[44:47], a[232:235], v[56:59], v[44:47]
    v_exp_f32 v227, v31
    v_mfma_f32_16x16x32_bf16 v[44:47], a[236:239], v[68:71], v[44:47]
    ds_read_b128 a[204:207], v195 offset:16384
    v_mfma_f32_16x16x32_bf16 v[44:47], a[240:243], v[104:107], v[44:47]
    buffer_load_dwordx4 v206, s[20:23], s34 offen offset:1024 nt lds
    v_mfma_f32_16x16x32_bf16 v[44:47], a[244:247], v[116:119], v[44:47]
    s_waitcnt lgkmcnt(3)
    buffer_load_dwordx4 v207, s[20:23], s34 offen offset:3072 nt lds
    v_mfma_f32_16x16x32_bf16 v[44:47], a[248:251], v[152:155], v[44:47]
    v_exp_f32 v220, v32
    v_mfma_f32_16x16x32_bf16 v[44:47], a[252:255], v[164:167], v[44:47]
    ds_read_b128 a[208:211], v192 offset:16640
    v_cvt_pk_bf16_f32 v124, v224, v225
    v_mfma_f32_16x16x32_bf16 v[40:43], a[252:255], v[160:163], v[244:247]
    v_cvt_pk_bf16_f32 v125, v226, v227
    v_mfma_f32_16x16x32_bf16 v[40:43], a[248:251], v[148:151], v[40:43]
    v_exp_f32 v221, v33
    v_mfma_f32_16x16x32_bf16 v[40:43], a[244:247], v[112:115], v[40:43]
    v_exp_f32 v222, v34
    v_mfma_f32_16x16x32_bf16 v[40:43], a[240:243], v[100:103], v[40:43]
    ds_read_b128 a[212:215], v193 offset:16640
    v_or3_b32 v216, v124, v125, v216
    v_mfma_f32_16x16x32_bf16 v[40:43], a[236:239], v[64:67], v[40:43]
    v_exp_f32 v223, v35
    v_mfma_f32_16x16x32_bf16 v[40:43], a[232:235], v[52:55], v[40:43]
    ds_read_b128 a[216:219], v194 offset:16640
    v_mfma_f32_16x16x32_bf16 v[40:43], a[228:231], v[16:19], v[40:43]
    v_exp_f32 v224, v44
    v_mfma_f32_16x16x32_bf16 v[40:43], a[224:227], v[4:7], v[40:43]
    ds_read_b128 a[220:223], v195 offset:16640
    v_cvt_pk_bf16_f32 v128, v220, v221
    v_mfma_f32_16x16x32_bf16 v[36:39], a[224:227], v[0:3], v[240:243]
    v_cvt_pk_bf16_f32 v129, v222, v223
    v_mfma_f32_16x16x32_bf16 v[36:39], a[228:231], v[12:15], v[36:39]
    v_exp_f32 v225, v45
    v_mfma_f32_16x16x32_bf16 v[36:39], a[232:235], v[48:51], v[36:39]
    v_exp_f32 v226, v46
    v_mfma_f32_16x16x32_bf16 v[36:39], a[236:239], v[60:63], v[36:39]
    ds_read_b128 a[224:227], v192 offset:17408
    v_or3_b32 v216, v128, v129, v216
    v_mfma_f32_16x16x32_bf16 v[36:39], a[240:243], v[96:99], v[36:39]
    v_exp_f32 v227, v47
    v_mfma_f32_16x16x32_bf16 v[36:39], a[244:247], v[108:111], v[36:39]
    v_exp_f32 v220, v40
    v_mfma_f32_16x16x32_bf16 v[36:39], a[248:251], v[144:147], v[36:39]
    ds_read_b128 a[228:231], v193 offset:17408
    v_cvt_pk_bf16_f32 v130, v224, v225
    v_mfma_f32_16x16x32_bf16 v[36:39], a[252:255], v[156:159], v[36:39]
    ds_read_b128 a[232:235], v194 offset:17408
    v_cvt_pk_bf16_f32 v131, v226, v227
    v_mfma_f32_16x16x32_bf16 v[72:75], a[192:195], v[0:3], v[240:243]
    s_waitcnt lgkmcnt(4)
    v_exp_f32 v221, v41
    v_mfma_f32_16x16x32_bf16 v[72:75], a[196:199], v[12:15], v[72:75]
    v_exp_f32 v222, v42
    v_mfma_f32_16x16x32_bf16 v[72:75], a[200:203], v[48:51], v[72:75]
    ds_read_b128 a[236:239], v195 offset:17408
    v_or3_b32 v216, v130, v131, v216
    v_mfma_f32_16x16x32_bf16 v[72:75], a[204:207], v[60:63], v[72:75]
    v_exp_f32 v223, v43
    v_mfma_f32_16x16x32_bf16 v[72:75], a[208:211], v[96:99], v[72:75]
    v_exp_f32 v224, v36
    v_mfma_f32_16x16x32_bf16 v[72:75], a[212:215], v[108:111], v[72:75]
    s_add_u32 s34, s34, 0xb800
    ds_read_b128 a[240:243], v192 offset:17664
    v_cvt_pk_bf16_f32 v126, v220, v221
    v_mfma_f32_16x16x32_bf16 v[72:75], a[216:219], v[144:147], v[72:75]
    s_waitcnt lgkmcnt(4)
    v_cvt_pk_bf16_f32 v127, v222, v223
    v_mfma_f32_16x16x32_bf16 v[72:75], a[220:223], v[156:159], v[72:75]
    s_andn2_b32 s34, s34, 0xb000
    v_exp_f32 v225, v37
    v_mfma_f32_16x16x32_bf16 v[76:79], a[220:223], v[160:163], v[244:247]
    s_add_u32 m0, s32, 32768
    v_exp_f32 v226, v38
    v_mfma_f32_16x16x32_bf16 v[76:79], a[216:219], v[148:151], v[76:79]
    ds_read_b128 a[244:247], v193 offset:17664
    v_or3_b32 v216, v126, v127, v216
    v_mfma_f32_16x16x32_bf16 v[76:79], a[212:215], v[112:115], v[76:79]
    v_exp_f32 v227, v39
    v_mfma_f32_16x16x32_bf16 v[76:79], a[208:211], v[100:103], v[76:79]
    ds_read_b128 a[248:251], v194 offset:17664
    v_mfma_f32_16x16x32_bf16 v[76:79], a[204:207], v[64:67], v[76:79]
    buffer_load_dwordx4 v204, s[16:19], s33 offen offset:0 nt lds
    v_mfma_f32_16x16x32_bf16 v[76:79], a[200:203], v[52:55], v[76:79]
    buffer_load_dwordx4 v205, s[16:19], s33 offen offset:2048 nt lds
    v_mfma_f32_16x16x32_bf16 v[76:79], a[196:199], v[16:19], v[76:79]
    v_exp_f32 v220, v72
    v_mfma_f32_16x16x32_bf16 v[76:79], a[192:195], v[4:7], v[76:79]
    ds_read_b128 a[252:255], v195 offset:17664
    v_cvt_pk_bf16_f32 v122, v224, v225
    v_mfma_f32_16x16x32_bf16 v[80:83], a[192:195], v[8:11], v[248:251]
    v_cvt_pk_bf16_f32 v123, v226, v227
    v_mfma_f32_16x16x32_bf16 v[80:83], a[196:199], v[20:23], v[80:83]
    v_exp_f32 v221, v73
    v_mfma_f32_16x16x32_bf16 v[80:83], a[200:203], v[56:59], v[80:83]
    v_exp_f32 v222, v74
    v_mfma_f32_16x16x32_bf16 v[80:83], a[204:207], v[68:71], v[80:83]
    v_or3_b32 v216, v122, v123, v216
    v_mfma_f32_16x16x32_bf16 v[80:83], a[208:211], v[104:107], v[80:83]
    v_exp_f32 v223, v75
    v_mfma_f32_16x16x32_bf16 v[80:83], a[212:215], v[116:119], v[80:83]
    v_exp_f32 v224, v76
    v_mfma_f32_16x16x32_bf16 v[80:83], a[216:219], v[152:155], v[80:83]
    v_cvt_pk_bf16_f32 v132, v220, v221
    v_cvt_pk_bf16_f32 v133, v222, v223
    v_mfma_f32_16x16x32_bf16 v[80:83], a[220:223], v[164:167], v[80:83]
    v_exp_f32 v225, v77
    v_mfma_f32_16x16x32_bf16 v[92:95], a[224:227], v[8:11], v[248:251]
    s_waitcnt lgkmcnt(1)
    v_exp_f32 v226, v78
    v_mfma_f32_16x16x32_bf16 v[92:95], a[228:231], v[20:23], v[92:95]
    v_or3_b32 v216, v132, v133, v216
    v_mfma_f32_16x16x32_bf16 v[92:95], a[232:235], v[56:59], v[92:95]
    v_exp_f32 v227, v79
    v_mfma_f32_16x16x32_bf16 v[92:95], a[236:239], v[68:71], v[92:95]
    v_exp_f32 v220, v80
    v_mfma_f32_16x16x32_bf16 v[92:95], a[240:243], v[104:107], v[92:95]
    v_cvt_pk_bf16_f32 v136, v224, v225
    v_cvt_pk_bf16_f32 v137, v226, v227
    v_mfma_f32_16x16x32_bf16 v[92:95], a[244:247], v[116:119], v[92:95]
    v_exp_f32 v221, v81
    v_mfma_f32_16x16x32_bf16 v[92:95], a[248:251], v[152:155], v[92:95]
    s_waitcnt lgkmcnt(0)
    v_exp_f32 v222, v82
    v_mfma_f32_16x16x32_bf16 v[92:95], a[252:255], v[164:167], v[92:95]
    v_or3_b32 v216, v136, v137, v216
    v_mfma_f32_16x16x32_bf16 v[88:91], a[252:255], v[160:163], v[244:247]
    v_exp_f32 v223, v83
    v_mfma_f32_16x16x32_bf16 v[88:91], a[248:251], v[148:151], v[88:91]
    v_mfma_f32_16x16x32_bf16 v[88:91], a[244:247], v[112:115], v[88:91]
    v_mfma_f32_16x16x32_bf16 v[88:91], a[240:243], v[100:103], v[88:91]
    s_nop 1
    v_exp_f32 v224, v92
    v_mfma_f32_16x16x32_bf16 v[88:91], a[236:239], v[64:67], v[88:91]
    v_cvt_pk_bf16_f32 v140, v220, v221
    v_cvt_pk_bf16_f32 v141, v222, v223
    v_mfma_f32_16x16x32_bf16 v[88:91], a[232:235], v[52:55], v[88:91]
    v_exp_f32 v225, v93
    v_mfma_f32_16x16x32_bf16 v[88:91], a[228:231], v[16:19], v[88:91]
    v_exp_f32 v226, v94
    v_mfma_f32_16x16x32_bf16 v[88:91], a[224:227], v[4:7], v[88:91]
    v_or3_b32 v216, v140, v141, v216
    v_mfma_f32_16x16x32_bf16 v[84:87], a[224:227], v[0:3], v[240:243]
    v_exp_f32 v227, v95
    v_mfma_f32_16x16x32_bf16 v[84:87], a[228:231], v[12:15], v[84:87]
    v_mfma_f32_16x16x32_bf16 v[84:87], a[232:235], v[48:51], v[84:87]
    buffer_load_dwordx4 v204, s[16:19], s33 offen offset:1024 nt lds
    v_mfma_f32_16x16x32_bf16 v[84:87], a[236:239], v[60:63], v[84:87]
    buffer_load_dwordx4 v205, s[16:19], s33 offen offset:3072 nt lds
    v_mfma_f32_16x16x32_bf16 v[84:87], a[240:243], v[96:99], v[84:87]
    s_add_u32 s33, s33, 0xb800
    v_exp_f32 v220, v88
    v_mfma_f32_16x16x32_bf16 v[84:87], a[244:247], v[108:111], v[84:87]
    s_andn2_b32 s33, s33, 0xb000
    v_cvt_pk_bf16_f32 v142, v224, v225
    v_cvt_pk_bf16_f32 v143, v226, v227
    v_mfma_f32_16x16x32_bf16 v[84:87], a[248:251], v[144:147], v[84:87]
    v_exp_f32 v221, v89
    v_mfma_f32_16x16x32_bf16 v[84:87], a[252:255], v[156:159], v[84:87]
    v_exp_f32 v222, v90
    v_or3_b32 v216, v142, v143, v216
    v_exp_f32 v223, v91
    s_nop 4
    v_exp_f32 v224, v84
    v_cvt_pk_bf16_f32 v138, v220, v221
    v_cvt_pk_bf16_f32 v139, v222, v223
    v_exp_f32 v225, v85
    v_exp_f32 v226, v86
    v_or3_b32 v216, v138, v139, v216
    v_exp_f32 v227, v87
    v_cvt_pk_bf16_f32 v134, v224, v225
    s_waitcnt vmcnt(4) lgkmcnt(0)
    s_barrier
    ds_read_b64_tr_b16 a[192:193], v196 offset:0
    ds_read_b64_tr_b16 a[194:195], v196 offset:1024
    ds_read_b64_tr_b16 a[196:197], v196 offset:16384
    ds_read_b64_tr_b16 a[198:199], v196 offset:17408
    ds_read_b64_tr_b16 a[200:201], v197 offset:0
    ds_read_b64_tr_b16 a[202:203], v197 offset:1024
    ds_read_b64_tr_b16 a[204:205], v197 offset:16384
    ds_read_b64_tr_b16 a[206:207], v197 offset:17408
    ds_read_b64_tr_b16 a[208:209], v198 offset:0
    ds_read_b64_tr_b16 a[210:211], v198 offset:1024
    ds_read_b64_tr_b16 a[212:213], v198 offset:16384
    ds_read_b64_tr_b16 a[214:215], v198 offset:17408
    v_cvt_pk_bf16_f32 v135, v226, v227
    v_or3_b32 v216, v134, v135, v216
    v_and_b32 v232, 0x40004000, v216
    v_cmp_ne_u32 vcc, 0, v232
    s_cbranch_vccnz L_slow2
L_back2:
    s_waitcnt lgkmcnt(10)
    v_mfma_f32_16x16x32_bf16 a[0:3], a[192:195], v[120:123], a[0:3]
    s_waitcnt lgkmcnt(8)
    v_mfma_f32_16x16x32_bf16 a[0:3], a[196:199], v[132:135], a[0:3]
    v_mfma_f32_16x16x32_bf16 a[4:7], a[196:199], v[136:139], a[4:7]
    v_mfma_f32_16x16x32_bf16 a[4:7], a[192:195], v[124:127], a[4:7]
    v_mfma_f32_16x16x32_bf16 a[8:11], a[192:195], v[128:131], a[8:11]
    ds_read_b64_tr_b16 a[216:217], v199 offset:0
    v_mfma_f32_16x16x32_bf16 a[8:11], a[196:199], v[140:143], a[8:11]
    v_mfma_f32_16x16x32_bf16 v[168:171], v[228:231], v[120:123], v[168:171]
    ds_read_b64_tr_b16 a[218:219], v199 offset:1024
    v_mfma_f32_16x16x32_bf16 v[168:171], v[228:231], v[132:135], v[168:171]
    ds_read_b64_tr_b16 a[220:221], v199 offset:16384
    v_mfma_f32_16x16x32_bf16 v[172:175], v[228:231], v[136:139], v[172:175]
    v_mfma_f32_16x16x32_bf16 v[172:175], v[228:231], v[124:127], v[172:175]
    ds_read_b64_tr_b16 a[222:223], v199 offset:17408
    v_mfma_f32_16x16x32_bf16 v[176:179], v[228:231], v[128:131], v[176:179]
    ds_read_b64_tr_b16 a[224:225], v200 offset:0
    v_mfma_f32_16x16x32_bf16 v[176:179], v[228:231], v[140:143], v[176:179]
    s_waitcnt lgkmcnt(5)
    ds_read_b64_tr_b16 a[226:227], v200 offset:1024
    v_mfma_f32_16x16x32_bf16 a[20:23], a[200:203], v[128:131], a[20:23]
    v_mfma_f32_16x16x32_bf16 a[20:23], a[204:207], v[140:143], a[20:23]
    ds_read_b64_tr_b16 a[228:229], v200 offset:16384
    v_mfma_f32_16x16x32_bf16 a[16:19], a[204:207], v[136:139], a[16:19]
    ds_read_b64_tr_b16 a[230:231], v200 offset:17408
    v_mfma_f32_16x16x32_bf16 a[16:19], a[200:203], v[124:127], a[16:19]
    v_mfma_f32_16x16x32_bf16 a[12:15], a[200:203], v[120:123], a[12:15]
    ds_read_b64_tr_b16 a[232:233], v201 offset:0
    v_mfma_f32_16x16x32_bf16 a[12:15], a[204:207], v[132:135], a[12:15]
    s_add_u32 m0, s32, 49152
    ds_read_b64_tr_b16 a[234:235], v201 offset:1024
    v_mfma_f32_16x16x32_bf16 a[24:27], a[208:211], v[120:123], a[24:27]
    ds_read_b64_tr_b16 a[236:237], v201 offset:16384
    v_mfma_f32_16x16x32_bf16 a[24:27], a[212:215], v[132:135], a[24:27]
    buffer_load_dwordx4 v204, s[16:19], s33 offen offset:0 nt lds
    v_mfma_f32_16x16x32_bf16 a[28:31], a[212:215], v[136:139], a[28:31]
    ds_read_b64_tr_b16 a[238:239], v201 offset:17408
    v_mfma_f32_16x16x32_bf16 a[28:31], a[208:211], v[124:127], a[28:31]
    ds_read_b64_tr_b16 a[240:241], v202 offset:0
    v_mfma_f32_16x16x32_bf16 a[32:35], a[208:211], v[128:131], a[32:35]
    buffer_load_dwordx4 v205, s[16:19], s33 offen offset:2048 nt lds
    v_mfma_f32_16x16x32_bf16 a[32:35], a[212:215], v[140:143], a[32:35]
    s_waitcnt lgkmcnt(6)
    ds_read_b64_tr_b16 a[242:243], v202 offset:1024
    v_mfma_f32_16x16x32_bf16 a[44:47], a[216:219], v[128:131], a[44:47]
    ds_read_b64_tr_b16 a[244:245], v202 offset:16384
    v_mfma_f32_16x16x32_bf16 a[44:47], a[220:223], v[140:143], a[44:47]
    ds_read_b64_tr_b16 a[246:247], v202 offset:17408
    v_mfma_f32_16x16x32_bf16 a[40:43], a[220:223], v[136:139], a[40:43]
    v_mfma_f32_16x16x32_bf16 a[40:43], a[216:219], v[124:127], a[40:43]
    ds_read_b64_tr_b16 a[248:249], v203 offset:0
    v_mfma_f32_16x16x32_bf16 a[36:39], a[216:219], v[120:123], a[36:39]
    ds_read_b64_tr_b16 a[250:251], v203 offset:1024
    v_mfma_f32_16x16x32_bf16 a[36:39], a[220:223], v[132:135], a[36:39]
    buffer_load_dwordx4 v204, s[16:19], s33 offen offset:1024 nt lds
    v_mfma_f32_16x16x32_bf16 a[48:51], a[224:227], v[120:123], a[48:51]
    s_waitcnt lgkmcnt(6)
    ds_read_b64_tr_b16 a[252:253], v203 offset:16384
    v_mfma_f32_16x16x32_bf16 a[48:51], a[228:231], v[132:135], a[48:51]
    ds_read_b64_tr_b16 a[254:255], v203 offset:17408
    buffer_load_dwordx4 v205, s[16:19], s33 offen offset:3072 nt lds
    v_mfma_f32_16x16x32_bf16 a[52:55], a[228:231], v[136:139], a[52:55]
    ds_read_b64_tr_b16 a[192:193], v196 offset:256
    v_mfma_f32_16x16x32_bf16 a[52:55], a[224:227], v[124:127], a[52:55]
    v_mfma_f32_16x16x32_bf16 a[56:59], a[224:227], v[128:131], a[56:59]
    ds_read_b64_tr_b16 a[194:195], v196 offset:1280
    v_mfma_f32_16x16x32_bf16 a[56:59], a[228:231], v[140:143], a[56:59]
    ds_read_b64_tr_b16 a[196:197], v196 offset:16640
    v_mfma_f32_16x16x32_bf16 a[68:71], a[232:235], v[128:131], a[68:71]
    v_mfma_f32_16x16x32_bf16 a[68:71], a[236:239], v[140:143], a[68:71]
    ds_read_b64_tr_b16 a[198:199], v196 offset:17664
    v_mfma_f32_16x16x32_bf16 a[64:67], a[236:239], v[136:139], a[64:67]
    ds_read_b64_tr_b16 a[200:201], v197 offset:256
    v_mfma_f32_16x16x32_bf16 a[64:67], a[232:235], v[124:127], a[64:67]
    v_mfma_f32_16x16x32_bf16 a[60:63], a[232:235], v[120:123], a[60:63]
    ds_read_b64_tr_b16 a[202:203], v197 offset:1280
    v_mfma_f32_16x16x32_bf16 a[60:63], a[236:239], v[132:135], a[60:63]
    s_waitcnt lgkmcnt(6)
    ds_read_b64_tr_b16 a[204:205], v197 offset:16640
    v_mfma_f32_16x16x32_bf16 a[72:75], a[240:243], v[120:123], a[72:75]
    ds_read_b64_tr_b16 a[206:207], v197 offset:17664
    v_mfma_f32_16x16x32_bf16 a[72:75], a[244:247], v[132:135], a[72:75]
    v_mfma_f32_16x16x32_bf16 a[76:79], a[244:247], v[136:139], a[76:79]
    ds_read_b64_tr_b16 a[208:209], v198 offset:256
    v_mfma_f32_16x16x32_bf16 a[76:79], a[240:243], v[124:127], a[76:79]
    ds_read_b64_tr_b16 a[210:211], v198 offset:1280
    v_mfma_f32_16x16x32_bf16 a[80:83], a[240:243], v[128:131], a[80:83]
    v_mfma_f32_16x16x32_bf16 a[80:83], a[244:247], v[140:143], a[80:83]
    ds_read_b64_tr_b16 a[212:213], v198 offset:16640
    v_mfma_f32_16x16x32_bf16 a[92:95], a[248:251], v[128:131], a[92:95]
    ds_read_b64_tr_b16 a[214:215], v198 offset:17664
    v_mfma_f32_16x16x32_bf16 a[92:95], a[252:255], v[140:143], a[92:95]
    ds_read_b64_tr_b16 a[216:217], v199 offset:256
    v_mfma_f32_16x16x32_bf16 a[88:91], a[252:255], v[136:139], a[88:91]
    v_mfma_f32_16x16x32_bf16 a[88:91], a[248:251], v[124:127], a[88:91]
    s_add_u32 s33, s33, 0xb800
    ds_read_b64_tr_b16 a[218:219], v199 offset:1280
    v_mfma_f32_16x16x32_bf16 a[84:87], a[248:251], v[120:123], a[84:87]
    ds_read_b64_tr_b16 a[220:221], v199 offset:16640
    v_mfma_f32_16x16x32_bf16 a[84:87], a[252:255], v[132:135], a[84:87]
    s_waitcnt lgkmcnt(7)
    v_mfma_f32_16x16x32_bf16 a[96:99], a[192:195], v[120:123], a[96:99]
    s_andn2_b32 s33, s33, 0xb000
    ds_read_b64_tr_b16 a[222:223], v199 offset:17664
    v_mfma_f32_16x16x32_bf16 a[96:99], a[196:199], v[132:135], a[96:99]
    s_add_u32 m0, s32, 98304
    ds_read_b64_tr_b16 a[224:225], v200 offset:256
    v_mfma_f32_16x16x32_bf16 a[100:103], a[196:199], v[136:139], a[100:103]
    ds_read_b64_tr_b16 a[226:227], v200 offset:1280
    v_mfma_f32_16x16x32_bf16 a[100:103], a[192:195], v[124:127], a[100:103]
    buffer_load_dwordx4 v206, s[20:23], s34 offen offset:0 nt lds
    v_mfma_f32_16x16x32_bf16 a[104:107], a[192:195], v[128:131], a[104:107]
    ds_read_b64_tr_b16 a[228:229], v200 offset:16640
    v_mfma_f32_16x16x32_bf16 a[104:107], a[196:199], v[140:143], a[104:107]
    ds_read_b64_tr_b16 a[230:231], v200 offset:17664
    v_mfma_f32_16x16x32_bf16 a[116:119], a[200:203], v[128:131], a[116:119]
    buffer_load_dwordx4 v207, s[20:23], s34 offen offset:2048 nt lds
    v_mfma_f32_16x16x32_bf16 a[116:119], a[204:207], v[140:143], a[116:119]
    ds_read_b64_tr_b16 a[232:233], v201 offset:256
    v_mfma_f32_16x16x32_bf16 a[112:115], a[204:207], v[136:139], a[112:115]
    ds_read_b64_tr_b16 a[234:235], v201 offset:1280
    v_mfma_f32_16x16x32_bf16 a[112:115], a[200:203], v[124:127], a[112:115]
    ds_read_b64_tr_b16 a[236:237], v201 offset:16640
    v_mfma_f32_16x16x32_bf16 a[108:111], a[200:203], v[120:123], a[108:111]
    v_mfma_f32_16x16x32_bf16 a[108:111], a[204:207], v[132:135], a[108:111]
    s_waitcnt lgkmcnt(6)
    ds_read_b64_tr_b16 a[238:239], v201 offset:17664
    v_mfma_f32_16x16x32_bf16 a[120:123], a[208:211], v[120:123], a[120:123]
    ds_read_b64_tr_b16 a[240:241], v202 offset:256
    v_mfma_f32_16x16x32_bf16 a[120:123], a[212:215], v[132:135], a[120:123]
    v_mfma_f32_16x16x32_bf16 a[124:127], a[212:215], v[136:139], a[124:127]
    ds_read_b64_tr_b16 a[242:243], v202 offset:1280
    v_mfma_f32_16x16x32_bf16 a[124:127], a[208:211], v[124:127], a[124:127]
    ds_read_b64_tr_b16 a[244:245], v202 offset:16640
    v_mfma_f32_16x16x32_bf16 a[128:131], a[208:211], v[128:131], a[128:131]
    ds_read_b64_tr_b16 a[246:247], v202 offset:17664
    v_mfma_f32_16x16x32_bf16 a[128:131], a[212:215], v[140:143], a[128:131]
    v_mfma_f32_16x16x32_bf16 a[140:143], a[216:219], v[128:131], a[140:143]
    ds_read_b64_tr_b16 a[248:249], v203 offset:256
    v_mfma_f32_16x16x32_bf16 a[140:143], a[220:223], v[140:143], a[140:143]
    ds_read_b64_tr_b16 a[250:251], v203 offset:1280
    v_mfma_f32_16x16x32_bf16 a[136:139], a[220:223], v[136:139], a[136:139]
    v_mfma_f32_16x16x32_bf16 a[136:139], a[216:219], v[124:127], a[136:139]
    ds_read_b64_tr_b16 a[252:253], v203 offset:16640
    v_mfma_f32_16x16x32_bf16 a[132:135], a[216:219], v[120:123], a[132:135]
    ds_read_b64_tr_b16 a[254:255], v203 offset:17664
    v_mfma_f32_16x16x32_bf16 a[132:135], a[220:223], v[132:135], a[132:135]
    s_waitcnt lgkmcnt(7)
    v_mfma_f32_16x16x32_bf16 a[144:147], a[224:227], v[120:123], a[144:147]
    v_mfma_f32_16x16x32_bf16 a[144:147], a[228:231], v[132:135], a[144:147]
    v_mfma_f32_16x16x32_bf16 a[148:151], a[228:231], v[136:139], a[148:151]
    v_mfma_f32_16x16x32_bf16 a[148:151], a[224:227], v[124:127], a[148:151]
    v_mfma_f32_16x16x32_bf16 a[152:155], a[224:227], v[128:131], a[152:155]
    v_mfma_f32_16x16x32_bf16 a[152:155], a[228:231], v[140:143], a[152:155]
    v_mfma_f32_16x16x32_bf16 a[164:167], a[232:235], v[128:131], a[164:167]
    buffer_load_dwordx4 v206, s[20:23], s34 offen offset:1024 nt lds
    v_mfma_f32_16x16x32_bf16 a[164:167], a[236:239], v[140:143], a[164:167]
    buffer_load_dwordx4 v207, s[20:23], s34 offen offset:3072 nt lds
    v_mfma_f32_16x16x32_bf16 a[160:163], a[236:239], v[136:139], a[160:163]
    s_add_u32 s34, s34, 0xb800
    v_mfma_f32_16x16x32_bf16 a[160:163], a[232:235], v[124:127], a[160:163]
    s_andn2_b32 s34, s34, 0xb000
    v_mfma_f32_16x16x32_bf16 a[156:159], a[232:235], v[120:123], a[156:159]
    s_sub_u32 s42, s42, 1
    v_mfma_f32_16x16x32_bf16 a[156:159], a[236:239], v[132:135], a[156:159]
    s_cmp_lg_u32 s42, 0
    s_cbranch_scc1 L_loop
    s_waitcnt lgkmcnt(0)
    s_waitcnt vmcnt(4) lgkmcnt(0)
    s_barrier
    ds_read_b128 a[192:195], v192 offset:32768
    ds_read_b128 a[196:199], v193 offset:32768
    v_mfma_f32_16x16x32_bf16 a[168:171], a[240:243], v[120:123], a[168:171]
    ds_read_b128 a[200:203], v194 offset:32768
    ds_read_b128 a[204:207], v195 offset:32768
    v_mfma_f32_16x16x32_bf16 a[168:171], a[244:247], v[132:135], a[168:171]
    ds_read_b128 a[208:211], v192 offset:33024
    ds_read_b128 a[212:215], v193 offset:33024
    v_mfma_f32_16x16x32_bf16 a[172:175], a[244:247], v[136:139], a[172:175]
    ds_read_b128 a[216:219], v194 offset:33024
    v_mfma_f32_16x16x32_bf16 a[172:175], a[240:243], v[124:127], a[172:175]
    v_mfma_f32_16x16x32_bf16 a[176:179], a[240:243], v[128:131], a[176:179]
    ds_read_b128 a[220:223], v195 offset:33024
    v_mfma_f32_16x16x32_bf16 a[176:179], a[244:247], v[140:143], a[176:179]
    v_mfma_f32_16x16x32_bf16 a[188:191], a[248:251], v[128:131], a[188:191]
    v_mfma_f32_16x16x32_bf16 a[188:191], a[252:255], v[140:143], a[188:191]
    ds_read_b128 a[224:227], v192 offset:33792
    v_mfma_f32_16x16x32_bf16 a[184:187], a[252:255], v[136:139], a[184:187]
    v_mfma_f32_16x16x32_bf16 a[184:187], a[248:251], v[124:127], a[184:187]
    v_mfma_f32_16x16x32_bf16 a[180:183], a[248:251], v[120:123], a[180:183]
    ds_read_b128 a[228:231], v193 offset:33792
    v_mfma_f32_16x16x32_bf16 a[180:183], a[252:255], v[132:135], a[180:183]
    s_waitcnt lgkmcnt(4)
    v_mfma_f32_16x16x32_bf16 v[24:27], a[192:195], v[0:3], v[240:243]
    v_mfma_f32_16x16x32_bf16 v[24:27], a[196:199], v[12:15], v[24:27]
    ds_read_b128 a[232:235], v194 offset:33792
    v_mfma_f32_16x16x32_bf16 v[24:27], a[200:203], v[48:51], v[24:27]
    v_mfma_f32_16x16x32_bf16 v[24:27], a[204:207], v[60:63], v[24:27]
    ds_read_b128 a[236:239], v195 offset:33792
    v_mfma_f32_16x16x32_bf16 v[24:27], a[208:211], v[96:99], v[24:27]
    v_mfma_f32_16x16x32_bf16 v[24:27], a[212:215], v[108:111], v[24:27]
    s_waitcnt lgkmcnt(3)
    v_mfma_f32_16x16x32_bf16 v[24:27], a[216:219], v[144:147], v[24:27]
    ds_read_b128 a[240:243], v192 offset:34048
    v_mfma_f32_16x16x32_bf16 v[24:27], a[220:223], v[156:159], v[24:27]
    v_mfma_f32_16x16x32_bf16 v[28:31], a[220:223], v[160:163], v[244:247]
    v_mfma_f32_16x16x32_bf16 v[28:31], a[216:219], v[148:151], v[28:31]
    ds_read_b128 a[244:247], v193 offset:34048
    v_mfma_f32_16x16x32_bf16 v[28:31], a[212:215], v[112:115], v[28:31]
    v_mfma_f32_16x16x32_bf16 v[28:31], a[208:211], v[100:103], v[28:31]
    s_add_u32 m0, s32, 114688
    s_nop 1
    v_exp_f32 v220, v24
    v_mfma_f32_16x16x32_bf16 v[28:31], a[204:207], v[64:67], v[28:31]
    v_exp_f32 v221, v25
    v_mfma_f32_16x16x32_bf16 v[28:31], a[200:203], v[52:55], v[28:31]
    v_exp_f32 v222, v26
    v_mfma_f32_16x16x32_bf16 v[28:31], a[196:199], v[16:19], v[28:31]
    v_exp_f32 v223, v27
    v_mfma_f32_16x16x32_bf16 v[28:31], a[192:195], v[4:7], v[28:31]
    ds_read_b128 a[248:251], v194 offset:34048
    buffer_load_dwordx4 v206, s[20:23], s34 offen offset:0 nt lds
    v_mfma_f32_16x16x32_bf16 v[32:35], a[192:195], v[8:11], v[248:251]
    ds_read_b128 a[252:255], v195 offset:34048
    v_mfma_f32_16x16x32_bf16 v[32:35], a[196:199], v[20:23], v[32:35]
    buffer_load_dwordx4 v207, s[20:23], s34 offen offset:2048 nt lds
    v_mfma_f32_16x16x32_bf16 v[32:35], a[200:203], v[56:59], v[32:35]
    ds_read_b128 a[192:195], v192 offset:49152
    v_mfma_f32_16x16x32_bf16 v[32:35], a[204:207], v[68:71], v[32:35]
    v_exp_f32 v224, v28
    v_mfma_f32_16x16x32_bf16 v[32:35], a[208:211], v[104:107], v[32:35]
    v_cvt_pk_bf16_f32 v120, v220, v221
    v_cvt_pk_bf16_f32 v121, v222, v223
    v_mfma_f32_16x16x32_bf16 v[32:35], a[212:215], v[116:119], v[32:35]
    v_exp_f32 v225, v29
    v_mfma_f32_16x16x32_bf16 v[32:35], a[216:219], v[152:155], v[32:35]
    v_exp_f32 v226, v30
    v_mfma_f32_16x16x32_bf16 v[32:35], a[220:223], v[164:167], v[32:35]
    ds_read_b128 a[196:199], v193 offset:49152
    v_or3_b32 v216, v120, v121, 0
    v_mfma_f32_16x16x32_bf16 v[44:47], a[224:227], v[8:11], v[248:251]
    s_waitcnt lgkmcnt(4)
    v_exp_f32 v227, v31
    v_mfma_f32_16x16x32_bf16 v[44:47], a[228:231], v[20:23], v[44:47]
    ds_read_b128 a[200:203], v194 offset:49152
    buffer_load_dwordx4 v206, s[20:23], s34 offen offset:1024 nt lds
    v_mfma_f32_16x16x32_bf16 v[44:47], a[232:235], v[56:59], v[44:47]
    buffer_load_dwordx4 v207, s[20:23], s34 offen offset:3072 nt lds
    v_mfma_f32_16x16x32_bf16 v[44:47], a[236:239], v[68:71], v[44:47]
    ds_read_b128 a[204:207], v195 offset:49152
    v_mfma_f32_16x16x32_bf16 v[44:47], a[240:243], v[104:107], v[44:47]
    v_exp_f32 v220, v32
    v_mfma_f32_16x16x32_bf16 v[44:47], a[244:247], v[116:119], v[44:47]
    s_waitcnt lgkmcnt(3)
    v_cvt_pk_bf16_f32 v124, v224, v225
    v_cvt_pk_bf16_f32 v125, v226, v227
    v_mfma_f32_16x16x32_bf16 v[44:47], a[248:251], v[152:155], v[44:47]
    v_exp_f32 v221, v33
    v_mfma_f32_16x16x32_bf16 v[44:47], a[252:255], v[164:167], v[44:47]
    v_exp_f32 v222, v34
    v_mfma_f32_16x16x32_bf16 v[40:43], a[252:255], v[160:163], v[244:247]
    ds_read_b128 a[208:211], v192 offset:49408
    v_or3_b32 v216, v124, v125, v216
    v_mfma_f32_16x16x32_bf16 v[40:43], a[248:251], v[148:151], v[40:43]
    v_exp_f32 v223, v35
    v_mfma_f32_16x16x32_bf16 v[40:43], a[244:247], v[112:115], v[40:43]
    ds_read_b128 a[212:215], v193 offset:49408
    v_mfma_f32_16x16x32_bf16 v[40:43], a[240:243], v[100:103], v[40:43]
    ds_read_b128 a[216:219], v194 offset:49408
    v_mfma_f32_16x16x32_bf16 v[40:43], a[236:239], v[64:67], v[40:43]
    v_exp_f32 v224, v44
    v_mfma_f32_16x16x32_bf16 v[40:43], a[232:235], v[52:55], v[40:43]
    v_cvt_pk_bf16_f32 v128, v220, v221
    v_cvt_pk_bf16_f32 v129, v222, v223
    v_mfma_f32_16x16x32_bf16 v[40:43], a[228:231], v[16:19], v[40:43]
    v_exp_f32 v225, v45
    v_mfma_f32_16x16x32_bf16 v[40:43], a[224:227], v[4:7], v[40:43]
    v_exp_f32 v226, v46
    v_mfma_f32_16x16x32_bf16 v[36:39], a[224:227], v[0:3], v[240:243]
    ds_read_b128 a[220:223], v195 offset:49408
    v_or3_b32 v216, v128, v129, v216
    v_mfma_f32_16x16x32_bf16 v[36:39], a[228:231], v[12:15], v[36:39]
    v_exp_f32 v227, v47
    v_mfma_f32_16x16x32_bf16 v[36:39], a[232:235], v[48:51], v[36:39]
    ds_read_b128 a[224:227], v192 offset:50176
    v_mfma_f32_16x16x32_bf16 v[36:39], a[236:239], v[60:63], v[36:39]
    v_exp_f32 v220, v40
    v_mfma_f32_16x16x32_bf16 v[36:39], a[240:243], v[96:99], v[36:39]
    ds_read_b128 a[228:231], v193 offset:50176
    v_cvt_pk_bf16_f32 v130, v224, v225
    v_mfma_f32_16x16x32_bf16 v[36:39], a[244:247], v[108:111], v[36:39]
    v_cvt_pk_bf16_f32 v131, v226, v227
    v_mfma_f32_16x16x32_bf16 v[36:39], a[248:251], v[144:147], v[36:39]
    v_exp_f32 v221, v41
    v_mfma_f32_16x16x32_bf16 v[36:39], a[252:255], v[156:159], v[36:39]
    v_exp_f32 v222, v42
    v_mfma_f32_16x16x32_bf16 v[72:75], a[192:195], v[0:3], v[240:243]
    s_waitcnt lgkmcnt(3)
    ds_read_b128 a[232:235], v194 offset:50176
    v_or3_b32 v216, v130, v131, v216
    v_mfma_f32_16x16x32_bf16 v[72:75], a[196:199], v[12:15], v[72:75]
    v_exp_f32 v223, v43
    v_mfma_f32_16x16x32_bf16 v[72:75], a[200:203], v[48:51], v[72:75]
    ds_read_b128 a[236:239], v195 offset:50176
    v_mfma_f32_16x16x32_bf16 v[72:75], a[204:207], v[60:63], v[72:75]
    v_exp_f32 v224, v36
    v_mfma_f32_16x16x32_bf16 v[72:75], a[208:211], v[96:99], v[72:75]
    v_cvt_pk_bf16_f32 v126, v220, v221
    v_cvt_pk_bf16_f32 v127, v222, v223
    v_mfma_f32_16x16x32_bf16 v[72:75], a[212:215], v[108:111], v[72:75]
    v_exp_f32 v225, v37
    v_mfma_f32_16x16x32_bf16 v[72:75], a[216:219], v[144:147], v[72:75]
    s_waitcnt lgkmcnt(2)
    v_exp_f32 v226, v38
    v_mfma_f32_16x16x32_bf16 v[72:75], a[220:223], v[156:159], v[72:75]
    s_add_u32 s34, s34, 0xb800
    ds_read_b128 a[240:243], v192 offset:50432
    v_or3_b32 v216, v126, v127, v216
    v_mfma_f32_16x16x32_bf16 v[76:79], a[220:223], v[160:163], v[244:247]
    s_andn2_b32 s34, s34, 0xb000
    v_exp_f32 v227, v39
    v_mfma_f32_16x16x32_bf16 v[76:79], a[216:219], v[148:151], v[76:79]
    v_readfirstlane_b32 s79, v239
    s_nop 1
    s_and_b32 s79, s79, 15
    s_cbranch_scc1 L_dbg
L_dbgok:
    ds_read_b128 a[244:247], v193 offset:50432
    v_mfma_f32_16x16x32_bf16 v[76:79], a[212:215], v[112:115], v[76:79]
    v_mfma_f32_16x16x32_bf16 v[76:79], a[208:211], v[100:103], v[76:79]
    ds_read_b128 a[248:251], v194 offset:50432
    v_mfma_f32_16x16x32_bf16 v[76:79], a[204:207], v[64:67], v[76:79]
    buffer_load_dword v218, v214, s[72:75], s31 offen sc1
    v_mfma_f32_16x16x32_bf16 v[76:79], a[200:203], v[52:55], v[76:79]
    v_exp_f32 v220, v72
    v_mfma_f32_16x16x32_bf16 v[76:79], a[196:199], v[16:19], v[76:79]
    ds_read_b128 a[252:255], v195 offset:50432
    v_cvt_pk_bf16_f32 v122, v224, v225
    v_mfma_f32_16x16x32_bf16 v[76:79], a[192:195], v[4:7], v[76:79]
    v_cvt_pk_bf16_f32 v123, v226, v227
    v_mfma_f32_16x16x32_bf16 v[80:83], a[192:195], v[8:11], v[248:251]
    v_exp_f32 v221, v73
    v_mfma_f32_16x16x32_bf16 v[80:83], a[196:199], v[20:23], v[80:83]
    v_exp_f32 v222, v74
    v_mfma_f32_16x16x32_bf16 v[80:83], a[200:203], v[56:59], v[80:83]
    v_or3_b32 v216, v122, v123, v216
    v_mfma_f32_16x16x32_bf16 v[80:83], a[204:207], v[68:71], v[80:83]
    v_exp_f32 v223, v75
    v_mfma_f32_16x16x32_bf16 v[80:83], a[208:211], v[104:107], v[80:83]
    v_exp_f32 v224, v76
    v_mfma_f32_16x16x32_bf16 v[80:83], a[212:215], v[116:119], v[80:83]
    v_cvt_pk_bf16_f32 v132, v220, v221
    v_cvt_pk_bf16_f32 v133, v222, v223
    v_mfma_f32_16x16x32_bf16 v[80:83], a[216:219], v[152:155], v[80:83]
    v_exp_f32 v225, v77
    v_mfma_f32_16x16x32_bf16 v[80:83], a[220:223], v[164:167], v[80:83]
    v_exp_f32 v226, v78
    v_mfma_f32_16x16x32_bf16 v[92:95], a[224:227], v[8:11], v[248:251]
    v_or3_b32 v216, v132, v133, v216
    v_mfma_f32_16x16x32_bf16 v[92:95], a[228:231], v[20:23], v[92:95]
    s_waitcnt lgkmcnt(0)
    v_exp_f32 v227, v79
    v_mfma_f32_16x16x32_bf16 v[92:95], a[232:235], v[56:59], v[92:95]
    v_mfma_f32_16x16x32_bf16 v[92:95], a[236:239], v[68:71], v[92:95]
    v_exp_f32 v220, v80
    v_mfma_f32_16x16x32_bf16 v[92:95], a[240:243], v[104:107], v[92:95]
L_hop1_0:
L_pad5:
    s_cbranch_execz L_pad9
    v_cvt_pk_bf16_f32 v136, v224, v225
    v_cvt_pk_bf16_f32 v137, v226, v227
    v_mfma_f32_16x16x32_bf16 v[92:95], a[244:247], v[116:119], v[92:95]
    v_exp_f32 v221, v81
    v_mfma_f32_16x16x32_bf16 v[92:95], a[248:251], v[152:155], v[92:95]
    v_exp_f32 v222, v82
    v_mfma_f32_16x16x32_bf16 v[92:95], a[252:255], v[164:167], v[92:95]
    v_or3_b32 v216, v136, v137, v216
    v_mfma_f32_16x16x32_bf16 v[88:91], a[252:255], v[160:163], v[244:247]
    v_exp_f32 v223, v83
    v_mfma_f32_16x16x32_bf16 v[88:91], a[248:251], v[148:151], v[88:91]
    v_mfma_f32_16x16x32_bf16 v[88:91], a[244:247], v[112:115], v[88:91]
    v_mfma_f32_16x16x32_bf16 v[88:91], a[240:243], v[100:103], v[88:91]
    s_nop 1
    v_exp_f32 v224, v92
    v_mfma_f32_16x16x32_bf16 v[88:91], a[236:239], v[64:67], v[88:91]
    v_cvt_pk_bf16_f32 v140, v220, v221
    v_cvt_pk_bf16_f32 v141, v222, v223
    v_mfma_f32_16x16x32_bf16 v[88:91], a[232:235], v[52:55], v[88:91]
    v_exp_f32 v225, v93
    v_mfma_f32_16x16x32_bf16 v[88:91], a[228:231], v[16:19], v[88:91]
    v_exp_f32 v226, v94
    v_mfma_f32_16x16x32_bf16 v[88:91], a[224:227], v[4:7], v[88:91]
    v_or3_b32 v216, v140, v141, v216
    v_mfma_f32_16x16x32_bf16 v[84:87], a[224:227], v[0:3], v[240:243]
    v_exp_f32 v227, v95
    v_mfma_f32_16x16x32_bf16 v[84:87], a[228:231], v[12:15], v[84:87]
    v_mfma_f32_16x16x32_bf16 v[84:87], a[232:235], v[48:51], v[84:87]
    v_mfma_f32_16x16x32_bf16 v[84:87], a[236:239], v[60:63], v[84:87]
    buffer_load_dword v219, v215, s[24:27], s44 offen
    v_mfma_f32_16x16x32_bf16 v[84:87], a[240:243], v[96:99], v[84:87]
    v_exp_f32 v220, v88
    v_mfma_f32_16x16x32_bf16 v[84:87], a[244:247], v[108:111], v[84:87]
    v_cvt_pk_bf16_f32 v142, v224, v225
    v_cvt_pk_bf16_f32 v143, v226, v227
    v_mfma_f32_16x16x32_bf16 v[84:87], a[248:251], v[144:147], v[84:87]
    v_exp_f32 v221, v89
    v_mfma_f32_16x16x32_bf16 v[84:87], a[252:255], v[156:159], v[84:87]
    v_exp_f32 v222, v90
    v_or3_b32 v216, v142, v143, v216
    v_exp_f32 v223, v91
    s_nop 4
    v_exp_f32 v224, v84
    v_cvt_pk_bf16_f32 v138, v220, v221
    v_cvt_pk_bf16_f32 v139, v222, v223
    v_exp_f32 v225, v85
    v_exp_f32 v226, v86
    v_or3_b32 v216, v138, v139, v216
    v_exp_f32 v227, v87
    v_cvt_pk_bf16_f32 v134, v224, v225
    s_waitcnt vmcnt(2) lgkmcnt(0)
    s_barrier
    ds_read_b64_tr_b16 a[192:193], v196 offset:32768
    ds_read_b64_tr_b16 a[194:195], v196 offset:33792
    ds_read_b64_tr_b16 a[196:197], v196 offset:49152
    ds_read_b64_tr_b16 a[198:199], v196 offset:50176
    ds_read_b64_tr_b16 a[200:201], v197 offset:32768
    ds_read_b64_tr_b16 a[202:203], v197 offset:33792
    ds_read_b64_tr_b16 a[204:205], v197 offset:49152
    ds_read_b64_tr_b16 a[206:207], v197 offset:50176
    ds_read_b64_tr_b16 a[208:209], v198 offset:32768
    ds_read_b64_tr_b16 a[210:211], v198 offset:33792
    ds_read_b64_tr_b16 a[212:213], v198 offset:49152
    ds_read_b64_tr_b16 a[214:215], v198 offset:50176
    v_cvt_pk_bf16_f32 v135, v226, v227
    v_or3_b32 v216, v134, v135, v216
    v_and_b32 v232, 0x40004000, v216
    v_cmp_ne_u32 vcc, 0, v232
    s_cbranch_vccnz L_slow3
L_back3:
    s_waitcnt lgkmcnt(10)
    v_mfma_f32_16x16x32_bf16 a[0:3], a[192:195], v[120:123], a[0:3]
    s_waitcnt lgkmcnt(8)
    s_waitcnt vmcnt(1)
    v_cmp_ne_u32 s[76:77], s97, v218
    s_nop 1
    s_cmp_lg_u64 s[76:77], 0
    s_cselect_b32 s79, 151552, 0
    s_cselect_b64 s[76:77], -1, 0
    v_mfma_f32_16x16x32_bf16 a[0:3], a[196:199], v[132:135], a[0:3]
    v_mfma_f32_16x16x32_bf16 a[4:7], a[196:199], v[136:139], a[4:7]
    s_add_u32 s56, s56, s79
    v_mfma_f32_16x16x32_bf16 a[4:7], a[192:195], v[124:127], a[4:7]
    s_add_u32 s57, s56, s79
    v_mfma_f32_16x16x32_bf16 a[8:11], a[192:195], v[128:131], a[8:11]
    ds_read_b64_tr_b16 a[216:217], v199 offset:32768
    v_mfma_f32_16x16x32_bf16 a[8:11], a[196:199], v[140:143], a[8:11]
    s_add_u32 s58, s57, s79
    v_mfma_f32_16x16x32_bf16 v[168:171], v[228:231], v[120:123], v[168:171]
    ds_read_b64_tr_b16 a[218:219], v199 offset:33792
    v_add_u32 v194, 131072, v255
    v_mfma_f32_16x16x32_bf16 v[168:171], v[228:231], v[132:135], v[168:171]
    ds_read_b64_tr_b16 a[220:221], v199 offset:49152
    v_xor_b32 v195, 32, v194
    v_mfma_f32_16x16x32_bf16 v[172:175], v[228:231], v[136:139], v[172:175]
    v_mfma_f32_16x16x32_bf16 v[172:175], v[228:231], v[124:127], v[172:175]
    ds_read_b64_tr_b16 a[222:223], v199 offset:50176
    v_mfma_f32_16x16x32_bf16 v[176:179], v[228:231], v[128:131], v[176:179]
    ds_read_b64_tr_b16 a[224:225], v200 offset:32768
    v_mfma_f32_16x16x32_bf16 v[176:179], v[228:231], v[140:143], v[176:179]
    s_waitcnt lgkmcnt(5)
    ds_read_b64_tr_b16 a[226:227], v200 offset:33792
    v_mov_b32 v213, v168
    v_mfma_f32_16x16x32_bf16 a[20:23], a[200:203], v[128:131], a[20:23]
    v_mfma_f32_16x16x32_bf16 a[20:23], a[204:207], v[140:143], a[20:23]
    ds_read_b64_tr_b16 a[228:229], v200 offset:49152
    v_mov_b32 v214, v172
    v_mfma_f32_16x16x32_bf16 a[16:19], a[204:207], v[136:139], a[16:19]
    ds_read_b64_tr_b16 a[230:231], v200 offset:50176
    v_mov_b32 v215, v176
    v_mfma_f32_16x16x32_bf16 a[16:19], a[200:203], v[124:127], a[16:19]
    v_mfma_f32_16x16x32_bf16 a[12:15], a[200:203], v[120:123], a[12:15]
    ds_read_b64_tr_b16 a[232:233], v201 offset:32768
    v_mov_b32 v236, v213
    v_mfma_f32_16x16x32_bf16 a[12:15], a[204:207], v[132:135], a[12:15]
    ds_read_b64_tr_b16 a[234:235], v201 offset:33792
    v_mov_b32 v237, v214
    v_mfma_f32_16x16x32_bf16 a[24:27], a[208:211], v[120:123], a[24:27]
    ds_read_b64_tr_b16 a[236:237], v201 offset:49152
    v_mov_b32 v238, v215
    v_mfma_f32_16x16x32_bf16 a[24:27], a[212:215], v[132:135], a[24:27]
    v_permlane16_swap_b32 v213, v236
    v_mfma_f32_16x16x32_bf16 a[28:31], a[212:215], v[136:139], a[28:31]
    v_permlane16_swap_b32 v214, v237
    v_mfma_f32_16x16x32_bf16 a[28:31], a[208:211], v[124:127], a[28:31]
    v_permlane16_swap_b32 v215, v238
    v_mfma_f32_16x16x32_bf16 a[32:35], a[208:211], v[128:131], a[32:35]
    ds_read_b64_tr_b16 a[238:239], v201 offset:50176
    v_add_f32 v213, v213, v236
    v_mfma_f32_16x16x32_bf16 a[32:35], a[212:215], v[140:143], a[32:35]
    s_waitcnt lgkmcnt(5)
    ds_read_b64_tr_b16 a[240:241], v202 offset:32768
    v_add_f32 v214, v214, v237
    v_mfma_f32_16x16x32_bf16 a[44:47], a[216:219], v[128:131], a[44:47]
    ds_read_b64_tr_b16 a[242:243], v202 offset:33792
    v_add_f32 v215, v215, v238
    v_mfma_f32_16x16x32_bf16 a[44:47], a[220:223], v[140:143], a[44:47]
    ds_read_b64_tr_b16 a[244:245], v202 offset:49152
    v_mov_b32 v236, v213
    v_mfma_f32_16x16x32_bf16 a[40:43], a[220:223], v[136:139], a[40:43]
    ds_read_b64_tr_b16 a[246:247], v202 offset:50176
    v_accvgpr_read_b32 v220, a0
    v_mfma_f32_16x16x32_bf16 a[40:43], a[216:219], v[124:127], a[40:43]
    s_mov_b32 s35, 768
    ds_read_b64_tr_b16 a[248:249], v203 offset:32768
    v_accvgpr_read_b32 v221, a1
    v_mfma_f32_16x16x32_bf16 a[36:39], a[216:219], v[120:123], a[36:39]
    ds_read_b64_tr_b16 a[250:251], v203 offset:33792
    v_accvgpr_read_b32 v222, a2
    v_mfma_f32_16x16x32_bf16 a[36:39], a[220:223], v[132:135], a[36:39]
    s_add_u32 s36, s35, 13312
    v_accvgpr_read_b32 v223, a3
    v_accvgpr_read_b32 v224, a12
    v_mfma_f32_16x16x32_bf16 a[48:51], a[224:227], v[120:123], a[48:51]
    s_waitcnt lgkmcnt(7)
    ds_read_b64_tr_b16 a[252:253], v203 offset:49152
    v_accvgpr_read_b32 v225, a13
    v_mfma_f32_16x16x32_bf16 a[48:51], a[228:231], v[132:135], a[48:51]
    s_mov_b32 s92, 832
    ds_read_b64_tr_b16 a[254:255], v203 offset:50176
    v_accvgpr_read_b32 v226, a14
    v_mfma_f32_16x16x32_bf16 a[52:55], a[228:231], v[136:139], a[52:55]
    s_add_u32 s93, s92, 13312
    ds_read_b64_tr_b16 a[192:193], v196 offset:33024
    v_accvgpr_read_b32 v227, a15
    v_mfma_f32_16x16x32_bf16 a[52:55], a[224:227], v[124:127], a[52:55]
    s_add_u32 m0, s32, 131072
    v_cvt_pk_bf16_f32 v0, v220, v221
    v_cvt_pk_bf16_f32 v1, v222, v223
    v_mfma_f32_16x16x32_bf16 a[56:59], a[224:227], v[128:131], a[56:59]
    ds_read_b64_tr_b16 a[194:195], v196 offset:34048
    v_cvt_pk_bf16_f32 v2, v224, v225
    v_mfma_f32_16x16x32_bf16 a[56:59], a[228:231], v[140:143], a[56:59]
    ds_read_b64_tr_b16 a[196:197], v196 offset:49408
    v_cvt_pk_bf16_f32 v3, v226, v227
    v_mfma_f32_16x16x32_bf16 a[68:71], a[232:235], v[128:131], a[68:71]
    s_waitcnt lgkmcnt(7)
    buffer_load_dwordx4 v210, s[24:27], s35 offen offset:0 lds
    v_accvgpr_read_b32 v228, a4
    v_mfma_f32_16x16x32_bf16 a[68:71], a[236:239], v[140:143], a[68:71]
    s_add_u32 m0, s32, 147456
    ds_read_b64_tr_b16 a[198:199], v196 offset:50432
    v_accvgpr_read_b32 v229, a5
    v_mfma_f32_16x16x32_bf16 a[64:67], a[236:239], v[136:139], a[64:67]
    ds_read_b64_tr_b16 a[200:201], v197 offset:33024
    v_accvgpr_read_b32 v230, a6
    v_mfma_f32_16x16x32_bf16 a[64:67], a[232:235], v[124:127], a[64:67]
    buffer_load_dwordx4 v210, s[24:27], s92 offen offset:0 lds
    v_accvgpr_read_b32 v231, a7
    v_mfma_f32_16x16x32_bf16 a[60:63], a[232:235], v[120:123], a[60:63]
    s_add_u32 m0, s32, 131072
    ds_read_b64_tr_b16 a[202:203], v197 offset:34048
    v_accvgpr_read_b32 v232, a16
    v_mfma_f32_16x16x32_bf16 a[60:63], a[236:239], v[132:135], a[60:63]
    ds_read_b64_tr_b16 a[204:205], v197 offset:49408
    v_accvgpr_read_b32 v233, a17
    v_mfma_f32_16x16x32_bf16 a[72:75], a[240:243], v[120:123], a[72:75]
    ds_read_b64_tr_b16 a[206:207], v197 offset:50432
    buffer_load_dwordx4 v211, s[24:27], s35 offen offset:2048 lds
    v_mfma_f32_16x16x32_bf16 a[72:75], a[244:247], v[132:135], a[72:75]
    s_add_u32 m0, s32, 147456
    s_nop 0
    buffer_load_dwordx4 v211, s[24:27], s92 offen offset:2048 lds
    v_accvgpr_read_b32 v234, a18
    v_mfma_f32_16x16x32_bf16 a[76:79], a[244:247], v[136:139], a[76:79]
    s_add_u32 m0, s32, 131072
    ds_read_b64_tr_b16 a[208:209], v198 offset:33024
    v_accvgpr_read_b32 v235, a19
    v_mfma_f32_16x16x32_bf16 a[76:79], a[240:243], v[124:127], a[76:79]
    ds_read_b64_tr_b16 a[210:211], v198 offset:34048
    v_cvt_pk_bf16_f32 v4, v228, v229
    v_mfma_f32_16x16x32_bf16 a[80:83], a[240:243], v[128:131], a[80:83]
    buffer_load_dwordx4 v210, s[24:27], s36 offen offset:1024 lds
    v_cvt_pk_bf16_f32 v5, v230, v231
    v_mfma_f32_16x16x32_bf16 a[80:83], a[244:247], v[140:143], a[80:83]
    s_waitcnt lgkmcnt(6)
    ds_read_b64_tr_b16 a[212:213], v198 offset:49408
    v_cvt_pk_bf16_f32 v6, v232, v233
    v_mfma_f32_16x16x32_bf16 a[92:95], a[248:251], v[128:131], a[92:95]
    s_add_u32 m0, s32, 147456
    ds_read_b64_tr_b16 a[214:215], v198 offset:50432
    v_cvt_pk_bf16_f32 v7, v234, v235
    v_mfma_f32_16x16x32_bf16 a[92:95], a[252:255], v[140:143], a[92:95]
    ds_read_b64_tr_b16 a[216:217], v199 offset:33024
    v_accvgpr_read_b32 v220, a8
    v_mfma_f32_16x16x32_bf16 a[88:91], a[252:255], v[136:139], a[88:91]
    buffer_load_dwordx4 v210, s[24:27], s93 offen offset:1024 lds
    v_accvgpr_read_b32 v221, a9
    v_mfma_f32_16x16x32_bf16 a[88:91], a[248:251], v[124:127], a[88:91]
    s_add_u32 m0, s32, 131072
    ds_read_b64_tr_b16 a[218:219], v199 offset:34048
    v_accvgpr_read_b32 v222, a10
    v_mfma_f32_16x16x32_bf16 a[84:87], a[248:251], v[120:123], a[84:87]
    ds_read_b64_tr_b16 a[220:221], v199 offset:49408
    v_accvgpr_read_b32 v223, a11
    v_mfma_f32_16x16x32_bf16 a[84:87], a[252:255], v[132:135], a[84:87]
    buffer_load_dwordx4 v211, s[24:27], s36 offen offset:3072 lds
    s_add_u32 m0, s32, 147456
    v_mfma_f32_16x16x32_bf16 a[96:99], a[192:195], v[120:123], a[96:99]
    ds_read_b64_tr_b16 a[222:223], v199 offset:50432
    v_accvgpr_read_b32 v224, a20
    v_mfma_f32_16x16x32_bf16 a[96:99], a[196:199], v[132:135], a[96:99]
    ds_read_b64_tr_b16 a[224:225], v200 offset:33024
    v_accvgpr_read_b32 v225, a21
    v_mfma_f32_16x16x32_bf16 a[100:103], a[196:199], v[136:139], a[100:103]
    ds_read_b64_tr_b16 a[226:227], v200 offset:34048
    buffer_load_dwordx4 v211, s[24:27], s93 offen offset:3072 lds
    v_mfma_f32_16x16x32_bf16 a[100:103], a[192:195], v[124:127], a[100:103]
    s_mul_i32 s35, s52, 128
    s_add_u32 s35, s35, 0
    v_accvgpr_read_b32 v226, a22
    v_mfma_f32_16x16x32_bf16 a[104:107], a[192:195], v[128:131], a[104:107]
    s_add_u32 s36, s35, 13312
    ds_read_b64_tr_b16 a[228:229], v200 offset:49408
    v_accvgpr_read_b32 v227, a23
    v_mfma_f32_16x16x32_bf16 a[104:107], a[196:199], v[140:143], a[104:107]
    s_waitcnt lgkmcnt(6)
    ds_read_b64_tr_b16 a[230:231], v200 offset:50432
    v_cvt_pk_bf16_f32 v8, v220, v221
    v_mfma_f32_16x16x32_bf16 a[116:119], a[200:203], v[128:131], a[116:119]
    s_mul_i32 s92, s52, 128
    v_cvt_pk_bf16_f32 v9, v222, v223
    v_cvt_pk_bf16_f32 v10, v224, v225
    v_mfma_f32_16x16x32_bf16 a[116:119], a[204:207], v[140:143], a[116:119]
    s_add_u32 s92, s92, 64
    ds_read_b64_tr_b16 a[232:233], v201 offset:33024
    v_cvt_pk_bf16_f32 v11, v226, v227
    v_mfma_f32_16x16x32_bf16 a[112:115], a[204:207], v[136:139], a[112:115]
    s_add_u32 s93, s92, 13312
    ds_read_b64_tr_b16 a[234:235], v201 offset:34048
    v_mov_b32 v237, v214
    v_mfma_f32_16x16x32_bf16 a[112:115], a[200:203], v[124:127], a[112:115]
    s_add_u32 m0, s32, 0
    ds_read_b64_tr_b16 a[236:237], v201 offset:49408
    v_mov_b32 v238, v215
    v_mfma_f32_16x16x32_bf16 a[108:111], a[200:203], v[120:123], a[108:111]
    v_permlane32_swap_b32 v213, v236
    v_mfma_f32_16x16x32_bf16 a[108:111], a[204:207], v[132:135], a[108:111]
    v_permlane32_swap_b32 v214, v237
    v_mfma_f32_16x16x32_bf16 a[120:123], a[208:211], v[120:123], a[120:123]
    v_permlane32_swap_b32 v215, v238
    v_mfma_f32_16x16x32_bf16 a[120:123], a[212:215], v[132:135], a[120:123]
    ds_read_b64_tr_b16 a[238:239], v201 offset:50432
    buffer_load_dwordx4 v210, s[24:27], s35 offen offset:0 lds
    v_mfma_f32_16x16x32_bf16 a[124:127], a[212:215], v[136:139], a[124:127]
    s_add_u32 m0, s32, 16384
    ds_read_b64_tr_b16 a[240:241], v202 offset:33024
    v_add_f32 v213, v213, v236
    v_mfma_f32_16x16x32_bf16 a[124:127], a[208:211], v[124:127], a[124:127]
    ds_read_b64_tr_b16 a[242:243], v202 offset:34048
    buffer_load_dwordx4 v210, s[24:27], s92 offen offset:0 lds
    v_mfma_f32_16x16x32_bf16 a[128:131], a[208:211], v[128:131], a[128:131]
    s_add_u32 m0, s32, 0
    ds_read_b64_tr_b16 a[244:245], v202 offset:49408
    v_add_f32 v214, v214, v237
    v_mfma_f32_16x16x32_bf16 a[128:131], a[212:215], v[140:143], a[128:131]
    s_waitcnt lgkmcnt(6)
    ds_read_b64_tr_b16 a[246:247], v202 offset:50432
    v_add_f32 v215, v215, v238
    v_mfma_f32_16x16x32_bf16 a[140:143], a[216:219], v[128:131], a[140:143]
    v_rcp_f32 v213, v213
    v_mfma_f32_16x16x32_bf16 a[140:143], a[220:223], v[140:143], a[140:143]
    v_rcp_f32 v214, v214
    v_mfma_f32_16x16x32_bf16 a[136:139], a[220:223], v[136:139], a[136:139]
    v_rcp_f32 v215, v215
    v_mfma_f32_16x16x32_bf16 a[136:139], a[216:219], v[124:127], a[136:139]
    ds_read_b64_tr_b16 a[248:249], v203 offset:33024
    buffer_load_dwordx4 v211, s[24:27], s35 offen offset:2048 lds
    v_mfma_f32_16x16x32_bf16 a[132:135], a[216:219], v[120:123], a[132:135]
    s_add_u32 m0, s32, 16384
    ds_read_b64_tr_b16 a[250:251], v203 offset:34048
    buffer_load_dwordx4 v211, s[24:27], s92 offen offset:2048 lds
    v_mfma_f32_16x16x32_bf16 a[132:135], a[220:223], v[132:135], a[132:135]
    s_add_u32 m0, s32, 0
    ds_read_b64_tr_b16 a[252:253], v203 offset:49408
    buffer_load_dwordx4 v210, s[24:27], s36 offen offset:1024 lds
    v_mfma_f32_16x16x32_bf16 a[144:147], a[224:227], v[120:123], a[144:147]
    s_add_u32 m0, s32, 16384
    ds_read_b64_tr_b16 a[254:255], v203 offset:50432
    v_accvgpr_read_b32 v228, a24
    v_mfma_f32_16x16x32_bf16 a[144:147], a[228:231], v[132:135], a[144:147]
    buffer_load_dwordx4 v210, s[24:27], s93 offen offset:1024 lds
    v_accvgpr_read_b32 v229, a25
    v_mfma_f32_16x16x32_bf16 a[148:151], a[228:231], v[136:139], a[148:151]
    s_add_u32 m0, s32, 0
    s_nop 0
    buffer_load_dwordx4 v211, s[24:27], s36 offen offset:3072 lds
    v_accvgpr_read_b32 v230, a26
    v_mfma_f32_16x16x32_bf16 a[148:151], a[224:227], v[124:127], a[148:151]
    s_add_u32 m0, s32, 16384
    v_accvgpr_read_b32 v231, a27
    v_accvgpr_read_b32 v232, a36
    v_mfma_f32_16x16x32_bf16 a[152:155], a[224:227], v[128:131], a[152:155]
    buffer_load_dwordx4 v211, s[24:27], s93 offen offset:3072 lds
    v_accvgpr_read_b32 v233, a37
    v_mfma_f32_16x16x32_bf16 a[152:155], a[228:231], v[140:143], a[152:155]
    s_waitcnt lgkmcnt(4)
    v_accvgpr_read_b32 v234, a38
    v_accvgpr_read_b32 v235, a39
    v_mfma_f32_16x16x32_bf16 a[164:167], a[232:235], v[128:131], a[164:167]
    v_cvt_pk_bf16_f32 v12, v228, v229
    v_cvt_pk_bf16_f32 v13, v230, v231
    v_mfma_f32_16x16x32_bf16 a[164:167], a[236:239], v[140:143], a[164:167]
    v_cvt_pk_bf16_f32 v14, v232, v233
    v_cvt_pk_bf16_f32 v15, v234, v235
    v_mfma_f32_16x16x32_bf16 a[160:163], a[236:239], v[136:139], a[160:163]
    v_accvgpr_read_b32 v220, a28
    v_accvgpr_read_b32 v221, a29
    v_mfma_f32_16x16x32_bf16 a[160:163], a[232:235], v[124:127], a[160:163]
    v_accvgpr_read_b32 v222, a30
    v_accvgpr_read_b32 v223, a31
    v_mfma_f32_16x16x32_bf16 a[156:159], a[232:235], v[120:123], a[156:159]
    v_accvgpr_read_b32 v224, a40
    v_accvgpr_read_b32 v225, a41
    v_mfma_f32_16x16x32_bf16 a[156:159], a[236:239], v[132:135], a[156:159]
    s_waitcnt vmcnt(8) lgkmcnt(0)
    s_barrier
    ds_read_b64_tr_b16 a[192:193], v194 offset:0
    v_accvgpr_read_b32 v226, a42
    v_mfma_f32_16x16x32_bf16 a[168:171], a[240:243], v[120:123], a[168:171]
    s_cmp_lg_u32 s76, 0
    s_cbranch_scc1 L_far
L_near:
    v_accvgpr_read_b32 v227, a43
    v_cvt_pk_bf16_f32 v16, v220, v221
    v_mfma_f32_16x16x32_bf16 a[168:171], a[244:247], v[132:135], a[168:171]
    ds_read_b64_tr_b16 a[194:195], v194 offset:1024
    v_cvt_pk_bf16_f32 v17, v222, v223
    v_mfma_f32_16x16x32_bf16 a[172:175], a[244:247], v[136:139], a[172:175]
    ds_read_b64_tr_b16 a[196:197], v195 offset:0
    v_mov_b32 v216, 1
    v_mfma_f32_16x16x32_bf16 a[172:175], a[240:243], v[124:127], a[172:175]
    v_lshrrev_b32 v217, 7, v208
    v_cvt_pk_bf16_f32 v18, v224, v225
    v_mfma_f32_16x16x32_bf16 a[176:179], a[240:243], v[128:131], a[176:179]
    ds_read_b64_tr_b16 a[198:199], v195 offset:1024
    v_cvt_pk_bf16_f32 v19, v226, v227
    v_mfma_f32_16x16x32_bf16 a[176:179], a[244:247], v[140:143], a[176:179]
    ds_read_b64_tr_b16 a[200:201], v194 offset:16384
    v_and_b32 v217, 480, v217
    v_mfma_f32_16x16x32_bf16 a[188:191], a[248:251], v[128:131], a[188:191]
    s_mul_i32 s35, s52, 64
    s_add_u32 s35, s35, 512
    s_add_u32 s36, s35, 13312
    v_mfma_f32_16x16x32_bf16 a[188:191], a[252:255], v[140:143], a[188:191]
    s_mul_i32 s92, s53, 64
    ds_read_b64_tr_b16 a[202:203], v194 offset:17408
    s_add_u32 s92, s92, 512
    v_mfma_f32_16x16x32_bf16 a[184:187], a[252:255], v[136:139], a[184:187]
    s_add_u32 s93, s92, 13312
    ds_read_b64_tr_b16 a[204:205], v195 offset:16384
    v_accvgpr_read_b32 v228, a32
    v_mfma_f32_16x16x32_bf16 a[184:187], a[248:251], v[124:127], a[184:187]
    s_add_u32 m0, s32, 65536
    ds_read_b64_tr_b16 a[206:207], v195 offset:17408
    v_accvgpr_read_b32 v229, a33
    v_mfma_f32_16x16x32_bf16 a[180:183], a[248:251], v[120:123], a[180:183]
    buffer_load_dwordx4 v210, s[24:27], s35 offen offset:0 lds
    v_accvgpr_read_b32 v230, a34
    v_mfma_f32_16x16x32_bf16 a[180:183], a[252:255], v[132:135], a[180:183]
    s_waitcnt lgkmcnt(6)
    ds_read_b64_tr_b16 a[208:209], v194 offset:2048
    v_accvgpr_read_b32 v231, a35
    v_mfma_f32_16x16x32_bf16 v[24:27], a[192:195], v[0:3], 0
    s_waitcnt lgkmcnt(5)
    ds_read_b64_tr_b16 a[210:211], v194 offset:3072
    s_add_u32 m0, s32, 49152
    v_mfma_f32_16x16x32_bf16 v[28:31], a[196:199], v[0:3], 0
    buffer_load_dwordx4 v210, s[24:27], s92 offen offset:0 lds
    v_accvgpr_read_b32 v232, a44
    v_mfma_f32_16x16x32_bf16 v[36:39], a[196:199], v[4:7], 0
    s_add_u32 m0, s32, 65536
    ds_read_b64_tr_b16 a[212:213], v195 offset:2048
    v_accvgpr_read_b32 v233, a45
    v_mfma_f32_16x16x32_bf16 v[32:35], a[192:195], v[4:7], 0
    ds_read_b64_tr_b16 a[214:215], v195 offset:3072
    v_accvgpr_read_b32 v234, a46
    v_mfma_f32_16x16x32_bf16 v[40:43], a[192:195], v[8:11], 0
    ds_read_b64_tr_b16 a[216:217], v194 offset:18432
    v_accvgpr_read_b32 v235, a47
    v_mfma_f32_16x16x32_bf16 v[44:47], a[196:199], v[8:11], 0
    s_waitcnt lgkmcnt(7)
    buffer_load_dwordx4 v211, s[24:27], s35 offen offset:2048 lds
    s_add_u32 m0, s32, 49152
    v_mfma_f32_16x16x32_bf16 v[88:91], a[200:203], v[8:11], 0
    s_waitcnt lgkmcnt(5)
    ds_read_b64_tr_b16 a[218:219], v194 offset:19456
    v_cvt_pk_bf16_f32 v20, v228, v229
    v_mfma_f32_16x16x32_bf16 v[92:95], a[204:207], v[8:11], 0
    ds_read_b64_tr_b16 a[220:221], v195 offset:18432
    v_cvt_pk_bf16_f32 v21, v230, v231
    v_mfma_f32_16x16x32_bf16 v[84:87], a[204:207], v[4:7], 0
    buffer_load_dwordx4 v211, s[24:27], s92 offen offset:2048 lds
    s_add_u32 m0, s32, 65536
    v_mfma_f32_16x16x32_bf16 v[80:83], a[200:203], v[4:7], 0
    ds_read_b64_tr_b16 a[222:223], v195 offset:19456
    v_cvt_pk_bf16_f32 v22, v232, v233
    v_mfma_f32_16x16x32_bf16 v[72:75], a[200:203], v[0:3], 0
    ds_read_b64_tr_b16 a[224:225], v194 offset:4096
    buffer_load_dwordx4 v210, s[24:27], s36 offen offset:1024 lds
    v_mfma_f32_16x16x32_bf16 v[76:79], a[204:207], v[0:3], 0
    s_waitcnt lgkmcnt(7)
    ds_read_b64_tr_b16 a[226:227], v194 offset:5120
    s_add_u32 m0, s32, 49152
    v_mfma_f32_16x16x32_bf16 v[24:27], a[208:211], v[12:15], v[24:27]
    s_waitcnt lgkmcnt(6)
    buffer_load_dwordx4 v210, s[24:27], s93 offen offset:1024 lds
    v_cvt_pk_bf16_f32 v23, v234, v235
    v_mfma_f32_16x16x32_bf16 v[28:31], a[212:215], v[12:15], v[28:31]
    s_add_u32 m0, s32, 65536
    ds_read_b64_tr_b16 a[228:229], v195 offset:4096
    v_accvgpr_read_b32 v220, a48
    v_mfma_f32_16x16x32_bf16 v[36:39], a[212:215], v[16:19], v[36:39]
    ds_read_b64_tr_b16 a[230:231], v195 offset:5120
    v_accvgpr_read_b32 v221, a49
    v_mfma_f32_16x16x32_bf16 v[32:35], a[208:211], v[16:19], v[32:35]
    buffer_load_dwordx4 v211, s[24:27], s36 offen offset:3072 lds
    s_add_u32 m0, s32, 49152
    v_mfma_f32_16x16x32_bf16 v[40:43], a[208:211], v[20:23], v[40:43]
    ds_read_b64_tr_b16 a[232:233], v194 offset:20480
    v_accvgpr_read_b32 v222, a50
    v_mfma_f32_16x16x32_bf16 v[44:47], a[212:215], v[20:23], v[44:47]
    s_waitcnt lgkmcnt(6)
    ds_read_b64_tr_b16 a[234:235], v194 offset:21504
    v_accvgpr_read_b32 v223, a51
    v_mfma_f32_16x16x32_bf16 v[88:91], a[216:219], v[20:23], v[88:91]
    s_waitcnt lgkmcnt(6)
    ds_read_b64_tr_b16 a[236:237], v195 offset:20480
    buffer_load_dwordx4 v211, s[24:27], s93 offen offset:3072 lds
    v_mfma_f32_16x16x32_bf16 v[92:95], a[220:223], v[20:23], v[92:95]
    s_mul_i32 s35, s53, 128
    s_add_u32 s35, s35, 0
    v_accvgpr_read_b32 v224, a60
    v_mfma_f32_16x16x32_bf16 v[84:87], a[220:223], v[16:19], v[84:87]
    s_add_u32 s36, s35, 13312
    ds_read_b64_tr_b16 a[238:239], v195 offset:21504
    v_accvgpr_read_b32 v225, a61
    v_mfma_f32_16x16x32_bf16 v[80:83], a[216:219], v[16:19], v[80:83]
    s_mul_i32 s92, s53, 128
    ds_read_b64_tr_b16 a[240:241], v194 offset:6144
    v_accvgpr_read_b32 v226, a62
    v_mfma_f32_16x16x32_bf16 v[72:75], a[216:219], v[12:15], v[72:75]
    s_add_u32 s92, s92, 64
    v_accvgpr_read_b32 v227, a63
    v_cvt_pk_bf16_f32 v48, v220, v221
    v_mfma_f32_16x16x32_bf16 v[76:79], a[220:223], v[12:15], v[76:79]
    s_add_u32 s93, s92, 13312
    ds_read_b64_tr_b16 a[242:243], v194 offset:7168
    v_cvt_pk_bf16_f32 v49, v222, v223
    v_cvt_pk_bf16_f32 v50, v224, v225
    v_cvt_pk_bf16_f32 v51, v226, v227
    s_waitcnt lgkmcnt(7)
    s_nop 0
    v_mfma_f32_16x16x32_bf16 v[24:27], a[224:227], v[48:51], v[24:27]
    s_waitcnt lgkmcnt(6)
    ds_read_b64_tr_b16 a[244:245], v195 offset:6144
    v_accvgpr_read_b32 v228, a52
    v_mfma_f32_16x16x32_bf16 v[28:31], a[228:231], v[48:51], v[28:31]
    s_add_u32 m0, s32, 81920
    ds_read_b64_tr_b16 a[246:247], v195 offset:7168
    v_accvgpr_read_b32 v229, a53
    v_accvgpr_read_b32 v230, a54
    v_accvgpr_read_b32 v231, a55
    v_accvgpr_read_b32 v232, a64
    v_accvgpr_read_b32 v233, a65
    v_accvgpr_read_b32 v234, a66
    v_accvgpr_read_b32 v235, a67
    v_cvt_pk_bf16_f32 v52, v228, v229
    v_cvt_pk_bf16_f32 v53, v230, v231
    v_cvt_pk_bf16_f32 v54, v232, v233
    v_cvt_pk_bf16_f32 v55, v234, v235
    s_nop 1
    v_mfma_f32_16x16x32_bf16 v[36:39], a[228:231], v[52:55], v[36:39]
    buffer_load_dwordx4 v210, s[24:27], s35 offen offset:0 lds
    v_accvgpr_read_b32 v220, a56
    v_mfma_f32_16x16x32_bf16 v[32:35], a[224:227], v[52:55], v[32:35]
    s_add_u32 m0, s32, 32768
    ds_read_b64_tr_b16 a[248:249], v194 offset:22528
    v_accvgpr_read_b32 v221, a57
    v_accvgpr_read_b32 v222, a58
    v_accvgpr_read_b32 v223, a59
    v_accvgpr_read_b32 v224, a68
    v_accvgpr_read_b32 v225, a69
    v_accvgpr_read_b32 v226, a70
    v_accvgpr_read_b32 v227, a71
    v_cvt_pk_bf16_f32 v56, v220, v221
    v_cvt_pk_bf16_f32 v57, v222, v223
    v_cvt_pk_bf16_f32 v58, v224, v225
    v_cvt_pk_bf16_f32 v59, v226, v227
    s_nop 1
    v_mfma_f32_16x16x32_bf16 v[40:43], a[224:227], v[56:59], v[40:43]
    ds_read_b64_tr_b16 a[250:251], v194 offset:23552
    v_accvgpr_read_b32 v228, a72
    v_mfma_f32_16x16x32_bf16 v[44:47], a[228:231], v[56:59], v[44:47]
    s_waitcnt lgkmcnt(7)
    buffer_load_dwordx4 v210, s[24:27], s92 offen offset:0 lds
    v_accvgpr_read_b32 v229, a73
    v_mfma_f32_16x16x32_bf16 v[88:91], a[232:235], v[56:59], v[88:91]
    s_waitcnt lgkmcnt(6)
    ds_read_b64_tr_b16 a[252:253], v195 offset:22528
    s_add_u32 m0, s32, 81920
    v_mfma_f32_16x16x32_bf16 v[92:95], a[236:239], v[56:59], v[92:95]
    ds_read_b64_tr_b16 a[254:255], v195 offset:23552
    v_accvgpr_read_b32 v230, a74
    v_mfma_f32_16x16x32_bf16 v[84:87], a[236:239], v[52:55], v[84:87]
    ds_read_b64_tr_b16 a[192:193], v194 offset:8192
    buffer_load_dwordx4 v211, s[24:27], s35 offen offset:2048 lds
    v_mfma_f32_16x16x32_bf16 v[80:83], a[232:235], v[52:55], v[80:83]
    s_add_u32 m0, s32, 32768
    s_nop 0
    buffer_load_dwordx4 v211, s[24:27], s92 offen offset:2048 lds
    v_accvgpr_read_b32 v231, a75
    v_mfma_f32_16x16x32_bf16 v[72:75], a[232:235], v[48:51], v[72:75]
    s_add_u32 m0, s32, 81920
    ds_read_b64_tr_b16 a[194:195], v194 offset:9216
    v_accvgpr_read_b32 v232, a84
    v_mfma_f32_16x16x32_bf16 v[76:79], a[236:239], v[48:51], v[76:79]
    ds_read_b64_tr_b16 a[196:197], v195 offset:8192
    v_accvgpr_read_b32 v233, a85
    v_accvgpr_read_b32 v234, a86
    v_accvgpr_read_b32 v235, a87
    v_cvt_pk_bf16_f32 v60, v228, v229
    v_cvt_pk_bf16_f32 v61, v230, v231
    v_cvt_pk_bf16_f32 v62, v232, v233
    v_cvt_pk_bf16_f32 v63, v234, v235
    s_waitcnt lgkmcnt(7)
    s_nop 0
    v_mfma_f32_16x16x32_bf16 v[24:27], a[240:243], v[60:63], v[24:27]
L_hop1_1:
L_pad6:
    s_cbranch_execz L_pad10
    buffer_load_dwordx4 v210, s[24:27], s36 offen offset:1024 lds
    v_accvgpr_read_b32 v220, a76
    v_mfma_f32_16x16x32_bf16 v[28:31], a[244:247], v[60:63], v[28:31]
    s_add_u32 m0, s32, 32768
    ds_read_b64_tr_b16 a[198:199], v195 offset:9216
    v_accvgpr_read_b32 v221, a77
    v_accvgpr_read_b32 v222, a78
    v_accvgpr_read_b32 v223, a79
    v_accvgpr_read_b32 v224, a88
    v_accvgpr_read_b32 v225, a89
    v_accvgpr_read_b32 v226, a90
    v_accvgpr_read_b32 v227, a91
    v_cvt_pk_bf16_f32 v64, v220, v221
    v_cvt_pk_bf16_f32 v65, v222, v223
    v_cvt_pk_bf16_f32 v66, v224, v225
    v_cvt_pk_bf16_f32 v67, v226, v227
    s_nop 1
    v_mfma_f32_16x16x32_bf16 v[36:39], a[244:247], v[64:67], v[36:39]
    ds_read_b64_tr_b16 a[200:201], v194 offset:24576
    v_accvgpr_read_b32 v228, a80
    v_mfma_f32_16x16x32_bf16 v[32:35], a[240:243], v[64:67], v[32:35]
    buffer_load_dwordx4 v210, s[24:27], s93 offen offset:1024 lds
    v_accvgpr_read_b32 v229, a81
    v_accvgpr_read_b32 v230, a82
    v_accvgpr_read_b32 v231, a83
    v_accvgpr_read_b32 v232, a92
    v_accvgpr_read_b32 v233, a93
    v_accvgpr_read_b32 v234, a94
    v_accvgpr_read_b32 v235, a95
    v_cvt_pk_bf16_f32 v68, v228, v229
    v_cvt_pk_bf16_f32 v69, v230, v231
    v_cvt_pk_bf16_f32 v70, v232, v233
    v_cvt_pk_bf16_f32 v71, v234, v235
    s_nop 1
    v_mfma_f32_16x16x32_bf16 v[40:43], a[240:243], v[68:71], v[40:43]
    s_add_u32 m0, s32, 81920
    ds_read_b64_tr_b16 a[202:203], v194 offset:25600
    v_accvgpr_read_b32 v220, a96
    v_mfma_f32_16x16x32_bf16 v[44:47], a[244:247], v[68:71], v[44:47]
    s_waitcnt lgkmcnt(6)
    ds_read_b64_tr_b16 a[204:205], v195 offset:24576
    v_accvgpr_read_b32 v221, a97
    v_mfma_f32_16x16x32_bf16 v[88:91], a[248:251], v[68:71], v[88:91]
    ds_read_b64_tr_b16 a[206:207], v195 offset:25600
    buffer_load_dwordx4 v211, s[24:27], s36 offen offset:3072 lds
    v_mfma_f32_16x16x32_bf16 v[92:95], a[252:255], v[68:71], v[92:95]
    s_add_u32 m0, s32, 32768
    s_nop 0
    buffer_load_dwordx4 v211, s[24:27], s93 offen offset:3072 lds
    v_accvgpr_read_b32 v222, a98
    v_mfma_f32_16x16x32_bf16 v[84:87], a[252:255], v[64:67], v[84:87]
    ds_read_b64_tr_b16 a[208:209], v194 offset:10240
    v_accvgpr_read_b32 v223, a99
    v_mfma_f32_16x16x32_bf16 v[80:83], a[248:251], v[64:67], v[80:83]
    ds_read_b64_tr_b16 a[210:211], v194 offset:11264
    v_accvgpr_read_b32 v224, a108
    v_mfma_f32_16x16x32_bf16 v[72:75], a[248:251], v[60:63], v[72:75]
    buffer_load_dword v192, v254, s[68:71], s45 offen
    s_add_u32 s45, s45, 4608
    v_mfma_f32_16x16x32_bf16 v[76:79], a[252:255], v[60:63], v[76:79]
    ds_read_b64_tr_b16 a[212:213], v195 offset:10240
    v_accvgpr_read_b32 v225, a109
    v_accvgpr_read_b32 v226, a110
    v_accvgpr_read_b32 v227, a111
    v_cvt_pk_bf16_f32 v96, v220, v221
    v_cvt_pk_bf16_f32 v97, v222, v223
    v_cvt_pk_bf16_f32 v98, v224, v225
    v_cvt_pk_bf16_f32 v99, v226, v227
    s_waitcnt lgkmcnt(7)
    s_nop 0
    v_mfma_f32_16x16x32_bf16 v[24:27], a[192:195], v[96:99], v[24:27]
    ds_read_b64_tr_b16 a[214:215], v195 offset:11264
    v_accvgpr_read_b32 v228, a100
    v_mfma_f32_16x16x32_bf16 v[28:31], a[196:199], v[96:99], v[28:31]
    ds_read_b64_tr_b16 a[216:217], v194 offset:26624
    buffer_load_dword v193, v254, s[68:71], s45 offen
    v_accvgpr_read_b32 v229, a101
    v_accvgpr_read_b32 v230, a102
    v_accvgpr_read_b32 v231, a103
    v_accvgpr_read_b32 v232, a112
    v_accvgpr_read_b32 v233, a113
    v_accvgpr_read_b32 v234, a114
    v_accvgpr_read_b32 v235, a115
    v_cvt_pk_bf16_f32 v100, v228, v229
    v_cvt_pk_bf16_f32 v101, v230, v231
    v_cvt_pk_bf16_f32 v102, v232, v233
    v_cvt_pk_bf16_f32 v103, v234, v235
    s_nop 1
    v_mfma_f32_16x16x32_bf16 v[36:39], a[196:199], v[100:103], v[36:39]
    s_add_u32 s45, s45, 4608
    v_accvgpr_read_b32 v220, a104
    v_accvgpr_read_b32 v221, a105
    v_mfma_f32_16x16x32_bf16 v[32:35], a[192:195], v[100:103], v[32:35]
    ds_read_b64_tr_b16 a[218:219], v194 offset:27648
    v_accvgpr_read_b32 v222, a106
    v_accvgpr_read_b32 v223, a107
    v_accvgpr_read_b32 v224, a116
    v_accvgpr_read_b32 v225, a117
    v_accvgpr_read_b32 v226, a118
    v_accvgpr_read_b32 v227, a119
    v_cvt_pk_bf16_f32 v104, v220, v221
    v_cvt_pk_bf16_f32 v105, v222, v223
    v_cvt_pk_bf16_f32 v106, v224, v225
    v_cvt_pk_bf16_f32 v107, v226, v227
    s_nop 1
    v_mfma_f32_16x16x32_bf16 v[40:43], a[192:195], v[104:107], v[40:43]
    ds_read_b64_tr_b16 a[220:221], v195 offset:26624
    v_accvgpr_read_b32 v228, a120
    v_mfma_f32_16x16x32_bf16 v[44:47], a[196:199], v[104:107], v[44:47]
    s_waitcnt lgkmcnt(7)
    v_accvgpr_read_b32 v229, a121
    v_accvgpr_read_b32 v230, a122
    v_mfma_f32_16x16x32_bf16 v[88:91], a[200:203], v[104:107], v[88:91]
    ds_read_b64_tr_b16 a[222:223], v195 offset:27648
    v_accvgpr_read_b32 v231, a123
    v_mfma_f32_16x16x32_bf16 v[92:95], a[204:207], v[104:107], v[92:95]
    ds_read_b64_tr_b16 a[224:225], v194 offset:12288
    v_accvgpr_read_b32 v232, a132
    v_mfma_f32_16x16x32_bf16 v[84:87], a[204:207], v[100:103], v[84:87]
    ds_read_b64_tr_b16 a[226:227], v194 offset:13312
    v_accvgpr_read_b32 v233, a133
    v_mfma_f32_16x16x32_bf16 v[80:83], a[200:203], v[100:103], v[80:83]
    v_accvgpr_read_b32 v234, a134
    v_accvgpr_read_b32 v235, a135
    v_mfma_f32_16x16x32_bf16 v[72:75], a[200:203], v[96:99], v[72:75]
    ds_read_b64_tr_b16 a[228:229], v195 offset:12288
    v_cvt_pk_bf16_f32 v108, v228, v229
    v_mfma_f32_16x16x32_bf16 v[76:79], a[204:207], v[96:99], v[76:79]
    ds_read_b64_tr_b16 a[230:231], v195 offset:13312
    v_cvt_pk_bf16_f32 v109, v230, v231
    v_cvt_pk_bf16_f32 v110, v232, v233
    v_cvt_pk_bf16_f32 v111, v234, v235
    s_waitcnt lgkmcnt(7)
    s_nop 0
    v_mfma_f32_16x16x32_bf16 v[24:27], a[208:211], v[108:111], v[24:27]
    v_accvgpr_read_b32 v220, a124
    v_accvgpr_read_b32 v221, a125
    v_mfma_f32_16x16x32_bf16 v[28:31], a[212:215], v[108:111], v[28:31]
    ds_read_b64_tr_b16 a[232:233], v194 offset:28672
    v_accvgpr_read_b32 v222, a126
    v_accvgpr_read_b32 v223, a127
    v_accvgpr_read_b32 v224, a136
    v_accvgpr_read_b32 v225, a137
    v_accvgpr_read_b32 v226, a138
    v_accvgpr_read_b32 v227, a139
    v_cvt_pk_bf16_f32 v112, v220, v221
    v_cvt_pk_bf16_f32 v113, v222, v223
    v_cvt_pk_bf16_f32 v114, v224, v225
    v_cvt_pk_bf16_f32 v115, v226, v227
    s_nop 1
    v_mfma_f32_16x16x32_bf16 v[36:39], a[212:215], v[112:115], v[36:39]
    ds_read_b64_tr_b16 a[234:235], v194 offset:29696
    v_accvgpr_read_b32 v228, a128
    v_mfma_f32_16x16x32_bf16 v[32:35], a[208:211], v[112:115], v[32:35]
    ds_read_b64_tr_b16 a[236:237], v195 offset:28672
    v_accvgpr_read_b32 v229, a129
    v_accvgpr_read_b32 v230, a130
    v_accvgpr_read_b32 v231, a131
    v_accvgpr_read_b32 v232, a140
    v_accvgpr_read_b32 v233, a141
    v_accvgpr_read_b32 v234, a142
    v_accvgpr_read_b32 v235, a143
    v_cvt_pk_bf16_f32 v116, v228, v229
    v_cvt_pk_bf16_f32 v117, v230, v231
    v_cvt_pk_bf16_f32 v118, v232, v233
    v_cvt_pk_bf16_f32 v119, v234, v235
    s_nop 1
    v_mfma_f32_16x16x32_bf16 v[40:43], a[208:211], v[116:119], v[40:43]
    v_accvgpr_read_b32 v220, a144
    v_accvgpr_read_b32 v221, a145
    v_mfma_f32_16x16x32_bf16 v[44:47], a[212:215], v[116:119], v[44:47]
    s_waitcnt lgkmcnt(6)
    ds_read_b64_tr_b16 a[238:239], v195 offset:29696
    v_accvgpr_read_b32 v222, a146
    v_mfma_f32_16x16x32_bf16 v[88:91], a[216:219], v[116:119], v[88:91]
    ds_read_b64_tr_b16 a[240:241], v194 offset:14336
    v_accvgpr_read_b32 v223, a147
    v_mfma_f32_16x16x32_bf16 v[92:95], a[220:223], v[116:119], v[92:95]
    v_accvgpr_read_b32 v224, a156
    v_accvgpr_read_b32 v225, a157
    v_mfma_f32_16x16x32_bf16 v[84:87], a[220:223], v[112:115], v[84:87]
    ds_read_b64_tr_b16 a[242:243], v194 offset:15360
    v_accvgpr_read_b32 v226, a158
    v_mfma_f32_16x16x32_bf16 v[80:83], a[216:219], v[112:115], v[80:83]
    ds_read_b64_tr_b16 a[244:245], v195 offset:14336
    v_accvgpr_read_b32 v227, a159
    v_mfma_f32_16x16x32_bf16 v[72:75], a[216:219], v[108:111], v[72:75]
    ds_read_b64_tr_b16 a[246:247], v195 offset:15360
    v_cvt_pk_bf16_f32 v144, v220, v221
    v_mfma_f32_16x16x32_bf16 v[76:79], a[220:223], v[108:111], v[76:79]
    v_cvt_pk_bf16_f32 v145, v222, v223
    v_cvt_pk_bf16_f32 v146, v224, v225
    v_cvt_pk_bf16_f32 v147, v226, v227
    s_waitcnt lgkmcnt(7)
    s_nop 0
    v_mfma_f32_16x16x32_bf16 v[24:27], a[224:227], v[144:147], v[24:27]
    ds_read_b64_tr_b16 a[248:249], v194 offset:30720
    v_accvgpr_read_b32 v228, a148
    v_mfma_f32_16x16x32_bf16 v[28:31], a[228:231], v[144:147], v[28:31]
    ds_read_b64_tr_b16 a[250:251], v194 offset:31744
    v_accvgpr_read_b32 v229, a149
    v_accvgpr_read_b32 v230, a150
    v_accvgpr_read_b32 v231, a151
    v_accvgpr_read_b32 v232, a160
    v_accvgpr_read_b32 v233, a161
    v_accvgpr_read_b32 v234, a162
    v_accvgpr_read_b32 v235, a163
    v_cvt_pk_bf16_f32 v148, v228, v229
    v_cvt_pk_bf16_f32 v149, v230, v231
    v_cvt_pk_bf16_f32 v150, v232, v233
    v_cvt_pk_bf16_f32 v151, v234, v235
    s_nop 1
    v_mfma_f32_16x16x32_bf16 v[36:39], a[228:231], v[148:151], v[36:39]
    v_accvgpr_read_b32 v220, a152
    v_accvgpr_read_b32 v221, a153
    v_mfma_f32_16x16x32_bf16 v[32:35], a[224:227], v[148:151], v[32:35]
    ds_read_b64_tr_b16 a[252:253], v195 offset:30720
    v_accvgpr_read_b32 v222, a154
    v_accvgpr_read_b32 v223, a155
    v_accvgpr_read_b32 v224, a164
    v_accvgpr_read_b32 v225, a165
    v_accvgpr_read_b32 v226, a166
    v_accvgpr_read_b32 v227, a167
    v_cvt_pk_bf16_f32 v152, v220, v221
    v_cvt_pk_bf16_f32 v153, v222, v223
    v_cvt_pk_bf16_f32 v154, v224, v225
    v_cvt_pk_bf16_f32 v155, v226, v227
    s_nop 1
    v_mfma_f32_16x16x32_bf16 v[40:43], a[224:227], v[152:155], v[40:43]
    ds_read_b64_tr_b16 a[254:255], v195 offset:31744
    v_accvgpr_read_b32 v228, a168
    v_mfma_f32_16x16x32_bf16 v[44:47], a[228:231], v[152:155], v[44:47]
    s_waitcnt lgkmcnt(7)
    v_add_u32 v194, 0xfffe0000, v194
    v_accvgpr_read_b32 v229, a169
    v_mfma_f32_16x16x32_bf16 v[88:91], a[232:235], v[152:155], v[88:91]
    v_accvgpr_read_b32 v230, a170
    v_accvgpr_read_b32 v231, a171
    v_mfma_f32_16x16x32_bf16 v[92:95], a[236:239], v[152:155], v[92:95]
    v_accvgpr_read_b32 v232, a180
    v_accvgpr_read_b32 v233, a181
    v_mfma_f32_16x16x32_bf16 v[84:87], a[236:239], v[148:151], v[84:87]
    v_add_u32 v195, 0xfffe0000, v195
    v_accvgpr_read_b32 v234, a182
    v_mfma_f32_16x16x32_bf16 v[80:83], a[232:235], v[148:151], v[80:83]
    v_accvgpr_read_b32 v235, a183
    v_cvt_pk_bf16_f32 v156, v228, v229
    v_mfma_f32_16x16x32_bf16 v[72:75], a[232:235], v[144:147], v[72:75]
    v_cvt_pk_bf16_f32 v157, v230, v231
    v_cvt_pk_bf16_f32 v158, v232, v233
    v_mfma_f32_16x16x32_bf16 v[76:79], a[236:239], v[144:147], v[76:79]
    s_waitcnt vmcnt(18) lgkmcnt(0)
    s_barrier
    ds_read_b64_tr_b16 a[192:193], v194 offset:0
    v_cvt_pk_bf16_f32 v159, v234, v235
    s_nop 1
    v_mfma_f32_16x16x32_bf16 v[24:27], a[240:243], v[156:159], v[24:27]
    v_bfe_u32 v249, v208, 12, 4
    v_accvgpr_read_b32 v220, a172
    v_mfma_f32_16x16x32_bf16 v[28:31], a[244:247], v[156:159], v[28:31]
    ds_read_b64_tr_b16 a[194:195], v194 offset:1024
    v_accvgpr_read_b32 v221, a173
    v_accvgpr_read_b32 v222, a174
    v_accvgpr_read_b32 v223, a175
    v_accvgpr_read_b32 v224, a184
    v_accvgpr_read_b32 v225, a185
    v_accvgpr_read_b32 v226, a186
    v_accvgpr_read_b32 v227, a187
    v_cvt_pk_bf16_f32 v160, v220, v221
    v_cvt_pk_bf16_f32 v161, v222, v223
    v_cvt_pk_bf16_f32 v162, v224, v225
    v_cvt_pk_bf16_f32 v163, v226, v227
    s_nop 1
    v_mfma_f32_16x16x32_bf16 v[36:39], a[244:247], v[160:163], v[36:39]
    ds_read_b64_tr_b16 a[196:197], v194 offset:2048
    v_lshrrev_b32 v250, 16, v208
    v_mfma_f32_16x16x32_bf16 v[32:35], a[240:243], v[160:163], v[32:35]
    v_mul_lo_u32 v248, s47, v250
    v_accvgpr_read_b32 v228, a176
    v_accvgpr_read_b32 v229, a177
    v_accvgpr_read_b32 v230, a178
    v_accvgpr_read_b32 v231, a179
    v_accvgpr_read_b32 v232, a188
    v_accvgpr_read_b32 v233, a189
    v_accvgpr_read_b32 v234, a190
    v_accvgpr_read_b32 v235, a191
    v_cvt_pk_bf16_f32 v164, v228, v229
    v_cvt_pk_bf16_f32 v165, v230, v231
    v_cvt_pk_bf16_f32 v166, v232, v233
    v_cvt_pk_bf16_f32 v167, v234, v235
    s_nop 1
    v_mfma_f32_16x16x32_bf16 v[40:43], a[240:243], v[164:167], v[40:43]
    ds_read_b64_tr_b16 a[198:199], v194 offset:3072
    v_lshl_add_u32 v248, v249, 4, v248
    v_mfma_f32_16x16x32_bf16 v[44:47], a[244:247], v[164:167], v[44:47]
    ds_read_b64_tr_b16 a[200:201], v194 offset:4096
    v_add_u32 v248, s46, v248
    v_mfma_f32_16x16x32_bf16 v[88:91], a[248:251], v[164:167], v[88:91]
    v_mfma_f32_16x16x32_bf16 v[92:95], a[252:255], v[164:167], v[92:95]
    ds_read_b64_tr_b16 a[202:203], v194 offset:5120
    v_mfma_f32_16x16x32_bf16 v[84:87], a[252:255], v[160:163], v[84:87]
    ds_read_b64_tr_b16 a[204:205], v194 offset:6144
    v_mfma_f32_16x16x32_bf16 v[80:83], a[248:251], v[160:163], v[80:83]
    ds_read_b64_tr_b16 a[206:207], v194 offset:7168
    v_mfma_f32_16x16x32_bf16 v[72:75], a[248:251], v[156:159], v[72:75]
    v_mfma_f32_16x16x32_bf16 v[76:79], a[252:255], v[156:159], v[76:79]
    s_waitcnt lgkmcnt(6)
    ds_read_b64_tr_b16 a[208:209], v194 offset:8192
    v_mul_f32 v24, v213, v24
    v_mfma_f32_16x16x32_bf16 v[120:123], a[192:195], v[0:3], 0
    s_waitcnt lgkmcnt(5)
    ds_read_b64_tr_b16 a[210:211], v194 offset:9216
    v_mul_f32 v25, v213, v25
    v_mfma_f32_16x16x32_bf16 v[120:123], a[196:199], v[12:15], v[120:123]
    s_waitcnt lgkmcnt(4)
    v_mfma_f32_16x16x32_bf16 v[120:123], a[200:203], v[48:51], v[120:123]
    s_waitcnt lgkmcnt(2)
    ds_read_b64_tr_b16 a[212:213], v194 offset:10240
    v_mul_f32 v26, v213, v26
    v_mfma_f32_16x16x32_bf16 v[120:123], a[204:207], v[60:63], v[120:123]
    s_add_u32 s4, s63, 0
    ds_read_b64_tr_b16 a[214:215], v194 offset:11264
    v_mul_f32 v27, v213, v27
    v_mfma_f32_16x16x32_bf16 v[128:131], a[204:207], v[64:67], 0
    ds_read_b64_tr_b16 a[216:217], v194 offset:12288
    v_cvt_pk_bf16_f32 v24, v24, v25
    v_mfma_f32_16x16x32_bf16 v[128:131], a[200:203], v[52:55], v[128:131]
    v_mfma_f32_16x16x32_bf16 v[128:131], a[196:199], v[16:19], v[128:131]
    ds_read_b64_tr_b16 a[218:219], v194 offset:13312
    v_cvt_pk_bf16_f32 v25, v26, v27
    v_mfma_f32_16x16x32_bf16 v[128:131], a[192:195], v[4:7], v[128:131]
    ds_read_b64_tr_b16 a[220:221], v194 offset:14336
    v_mul_f32 v32, v214, v32
    v_mfma_f32_16x16x32_bf16 v[136:139], a[192:195], v[8:11], 0
    v_mul_f32 v33, v214, v33
    v_mul_f32 v34, v214, v34
    v_mfma_f32_16x16x32_bf16 v[136:139], a[196:199], v[20:23], v[136:139]
    ds_read_b64_tr_b16 a[222:223], v194 offset:15360
    v_mul_f32 v35, v214, v35
    v_mfma_f32_16x16x32_bf16 v[136:139], a[200:203], v[56:59], v[136:139]
    ds_read_b64_tr_b16 a[224:225], v195 offset:0
    v_cvt_pk_bf16_f32 v32, v32, v33
    v_mfma_f32_16x16x32_bf16 v[136:139], a[204:207], v[68:71], v[136:139]
    s_waitcnt lgkmcnt(7)
    ds_read_b64_tr_b16 a[226:227], v195 offset:1024
    v_cvt_pk_bf16_f32 v33, v34, v35
    v_mfma_f32_16x16x32_bf16 v[136:139], a[208:211], v[104:107], v[136:139]
    s_waitcnt lgkmcnt(6)
    v_mul_f32 v40, v215, v40
    v_mul_f32 v41, v215, v41
    v_mfma_f32_16x16x32_bf16 v[136:139], a[212:215], v[116:119], v[136:139]
    s_waitcnt lgkmcnt(4)
    ds_read_b64_tr_b16 a[228:229], v195 offset:2048
    v_mul_f32 v42, v215, v42
    v_mfma_f32_16x16x32_bf16 v[136:139], a[216:219], v[152:155], v[136:139]
    s_waitcnt lgkmcnt(3)
    ds_read_b64_tr_b16 a[230:231], v195 offset:3072
    v_mul_f32 v43, v215, v43
    v_mfma_f32_16x16x32_bf16 v[136:139], a[220:223], v[164:167], v[136:139]
    v_cvt_pk_bf16_f32 v40, v40, v41
    v_cvt_pk_bf16_f32 v41, v42, v43
    v_mfma_f32_16x16x32_bf16 v[128:131], a[220:223], v[160:163], v[128:131]
    ds_read_b64_tr_b16 a[232:233], v195 offset:4096
    v_mul_f32 v28, v213, v28
    v_mfma_f32_16x16x32_bf16 v[128:131], a[216:219], v[148:151], v[128:131]
    ds_read_b64_tr_b16 a[234:235], v195 offset:5120
    v_mul_f32 v29, v213, v29
    v_mfma_f32_16x16x32_bf16 v[128:131], a[212:215], v[112:115], v[128:131]
    ds_read_b64_tr_b16 a[236:237], v195 offset:6144
    v_mul_f32 v30, v213, v30
    v_mfma_f32_16x16x32_bf16 v[128:131], a[208:211], v[100:103], v[128:131]
    v_mul_f32 v31, v213, v31
    v_cvt_pk_bf16_f32 v26, v28, v29
    v_mfma_f32_16x16x32_bf16 v[120:123], a[208:211], v[96:99], v[120:123]
    ds_read_b64_tr_b16 a[238:239], v195 offset:7168
    v_cvt_pk_bf16_f32 v27, v30, v31
    v_mfma_f32_16x16x32_bf16 v[120:123], a[212:215], v[108:111], v[120:123]
    buffer_store_dwordx4 v[24:27], v212, s[68:71], s4 offen offset:0 sc1
    v_mul_f32 v36, v214, v36
    v_mfma_f32_16x16x32_bf16 v[120:123], a[216:219], v[144:147], v[120:123]
    ds_read_b64_tr_b16 a[240:241], v195 offset:8192
    v_mul_f32 v37, v214, v37
    v_mfma_f32_16x16x32_bf16 v[120:123], a[220:223], v[156:159], v[120:123]
    s_waitcnt lgkmcnt(6)
    ds_read_b64_tr_b16 a[242:243], v195 offset:9216
    v_mul_f32 v38, v214, v38
    v_mfma_f32_16x16x32_bf16 v[124:127], a[224:227], v[0:3], 0
    s_waitcnt lgkmcnt(6)
    ds_read_b64_tr_b16 a[244:245], v195 offset:10240
    v_mul_f32 v39, v214, v39
    v_mfma_f32_16x16x32_bf16 v[124:127], a[228:231], v[12:15], v[124:127]
    s_waitcnt lgkmcnt(5)
    ds_read_b64_tr_b16 a[246:247], v195 offset:11264
    v_cvt_pk_bf16_f32 v34, v36, v37
    v_mfma_f32_16x16x32_bf16 v[124:127], a[232:235], v[48:51], v[124:127]
    s_waitcnt lgkmcnt(4)
    v_cvt_pk_bf16_f32 v35, v38, v39
    v_mul_f32 v44, v215, v44
    v_mfma_f32_16x16x32_bf16 v[124:127], a[236:239], v[60:63], v[124:127]
    buffer_store_dwordx4 v[32:35], v212, s[68:71], s4 offen offset:1024 sc1
    v_mul_f32 v45, v215, v45
    v_mfma_f32_16x16x32_bf16 v[132:135], a[236:239], v[64:67], 0
    ds_read_b64_tr_b16 a[248:249], v195 offset:12288
    v_mul_f32 v46, v215, v46
    v_mfma_f32_16x16x32_bf16 v[132:135], a[232:235], v[52:55], v[132:135]
    ds_read_b64_tr_b16 a[250:251], v195 offset:13312
    v_mul_f32 v47, v215, v47
    v_mfma_f32_16x16x32_bf16 v[132:135], a[228:231], v[16:19], v[132:135]
    ds_read_b64_tr_b16 a[252:253], v195 offset:14336
    v_cvt_pk_bf16_f32 v42, v44, v45
    v_mfma_f32_16x16x32_bf16 v[132:135], a[224:227], v[4:7], v[132:135]
    ds_read_b64_tr_b16 a[254:255], v195 offset:15360
    v_cvt_pk_bf16_f32 v43, v46, v47
    v_mfma_f32_16x16x32_bf16 v[140:143], a[224:227], v[8:11], 0
    buffer_store_dwordx4 v[40:43], v212, s[68:71], s4 offen offset:2048 sc1
    s_nop 1
    s_add_u32 s4, s63, 12288
    v_mfma_f32_16x16x32_bf16 v[140:143], a[228:231], v[20:23], v[140:143]
    ds_read_b64_tr_b16 a[192:193], v194 offset:16384
    v_mul_f32 v72, v213, v72
    v_mfma_f32_16x16x32_bf16 v[140:143], a[232:235], v[56:59], v[140:143]
    ds_read_b64_tr_b16 a[194:195], v194 offset:17408
    v_mul_f32 v73, v213, v73
    v_mfma_f32_16x16x32_bf16 v[140:143], a[236:239], v[68:71], v[140:143]
    s_waitcnt lgkmcnt(6)
    ds_read_b64_tr_b16 a[196:197], v194 offset:18432
    v_mul_f32 v74, v213, v74
    v_mfma_f32_16x16x32_bf16 v[140:143], a[240:243], v[104:107], v[140:143]
    v_mul_f32 v75, v213, v75
    v_cvt_pk_bf16_f32 v72, v72, v73
    v_mfma_f32_16x16x32_bf16 v[140:143], a[244:247], v[116:119], v[140:143]
    s_waitcnt lgkmcnt(5)
    ds_read_b64_tr_b16 a[198:199], v194 offset:19456
    v_cvt_pk_bf16_f32 v73, v74, v75
    v_mfma_f32_16x16x32_bf16 v[140:143], a[248:251], v[152:155], v[140:143]
    s_waitcnt lgkmcnt(4)
    ds_read_b64_tr_b16 a[200:201], v194 offset:20480
    v_mul_f32 v80, v214, v80
    v_mfma_f32_16x16x32_bf16 v[140:143], a[252:255], v[164:167], v[140:143]
    v_mul_f32 v81, v214, v81
    v_mul_f32 v82, v214, v82
    v_mfma_f32_16x16x32_bf16 v[132:135], a[252:255], v[160:163], v[132:135]
    ds_read_b64_tr_b16 a[202:203], v194 offset:21504
    v_mul_f32 v83, v214, v83
    v_mfma_f32_16x16x32_bf16 v[132:135], a[248:251], v[148:151], v[132:135]
    ds_read_b64_tr_b16 a[204:205], v194 offset:22528
    v_cvt_pk_bf16_f32 v80, v80, v81
    v_mfma_f32_16x16x32_bf16 v[132:135], a[244:247], v[112:115], v[132:135]
    ds_read_b64_tr_b16 a[206:207], v194 offset:23552
    v_cvt_pk_bf16_f32 v81, v82, v83
    v_mfma_f32_16x16x32_bf16 v[132:135], a[240:243], v[100:103], v[132:135]
    v_mul_f32 v88, v215, v88
    v_mul_f32 v89, v215, v89
    v_mfma_f32_16x16x32_bf16 v[124:127], a[240:243], v[96:99], v[124:127]
    ds_read_b64_tr_b16 a[208:209], v194 offset:24576
    v_mul_f32 v90, v215, v90
    v_mfma_f32_16x16x32_bf16 v[124:127], a[244:247], v[108:111], v[124:127]
    ds_read_b64_tr_b16 a[210:211], v194 offset:25600
    v_mul_f32 v91, v215, v91
    v_mfma_f32_16x16x32_bf16 v[124:127], a[248:251], v[144:147], v[124:127]
    v_cvt_pk_bf16_f32 v88, v88, v89
    v_cvt_pk_bf16_f32 v89, v90, v91
    v_mfma_f32_16x16x32_bf16 v[124:127], a[252:255], v[156:159], v[124:127]
    s_waitcnt lgkmcnt(6)
    ds_read_b64_tr_b16 a[212:213], v194 offset:26624
    v_mul_f32 v76, v213, v76
    v_mfma_f32_16x16x32_bf16 v[168:171], a[192:195], v[0:3], 0
    ds_read_b64_tr_b16 a[214:215], v194 offset:27648
    v_mul_f32 v77, v213, v77
    v_mfma_f32_16x16x32_bf16 v[168:171], a[196:199], v[12:15], v[168:171]
    s_waitcnt lgkmcnt(6)
    ds_read_b64_tr_b16 a[216:217], v194 offset:28672
    v_mul_f32 v78, v213, v78
    v_mfma_f32_16x16x32_bf16 v[168:171], a[200:203], v[48:51], v[168:171]
    s_waitcnt lgkmcnt(5)
    v_mul_f32 v79, v213, v79
    v_cvt_pk_bf16_f32 v74, v76, v77
    v_mfma_f32_16x16x32_bf16 v[168:171], a[204:207], v[60:63], v[168:171]
    ds_read_b64_tr_b16 a[218:219], v194 offset:29696
    v_cvt_pk_bf16_f32 v75, v78, v79
    v_mfma_f32_16x16x32_bf16 v[176:179], a[204:207], v[64:67], 0
    buffer_store_dwordx4 v[72:75], v212, s[68:71], s4 offen offset:0 sc1
    v_mul_f32 v84, v214, v84
    v_mfma_f32_16x16x32_bf16 v[176:179], a[200:203], v[52:55], v[176:179]
    ds_read_b64_tr_b16 a[220:221], v194 offset:30720
    v_mul_f32 v85, v214, v85
    v_mfma_f32_16x16x32_bf16 v[176:179], a[196:199], v[16:19], v[176:179]
    ds_read_b64_tr_b16 a[222:223], v194 offset:31744
    v_mul_f32 v86, v214, v86
    v_mul_f32 v87, v214, v87
    v_mfma_f32_16x16x32_bf16 v[176:179], a[192:195], v[4:7], v[176:179]
    ds_read_b64_tr_b16 a[224:225], v195 offset:16384
    v_cvt_pk_bf16_f32 v82, v84, v85
    v_mfma_f32_16x16x32_bf16 v[184:187], a[192:195], v[8:11], 0
    ds_read_b64_tr_b16 a[226:227], v195 offset:17408
    v_cvt_pk_bf16_f32 v83, v86, v87
    v_mfma_f32_16x16x32_bf16 v[184:187], a[196:199], v[20:23], v[184:187]
    buffer_store_dwordx4 v[80:83], v212, s[68:71], s4 offen offset:1024 sc1
    v_mul_f32 v92, v215, v92
    v_mfma_f32_16x16x32_bf16 v[184:187], a[200:203], v[56:59], v[184:187]
    ds_read_b64_tr_b16 a[228:229], v195 offset:18432
    v_mul_f32 v93, v215, v93
    v_mul_f32 v94, v215, v94
    v_mfma_f32_16x16x32_bf16 v[184:187], a[204:207], v[68:71], v[184:187]
    s_waitcnt lgkmcnt(6)
    ds_read_b64_tr_b16 a[230:231], v195 offset:19456
    v_mul_f32 v95, v215, v95
    v_mfma_f32_16x16x32_bf16 v[184:187], a[208:211], v[104:107], v[184:187]
    v_cvt_pk_bf16_f32 v90, v92, v93
    v_cvt_pk_bf16_f32 v91, v94, v95
    v_mfma_f32_16x16x32_bf16 v[184:187], a[212:215], v[116:119], v[184:187]
    s_waitcnt lgkmcnt(6)
    buffer_store_dwordx4 v[88:91], v212, s[68:71], s4 offen offset:2048 sc1
    s_nop 1
    s_mul_i32 s4, s52, 24576
    v_mul_f32 v120, v213, v120
    v_mfma_f32_16x16x32_bf16 v[184:187], a[216:219], v[152:155], v[184:187]
    s_waitcnt lgkmcnt(4)
    ds_read_b64_tr_b16 a[232:233], v195 offset:20480
    s_add_u32 s4, s4, 0
    v_mul_f32 v121, v213, v121
    v_mfma_f32_16x16x32_bf16 v[184:187], a[220:223], v[164:167], v[184:187]
    s_add_u32 s4, s4, s56
    ds_read_b64_tr_b16 a[234:235], v195 offset:21504
    v_mul_f32 v122, v213, v122
    v_mfma_f32_16x16x32_bf16 v[176:179], a[220:223], v[160:163], v[176:179]
    ds_read_b64_tr_b16 a[236:237], v195 offset:22528
    v_mul_f32 v123, v213, v123
    v_mfma_f32_16x16x32_bf16 v[176:179], a[216:219], v[148:151], v[176:179]
    ds_read_b64_tr_b16 a[238:239], v195 offset:23552
    v_cvt_pk_bf16_f32 v120, v120, v121
    v_cvt_pk_bf16_f32 v121, v122, v123
    v_mfma_f32_16x16x32_bf16 v[176:179], a[212:215], v[112:115], v[176:179]
    ds_read_b64_tr_b16 a[240:241], v195 offset:24576
    v_mul_f32 v128, v214, v128
    v_mfma_f32_16x16x32_bf16 v[176:179], a[208:211], v[100:103], v[176:179]
    v_mul_f32 v129, v214, v129
    v_mul_f32 v130, v214, v130
    v_mfma_f32_16x16x32_bf16 v[168:171], a[208:211], v[96:99], v[168:171]
    ds_read_b64_tr_b16 a[242:243], v195 offset:25600
    v_mul_f32 v131, v214, v131
    v_mfma_f32_16x16x32_bf16 v[168:171], a[212:215], v[108:111], v[168:171]
    ds_read_b64_tr_b16 a[244:245], v195 offset:26624
    v_cvt_pk_bf16_f32 v128, v128, v129
    v_mfma_f32_16x16x32_bf16 v[168:171], a[216:219], v[144:147], v[168:171]
    ds_read_b64_tr_b16 a[246:247], v195 offset:27648
    v_cvt_pk_bf16_f32 v129, v130, v131
    v_mfma_f32_16x16x32_bf16 v[168:171], a[220:223], v[156:159], v[168:171]
    s_waitcnt lgkmcnt(8)
    v_mul_f32 v136, v215, v136
    v_mul_f32 v137, v215, v137
    v_mfma_f32_16x16x32_bf16 v[172:175], a[224:227], v[0:3], 0
    ds_read_b64_tr_b16 a[248:249], v195 offset:28672
    v_mul_f32 v138, v215, v138
    v_mfma_f32_16x16x32_bf16 v[172:175], a[228:231], v[12:15], v[172:175]
    s_waitcnt lgkmcnt(7)
    ds_read_b64_tr_b16 a[250:251], v195 offset:29696
    v_mul_f32 v139, v215, v139
    v_mfma_f32_16x16x32_bf16 v[172:175], a[232:235], v[48:51], v[172:175]
    s_waitcnt lgkmcnt(6)
    v_cvt_pk_bf16_f32 v136, v136, v137
    v_cvt_pk_bf16_f32 v137, v138, v139
    v_mfma_f32_16x16x32_bf16 v[172:175], a[236:239], v[60:63], v[172:175]
    ds_read_b64_tr_b16 a[252:253], v195 offset:30720
    v_mul_f32 v124, v213, v124
    v_mfma_f32_16x16x32_bf16 v[180:183], a[236:239], v[64:67], 0
L_hop1_2:
L_pad7:
    s_cbranch_execz L_hopped1
    ds_read_b64_tr_b16 a[254:255], v195 offset:31744
    v_mul_f32 v125, v213, v125
    v_mfma_f32_16x16x32_bf16 v[180:183], a[232:235], v[52:55], v[180:183]
    v_add_u32 v194, 0x10000, v194
    v_mul_f32 v126, v213, v126
    v_mfma_f32_16x16x32_bf16 v[180:183], a[228:231], v[16:19], v[180:183]
    v_mul_f32 v127, v213, v127
    v_cvt_pk_bf16_f32 v122, v124, v125
    v_mfma_f32_16x16x32_bf16 v[180:183], a[224:227], v[4:7], v[180:183]
    v_cvt_pk_bf16_f32 v123, v126, v127
    v_mul_f32 v132, v214, v132
    v_mfma_f32_16x16x32_bf16 v[188:191], a[224:227], v[8:11], 0
    buffer_store_dwordx4 v[120:123], v212, s[68:71], s4 offen offset:0
    v_add_u32 v195, 0x10000, v195
    v_mfma_f32_16x16x32_bf16 v[188:191], a[228:231], v[20:23], v[188:191]
    v_mul_f32 v133, v214, v133
    v_mul_f32 v134, v214, v134
    v_mfma_f32_16x16x32_bf16 v[188:191], a[232:235], v[56:59], v[188:191]
    v_mul_f32 v135, v214, v135
    v_cvt_pk_bf16_f32 v130, v132, v133
    v_mfma_f32_16x16x32_bf16 v[188:191], a[236:239], v[68:71], v[188:191]
    s_waitcnt lgkmcnt(2)
    s_waitcnt vmcnt(10) lgkmcnt(0)
    s_barrier
    ds_read_b64_tr_b16 a[192:193], v194 offset:0
    v_cvt_pk_bf16_f32 v131, v134, v135
    v_mfma_f32_16x16x32_bf16 v[188:191], a[240:243], v[104:107], v[188:191]
    s_mul_i32 s35, s54, 128
    buffer_store_dwordx4 v[128:131], v212, s[68:71], s4 offen offset:1024
    v_mul_f32 v140, v215, v140
    v_mfma_f32_16x16x32_bf16 v[188:191], a[244:247], v[116:119], v[188:191]
    ds_read_b64_tr_b16 a[194:195], v194 offset:1024
    v_mul_f32 v141, v215, v141
    v_mfma_f32_16x16x32_bf16 v[188:191], a[248:251], v[152:155], v[188:191]
    ds_read_b64_tr_b16 a[196:197], v194 offset:2048
    v_mul_f32 v142, v215, v142
    v_mfma_f32_16x16x32_bf16 v[188:191], a[252:255], v[164:167], v[188:191]
    s_add_u32 s35, s35, 0
    v_mul_f32 v143, v215, v143
    v_cvt_pk_bf16_f32 v138, v140, v141
    v_mfma_f32_16x16x32_bf16 v[180:183], a[252:255], v[160:163], v[180:183]
    ds_read_b64_tr_b16 a[198:199], v194 offset:3072
    v_cvt_pk_bf16_f32 v139, v142, v143
    v_mfma_f32_16x16x32_bf16 v[180:183], a[248:251], v[148:151], v[180:183]
    s_add_u32 s36, s35, 13312
    buffer_store_dwordx4 v[136:139], v212, s[68:71], s4 offen offset:2048
    s_nop 1
    s_mul_i32 s4, s52, 24576
    v_mul_f32 v168, v213, v168
    v_mfma_f32_16x16x32_bf16 v[180:183], a[244:247], v[112:115], v[180:183]
    s_add_u32 s4, s4, 12288
    ds_read_b64_tr_b16 a[200:201], v194 offset:4096
    v_mul_f32 v169, v213, v169
    v_mfma_f32_16x16x32_bf16 v[180:183], a[240:243], v[100:103], v[180:183]
    s_add_u32 s4, s4, s56
    ds_read_b64_tr_b16 a[202:203], v194 offset:5120
    v_mul_f32 v170, v213, v170
    v_mfma_f32_16x16x32_bf16 v[172:175], a[240:243], v[96:99], v[172:175]
    s_mul_i32 s92, s54, 128
    ds_read_b64_tr_b16 a[204:205], v194 offset:6144
    v_mul_f32 v171, v213, v171
    v_mfma_f32_16x16x32_bf16 v[172:175], a[244:247], v[108:111], v[172:175]
    s_add_u32 s92, s92, 64
    ds_read_b64_tr_b16 a[206:207], v194 offset:7168
    v_cvt_pk_bf16_f32 v168, v168, v169
    v_cvt_pk_bf16_f32 v169, v170, v171
    v_mfma_f32_16x16x32_bf16 v[172:175], a[248:251], v[144:147], v[172:175]
    v_mul_f32 v176, v214, v176
    v_mul_f32 v177, v214, v177
    v_mfma_f32_16x16x32_bf16 v[172:175], a[252:255], v[156:159], v[172:175]
    s_waitcnt lgkmcnt(6)
    ds_read_b64_tr_b16 a[208:209], v194 offset:8192
    v_mul_f32 v178, v214, v178
    v_mfma_f32_16x16x32_bf16 v[24:27], a[192:195], v[0:3], 0
    s_waitcnt lgkmcnt(5)
    ds_read_b64_tr_b16 a[210:211], v194 offset:9216
    v_mul_f32 v179, v214, v179
    v_mfma_f32_16x16x32_bf16 v[24:27], a[196:199], v[12:15], v[24:27]
    s_waitcnt lgkmcnt(4)
    s_add_u32 s93, s92, 13312
    v_cvt_pk_bf16_f32 v176, v176, v177
    v_mfma_f32_16x16x32_bf16 v[24:27], a[200:203], v[48:51], v[24:27]
    s_waitcnt lgkmcnt(2)
    ds_read_b64_tr_b16 a[212:213], v194 offset:10240
    v_cvt_pk_bf16_f32 v177, v178, v179
    v_mfma_f32_16x16x32_bf16 v[24:27], a[204:207], v[60:63], v[24:27]
    s_add_u32 m0, s32, 98304
    ds_read_b64_tr_b16 a[214:215], v194 offset:11264
    v_mul_f32 v184, v215, v184
    v_mfma_f32_16x16x32_bf16 v[32:35], a[204:207], v[64:67], 0
    ds_read_b64_tr_b16 a[216:217], v194 offset:12288
    v_mul_f32 v185, v215, v185
    v_mul_f32 v186, v215, v186
    v_mfma_f32_16x16x32_bf16 v[32:35], a[200:203], v[52:55], v[32:35]
    buffer_load_dwordx4 v210, s[24:27], s35 offen offset:0 lds
    v_mul_f32 v187, v215, v187
    v_mfma_f32_16x16x32_bf16 v[32:35], a[196:199], v[16:19], v[32:35]
    s_add_u32 m0, s32, 114688
    ds_read_b64_tr_b16 a[218:219], v194 offset:13312
    v_cvt_pk_bf16_f32 v184, v184, v185
    v_mfma_f32_16x16x32_bf16 v[32:35], a[192:195], v[4:7], v[32:35]
    ds_read_b64_tr_b16 a[220:221], v194 offset:14336
    v_cvt_pk_bf16_f32 v185, v186, v187
    v_mul_f32 v172, v213, v172
    v_mfma_f32_16x16x32_bf16 v[40:43], a[192:195], v[8:11], 0
    buffer_load_dwordx4 v210, s[24:27], s92 offen offset:0 lds
    v_mul_f32 v173, v213, v173
    v_mfma_f32_16x16x32_bf16 v[40:43], a[196:199], v[20:23], v[40:43]
    s_add_u32 m0, s32, 98304
    ds_read_b64_tr_b16 a[222:223], v194 offset:15360
    v_mul_f32 v174, v213, v174
    v_mfma_f32_16x16x32_bf16 v[40:43], a[200:203], v[56:59], v[40:43]
    ds_read_b64_tr_b16 a[224:225], v195 offset:0
    v_mul_f32 v175, v213, v175
    v_mfma_f32_16x16x32_bf16 v[40:43], a[204:207], v[68:71], v[40:43]
    s_waitcnt lgkmcnt(7)
    ds_read_b64_tr_b16 a[226:227], v195 offset:1024
    v_cvt_pk_bf16_f32 v170, v172, v173
    v_cvt_pk_bf16_f32 v171, v174, v175
    v_mfma_f32_16x16x32_bf16 v[40:43], a[208:211], v[104:107], v[40:43]
    s_waitcnt lgkmcnt(6)
    buffer_store_dwordx4 v[168:171], v212, s[68:71], s4 offen offset:0
    v_mul_f32 v180, v214, v180
    v_mfma_f32_16x16x32_bf16 v[40:43], a[212:215], v[116:119], v[40:43]
    s_waitcnt lgkmcnt(4)
    ds_read_b64_tr_b16 a[228:229], v195 offset:2048
    v_mul_f32 v181, v214, v181
    v_mfma_f32_16x16x32_bf16 v[40:43], a[216:219], v[152:155], v[40:43]
    s_waitcnt lgkmcnt(3)
    ds_read_b64_tr_b16 a[230:231], v195 offset:3072
    buffer_load_dwordx4 v211, s[24:27], s35 offen offset:2048 lds
    v_mul_f32 v182, v214, v182
    v_mfma_f32_16x16x32_bf16 v[40:43], a[220:223], v[164:167], v[40:43]
    s_add_u32 m0, s32, 114688
    s_nop 0
    buffer_load_dwordx4 v211, s[24:27], s92 offen offset:2048 lds
    v_mul_f32 v183, v214, v183
    v_cvt_pk_bf16_f32 v178, v180, v181
    v_mfma_f32_16x16x32_bf16 v[32:35], a[220:223], v[160:163], v[32:35]
    ds_read_b64_tr_b16 a[232:233], v195 offset:4096
    v_cvt_pk_bf16_f32 v179, v182, v183
    v_mfma_f32_16x16x32_bf16 v[32:35], a[216:219], v[148:151], v[32:35]
    s_add_u32 m0, s32, 98304
    buffer_store_dwordx4 v[176:179], v212, s[68:71], s4 offen offset:1024
    v_mul_f32 v188, v215, v188
    v_mfma_f32_16x16x32_bf16 v[32:35], a[212:215], v[112:115], v[32:35]
    ds_read_b64_tr_b16 a[234:235], v195 offset:5120
    v_mul_f32 v189, v215, v189
    v_mul_f32 v190, v215, v190
    v_mfma_f32_16x16x32_bf16 v[32:35], a[208:211], v[100:103], v[32:35]
    ds_read_b64_tr_b16 a[236:237], v195 offset:6144
    v_mul_f32 v191, v215, v191
    v_mfma_f32_16x16x32_bf16 v[24:27], a[208:211], v[96:99], v[24:27]
    ds_read_b64_tr_b16 a[238:239], v195 offset:7168
    v_cvt_pk_bf16_f32 v186, v188, v189
    v_mfma_f32_16x16x32_bf16 v[24:27], a[212:215], v[108:111], v[24:27]
    ds_read_b64_tr_b16 a[240:241], v195 offset:8192
    v_cvt_pk_bf16_f32 v187, v190, v191
    v_mfma_f32_16x16x32_bf16 v[24:27], a[216:219], v[144:147], v[24:27]
    buffer_store_dwordx4 v[184:187], v212, s[68:71], s4 offen offset:2048
    buffer_load_dwordx4 v210, s[24:27], s36 offen offset:1024 lds
    v_mfma_f32_16x16x32_bf16 v[24:27], a[220:223], v[156:159], v[24:27]
    s_waitcnt lgkmcnt(6)
    ds_read_b64_tr_b16 a[242:243], v195 offset:9216
    v_mov_b32 v245, 1
    v_mfma_f32_16x16x32_bf16 v[28:31], a[224:227], v[0:3], 0
    s_waitcnt lgkmcnt(6)
    ds_read_b64_tr_b16 a[244:245], v195 offset:10240
    s_add_u32 m0, s32, 114688
    v_mfma_f32_16x16x32_bf16 v[28:31], a[228:231], v[12:15], v[28:31]
    s_waitcnt lgkmcnt(5)
    ds_read_b64_tr_b16 a[246:247], v195 offset:11264
    v_mfma_f32_16x16x32_bf16 v[28:31], a[232:235], v[48:51], v[28:31]
    s_waitcnt lgkmcnt(4)
    buffer_load_dwordx4 v210, s[24:27], s93 offen offset:1024 lds
    v_mfma_f32_16x16x32_bf16 v[28:31], a[236:239], v[60:63], v[28:31]
    s_waitcnt vmcnt(9)
    buffer_store_dword v245, v208, s[72:75], s28 offen
    s_add_u32 m0, s32, 98304
    v_mfma_f32_16x16x32_bf16 v[36:39], a[236:239], v[64:67], 0
    ds_read_b64_tr_b16 a[248:249], v195 offset:12288
    v_mfma_f32_16x16x32_bf16 v[36:39], a[232:235], v[52:55], v[36:39]
    ds_read_b64_tr_b16 a[250:251], v195 offset:13312
    v_mfma_f32_16x16x32_bf16 v[36:39], a[228:231], v[16:19], v[36:39]
    ds_read_b64_tr_b16 a[252:253], v195 offset:14336
    buffer_load_dwordx4 v211, s[24:27], s36 offen offset:3072 lds
    v_mfma_f32_16x16x32_bf16 v[36:39], a[224:227], v[4:7], v[36:39]
    s_add_u32 m0, s32, 114688
    ds_read_b64_tr_b16 a[254:255], v195 offset:15360
    v_mfma_f32_16x16x32_bf16 v[44:47], a[224:227], v[8:11], 0
    ds_read_b64_tr_b16 a[192:193], v194 offset:16384
    v_mfma_f32_16x16x32_bf16 v[44:47], a[228:231], v[20:23], v[44:47]
    buffer_load_dwordx4 v211, s[24:27], s93 offen offset:3072 lds
    v_mul_f32 v24, v213, v24
    v_mfma_f32_16x16x32_bf16 v[44:47], a[232:235], v[56:59], v[44:47]
    s_mul_i32 s35, s54, 64
    ds_read_b64_tr_b16 a[194:195], v194 offset:17408
    v_mul_f32 v25, v213, v25
    v_mfma_f32_16x16x32_bf16 v[44:47], a[236:239], v[68:71], v[44:47]
    s_waitcnt lgkmcnt(6)
    ds_read_b64_tr_b16 a[196:197], v194 offset:18432
    v_mul_f32 v26, v213, v26
    v_mfma_f32_16x16x32_bf16 v[44:47], a[240:243], v[104:107], v[44:47]
    s_add_u32 s35, s35, 512
    v_mfma_f32_16x16x32_bf16 v[44:47], a[244:247], v[116:119], v[44:47]
    s_waitcnt lgkmcnt(5)
    ds_read_b64_tr_b16 a[198:199], v194 offset:19456
    v_mul_f32 v27, v213, v27
    v_mfma_f32_16x16x32_bf16 v[44:47], a[248:251], v[152:155], v[44:47]
    s_waitcnt lgkmcnt(4)
    ds_read_b64_tr_b16 a[200:201], v194 offset:20480
    s_mul_i32 s4, s52, 12288
    v_mfma_f32_16x16x32_bf16 v[44:47], a[252:255], v[164:167], v[44:47]
    s_add_u32 s36, s35, 13312
    v_mfma_f32_16x16x32_bf16 v[36:39], a[252:255], v[160:163], v[36:39]
    s_add_u32 s4, s4, 98304
    ds_read_b64_tr_b16 a[202:203], v194 offset:21504
    v_cvt_pk_bf16_f32 v24, v24, v25
    v_mfma_f32_16x16x32_bf16 v[36:39], a[248:251], v[148:151], v[36:39]
    s_mul_i32 s92, s55, 64
    buffer_load_dword v244, off, s[72:75], s60 sc1
    s_add_u32 s4, s4, s56
    v_mfma_f32_16x16x32_bf16 v[36:39], a[244:247], v[112:115], v[36:39]
    s_add_u32 s92, s92, 512
    ds_read_b64_tr_b16 a[204:205], v194 offset:22528
    v_cvt_pk_bf16_f32 v25, v26, v27
    v_mfma_f32_16x16x32_bf16 v[36:39], a[240:243], v[100:103], v[36:39]
    s_add_u32 s93, s92, 13312
    ds_read_b64_tr_b16 a[206:207], v194 offset:23552
    v_mul_f32 v32, v214, v32
    v_mfma_f32_16x16x32_bf16 v[28:31], a[240:243], v[96:99], v[28:31]
    ds_read_b64_tr_b16 a[208:209], v194 offset:24576
    v_mul_f32 v33, v214, v33
    v_mfma_f32_16x16x32_bf16 v[28:31], a[244:247], v[108:111], v[28:31]
    s_add_u32 m0, s32, 131072
    ds_read_b64_tr_b16 a[210:211], v194 offset:25600
    v_mul_f32 v34, v214, v34
    v_mfma_f32_16x16x32_bf16 v[28:31], a[248:251], v[144:147], v[28:31]
    v_mul_f32 v35, v214, v35
    v_cvt_pk_bf16_f32 v32, v32, v33
    v_mfma_f32_16x16x32_bf16 v[28:31], a[252:255], v[156:159], v[28:31]
    s_waitcnt lgkmcnt(6)
    ds_read_b64_tr_b16 a[212:213], v194 offset:26624
    v_cvt_pk_bf16_f32 v33, v34, v35
    v_mfma_f32_16x16x32_bf16 v[72:75], a[192:195], v[0:3], 0
    ds_read_b64_tr_b16 a[214:215], v194 offset:27648
    v_mul_f32 v40, v215, v40
    v_mfma_f32_16x16x32_bf16 v[72:75], a[196:199], v[12:15], v[72:75]
    s_waitcnt lgkmcnt(6)
    ds_read_b64_tr_b16 a[216:217], v194 offset:28672
    v_mul_f32 v41, v215, v41
    v_mfma_f32_16x16x32_bf16 v[72:75], a[200:203], v[48:51], v[72:75]
    s_waitcnt lgkmcnt(5)
    buffer_load_dwordx4 v210, s[24:27], s35 offen offset:0 lds
    v_mul_f32 v42, v215, v42
    v_mfma_f32_16x16x32_bf16 v[72:75], a[204:207], v[60:63], v[72:75]
    s_add_u32 m0, s32, 16384
    ds_read_b64_tr_b16 a[218:219], v194 offset:29696
    v_mov_b32 v245, 2
    v_mul_f32 v43, v215, v43
    v_mfma_f32_16x16x32_bf16 v[80:83], a[204:207], v[64:67], 0
    s_mul_i32 s78, s53, 24576
    ds_read_b64_tr_b16 a[220:221], v194 offset:30720
    v_cvt_pk_bf16_f32 v40, v40, v41
    v_mfma_f32_16x16x32_bf16 v[80:83], a[200:203], v[52:55], v[80:83]
    s_add_u32 s78, s78, 0
    buffer_load_dwordx4 v210, s[24:27], s92 offen offset:0 lds
    v_cvt_pk_bf16_f32 v41, v42, v43
    v_mul_f32 v28, v213, v28
    v_mfma_f32_16x16x32_bf16 v[80:83], a[196:199], v[16:19], v[80:83]
    s_add_u32 m0, s32, 131072
    ds_read_b64_tr_b16 a[222:223], v194 offset:31744
    v_mul_f32 v29, v213, v29
    v_mfma_f32_16x16x32_bf16 v[80:83], a[192:195], v[4:7], v[80:83]
    s_add_u32 s78, s78, s56
    ds_read_b64_tr_b16 a[224:225], v195 offset:16384
    v_mul_f32 v30, v213, v30
    v_mfma_f32_16x16x32_bf16 v[88:91], a[192:195], v[8:11], 0
    s_waitcnt vmcnt(8)
    buffer_store_dword v245, v208, s[72:75], s28 offen
    v_mul_f32 v31, v213, v31
    v_mfma_f32_16x16x32_bf16 v[88:91], a[196:199], v[20:23], v[88:91]
    ds_read_b64_tr_b16 a[226:227], v195 offset:17408
    v_cvt_pk_bf16_f32 v26, v28, v29
    v_cvt_pk_bf16_f32 v27, v30, v31
    v_mfma_f32_16x16x32_bf16 v[88:91], a[200:203], v[56:59], v[88:91]
    buffer_store_dwordx4 v[24:27], v212, s[68:71], s4 offen offset:0
    buffer_load_dwordx4 v211, s[24:27], s35 offen offset:2048 lds
    v_mul_f32 v36, v214, v36
    v_mfma_f32_16x16x32_bf16 v[88:91], a[204:207], v[68:71], v[88:91]
    s_waitcnt lgkmcnt(5)
    ds_read_b64_tr_b16 a[228:229], v195 offset:18432
    s_waitcnt vmcnt(5)
    v_readfirstlane_b32 s79, v244
    s_nop 0
    s_cmp_lt_u32 s79, 1
    s_cbranch_scc1 L_rs3
L_rb3:
    s_add_u32 m0, s32, 16384
    v_mul_f32 v37, v214, v37
    v_mfma_f32_16x16x32_bf16 v[88:91], a[208:211], v[104:107], v[88:91]
    buffer_load_dwordx4 v[220:223], v212, s[68:71], s78 offen offset:0 sc1
    v_mul_f32 v38, v214, v38
    v_mul_f32 v39, v214, v39
    v_mfma_f32_16x16x32_bf16 v[88:91], a[212:215], v[116:119], v[88:91]
    s_waitcnt lgkmcnt(5)
    buffer_load_dwordx4 v[224:227], v212, s[68:71], s78 offen offset:1024 sc1
    v_cvt_pk_bf16_f32 v34, v36, v37
    v_mfma_f32_16x16x32_bf16 v[88:91], a[216:219], v[152:155], v[88:91]
    s_waitcnt lgkmcnt(3)
    buffer_load_dwordx4 v[228:231], v212, s[68:71], s78 offen offset:2048 sc1
    buffer_load_dwordx4 v211, s[24:27], s92 offen offset:2048 lds
    v_cvt_pk_bf16_f32 v35, v38, v39
    v_mfma_f32_16x16x32_bf16 v[88:91], a[220:223], v[164:167], v[88:91]
    s_add_u32 m0, s32, 131072
    buffer_store_dwordx4 v[32:35], v212, s[68:71], s4 offen offset:1024
    ds_read_b64_tr_b16 a[230:231], v195 offset:19456
    v_mul_f32 v44, v215, v44
    v_mfma_f32_16x16x32_bf16 v[80:83], a[220:223], v[160:163], v[80:83]
    ds_read_b64_tr_b16 a[232:233], v195 offset:20480
    v_mul_f32 v45, v215, v45
    v_mul_f32 v46, v215, v46
    v_mfma_f32_16x16x32_bf16 v[80:83], a[216:219], v[148:151], v[80:83]
    ds_read_b64_tr_b16 a[234:235], v195 offset:21504
    v_mul_f32 v47, v215, v47
    v_mfma_f32_16x16x32_bf16 v[80:83], a[212:215], v[112:115], v[80:83]
    ds_read_b64_tr_b16 a[236:237], v195 offset:22528
    buffer_load_dwordx4 v210, s[24:27], s36 offen offset:1024 lds
    v_cvt_pk_bf16_f32 v42, v44, v45
    v_mfma_f32_16x16x32_bf16 v[80:83], a[208:211], v[100:103], v[80:83]
    s_add_u32 m0, s32, 16384
    ds_read_b64_tr_b16 a[238:239], v195 offset:23552
    v_cvt_pk_bf16_f32 v43, v46, v47
    v_mfma_f32_16x16x32_bf16 v[72:75], a[208:211], v[96:99], v[72:75]
    buffer_store_dwordx4 v[40:43], v212, s[68:71], s4 offen offset:2048
    v_mfma_f32_16x16x32_bf16 v[72:75], a[212:215], v[108:111], v[72:75]
    ds_read_b64_tr_b16 a[240:241], v195 offset:24576
    v_mfma_f32_16x16x32_bf16 v[72:75], a[216:219], v[144:147], v[72:75]
    ds_read_b64_tr_b16 a[242:243], v195 offset:25600
    buffer_load_dwordx4 v210, s[24:27], s93 offen offset:1024 lds
    v_mfma_f32_16x16x32_bf16 v[72:75], a[220:223], v[156:159], v[72:75]
    s_waitcnt lgkmcnt(7)
    ds_read_b64_tr_b16 a[244:245], v195 offset:26624
    s_add_u32 m0, s32, 131072
    v_mfma_f32_16x16x32_bf16 v[76:79], a[224:227], v[0:3], 0
    s_waitcnt lgkmcnt(7)
    ds_read_b64_tr_b16 a[246:247], v195 offset:27648
    v_mfma_f32_16x16x32_bf16 v[76:79], a[228:231], v[12:15], v[76:79]
    s_waitcnt lgkmcnt(6)
    ds_read_b64_tr_b16 a[248:249], v195 offset:28672
    v_mfma_f32_16x16x32_bf16 v[76:79], a[232:235], v[48:51], v[76:79]
    s_waitcnt lgkmcnt(5)
    ds_read_b64_tr_b16 a[250:251], v195 offset:29696
    buffer_load_dwordx4 v211, s[24:27], s36 offen offset:3072 lds
    v_mfma_f32_16x16x32_bf16 v[76:79], a[236:239], v[60:63], v[76:79]
    s_add_u32 m0, s32, 16384
    buffer_load_dword v244, off, s[72:75], s60 sc1
    s_waitcnt vmcnt(9)
    v_lshlrev_b32 v246, 16, v220
    v_mfma_f32_16x16x32_bf16 v[84:87], a[236:239], v[64:67], 0
    s_mul_i32 s4, s53, 24576
    ds_read_b64_tr_b16 a[252:253], v195 offset:30720
    v_and_b32 v220, 0xffff0000, v220
    v_mfma_f32_16x16x32_bf16 v[84:87], a[232:235], v[52:55], v[84:87]
    s_add_u32 s4, s4, 0
    ds_read_b64_tr_b16 a[254:255], v195 offset:31744
    v_add_u32 v194, 0xffff8000, v194
    v_mfma_f32_16x16x32_bf16 v[84:87], a[228:231], v[16:19], v[84:87]
    s_add_u32 s4, s4, s57
    buffer_load_dwordx4 v211, s[24:27], s93 offen offset:3072 lds
    v_fma_f32 v72, v72, v213, v246
    v_mfma_f32_16x16x32_bf16 v[84:87], a[224:227], v[4:7], v[84:87]
    v_fma_f32 v73, v73, v213, v220
    v_lshlrev_b32 v247, 16, v221
    v_mfma_f32_16x16x32_bf16 v[92:95], a[224:227], v[8:11], 0
    v_add_u32 v195, 0xffff8000, v195
    v_and_b32 v221, 0xffff0000, v221
    v_mfma_f32_16x16x32_bf16 v[92:95], a[228:231], v[20:23], v[92:95]
    v_fma_f32 v74, v74, v213, v247
    v_fma_f32 v75, v75, v213, v221
    v_mfma_f32_16x16x32_bf16 v[92:95], a[232:235], v[56:59], v[92:95]
    v_cvt_pk_bf16_f32 v72, v72, v73
    v_cvt_pk_bf16_f32 v73, v74, v75
    v_mfma_f32_16x16x32_bf16 v[92:95], a[236:239], v[68:71], v[92:95]
    s_waitcnt lgkmcnt(3)
    s_waitcnt lgkmcnt(0)
    s_barrier
    ds_read_b64_tr_b16 a[192:193], v194 offset:0
    s_waitcnt vmcnt(9)
    v_lshlrev_b32 v246, 16, v224
    v_mfma_f32_16x16x32_bf16 v[92:95], a[240:243], v[104:107], v[92:95]
    s_mul_i32 s35, s55, 128
    v_and_b32 v224, 0xffff0000, v224
    v_fma_f32 v80, v80, v214, v246
    v_mfma_f32_16x16x32_bf16 v[92:95], a[244:247], v[116:119], v[92:95]
    ds_read_b64_tr_b16 a[194:195], v194 offset:1024
    v_fma_f32 v81, v81, v214, v224
    v_mfma_f32_16x16x32_bf16 v[92:95], a[248:251], v[152:155], v[92:95]
    ds_read_b64_tr_b16 a[196:197], v194 offset:2048
    v_lshlrev_b32 v247, 16, v225
    v_mfma_f32_16x16x32_bf16 v[92:95], a[252:255], v[164:167], v[92:95]
    v_and_b32 v225, 0xffff0000, v225
    v_fma_f32 v82, v82, v214, v247
    v_mfma_f32_16x16x32_bf16 v[84:87], a[252:255], v[160:163], v[84:87]
    ds_read_b64_tr_b16 a[198:199], v194 offset:3072
    v_fma_f32 v83, v83, v214, v225
    v_mfma_f32_16x16x32_bf16 v[84:87], a[248:251], v[148:151], v[84:87]
    s_add_u32 s35, s35, 0
    ds_read_b64_tr_b16 a[200:201], v194 offset:4096
    v_cvt_pk_bf16_f32 v80, v80, v81
    v_mfma_f32_16x16x32_bf16 v[84:87], a[244:247], v[112:115], v[84:87]
    s_mul_i32 s78, s53, 24576
    v_cvt_pk_bf16_f32 v81, v82, v83
    v_mfma_f32_16x16x32_bf16 v[84:87], a[240:243], v[100:103], v[84:87]
    s_add_u32 s78, s78, 12288
    ds_read_b64_tr_b16 a[202:203], v194 offset:5120
    s_waitcnt vmcnt(8)
    v_lshlrev_b32 v246, 16, v228
    v_mfma_f32_16x16x32_bf16 v[76:79], a[240:243], v[96:99], v[76:79]
    s_add_u32 s78, s78, s56
    ds_read_b64_tr_b16 a[204:205], v194 offset:6144
    v_and_b32 v228, 0xffff0000, v228
    v_mfma_f32_16x16x32_bf16 v[76:79], a[244:247], v[108:111], v[76:79]
    s_add_u32 s36, s35, 13312
    ds_read_b64_tr_b16 a[206:207], v194 offset:7168
    s_waitcnt vmcnt(1)
    v_readfirstlane_b32 s79, v244
    s_nop 0
    s_cmp_lt_u32 s79, 2
    s_cbranch_scc1 L_rs4
L_rb4:
    v_fma_f32 v88, v88, v215, v246
    v_mfma_f32_16x16x32_bf16 v[76:79], a[248:251], v[144:147], v[76:79]
    buffer_load_dwordx4 v[232:235], v212, s[68:71], s78 offen offset:0 sc1
    v_fma_f32 v89, v89, v215, v228
    v_mfma_f32_16x16x32_bf16 v[76:79], a[252:255], v[156:159], v[76:79]
    s_waitcnt lgkmcnt(6)
    ds_read_b64_tr_b16 a[208:209], v194 offset:8192
    v_lshlrev_b32 v247, 16, v229
    v_mfma_f32_16x16x32_bf16 v[120:123], a[192:195], v[0:3], 0
    s_waitcnt lgkmcnt(5)
    buffer_load_dwordx4 v[236:239], v212, s[68:71], s78 offen offset:1024 sc1
    v_and_b32 v229, 0xffff0000, v229
    v_mfma_f32_16x16x32_bf16 v[120:123], a[196:199], v[12:15], v[120:123]
    s_waitcnt lgkmcnt(3)
    ds_read_b64_tr_b16 a[210:211], v194 offset:9216
    v_mov_b32 v245, 3
    v_mfma_f32_16x16x32_bf16 v[120:123], a[200:203], v[48:51], v[120:123]
    s_waitcnt lgkmcnt(2)
    buffer_load_dwordx4 v[240:243], v212, s[68:71], s78 offen offset:2048 sc1
    v_fma_f32 v90, v90, v215, v247
    v_mfma_f32_16x16x32_bf16 v[120:123], a[204:207], v[60:63], v[120:123]
    s_mul_i32 s92, s55, 128
    ds_read_b64_tr_b16 a[212:213], v194 offset:10240
    v_fma_f32 v91, v91, v215, v229
    v_mfma_f32_16x16x32_bf16 v[128:131], a[204:207], v[64:67], 0
    ds_read_b64_tr_b16 a[214:215], v194 offset:11264
    v_cvt_pk_bf16_f32 v88, v88, v89
    v_mfma_f32_16x16x32_bf16 v[128:131], a[200:203], v[52:55], v[128:131]
    s_add_u32 s92, s92, 64
    ds_read_b64_tr_b16 a[216:217], v194 offset:12288
    v_cvt_pk_bf16_f32 v89, v90, v91
    v_mfma_f32_16x16x32_bf16 v[128:131], a[196:199], v[16:19], v[128:131]
    buffer_store_dword v245, v208, s[72:75], s28 offen
    v_lshlrev_b32 v246, 16, v222
    v_mfma_f32_16x16x32_bf16 v[128:131], a[192:195], v[4:7], v[128:131]
    ds_read_b64_tr_b16 a[218:219], v194 offset:13312
    v_and_b32 v222, 0xffff0000, v222
    v_mfma_f32_16x16x32_bf16 v[136:139], a[192:195], v[8:11], 0
    ds_read_b64_tr_b16 a[220:221], v194 offset:14336
    v_fma_f32 v76, v76, v213, v246
    v_fma_f32 v77, v77, v213, v222
    v_mfma_f32_16x16x32_bf16 v[136:139], a[196:199], v[20:23], v[136:139]
    s_add_u32 s93, s92, 13312
    ds_read_b64_tr_b16 a[222:223], v194 offset:15360
    v_lshlrev_b32 v247, 16, v223
    v_mfma_f32_16x16x32_bf16 v[136:139], a[200:203], v[56:59], v[136:139]
    ds_read_b64_tr_b16 a[224:225], v195 offset:0
    v_and_b32 v223, 0xffff0000, v223
    v_mfma_f32_16x16x32_bf16 v[136:139], a[204:207], v[68:71], v[136:139]
    s_waitcnt lgkmcnt(7)
    ds_read_b64_tr_b16 a[226:227], v195 offset:1024
    v_fma_f32 v78, v78, v213, v247
    v_fma_f32 v79, v79, v213, v223
    v_mfma_f32_16x16x32_bf16 v[136:139], a[208:211], v[104:107], v[136:139]
    s_waitcnt lgkmcnt(6)
    v_cvt_pk_bf16_f32 v74, v76, v77
    v_cvt_pk_bf16_f32 v75, v78, v79
    v_mfma_f32_16x16x32_bf16 v[136:139], a[212:215], v[116:119], v[136:139]
    s_waitcnt lgkmcnt(4)
    buffer_store_dwordx4 v[72:75], v212, s[68:71], s4 offen offset:0
    v_lshlrev_b32 v246, 16, v226
    v_mfma_f32_16x16x32_bf16 v[136:139], a[216:219], v[152:155], v[136:139]
    s_waitcnt lgkmcnt(2)
    ds_read_b64_tr_b16 a[228:229], v195 offset:2048
    v_and_b32 v226, 0xffff0000, v226
    v_mfma_f32_16x16x32_bf16 v[136:139], a[220:223], v[164:167], v[136:139]
    s_add_u32 m0, s32, 147456
    ds_read_b64_tr_b16 a[230:231], v195 offset:3072
    v_fma_f32 v84, v84, v214, v246
    v_mfma_f32_16x16x32_bf16 v[128:131], a[220:223], v[160:163], v[128:131]
    ds_read_b64_tr_b16 a[232:233], v195 offset:4096
    v_fma_f32 v85, v85, v214, v226
    v_mfma_f32_16x16x32_bf16 v[128:131], a[216:219], v[148:151], v[128:131]
    ds_read_b64_tr_b16 a[234:235], v195 offset:5120
    v_lshlrev_b32 v247, 16, v227
    v_mfma_f32_16x16x32_bf16 v[128:131], a[212:215], v[112:115], v[128:131]
    ds_read_b64_tr_b16 a[236:237], v195 offset:6144
    v_and_b32 v227, 0xffff0000, v227
    v_mfma_f32_16x16x32_bf16 v[128:131], a[208:211], v[100:103], v[128:131]
    buffer_load_dwordx4 v210, s[24:27], s35 offen offset:0 lds
    v_fma_f32 v86, v86, v214, v247
    v_fma_f32 v87, v87, v214, v227
    v_mfma_f32_16x16x32_bf16 v[120:123], a[208:211], v[96:99], v[120:123]
    ds_read_b64_tr_b16 a[238:239], v195 offset:7168
    v_cvt_pk_bf16_f32 v82, v84, v85
    v_mfma_f32_16x16x32_bf16 v[120:123], a[212:215], v[108:111], v[120:123]
    s_add_u32 m0, s32, 0
    ds_read_b64_tr_b16 a[240:241], v195 offset:8192
    v_cvt_pk_bf16_f32 v83, v86, v87
    v_mfma_f32_16x16x32_bf16 v[120:123], a[216:219], v[144:147], v[120:123]
    buffer_store_dwordx4 v[80:83], v212, s[68:71], s4 offen offset:1024
    v_lshlrev_b32 v246, 16, v230
    v_and_b32 v230, 0xffff0000, v230
    v_mfma_f32_16x16x32_bf16 v[120:123], a[220:223], v[156:159], v[120:123]
    s_waitcnt lgkmcnt(7)
    ds_read_b64_tr_b16 a[242:243], v195 offset:9216
    v_fma_f32 v92, v92, v215, v246
    v_mfma_f32_16x16x32_bf16 v[124:127], a[224:227], v[0:3], 0
    s_waitcnt lgkmcnt(6)
    ds_read_b64_tr_b16 a[244:245], v195 offset:10240
    v_fma_f32 v93, v93, v215, v230
    v_mfma_f32_16x16x32_bf16 v[124:127], a[228:231], v[12:15], v[124:127]
    s_waitcnt lgkmcnt(5)
    ds_read_b64_tr_b16 a[246:247], v195 offset:11264
    v_lshlrev_b32 v247, 16, v231
    v_mfma_f32_16x16x32_bf16 v[124:127], a[232:235], v[48:51], v[124:127]
    s_waitcnt lgkmcnt(4)
    buffer_load_dwordx4 v210, s[24:27], s92 offen offset:0 lds
    v_and_b32 v231, 0xffff0000, v231
    v_fma_f32 v94, v94, v215, v247
    v_mfma_f32_16x16x32_bf16 v[124:127], a[236:239], v[60:63], v[124:127]
    buffer_load_dword v244, off, s[72:75], s60 sc1
    v_fma_f32 v95, v95, v215, v231
    v_mfma_f32_16x16x32_bf16 v[132:135], a[236:239], v[64:67], 0
    ds_read_b64_tr_b16 a[248:249], v195 offset:12288
    v_cvt_pk_bf16_f32 v90, v92, v93
    v_mfma_f32_16x16x32_bf16 v[132:135], a[232:235], v[52:55], v[132:135]
    s_add_u32 m0, s32, 147456
    ds_read_b64_tr_b16 a[250:251], v195 offset:13312
    v_cvt_pk_bf16_f32 v91, v94, v95
    v_mfma_f32_16x16x32_bf16 v[132:135], a[228:231], v[16:19], v[132:135]
    s_waitcnt vmcnt(8)
    buffer_store_dwordx4 v[88:91], v212, s[68:71], s4 offen offset:2048
    s_nop 1
    s_mul_i32 s4, s53, 24576
    v_lshlrev_b32 v246, 16, v232
    v_mfma_f32_16x16x32_bf16 v[132:135], a[224:227], v[4:7], v[132:135]
    s_add_u32 s4, s4, 12288
    ds_read_b64_tr_b16 a[252:253], v195 offset:14336
    v_and_b32 v232, 0xffff0000, v232
    v_mfma_f32_16x16x32_bf16 v[140:143], a[224:227], v[8:11], 0
    s_add_u32 s4, s4, s57
    ds_read_b64_tr_b16 a[254:255], v195 offset:15360
    v_fma_f32 v120, v120, v213, v246
    v_mfma_f32_16x16x32_bf16 v[140:143], a[228:231], v[20:23], v[140:143]
    ds_read_b64_tr_b16 a[192:193], v194 offset:16384
    v_fma_f32 v121, v121, v213, v232
    v_mfma_f32_16x16x32_bf16 v[140:143], a[232:235], v[56:59], v[140:143]
    ds_read_b64_tr_b16 a[194:195], v194 offset:17408
    v_lshlrev_b32 v247, 16, v233
    v_and_b32 v233, 0xffff0000, v233
    v_mfma_f32_16x16x32_bf16 v[140:143], a[236:239], v[68:71], v[140:143]
    s_waitcnt lgkmcnt(6)
    ds_read_b64_tr_b16 a[196:197], v194 offset:18432
    v_fma_f32 v122, v122, v213, v247
    v_mfma_f32_16x16x32_bf16 v[140:143], a[240:243], v[104:107], v[140:143]
    buffer_load_dwordx4 v211, s[24:27], s35 offen offset:2048 lds
    v_fma_f32 v123, v123, v213, v233
    v_mfma_f32_16x16x32_bf16 v[140:143], a[244:247], v[116:119], v[140:143]
    s_waitcnt lgkmcnt(5)
    ds_read_b64_tr_b16 a[198:199], v194 offset:19456
    v_cvt_pk_bf16_f32 v120, v120, v121
    v_mfma_f32_16x16x32_bf16 v[140:143], a[248:251], v[152:155], v[140:143]
    s_waitcnt lgkmcnt(4)
    ds_read_b64_tr_b16 a[200:201], v194 offset:20480
    v_cvt_pk_bf16_f32 v121, v122, v123
    v_mfma_f32_16x16x32_bf16 v[140:143], a[252:255], v[164:167], v[140:143]
    s_waitcnt vmcnt(9)
    s_add_u32 m0, s32, 0
    v_lshlrev_b32 v246, 16, v236
    v_and_b32 v236, 0xffff0000, v236
    v_mfma_f32_16x16x32_bf16 v[132:135], a[252:255], v[160:163], v[132:135]
L_hop1_3:
L_pad8:
    s_cbranch_execz L_hopped1
    ds_read_b64_tr_b16 a[202:203], v194 offset:21504
    v_fma_f32 v128, v128, v214, v246
    v_mfma_f32_16x16x32_bf16 v[132:135], a[248:251], v[148:151], v[132:135]
    s_mul_i32 s78, s53, 12288
    ds_read_b64_tr_b16 a[204:205], v194 offset:22528
    v_mov_b32 v245, 4
    v_fma_f32 v129, v129, v214, v236
    v_mfma_f32_16x16x32_bf16 v[132:135], a[244:247], v[112:115], v[132:135]
    s_add_u32 s78, s78, 98304
    ds_read_b64_tr_b16 a[206:207], v194 offset:23552
    v_lshlrev_b32 v247, 16, v237
    v_and_b32 v237, 0xffff0000, v237
    v_mfma_f32_16x16x32_bf16 v[132:135], a[240:243], v[100:103], v[132:135]
    s_add_u32 s78, s78, s56
    buffer_load_dwordx4 v211, s[24:27], s92 offen offset:2048 lds
    v_fma_f32 v130, v130, v214, v247
    v_mfma_f32_16x16x32_bf16 v[124:127], a[240:243], v[96:99], v[124:127]
    ds_read_b64_tr_b16 a[208:209], v194 offset:24576
    v_fma_f32 v131, v131, v214, v237
    v_mfma_f32_16x16x32_bf16 v[124:127], a[244:247], v[108:111], v[124:127]
    s_add_u32 m0, s32, 147456
    ds_read_b64_tr_b16 a[210:211], v194 offset:25600
    s_waitcnt vmcnt(3)
    v_readfirstlane_b32 s79, v244
    s_nop 0
    s_cmp_lt_u32 s79, 3
    s_cbranch_scc1 L_rs5
L_rb5:
    v_cvt_pk_bf16_f32 v128, v128, v129
    v_cvt_pk_bf16_f32 v129, v130, v131
    v_mfma_f32_16x16x32_bf16 v[124:127], a[248:251], v[144:147], v[124:127]
    s_waitcnt vmcnt(2)
    buffer_store_dword v245, v208, s[72:75], s28 offen
    v_lshlrev_b32 v246, 16, v240
    v_mfma_f32_16x16x32_bf16 v[124:127], a[252:255], v[156:159], v[124:127]
    s_waitcnt lgkmcnt(6)
    buffer_load_dwordx4 v[196:199], v212, s[68:71], s78 offen offset:0 sc1
    v_and_b32 v240, 0xffff0000, v240
    v_mfma_f32_16x16x32_bf16 v[168:171], a[192:195], v[0:3], 0
    buffer_load_dwordx4 v[200:203], v212, s[68:71], s78 offen offset:1024 sc1
    v_fma_f32 v136, v136, v215, v246
    v_mfma_f32_16x16x32_bf16 v[168:171], a[196:199], v[12:15], v[168:171]
    s_waitcnt lgkmcnt(4)
    ds_read_b64_tr_b16 a[212:213], v194 offset:26624
    v_fma_f32 v137, v137, v215, v240
    v_lshlrev_b32 v247, 16, v241
    v_mfma_f32_16x16x32_bf16 v[168:171], a[200:203], v[48:51], v[168:171]
    s_waitcnt lgkmcnt(3)
    buffer_load_dwordx4 v[204:207], v212, s[68:71], s78 offen offset:2048 sc1
    v_and_b32 v241, 0xffff0000, v241
    v_mfma_f32_16x16x32_bf16 v[168:171], a[204:207], v[60:63], v[168:171]
    ds_read_b64_tr_b16 a[214:215], v194 offset:27648
    v_fma_f32 v138, v138, v215, v247
    v_mfma_f32_16x16x32_bf16 v[176:179], a[204:207], v[64:67], 0
    ds_read_b64_tr_b16 a[216:217], v194 offset:28672
    buffer_load_dwordx4 v210, s[24:27], s36 offen offset:1024 lds
    v_fma_f32 v139, v139, v215, v241
    v_mfma_f32_16x16x32_bf16 v[176:179], a[200:203], v[52:55], v[176:179]
    s_add_u32 m0, s32, 0
    ds_read_b64_tr_b16 a[218:219], v194 offset:29696
    v_cvt_pk_bf16_f32 v136, v136, v137
    v_cvt_pk_bf16_f32 v137, v138, v139
    v_mfma_f32_16x16x32_bf16 v[176:179], a[196:199], v[16:19], v[176:179]
    ds_read_b64_tr_b16 a[220:221], v194 offset:30720
    v_lshlrev_b32 v246, 16, v234
    v_mfma_f32_16x16x32_bf16 v[176:179], a[192:195], v[4:7], v[176:179]
    ds_read_b64_tr_b16 a[222:223], v194 offset:31744
    v_and_b32 v234, 0xffff0000, v234
    v_mfma_f32_16x16x32_bf16 v[184:187], a[192:195], v[8:11], 0
    ds_read_b64_tr_b16 a[224:225], v195 offset:16384
    v_fma_f32 v124, v124, v213, v246
    v_fma_f32 v125, v125, v213, v234
    v_mfma_f32_16x16x32_bf16 v[184:187], a[196:199], v[20:23], v[184:187]
    ds_read_b64_tr_b16 a[226:227], v195 offset:17408
    v_lshlrev_b32 v247, 16, v235
    v_mfma_f32_16x16x32_bf16 v[184:187], a[200:203], v[56:59], v[184:187]
    ds_read_b64_tr_b16 a[228:229], v195 offset:18432
    v_and_b32 v235, 0xffff0000, v235
    v_mfma_f32_16x16x32_bf16 v[184:187], a[204:207], v[68:71], v[184:187]
    s_waitcnt lgkmcnt(8)
    ds_read_b64_tr_b16 a[230:231], v195 offset:19456
    v_fma_f32 v126, v126, v213, v247
    v_fma_f32 v127, v127, v213, v235
    v_mfma_f32_16x16x32_bf16 v[184:187], a[208:211], v[104:107], v[184:187]
    s_waitcnt lgkmcnt(8)
    buffer_load_dwordx4 v210, s[24:27], s93 offen offset:1024 lds
    v_cvt_pk_bf16_f32 v122, v124, v125
    v_mfma_f32_16x16x32_bf16 v[184:187], a[212:215], v[116:119], v[184:187]
    s_waitcnt lgkmcnt(6)
    ds_read_b64_tr_b16 a[232:233], v195 offset:20480
    v_cvt_pk_bf16_f32 v123, v126, v127
    v_mfma_f32_16x16x32_bf16 v[184:187], a[216:219], v[152:155], v[184:187]
    s_waitcnt lgkmcnt(5)
    buffer_store_dwordx4 v[120:123], v212, s[68:71], s4 offen offset:0
    v_lshlrev_b32 v246, 16, v238
    v_mfma_f32_16x16x32_bf16 v[184:187], a[220:223], v[164:167], v[184:187]
    s_add_u32 m0, s32, 147456
    ds_read_b64_tr_b16 a[234:235], v195 offset:21504
    v_and_b32 v238, 0xffff0000, v238
    v_fma_f32 v132, v132, v214, v246
    v_mfma_f32_16x16x32_bf16 v[176:179], a[220:223], v[160:163], v[176:179]
    ds_read_b64_tr_b16 a[236:237], v195 offset:22528
    v_fma_f32 v133, v133, v214, v238
    v_mfma_f32_16x16x32_bf16 v[176:179], a[216:219], v[148:151], v[176:179]
    ds_read_b64_tr_b16 a[238:239], v195 offset:23552
    v_lshlrev_b32 v247, 16, v239
    v_mfma_f32_16x16x32_bf16 v[176:179], a[212:215], v[112:115], v[176:179]
    ds_read_b64_tr_b16 a[240:241], v195 offset:24576
    v_and_b32 v239, 0xffff0000, v239
    v_mfma_f32_16x16x32_bf16 v[176:179], a[208:211], v[100:103], v[176:179]
    buffer_load_dwordx4 v211, s[24:27], s36 offen offset:3072 lds
    v_fma_f32 v134, v134, v214, v247
    v_fma_f32 v135, v135, v214, v239
    v_mfma_f32_16x16x32_bf16 v[168:171], a[208:211], v[96:99], v[168:171]
    ds_read_b64_tr_b16 a[242:243], v195 offset:25600
    v_cvt_pk_bf16_f32 v130, v132, v133
    v_mfma_f32_16x16x32_bf16 v[168:171], a[212:215], v[108:111], v[168:171]
    s_add_u32 m0, s32, 0
    ds_read_b64_tr_b16 a[244:245], v195 offset:26624
    v_cvt_pk_bf16_f32 v131, v134, v135
    v_mfma_f32_16x16x32_bf16 v[168:171], a[216:219], v[144:147], v[168:171]
    buffer_store_dwordx4 v[128:131], v212, s[68:71], s4 offen offset:1024
    v_lshlrev_b32 v246, 16, v242
    v_and_b32 v242, 0xffff0000, v242
    v_mfma_f32_16x16x32_bf16 v[168:171], a[220:223], v[156:159], v[168:171]
    s_waitcnt lgkmcnt(6)
    ds_read_b64_tr_b16 a[246:247], v195 offset:27648
    v_fma_f32 v140, v140, v215, v246
    v_mfma_f32_16x16x32_bf16 v[172:175], a[224:227], v[0:3], 0
    ds_read_b64_tr_b16 a[248:249], v195 offset:28672
    v_fma_f32 v141, v141, v215, v242
    v_mfma_f32_16x16x32_bf16 v[172:175], a[228:231], v[12:15], v[172:175]
    s_waitcnt lgkmcnt(7)
    ds_read_b64_tr_b16 a[250:251], v195 offset:29696
    v_lshlrev_b32 v247, 16, v243
    v_mfma_f32_16x16x32_bf16 v[172:175], a[232:235], v[48:51], v[172:175]
    s_waitcnt lgkmcnt(6)
    buffer_load_dwordx4 v211, s[24:27], s93 offen offset:3072 lds
    v_and_b32 v243, 0xffff0000, v243
    v_fma_f32 v142, v142, v215, v247
    v_mfma_f32_16x16x32_bf16 v[172:175], a[236:239], v[60:63], v[172:175]
    buffer_load_dword v244, off, s[72:75], s61 sc1
    v_fma_f32 v143, v143, v215, v243
    v_mfma_f32_16x16x32_bf16 v[180:183], a[236:239], v[64:67], 0
    ds_read_b64_tr_b16 a[252:253], v195 offset:30720
    v_cvt_pk_bf16_f32 v138, v140, v141
    v_mfma_f32_16x16x32_bf16 v[180:183], a[232:235], v[52:55], v[180:183]
    ds_read_b64_tr_b16 a[254:255], v195 offset:31744
    v_add_u32 v194, 0x10000, v194
    v_cvt_pk_bf16_f32 v139, v142, v143
    v_mfma_f32_16x16x32_bf16 v[180:183], a[228:231], v[16:19], v[180:183]
    s_waitcnt vmcnt(9)
    buffer_store_dwordx4 v[136:139], v212, s[68:71], s4 offen offset:2048
    s_nop 1
    s_mul_i32 s4, s53, 12288
    v_lshlrev_b32 v246, 16, v196
    v_mfma_f32_16x16x32_bf16 v[180:183], a[224:227], v[4:7], v[180:183]
    s_add_u32 s4, s4, 98304
    v_and_b32 v196, 0xffff0000, v196
    v_fma_f32 v168, v168, v213, v246
    v_mfma_f32_16x16x32_bf16 v[188:191], a[224:227], v[8:11], 0
    s_add_u32 s4, s4, s57
    v_add_u32 v195, 0x10000, v195
    v_fma_f32 v169, v169, v213, v196
    v_mfma_f32_16x16x32_bf16 v[188:191], a[228:231], v[20:23], v[188:191]
    v_lshlrev_b32 v247, 16, v197
    v_and_b32 v197, 0xffff0000, v197
    v_mfma_f32_16x16x32_bf16 v[188:191], a[232:235], v[56:59], v[188:191]
    v_fma_f32 v170, v170, v213, v247
    v_fma_f32 v171, v171, v213, v197
    v_mfma_f32_16x16x32_bf16 v[188:191], a[236:239], v[68:71], v[188:191]
    s_waitcnt lgkmcnt(2)
    s_waitcnt lgkmcnt(0)
    s_barrier
    ds_read_b64_tr_b16 a[192:193], v194 offset:0
    v_cvt_pk_bf16_f32 v168, v168, v169
    v_mfma_f32_16x16x32_bf16 v[188:191], a[240:243], v[104:107], v[188:191]
    buffer_store_dword v216, v209, s[72:75], s30 offen sc1
    v_cvt_pk_bf16_f32 v169, v170, v171
    v_mfma_f32_16x16x32_bf16 v[188:191], a[244:247], v[116:119], v[188:191]
    s_waitcnt vmcnt(10)
    ds_read_b64_tr_b16 a[194:195], v194 offset:1024
    v_lshlrev_b32 v246, 16, v200
    v_mfma_f32_16x16x32_bf16 v[188:191], a[248:251], v[152:155], v[188:191]
    ds_read_b64_tr_b16 a[196:197], v194 offset:2048
    v_and_b32 v200, 0xffff0000, v200
    v_mfma_f32_16x16x32_bf16 v[188:191], a[252:255], v[164:167], v[188:191]
    v_fma_f32 v176, v176, v214, v246
    v_fma_f32 v177, v177, v214, v200
    v_mfma_f32_16x16x32_bf16 v[180:183], a[252:255], v[160:163], v[180:183]
    ds_read_b64_tr_b16 a[198:199], v194 offset:3072
    v_lshlrev_b32 v247, 16, v201
    v_mfma_f32_16x16x32_bf16 v[180:183], a[248:251], v[148:151], v[180:183]
    s_mul_i32 s78, s54, 24576
    ds_read_b64_tr_b16 a[200:201], v194 offset:4096
    v_mov_b32 v245, 5
    v_mfma_f32_16x16x32_bf16 v[180:183], a[244:247], v[112:115], v[180:183]
    s_add_u32 s78, s78, 0
    v_and_b32 v201, 0xffff0000, v201
    v_fma_f32 v178, v178, v214, v247
    v_mfma_f32_16x16x32_bf16 v[180:183], a[240:243], v[100:103], v[180:183]
    s_add_u32 s78, s78, s57
    ds_read_b64_tr_b16 a[202:203], v194 offset:5120
    v_fma_f32 v179, v179, v214, v201
    v_mfma_f32_16x16x32_bf16 v[172:175], a[240:243], v[96:99], v[172:175]
    ds_read_b64_tr_b16 a[204:205], v194 offset:6144
    v_cvt_pk_bf16_f32 v176, v176, v177
    v_mfma_f32_16x16x32_bf16 v[172:175], a[244:247], v[108:111], v[172:175]
    s_waitcnt vmcnt(2)
    v_readfirstlane_b32 s79, v244
    s_nop 0
    s_cmp_lt_u32 s79, 4
    s_cbranch_scc1 L_rs6
L_rb6:
    ds_read_b64_tr_b16 a[206:207], v194 offset:7168
    v_cvt_pk_bf16_f32 v177, v178, v179
    v_mfma_f32_16x16x32_bf16 v[172:175], a[248:251], v[144:147], v[172:175]
    s_waitcnt vmcnt(1)
    buffer_store_dword v245, v208, s[72:75], s28 offen
    v_lshlrev_b32 v246, 16, v204
    v_mfma_f32_16x16x32_bf16 v[172:175], a[252:255], v[156:159], v[172:175]
    s_waitcnt lgkmcnt(6)
    buffer_load_dwordx4 v[220:223], v212, s[68:71], s78 offen offset:0 sc1
    v_and_b32 v204, 0xffff0000, v204
    v_mfma_f32_16x16x32_bf16 v[24:27], a[192:195], v[0:3], 0
    s_waitcnt lgkmcnt(4)
    buffer_load_dwordx4 v[224:227], v212, s[68:71], s78 offen offset:1024 sc1
    v_fma_f32 v184, v184, v215, v246
    v_mfma_f32_16x16x32_bf16 v[24:27], a[196:199], v[12:15], v[24:27]
    s_waitcnt lgkmcnt(2)
    ds_read_b64_tr_b16 a[208:209], v194 offset:8192
    v_fma_f32 v185, v185, v215, v204
    v_lshlrev_b32 v247, 16, v205
    v_mfma_f32_16x16x32_bf16 v[24:27], a[200:203], v[48:51], v[24:27]
    s_waitcnt lgkmcnt(1)
    buffer_load_dwordx4 v[228:231], v212, s[68:71], s78 offen offset:2048 sc1
    v_and_b32 v205, 0xffff0000, v205
    v_mfma_f32_16x16x32_bf16 v[24:27], a[204:207], v[60:63], v[24:27]
    ds_read_b64_tr_b16 a[210:211], v194 offset:9216
    v_fma_f32 v186, v186, v215, v247
    v_mfma_f32_16x16x32_bf16 v[32:35], a[204:207], v[64:67], 0
    ds_read_b64_tr_b16 a[212:213], v194 offset:10240
    v_fma_f32 v187, v187, v215, v205
    v_cvt_pk_bf16_f32 v184, v184, v185
    v_mfma_f32_16x16x32_bf16 v[32:35], a[200:203], v[52:55], v[32:35]
    ds_read_b64_tr_b16 a[214:215], v194 offset:11264
    v_cvt_pk_bf16_f32 v185, v186, v187
    v_mfma_f32_16x16x32_bf16 v[32:35], a[196:199], v[16:19], v[32:35]
    ds_read_b64_tr_b16 a[216:217], v194 offset:12288
    v_lshlrev_b32 v246, 16, v198
    v_mfma_f32_16x16x32_bf16 v[32:35], a[192:195], v[4:7], v[32:35]
    ds_read_b64_tr_b16 a[218:219], v194 offset:13312
    v_and_b32 v198, 0xffff0000, v198
    v_mfma_f32_16x16x32_bf16 v[40:43], a[192:195], v[8:11], 0
    ds_read_b64_tr_b16 a[220:221], v194 offset:14336
    v_fma_f32 v172, v172, v213, v246
    v_fma_f32 v173, v173, v213, v198
    v_mfma_f32_16x16x32_bf16 v[40:43], a[196:199], v[20:23], v[40:43]
    ds_read_b64_tr_b16 a[222:223], v194 offset:15360
    v_lshlrev_b32 v247, 16, v199
    v_mfma_f32_16x16x32_bf16 v[40:43], a[200:203], v[56:59], v[40:43]
    ds_read_b64_tr_b16 a[224:225], v195 offset:0
    v_and_b32 v199, 0xffff0000, v199
    v_mfma_f32_16x16x32_bf16 v[40:43], a[204:207], v[68:71], v[40:43]
    s_waitcnt lgkmcnt(7)
    ds_read_b64_tr_b16 a[226:227], v195 offset:1024
    v_fma_f32 v174, v174, v213, v247
    v_fma_f32 v175, v175, v213, v199
    v_mfma_f32_16x16x32_bf16 v[40:43], a[208:211], v[104:107], v[40:43]
    s_waitcnt lgkmcnt(6)
    v_cvt_pk_bf16_f32 v170, v172, v173
    v_cvt_pk_bf16_f32 v171, v174, v175
    v_mfma_f32_16x16x32_bf16 v[40:43], a[212:215], v[116:119], v[40:43]
    s_waitcnt lgkmcnt(4)
    buffer_store_dwordx4 v[168:171], v212, s[68:71], s4 offen offset:0
    v_lshlrev_b32 v246, 16, v202
    v_mfma_f32_16x16x32_bf16 v[40:43], a[216:219], v[152:155], v[40:43]
    s_waitcnt lgkmcnt(2)
    ds_read_b64_tr_b16 a[228:229], v195 offset:2048
    v_and_b32 v202, 0xffff0000, v202
    v_mfma_f32_16x16x32_bf16 v[40:43], a[220:223], v[164:167], v[40:43]
    ds_read_b64_tr_b16 a[230:231], v195 offset:3072
    v_fma_f32 v180, v180, v214, v246
    v_mfma_f32_16x16x32_bf16 v[32:35], a[220:223], v[160:163], v[32:35]
    ds_read_b64_tr_b16 a[232:233], v195 offset:4096
    v_fma_f32 v181, v181, v214, v202
    v_mfma_f32_16x16x32_bf16 v[32:35], a[216:219], v[148:151], v[32:35]
    ds_read_b64_tr_b16 a[234:235], v195 offset:5120
    v_lshlrev_b32 v247, 16, v203
    v_mfma_f32_16x16x32_bf16 v[32:35], a[212:215], v[112:115], v[32:35]
    ds_read_b64_tr_b16 a[236:237], v195 offset:6144
    v_and_b32 v203, 0xffff0000, v203
    v_mfma_f32_16x16x32_bf16 v[32:35], a[208:211], v[100:103], v[32:35]
    v_fma_f32 v182, v182, v214, v247
    v_fma_f32 v183, v183, v214, v203
    v_mfma_f32_16x16x32_bf16 v[24:27], a[208:211], v[96:99], v[24:27]
    ds_read_b64_tr_b16 a[238:239], v195 offset:7168
    v_cvt_pk_bf16_f32 v178, v180, v181
    v_mfma_f32_16x16x32_bf16 v[24:27], a[212:215], v[108:111], v[24:27]
    ds_read_b64_tr_b16 a[240:241], v195 offset:8192
    v_cvt_pk_bf16_f32 v179, v182, v183
    v_mfma_f32_16x16x32_bf16 v[24:27], a[216:219], v[144:147], v[24:27]
    buffer_store_dwordx4 v[176:179], v212, s[68:71], s4 offen offset:1024
    v_lshlrev_b32 v246, 16, v206
    v_and_b32 v206, 0xffff0000, v206
    v_mfma_f32_16x16x32_bf16 v[24:27], a[220:223], v[156:159], v[24:27]
    s_waitcnt lgkmcnt(7)
    ds_read_b64_tr_b16 a[242:243], v195 offset:9216
    v_fma_f32 v188, v188, v215, v246
    v_mfma_f32_16x16x32_bf16 v[28:31], a[224:227], v[0:3], 0
    s_waitcnt lgkmcnt(6)
    ds_read_b64_tr_b16 a[244:245], v195 offset:10240
    v_fma_f32 v189, v189, v215, v206
    v_mfma_f32_16x16x32_bf16 v[28:31], a[228:231], v[12:15], v[28:31]
    s_waitcnt lgkmcnt(5)
    ds_read_b64_tr_b16 a[246:247], v195 offset:11264
    v_lshlrev_b32 v247, 16, v207
    v_mfma_f32_16x16x32_bf16 v[28:31], a[232:235], v[48:51], v[28:31]
    s_waitcnt lgkmcnt(4)
    v_and_b32 v207, 0xffff0000, v207
    v_fma_f32 v190, v190, v215, v247
    v_mfma_f32_16x16x32_bf16 v[28:31], a[236:239], v[60:63], v[28:31]
    buffer_load_dword v244, off, s[72:75], s61 sc1
    v_fma_f32 v191, v191, v215, v207
    v_mfma_f32_16x16x32_bf16 v[36:39], a[236:239], v[64:67], 0
    ds_read_b64_tr_b16 a[248:249], v195 offset:12288
    v_cvt_pk_bf16_f32 v186, v188, v189
    v_mfma_f32_16x16x32_bf16 v[36:39], a[232:235], v[52:55], v[36:39]
    ds_read_b64_tr_b16 a[250:251], v195 offset:13312
    v_cvt_pk_bf16_f32 v187, v190, v191
    v_mfma_f32_16x16x32_bf16 v[36:39], a[228:231], v[16:19], v[36:39]
    s_waitcnt vmcnt(5)
    buffer_store_dwordx4 v[184:187], v212, s[68:71], s4 offen offset:2048
    s_nop 1
    s_mul_i32 s4, s54, 24576
    v_lshlrev_b32 v246, 16, v220
    v_mfma_f32_16x16x32_bf16 v[36:39], a[224:227], v[4:7], v[36:39]
    s_add_u32 s4, s4, 0
    ds_read_b64_tr_b16 a[252:253], v195 offset:14336
    v_and_b32 v220, 0xffff0000, v220
    v_mfma_f32_16x16x32_bf16 v[44:47], a[224:227], v[8:11], 0
    s_add_u32 s4, s4, s58
    ds_read_b64_tr_b16 a[254:255], v195 offset:15360
    v_fma_f32 v24, v24, v213, v246
    v_mfma_f32_16x16x32_bf16 v[44:47], a[228:231], v[20:23], v[44:47]
    ds_read_b64_tr_b16 a[192:193], v194 offset:16384
    v_fma_f32 v25, v25, v213, v220
    v_mfma_f32_16x16x32_bf16 v[44:47], a[232:235], v[56:59], v[44:47]
    ds_read_b64_tr_b16 a[194:195], v194 offset:17408
    v_lshlrev_b32 v247, 16, v221
    v_and_b32 v221, 0xffff0000, v221
    v_mfma_f32_16x16x32_bf16 v[44:47], a[236:239], v[68:71], v[44:47]
    s_waitcnt lgkmcnt(6)
    ds_read_b64_tr_b16 a[196:197], v194 offset:18432
    v_fma_f32 v26, v26, v213, v247
    v_mfma_f32_16x16x32_bf16 v[44:47], a[240:243], v[104:107], v[44:47]
    v_fma_f32 v27, v27, v213, v221
    v_cvt_pk_bf16_f32 v24, v24, v25
    v_mfma_f32_16x16x32_bf16 v[44:47], a[244:247], v[116:119], v[44:47]
    s_waitcnt lgkmcnt(5)
    ds_read_b64_tr_b16 a[198:199], v194 offset:19456
    v_cvt_pk_bf16_f32 v25, v26, v27
    v_mfma_f32_16x16x32_bf16 v[44:47], a[248:251], v[152:155], v[44:47]
    s_waitcnt lgkmcnt(4)
    ds_read_b64_tr_b16 a[200:201], v194 offset:20480
    v_mov_b32 v245, 6
    v_mfma_f32_16x16x32_bf16 v[44:47], a[252:255], v[164:167], v[44:47]
    s_waitcnt vmcnt(5)
    v_lshlrev_b32 v246, 16, v224
    v_and_b32 v224, 0xffff0000, v224
    v_mfma_f32_16x16x32_bf16 v[36:39], a[252:255], v[160:163], v[36:39]
    ds_read_b64_tr_b16 a[202:203], v194 offset:21504
    v_fma_f32 v32, v32, v214, v246
    v_mfma_f32_16x16x32_bf16 v[36:39], a[248:251], v[148:151], v[36:39]
    s_mul_i32 s78, s54, 24576
    ds_read_b64_tr_b16 a[204:205], v194 offset:22528
    v_fma_f32 v33, v33, v214, v224
    v_lshlrev_b32 v247, 16, v225
    v_mfma_f32_16x16x32_bf16 v[36:39], a[244:247], v[112:115], v[36:39]
    s_add_u32 s78, s78, 12288
    ds_read_b64_tr_b16 a[206:207], v194 offset:23552
    v_and_b32 v225, 0xffff0000, v225
    v_mfma_f32_16x16x32_bf16 v[36:39], a[240:243], v[100:103], v[36:39]
    s_add_u32 s78, s78, s57
    v_fma_f32 v34, v34, v214, v247
    v_fma_f32 v35, v35, v214, v225
    v_mfma_f32_16x16x32_bf16 v[28:31], a[240:243], v[96:99], v[28:31]
    ds_read_b64_tr_b16 a[208:209], v194 offset:24576
    v_cvt_pk_bf16_f32 v32, v32, v33
    v_mfma_f32_16x16x32_bf16 v[28:31], a[244:247], v[108:111], v[28:31]
    s_waitcnt vmcnt(1)
    v_readfirstlane_b32 s79, v244
    s_nop 0
    s_cmp_lt_u32 s79, 5
    s_cbranch_scc1 L_rs7
L_rb7:
    ds_read_b64_tr_b16 a[210:211], v194 offset:25600
    v_cvt_pk_bf16_f32 v33, v34, v35
    v_mfma_f32_16x16x32_bf16 v[28:31], a[248:251], v[144:147], v[28:31]
    s_waitcnt vmcnt(0)
    buffer_store_dword v245, v208, s[72:75], s28 offen
    v_lshlrev_b32 v246, 16, v228
    v_mfma_f32_16x16x32_bf16 v[28:31], a[252:255], v[156:159], v[28:31]
    s_waitcnt lgkmcnt(6)
    buffer_load_dwordx4 v[232:235], v212, s[68:71], s78 offen offset:0 sc1
    v_and_b32 v228, 0xffff0000, v228
    v_mfma_f32_16x16x32_bf16 v[72:75], a[192:195], v[0:3], 0
    buffer_load_dwordx4 v[236:239], v212, s[68:71], s78 offen offset:1024 sc1
    v_fma_f32 v40, v40, v215, v246
    v_mfma_f32_16x16x32_bf16 v[72:75], a[196:199], v[12:15], v[72:75]
    s_waitcnt lgkmcnt(4)
    ds_read_b64_tr_b16 a[212:213], v194 offset:26624
    v_fma_f32 v41, v41, v215, v228
    v_lshlrev_b32 v247, 16, v229
    v_mfma_f32_16x16x32_bf16 v[72:75], a[200:203], v[48:51], v[72:75]
    s_waitcnt lgkmcnt(3)
    buffer_load_dwordx4 v[240:243], v212, s[68:71], s78 offen offset:2048 sc1
    v_and_b32 v229, 0xffff0000, v229
    v_mfma_f32_16x16x32_bf16 v[72:75], a[204:207], v[60:63], v[72:75]
    ds_read_b64_tr_b16 a[214:215], v194 offset:27648
    v_fma_f32 v42, v42, v215, v247
    v_mfma_f32_16x16x32_bf16 v[80:83], a[204:207], v[64:67], 0
    ds_read_b64_tr_b16 a[216:217], v194 offset:28672
    v_fma_f32 v43, v43, v215, v229
    v_cvt_pk_bf16_f32 v40, v40, v41
    v_mfma_f32_16x16x32_bf16 v[80:83], a[200:203], v[52:55], v[80:83]
    ds_read_b64_tr_b16 a[218:219], v194 offset:29696
    v_cvt_pk_bf16_f32 v41, v42, v43
    v_mfma_f32_16x16x32_bf16 v[80:83], a[196:199], v[16:19], v[80:83]
    ds_read_b64_tr_b16 a[220:221], v194 offset:30720
    v_lshlrev_b32 v246, 16, v222
    v_mfma_f32_16x16x32_bf16 v[80:83], a[192:195], v[4:7], v[80:83]
    ds_read_b64_tr_b16 a[222:223], v194 offset:31744
    v_and_b32 v222, 0xffff0000, v222
    v_mfma_f32_16x16x32_bf16 v[88:91], a[192:195], v[8:11], 0
    ds_read_b64_tr_b16 a[224:225], v195 offset:16384
    v_fma_f32 v28, v28, v213, v246
    v_fma_f32 v29, v29, v213, v222
    v_mfma_f32_16x16x32_bf16 v[88:91], a[196:199], v[20:23], v[88:91]
    ds_read_b64_tr_b16 a[226:227], v195 offset:17408
    v_lshlrev_b32 v247, 16, v223
    v_mfma_f32_16x16x32_bf16 v[88:91], a[200:203], v[56:59], v[88:91]
    ds_read_b64_tr_b16 a[228:229], v195 offset:18432
    v_and_b32 v223, 0xffff0000, v223
    v_mfma_f32_16x16x32_bf16 v[88:91], a[204:207], v[68:71], v[88:91]
    s_waitcnt lgkmcnt(8)
    ds_read_b64_tr_b16 a[230:231], v195 offset:19456
    v_fma_f32 v30, v30, v213, v247
    v_fma_f32 v31, v31, v213, v223
    v_mfma_f32_16x16x32_bf16 v[88:91], a[208:211], v[104:107], v[88:91]
    s_waitcnt lgkmcnt(8)
    v_cvt_pk_bf16_f32 v26, v28, v29
    v_cvt_pk_bf16_f32 v27, v30, v31
    v_mfma_f32_16x16x32_bf16 v[88:91], a[212:215], v[116:119], v[88:91]
    s_waitcnt lgkmcnt(6)
    buffer_store_dwordx4 v[24:27], v212, s[68:71], s4 offen offset:0
    v_lshlrev_b32 v246, 16, v226
    v_mfma_f32_16x16x32_bf16 v[88:91], a[216:219], v[152:155], v[88:91]
    s_waitcnt lgkmcnt(4)
    ds_read_b64_tr_b16 a[232:233], v195 offset:20480
    v_and_b32 v226, 0xffff0000, v226
    v_mfma_f32_16x16x32_bf16 v[88:91], a[220:223], v[164:167], v[88:91]
    ds_read_b64_tr_b16 a[234:235], v195 offset:21504
    v_fma_f32 v36, v36, v214, v246
    v_mfma_f32_16x16x32_bf16 v[80:83], a[220:223], v[160:163], v[80:83]
    ds_read_b64_tr_b16 a[236:237], v195 offset:22528
    v_fma_f32 v37, v37, v214, v226
    v_mfma_f32_16x16x32_bf16 v[80:83], a[216:219], v[148:151], v[80:83]
    ds_read_b64_tr_b16 a[238:239], v195 offset:23552
    v_lshlrev_b32 v247, 16, v227
    v_mfma_f32_16x16x32_bf16 v[80:83], a[212:215], v[112:115], v[80:83]
    ds_read_b64_tr_b16 a[240:241], v195 offset:24576
    v_and_b32 v227, 0xffff0000, v227
    v_mfma_f32_16x16x32_bf16 v[80:83], a[208:211], v[100:103], v[80:83]
    v_fma_f32 v38, v38, v214, v247
    v_fma_f32 v39, v39, v214, v227
    v_mfma_f32_16x16x32_bf16 v[72:75], a[208:211], v[96:99], v[72:75]
    ds_read_b64_tr_b16 a[242:243], v195 offset:25600
    v_cvt_pk_bf16_f32 v34, v36, v37
    v_mfma_f32_16x16x32_bf16 v[72:75], a[212:215], v[108:111], v[72:75]
    ds_read_b64_tr_b16 a[244:245], v195 offset:26624
    v_cvt_pk_bf16_f32 v35, v38, v39
    v_mfma_f32_16x16x32_bf16 v[72:75], a[216:219], v[144:147], v[72:75]
    buffer_store_dwordx4 v[32:35], v212, s[68:71], s4 offen offset:1024
    v_lshlrev_b32 v246, 16, v230
    v_and_b32 v230, 0xffff0000, v230
    v_mfma_f32_16x16x32_bf16 v[72:75], a[220:223], v[156:159], v[72:75]
    s_waitcnt lgkmcnt(7)
    ds_read_b64_tr_b16 a[246:247], v195 offset:27648
    v_fma_f32 v44, v44, v215, v246
    v_mfma_f32_16x16x32_bf16 v[76:79], a[224:227], v[0:3], 0
    ds_read_b64_tr_b16 a[248:249], v195 offset:28672
    v_fma_f32 v45, v45, v215, v230
    v_mfma_f32_16x16x32_bf16 v[76:79], a[228:231], v[12:15], v[76:79]
    s_waitcnt lgkmcnt(7)
    ds_read_b64_tr_b16 a[250:251], v195 offset:29696
    v_lshlrev_b32 v247, 16, v231
    v_mfma_f32_16x16x32_bf16 v[76:79], a[232:235], v[48:51], v[76:79]
    s_waitcnt lgkmcnt(6)
    v_and_b32 v231, 0xffff0000, v231
    v_fma_f32 v46, v46, v215, v247
    v_mfma_f32_16x16x32_bf16 v[76:79], a[236:239], v[60:63], v[76:79]
    buffer_load_dword v244, off, s[72:75], s61 sc1
    v_fma_f32 v47, v47, v215, v231
    v_mfma_f32_16x16x32_bf16 v[84:87], a[236:239], v[64:67], 0
    ds_read_b64_tr_b16 a[252:253], v195 offset:30720
    v_cvt_pk_bf16_f32 v42, v44, v45
    v_mfma_f32_16x16x32_bf16 v[84:87], a[232:235], v[52:55], v[84:87]
    ds_read_b64_tr_b16 a[254:255], v195 offset:31744
    v_add_u32 v194, 0x8000, v194
    v_cvt_pk_bf16_f32 v43, v46, v47
    v_mfma_f32_16x16x32_bf16 v[84:87], a[228:231], v[16:19], v[84:87]
    s_waitcnt vmcnt(5)
    buffer_store_dwordx4 v[40:43], v212, s[68:71], s4 offen offset:2048
    s_nop 1
    s_mul_i32 s4, s54, 24576
    v_lshlrev_b32 v246, 16, v232
    v_mfma_f32_16x16x32_bf16 v[84:87], a[224:227], v[4:7], v[84:87]
    s_add_u32 s4, s4, 12288
    v_and_b32 v232, 0xffff0000, v232
    v_fma_f32 v72, v72, v213, v246
    v_mfma_f32_16x16x32_bf16 v[92:95], a[224:227], v[8:11], 0
    s_add_u32 s4, s4, s58
    v_add_u32 v195, 0x8000, v195
    v_fma_f32 v73, v73, v213, v232
    v_mfma_f32_16x16x32_bf16 v[92:95], a[228:231], v[20:23], v[92:95]
    v_lshlrev_b32 v247, 16, v233
    v_and_b32 v233, 0xffff0000, v233
    v_mfma_f32_16x16x32_bf16 v[92:95], a[232:235], v[56:59], v[92:95]
    v_fma_f32 v74, v74, v213, v247
    v_fma_f32 v75, v75, v213, v233
    v_mfma_f32_16x16x32_bf16 v[92:95], a[236:239], v[68:71], v[92:95]
    s_waitcnt lgkmcnt(2)
    s_waitcnt lgkmcnt(0)
    s_barrier
    ds_read_b64_tr_b16 a[192:193], v194 offset:0
    v_cvt_pk_bf16_f32 v72, v72, v73
    v_mfma_f32_16x16x32_bf16 v[92:95], a[240:243], v[104:107], v[92:95]
    v_cvt_pk_bf16_f32 v73, v74, v75
    s_waitcnt vmcnt(5)
    v_lshlrev_b32 v246, 16, v236
    v_mfma_f32_16x16x32_bf16 v[92:95], a[244:247], v[116:119], v[92:95]
    ds_read_b64_tr_b16 a[194:195], v194 offset:1024
    v_and_b32 v236, 0xffff0000, v236
    v_mfma_f32_16x16x32_bf16 v[92:95], a[248:251], v[152:155], v[92:95]
    ds_read_b64_tr_b16 a[196:197], v194 offset:2048
    v_fma_f32 v80, v80, v214, v246
    v_mfma_f32_16x16x32_bf16 v[92:95], a[252:255], v[164:167], v[92:95]
    v_fma_f32 v81, v81, v214, v236
    v_lshlrev_b32 v247, 16, v237
    v_mfma_f32_16x16x32_bf16 v[84:87], a[252:255], v[160:163], v[84:87]
    ds_read_b64_tr_b16 a[198:199], v194 offset:3072
    v_and_b32 v237, 0xffff0000, v237
    v_mfma_f32_16x16x32_bf16 v[84:87], a[248:251], v[148:151], v[84:87]
    s_mul_i32 s78, s54, 12288
    ds_read_b64_tr_b16 a[200:201], v194 offset:4096
    v_mov_b32 v245, 7
    v_mfma_f32_16x16x32_bf16 v[84:87], a[244:247], v[112:115], v[84:87]
    s_add_u32 s78, s78, 98304
    v_fma_f32 v82, v82, v214, v247
    v_fma_f32 v83, v83, v214, v237
    v_mfma_f32_16x16x32_bf16 v[84:87], a[240:243], v[100:103], v[84:87]
    s_add_u32 s78, s78, s57
    ds_read_b64_tr_b16 a[202:203], v194 offset:5120
    v_cvt_pk_bf16_f32 v80, v80, v81
    v_mfma_f32_16x16x32_bf16 v[76:79], a[240:243], v[96:99], v[76:79]
    ds_read_b64_tr_b16 a[204:205], v194 offset:6144
    v_cvt_pk_bf16_f32 v81, v82, v83
    v_mfma_f32_16x16x32_bf16 v[76:79], a[244:247], v[108:111], v[76:79]
    s_waitcnt vmcnt(4)
    s_waitcnt vmcnt(1)
    v_readfirstlane_b32 s79, v244
    s_nop 0
    s_cmp_lt_u32 s79, 6
    s_cbranch_scc1 L_rs8
L_rb8:
    v_lshlrev_b32 v246, 16, v240
    v_and_b32 v240, 0xffff0000, v240
    v_mfma_f32_16x16x32_bf16 v[76:79], a[248:251], v[144:147], v[76:79]
    s_waitcnt vmcnt(0)
    buffer_store_dword v245, v208, s[72:75], s28 offen
    v_fma_f32 v88, v88, v215, v246
    v_mfma_f32_16x16x32_bf16 v[76:79], a[252:255], v[156:159], v[76:79]
    s_waitcnt lgkmcnt(5)
L_pad9:
    s_cbranch_execz L_hopped1
    buffer_load_dwordx4 v[196:199], v212, s[68:71], s78 offen offset:0 sc1
    v_fma_f32 v89, v89, v215, v240
    v_mfma_f32_16x16x32_bf16 v[120:123], a[192:195], v[0:3], 0
    s_waitcnt lgkmcnt(3)
    buffer_load_dwordx4 v[200:203], v212, s[68:71], s78 offen offset:1024 sc1
    v_lshlrev_b32 v247, 16, v241
    v_mfma_f32_16x16x32_bf16 v[120:123], a[196:199], v[12:15], v[120:123]
    s_waitcnt lgkmcnt(1)
    ds_read_b64_tr_b16 a[206:207], v194 offset:7168
    v_and_b32 v241, 0xffff0000, v241
    v_mfma_f32_16x16x32_bf16 v[120:123], a[200:203], v[48:51], v[120:123]
    s_waitcnt lgkmcnt(0)
    buffer_load_dwordx4 v[204:207], v212, s[68:71], s78 offen offset:2048 sc1
    ds_read_b64_tr_b16 a[208:209], v194 offset:8192
    v_mfma_f32_16x16x32_bf16 v[120:123], a[204:207], v[60:63], v[120:123]
    ds_read_b64_tr_b16 a[210:211], v194 offset:9216
    v_fma_f32 v90, v90, v215, v247
    v_mfma_f32_16x16x32_bf16 v[128:131], a[204:207], v[64:67], 0
    ds_read_b64_tr_b16 a[212:213], v194 offset:10240
    v_fma_f32 v91, v91, v215, v241
    v_cvt_pk_bf16_f32 v88, v88, v89
    v_mfma_f32_16x16x32_bf16 v[128:131], a[200:203], v[52:55], v[128:131]
    ds_read_b64_tr_b16 a[214:215], v194 offset:11264
    v_cvt_pk_bf16_f32 v89, v90, v91
    v_mfma_f32_16x16x32_bf16 v[128:131], a[196:199], v[16:19], v[128:131]
    ds_read_b64_tr_b16 a[216:217], v194 offset:12288
    v_lshlrev_b32 v246, 16, v234
    v_mfma_f32_16x16x32_bf16 v[128:131], a[192:195], v[4:7], v[128:131]
    ds_read_b64_tr_b16 a[218:219], v194 offset:13312
    v_and_b32 v234, 0xffff0000, v234
    v_mfma_f32_16x16x32_bf16 v[136:139], a[192:195], v[8:11], 0
    ds_read_b64_tr_b16 a[220:221], v194 offset:14336
    v_fma_f32 v76, v76, v213, v246
    v_fma_f32 v77, v77, v213, v234
    v_mfma_f32_16x16x32_bf16 v[136:139], a[196:199], v[20:23], v[136:139]
    ds_read_b64_tr_b16 a[222:223], v194 offset:15360
    v_lshlrev_b32 v247, 16, v235
    v_mfma_f32_16x16x32_bf16 v[136:139], a[200:203], v[56:59], v[136:139]
    v_and_b32 v235, 0xffff0000, v235
    v_fma_f32 v78, v78, v213, v247
    v_mfma_f32_16x16x32_bf16 v[136:139], a[204:207], v[68:71], v[136:139]
    s_waitcnt lgkmcnt(6)
    ds_read_b64_tr_b16 a[224:225], v195 offset:0
    v_fma_f32 v79, v79, v213, v235
    v_mfma_f32_16x16x32_bf16 v[136:139], a[208:211], v[104:107], v[136:139]
    s_waitcnt lgkmcnt(5)
    ds_read_b64_tr_b16 a[226:227], v195 offset:1024
    v_cvt_pk_bf16_f32 v74, v76, v77
    v_mfma_f32_16x16x32_bf16 v[136:139], a[212:215], v[116:119], v[136:139]
    s_waitcnt lgkmcnt(4)
    v_cvt_pk_bf16_f32 v75, v78, v79
    v_lshlrev_b32 v246, 16, v238
    v_mfma_f32_16x16x32_bf16 v[136:139], a[216:219], v[152:155], v[136:139]
    s_waitcnt lgkmcnt(2)
    buffer_store_dwordx4 v[72:75], v212, s[68:71], s4 offen offset:0
    v_and_b32 v238, 0xffff0000, v238
    v_mfma_f32_16x16x32_bf16 v[136:139], a[220:223], v[164:167], v[136:139]
    ds_read_b64_tr_b16 a[228:229], v195 offset:2048
    v_fma_f32 v84, v84, v214, v246
    v_mfma_f32_16x16x32_bf16 v[128:131], a[220:223], v[160:163], v[128:131]
    ds_read_b64_tr_b16 a[230:231], v195 offset:3072
    v_fma_f32 v85, v85, v214, v238
    v_mfma_f32_16x16x32_bf16 v[128:131], a[216:219], v[148:151], v[128:131]
    ds_read_b64_tr_b16 a[232:233], v195 offset:4096
    v_lshlrev_b32 v247, 16, v239
    v_mfma_f32_16x16x32_bf16 v[128:131], a[212:215], v[112:115], v[128:131]
    ds_read_b64_tr_b16 a[234:235], v195 offset:5120
    v_and_b32 v239, 0xffff0000, v239
    v_mfma_f32_16x16x32_bf16 v[128:131], a[208:211], v[100:103], v[128:131]
    ds_read_b64_tr_b16 a[236:237], v195 offset:6144
    v_fma_f32 v86, v86, v214, v247
    v_fma_f32 v87, v87, v214, v239
    v_mfma_f32_16x16x32_bf16 v[120:123], a[208:211], v[96:99], v[120:123]
    v_cvt_pk_bf16_f32 v82, v84, v85
    v_cvt_pk_bf16_f32 v83, v86, v87
    v_mfma_f32_16x16x32_bf16 v[120:123], a[212:215], v[108:111], v[120:123]
    buffer_store_dwordx4 v[80:83], v212, s[68:71], s4 offen offset:1024
    v_lshlrev_b32 v246, 16, v242
    v_mfma_f32_16x16x32_bf16 v[120:123], a[216:219], v[144:147], v[120:123]
    ds_read_b64_tr_b16 a[238:239], v195 offset:7168
    v_and_b32 v242, 0xffff0000, v242
    v_mfma_f32_16x16x32_bf16 v[120:123], a[220:223], v[156:159], v[120:123]
    s_waitcnt lgkmcnt(6)
    ds_read_b64_tr_b16 a[240:241], v195 offset:8192
    v_fma_f32 v92, v92, v215, v246
    v_mfma_f32_16x16x32_bf16 v[124:127], a[224:227], v[0:3], 0
    s_waitcnt lgkmcnt(5)
    ds_read_b64_tr_b16 a[242:243], v195 offset:9216
    v_fma_f32 v93, v93, v215, v242
    v_mfma_f32_16x16x32_bf16 v[124:127], a[228:231], v[12:15], v[124:127]
    s_waitcnt lgkmcnt(4)
    ds_read_b64_tr_b16 a[244:245], v195 offset:10240
    v_lshlrev_b32 v247, 16, v243
    v_mfma_f32_16x16x32_bf16 v[124:127], a[232:235], v[48:51], v[124:127]
    s_waitcnt lgkmcnt(3)
    v_and_b32 v243, 0xffff0000, v243
    v_fma_f32 v94, v94, v215, v247
    v_mfma_f32_16x16x32_bf16 v[124:127], a[236:239], v[60:63], v[124:127]
    buffer_load_dword v244, off, s[72:75], s60 sc1
    v_fma_f32 v95, v95, v215, v243
    v_mfma_f32_16x16x32_bf16 v[132:135], a[236:239], v[64:67], 0
    ds_read_b64_tr_b16 a[246:247], v195 offset:11264
    v_cvt_pk_bf16_f32 v90, v92, v93
    v_mfma_f32_16x16x32_bf16 v[132:135], a[232:235], v[52:55], v[132:135]
    ds_read_b64_tr_b16 a[248:249], v195 offset:12288
    v_cvt_pk_bf16_f32 v91, v94, v95
    v_mfma_f32_16x16x32_bf16 v[132:135], a[228:231], v[16:19], v[132:135]
    s_waitcnt vmcnt(5)
    buffer_store_dwordx4 v[88:91], v212, s[68:71], s4 offen offset:2048
    s_nop 1
    s_mul_i32 s4, s54, 12288
    v_lshlrev_b32 v246, 16, v196
    v_mfma_f32_16x16x32_bf16 v[132:135], a[224:227], v[4:7], v[132:135]
    s_add_u32 s4, s4, 98304
    ds_read_b64_tr_b16 a[250:251], v195 offset:13312
    v_and_b32 v196, 0xffff0000, v196
    v_mfma_f32_16x16x32_bf16 v[140:143], a[224:227], v[8:11], 0
    s_add_u32 s4, s4, s58
    ds_read_b64_tr_b16 a[252:253], v195 offset:14336
    v_fma_f32 v120, v120, v213, v246
    v_mfma_f32_16x16x32_bf16 v[140:143], a[228:231], v[20:23], v[140:143]
    ds_read_b64_tr_b16 a[254:255], v195 offset:15360
    v_fma_f32 v121, v121, v213, v196
    v_mfma_f32_16x16x32_bf16 v[140:143], a[232:235], v[56:59], v[140:143]
    ds_read_b64_tr_b16 a[192:193], v194 offset:16384
    v_lshlrev_b32 v247, 16, v197
    v_and_b32 v197, 0xffff0000, v197
    v_mfma_f32_16x16x32_bf16 v[140:143], a[236:239], v[68:71], v[140:143]
    s_waitcnt lgkmcnt(6)
    ds_read_b64_tr_b16 a[194:195], v194 offset:17408
    v_fma_f32 v122, v122, v213, v247
    v_mfma_f32_16x16x32_bf16 v[140:143], a[240:243], v[104:107], v[140:143]
    s_waitcnt lgkmcnt(6)
    v_fma_f32 v123, v123, v213, v197
    v_cvt_pk_bf16_f32 v120, v120, v121
    v_mfma_f32_16x16x32_bf16 v[140:143], a[244:247], v[116:119], v[140:143]
    s_waitcnt lgkmcnt(4)
    ds_read_b64_tr_b16 a[196:197], v194 offset:18432
    v_cvt_pk_bf16_f32 v121, v122, v123
    v_mfma_f32_16x16x32_bf16 v[140:143], a[248:251], v[152:155], v[140:143]
    s_waitcnt lgkmcnt(3)
    ds_read_b64_tr_b16 a[198:199], v194 offset:19456
    v_mov_b32 v245, 8
    v_mfma_f32_16x16x32_bf16 v[140:143], a[252:255], v[164:167], v[140:143]
    s_waitcnt vmcnt(5)
    v_lshlrev_b32 v246, 16, v200
    v_and_b32 v200, 0xffff0000, v200
    v_mfma_f32_16x16x32_bf16 v[132:135], a[252:255], v[160:163], v[132:135]
    ds_read_b64_tr_b16 a[200:201], v194 offset:20480
    v_fma_f32 v128, v128, v214, v246
    v_mfma_f32_16x16x32_bf16 v[132:135], a[248:251], v[148:151], v[132:135]
    s_mul_i32 s78, s55, 24576
    ds_read_b64_tr_b16 a[202:203], v194 offset:21504
    v_fma_f32 v129, v129, v214, v200
    v_lshlrev_b32 v247, 16, v201
    v_mfma_f32_16x16x32_bf16 v[132:135], a[244:247], v[112:115], v[132:135]
    s_add_u32 s78, s78, 0
    v_and_b32 v201, 0xffff0000, v201
    v_fma_f32 v130, v130, v214, v247
    v_mfma_f32_16x16x32_bf16 v[132:135], a[240:243], v[100:103], v[132:135]
    s_add_u32 s78, s78, s58
    ds_read_b64_tr_b16 a[204:205], v194 offset:22528
    v_fma_f32 v131, v131, v214, v201
    v_mfma_f32_16x16x32_bf16 v[124:127], a[240:243], v[96:99], v[124:127]
    ds_read_b64_tr_b16 a[206:207], v194 offset:23552
    v_cvt_pk_bf16_f32 v128, v128, v129
    v_mfma_f32_16x16x32_bf16 v[124:127], a[244:247], v[108:111], v[124:127]
    s_waitcnt vmcnt(1)
    v_readfirstlane_b32 s79, v244
    s_nop 0
    s_cmp_lt_u32 s79, 7
    s_cbranch_scc1 L_rs9
L_rb9:
    v_cvt_pk_bf16_f32 v129, v130, v131
    v_lshlrev_b32 v246, 16, v204
    v_mfma_f32_16x16x32_bf16 v[124:127], a[248:251], v[144:147], v[124:127]
    s_waitcnt vmcnt(0)
    buffer_store_dword v245, v208, s[72:75], s28 offen
    v_and_b32 v204, 0xffff0000, v204
    v_mfma_f32_16x16x32_bf16 v[124:127], a[252:255], v[156:159], v[124:127]
    s_waitcnt lgkmcnt(5)
    buffer_load_dwordx4 v[220:223], v212, s[68:71], s78 offen offset:0 sc1
    v_fma_f32 v136, v136, v215, v246
    v_mfma_f32_16x16x32_bf16 v[168:171], a[192:195], v[0:3], 0
    s_waitcnt lgkmcnt(4)
    buffer_load_dwordx4 v[224:227], v212, s[68:71], s78 offen offset:1024 sc1
    v_fma_f32 v137, v137, v215, v204
    v_mfma_f32_16x16x32_bf16 v[168:171], a[196:199], v[12:15], v[168:171]
    s_waitcnt lgkmcnt(2)
    ds_read_b64_tr_b16 a[208:209], v194 offset:24576
    v_lshlrev_b32 v247, 16, v205
    v_mfma_f32_16x16x32_bf16 v[168:171], a[200:203], v[48:51], v[168:171]
    s_waitcnt lgkmcnt(1)
    buffer_load_dwordx4 v[228:231], v212, s[68:71], s78 offen offset:2048 sc1
    ds_read_b64_tr_b16 a[210:211], v194 offset:25600
    v_and_b32 v205, 0xffff0000, v205
    v_mfma_f32_16x16x32_bf16 v[168:171], a[204:207], v[60:63], v[168:171]
    ds_read_b64_tr_b16 a[212:213], v194 offset:26624
    v_fma_f32 v138, v138, v215, v247
    v_mfma_f32_16x16x32_bf16 v[176:179], a[204:207], v[64:67], 0
    ds_read_b64_tr_b16 a[214:215], v194 offset:27648
    v_fma_f32 v139, v139, v215, v205
    v_cvt_pk_bf16_f32 v136, v136, v137
    v_mfma_f32_16x16x32_bf16 v[176:179], a[200:203], v[52:55], v[176:179]
    ds_read_b64_tr_b16 a[216:217], v194 offset:28672
    v_cvt_pk_bf16_f32 v137, v138, v139
    v_mfma_f32_16x16x32_bf16 v[176:179], a[196:199], v[16:19], v[176:179]
    ds_read_b64_tr_b16 a[218:219], v194 offset:29696
    v_lshlrev_b32 v246, 16, v198
    v_mfma_f32_16x16x32_bf16 v[176:179], a[192:195], v[4:7], v[176:179]
    ds_read_b64_tr_b16 a[220:221], v194 offset:30720
    v_and_b32 v198, 0xffff0000, v198
    v_mfma_f32_16x16x32_bf16 v[184:187], a[192:195], v[8:11], 0
    ds_read_b64_tr_b16 a[222:223], v194 offset:31744
    v_fma_f32 v124, v124, v213, v246
    v_fma_f32 v125, v125, v213, v198
    v_mfma_f32_16x16x32_bf16 v[184:187], a[196:199], v[20:23], v[184:187]
    ds_read_b64_tr_b16 a[224:225], v195 offset:16384
    v_lshlrev_b32 v247, 16, v199
    v_mfma_f32_16x16x32_bf16 v[184:187], a[200:203], v[56:59], v[184:187]
    v_and_b32 v199, 0xffff0000, v199
    v_fma_f32 v126, v126, v213, v247
    v_mfma_f32_16x16x32_bf16 v[184:187], a[204:207], v[68:71], v[184:187]
    s_waitcnt lgkmcnt(7)
    ds_read_b64_tr_b16 a[226:227], v195 offset:17408
    v_fma_f32 v127, v127, v213, v199
    v_mfma_f32_16x16x32_bf16 v[184:187], a[208:211], v[104:107], v[184:187]
    s_waitcnt lgkmcnt(6)
    ds_read_b64_tr_b16 a[228:229], v195 offset:18432
    v_cvt_pk_bf16_f32 v122, v124, v125
    v_mfma_f32_16x16x32_bf16 v[184:187], a[212:215], v[116:119], v[184:187]
    s_waitcnt lgkmcnt(5)
    v_cvt_pk_bf16_f32 v123, v126, v127
    v_lshlrev_b32 v246, 16, v202
    v_mfma_f32_16x16x32_bf16 v[184:187], a[216:219], v[152:155], v[184:187]
    s_waitcnt lgkmcnt(3)
    buffer_store_dwordx4 v[120:123], v212, s[68:71], s4 offen offset:0
    v_and_b32 v202, 0xffff0000, v202
    v_mfma_f32_16x16x32_bf16 v[184:187], a[220:223], v[164:167], v[184:187]
    ds_read_b64_tr_b16 a[230:231], v195 offset:19456
    v_fma_f32 v132, v132, v214, v246
    v_mfma_f32_16x16x32_bf16 v[176:179], a[220:223], v[160:163], v[176:179]
    ds_read_b64_tr_b16 a[232:233], v195 offset:20480
    v_fma_f32 v133, v133, v214, v202
    v_mfma_f32_16x16x32_bf16 v[176:179], a[216:219], v[148:151], v[176:179]
    ds_read_b64_tr_b16 a[234:235], v195 offset:21504
    v_lshlrev_b32 v247, 16, v203
    v_mfma_f32_16x16x32_bf16 v[176:179], a[212:215], v[112:115], v[176:179]
    ds_read_b64_tr_b16 a[236:237], v195 offset:22528
    v_and_b32 v203, 0xffff0000, v203
    v_mfma_f32_16x16x32_bf16 v[176:179], a[208:211], v[100:103], v[176:179]
    ds_read_b64_tr_b16 a[238:239], v195 offset:23552
    v_fma_f32 v134, v134, v214, v247
    v_fma_f32 v135, v135, v214, v203
    v_mfma_f32_16x16x32_bf16 v[168:171], a[208:211], v[96:99], v[168:171]
    v_cvt_pk_bf16_f32 v130, v132, v133
    v_cvt_pk_bf16_f32 v131, v134, v135
    v_mfma_f32_16x16x32_bf16 v[168:171], a[212:215], v[108:111], v[168:171]
    buffer_store_dwordx4 v[128:131], v212, s[68:71], s4 offen offset:1024
    v_lshlrev_b32 v246, 16, v206
    v_mfma_f32_16x16x32_bf16 v[168:171], a[216:219], v[144:147], v[168:171]
    ds_read_b64_tr_b16 a[240:241], v195 offset:24576
    v_and_b32 v206, 0xffff0000, v206
    v_mfma_f32_16x16x32_bf16 v[168:171], a[220:223], v[156:159], v[168:171]
    s_waitcnt lgkmcnt(6)
    ds_read_b64_tr_b16 a[242:243], v195 offset:25600
    v_fma_f32 v140, v140, v215, v246
    v_mfma_f32_16x16x32_bf16 v[172:175], a[224:227], v[0:3], 0
    s_waitcnt lgkmcnt(6)
    ds_read_b64_tr_b16 a[244:245], v195 offset:26624
    v_fma_f32 v141, v141, v215, v206
    v_mfma_f32_16x16x32_bf16 v[172:175], a[228:231], v[12:15], v[172:175]
    s_waitcnt lgkmcnt(5)
    ds_read_b64_tr_b16 a[246:247], v195 offset:27648
    v_lshlrev_b32 v247, 16, v207
    v_mfma_f32_16x16x32_bf16 v[172:175], a[232:235], v[48:51], v[172:175]
    s_waitcnt lgkmcnt(4)
    v_and_b32 v207, 0xffff0000, v207
    v_fma_f32 v142, v142, v215, v247
    v_mfma_f32_16x16x32_bf16 v[172:175], a[236:239], v[60:63], v[172:175]
    buffer_load_dword v244, off, s[72:75], s60 sc1
    v_fma_f32 v143, v143, v215, v207
    v_mfma_f32_16x16x32_bf16 v[180:183], a[236:239], v[64:67], 0
    ds_read_b64_tr_b16 a[248:249], v195 offset:28672
    v_cvt_pk_bf16_f32 v138, v140, v141
    v_mfma_f32_16x16x32_bf16 v[180:183], a[232:235], v[52:55], v[180:183]
    ds_read_b64_tr_b16 a[250:251], v195 offset:29696
    v_cvt_pk_bf16_f32 v139, v142, v143
    v_mfma_f32_16x16x32_bf16 v[180:183], a[228:231], v[16:19], v[180:183]
    s_waitcnt vmcnt(5)
    buffer_store_dwordx4 v[136:139], v212, s[68:71], s4 offen offset:2048
    s_nop 1
    s_mul_i32 s4, s55, 24576
    v_lshlrev_b32 v246, 16, v220
    v_mfma_f32_16x16x32_bf16 v[180:183], a[224:227], v[4:7], v[180:183]
    s_add_u32 s4, s4, 0
    ds_read_b64_tr_b16 a[252:253], v195 offset:30720
    v_and_b32 v220, 0xffff0000, v220
    v_mfma_f32_16x16x32_bf16 v[188:191], a[224:227], v[8:11], 0
    s_add_u32 s4, s4, s59
    ds_read_b64_tr_b16 a[254:255], v195 offset:31744
    v_add_u32 v194, 0xfffe0000, v194
    v_fma_f32 v168, v168, v213, v246
    v_mfma_f32_16x16x32_bf16 v[188:191], a[228:231], v[20:23], v[188:191]
    v_add_u32 v195, 0xfffe0000, v195
    v_fma_f32 v169, v169, v213, v220
    v_mfma_f32_16x16x32_bf16 v[188:191], a[232:235], v[56:59], v[188:191]
    v_lshlrev_b32 v247, 16, v221
    v_and_b32 v221, 0xffff0000, v221
    v_mfma_f32_16x16x32_bf16 v[188:191], a[236:239], v[68:71], v[188:191]
    s_waitcnt lgkmcnt(4)
    ds_read_b64_tr_b16 a[192:193], v194 offset:0
    v_fma_f32 v170, v170, v213, v247
    v_mfma_f32_16x16x32_bf16 v[188:191], a[240:243], v[104:107], v[188:191]
    v_fma_f32 v171, v171, v213, v221
    v_cvt_pk_bf16_f32 v168, v168, v169
    v_mfma_f32_16x16x32_bf16 v[188:191], a[244:247], v[116:119], v[188:191]
    s_waitcnt lgkmcnt(3)
    ds_read_b64_tr_b16 a[194:195], v194 offset:1024
    v_cvt_pk_bf16_f32 v169, v170, v171
    v_mfma_f32_16x16x32_bf16 v[188:191], a[248:251], v[152:155], v[188:191]
    s_waitcnt lgkmcnt(2)
    ds_read_b64_tr_b16 a[196:197], v194 offset:2048
    v_mov_b32 v245, 9
    v_mfma_f32_16x16x32_bf16 v[188:191], a[252:255], v[164:167], v[188:191]
    s_waitcnt vmcnt(5)
    v_lshlrev_b32 v246, 16, v224
    v_and_b32 v224, 0xffff0000, v224
    v_mfma_f32_16x16x32_bf16 v[180:183], a[252:255], v[160:163], v[180:183]
    ds_read_b64_tr_b16 a[198:199], v194 offset:3072
    v_fma_f32 v176, v176, v214, v246
    v_mfma_f32_16x16x32_bf16 v[180:183], a[248:251], v[148:151], v[180:183]
    s_mul_i32 s78, s55, 24576
    ds_read_b64_tr_b16 a[200:201], v194 offset:4096
    v_fma_f32 v177, v177, v214, v224
    v_lshlrev_b32 v247, 16, v225
    v_mfma_f32_16x16x32_bf16 v[180:183], a[244:247], v[112:115], v[180:183]
    s_add_u32 s78, s78, 12288
    v_and_b32 v225, 0xffff0000, v225
    v_fma_f32 v178, v178, v214, v247
    v_mfma_f32_16x16x32_bf16 v[180:183], a[240:243], v[100:103], v[180:183]
    s_add_u32 s78, s78, s58
    ds_read_b64_tr_b16 a[202:203], v194 offset:5120
    v_fma_f32 v179, v179, v214, v225
    v_mfma_f32_16x16x32_bf16 v[172:175], a[240:243], v[96:99], v[172:175]
    ds_read_b64_tr_b16 a[204:205], v194 offset:6144
    v_cvt_pk_bf16_f32 v176, v176, v177
    v_mfma_f32_16x16x32_bf16 v[172:175], a[244:247], v[108:111], v[172:175]
    s_waitcnt vmcnt(1)
    v_readfirstlane_b32 s79, v244
    s_nop 0
    s_cmp_lt_u32 s79, 8
    s_cbranch_scc1 L_rs10
L_rb10:
    v_cvt_pk_bf16_f32 v177, v178, v179
    v_lshlrev_b32 v246, 16, v228
    v_mfma_f32_16x16x32_bf16 v[172:175], a[248:251], v[144:147], v[172:175]
    s_waitcnt vmcnt(0)
    buffer_store_dword v245, v208, s[72:75], s28 offen
    v_and_b32 v228, 0xffff0000, v228
    v_mfma_f32_16x16x32_bf16 v[172:175], a[252:255], v[156:159], v[172:175]
    s_waitcnt lgkmcnt(5)
    buffer_load_dwordx4 v[232:235], v212, s[68:71], s78 offen offset:0 sc1
    v_fma_f32 v184, v184, v215, v246
    v_mfma_f32_16x16x32_bf16 v[24:27], a[192:195], v[0:3], 0
    s_waitcnt lgkmcnt(3)
    buffer_load_dwordx4 v[236:239], v212, s[68:71], s78 offen offset:1024 sc1
    v_fma_f32 v185, v185, v215, v228
    v_mfma_f32_16x16x32_bf16 v[24:27], a[196:199], v[12:15], v[24:27]
    s_waitcnt lgkmcnt(1)
    ds_read_b64_tr_b16 a[206:207], v194 offset:7168
    v_lshlrev_b32 v247, 16, v229
    v_mfma_f32_16x16x32_bf16 v[24:27], a[200:203], v[48:51], v[24:27]
    s_waitcnt lgkmcnt(0)
    buffer_load_dwordx4 v[240:243], v212, s[68:71], s78 offen offset:2048 sc1
    ds_read_b64_tr_b16 a[208:209], v194 offset:8192
    v_and_b32 v229, 0xffff0000, v229
    v_mfma_f32_16x16x32_bf16 v[24:27], a[204:207], v[60:63], v[24:27]
    ds_read_b64_tr_b16 a[210:211], v194 offset:9216
    v_fma_f32 v186, v186, v215, v247
    v_mfma_f32_16x16x32_bf16 v[32:35], a[204:207], v[64:67], 0
    ds_read_b64_tr_b16 a[212:213], v194 offset:10240
    v_fma_f32 v187, v187, v215, v229
    v_cvt_pk_bf16_f32 v184, v184, v185
    v_mfma_f32_16x16x32_bf16 v[32:35], a[200:203], v[52:55], v[32:35]
    ds_read_b64_tr_b16 a[214:215], v194 offset:11264
    v_cvt_pk_bf16_f32 v185, v186, v187
    v_mfma_f32_16x16x32_bf16 v[32:35], a[196:199], v[16:19], v[32:35]
    ds_read_b64_tr_b16 a[216:217], v194 offset:12288
    v_lshlrev_b32 v246, 16, v222
    v_mfma_f32_16x16x32_bf16 v[32:35], a[192:195], v[4:7], v[32:35]
    ds_read_b64_tr_b16 a[218:219], v194 offset:13312
    v_and_b32 v222, 0xffff0000, v222
    v_mfma_f32_16x16x32_bf16 v[40:43], a[192:195], v[8:11], 0
    ds_read_b64_tr_b16 a[220:221], v194 offset:14336
    v_fma_f32 v172, v172, v213, v246
    v_fma_f32 v173, v173, v213, v222
    v_mfma_f32_16x16x32_bf16 v[40:43], a[196:199], v[20:23], v[40:43]
    ds_read_b64_tr_b16 a[222:223], v194 offset:15360
    v_lshlrev_b32 v247, 16, v223
    v_mfma_f32_16x16x32_bf16 v[40:43], a[200:203], v[56:59], v[40:43]
    v_and_b32 v223, 0xffff0000, v223
    v_fma_f32 v174, v174, v213, v247
    v_mfma_f32_16x16x32_bf16 v[40:43], a[204:207], v[68:71], v[40:43]
    s_waitcnt lgkmcnt(6)
    ds_read_b64_tr_b16 a[224:225], v195 offset:0
    v_fma_f32 v175, v175, v213, v223
    v_mfma_f32_16x16x32_bf16 v[40:43], a[208:211], v[104:107], v[40:43]
    s_waitcnt lgkmcnt(5)
    ds_read_b64_tr_b16 a[226:227], v195 offset:1024
    v_cvt_pk_bf16_f32 v170, v172, v173
    v_mfma_f32_16x16x32_bf16 v[40:43], a[212:215], v[116:119], v[40:43]
    s_waitcnt lgkmcnt(4)
    v_cvt_pk_bf16_f32 v171, v174, v175
    v_lshlrev_b32 v246, 16, v226
    v_mfma_f32_16x16x32_bf16 v[40:43], a[216:219], v[152:155], v[40:43]
    s_waitcnt lgkmcnt(2)
    buffer_load_dword v244, off, s[72:75], s60 sc1
    buffer_store_dwordx4 v[168:171], v212, s[68:71], s4 offen offset:0 sc1
    v_mfma_f32_16x16x32_bf16 v[40:43], a[220:223], v[164:167], v[40:43]
    ds_read_b64_tr_b16 a[228:229], v195 offset:2048
    v_and_b32 v226, 0xffff0000, v226
    v_fma_f32 v180, v180, v214, v246
    v_mfma_f32_16x16x32_bf16 v[32:35], a[220:223], v[160:163], v[32:35]
    ds_read_b64_tr_b16 a[230:231], v195 offset:3072
    v_fma_f32 v181, v181, v214, v226
    v_mfma_f32_16x16x32_bf16 v[32:35], a[216:219], v[148:151], v[32:35]
    ds_read_b64_tr_b16 a[232:233], v195 offset:4096
    v_lshlrev_b32 v247, 16, v227
    v_mfma_f32_16x16x32_bf16 v[32:35], a[212:215], v[112:115], v[32:35]
    ds_read_b64_tr_b16 a[234:235], v195 offset:5120
    v_and_b32 v227, 0xffff0000, v227
    v_mfma_f32_16x16x32_bf16 v[32:35], a[208:211], v[100:103], v[32:35]
    ds_read_b64_tr_b16 a[236:237], v195 offset:6144
    v_fma_f32 v182, v182, v214, v247
    v_fma_f32 v183, v183, v214, v227
    v_mfma_f32_16x16x32_bf16 v[24:27], a[208:211], v[96:99], v[24:27]
    v_cvt_pk_bf16_f32 v178, v180, v181
    v_cvt_pk_bf16_f32 v179, v182, v183
    v_mfma_f32_16x16x32_bf16 v[24:27], a[212:215], v[108:111], v[24:27]
    buffer_store_dwordx4 v[176:179], v212, s[68:71], s4 offen offset:1024 sc1
    v_lshlrev_b32 v246, 16, v230
    v_mfma_f32_16x16x32_bf16 v[24:27], a[216:219], v[144:147], v[24:27]
    ds_read_b64_tr_b16 a[238:239], v195 offset:7168
    v_and_b32 v230, 0xffff0000, v230
    v_mfma_f32_16x16x32_bf16 v[24:27], a[220:223], v[156:159], v[24:27]
    s_waitcnt lgkmcnt(6)
    ds_read_b64_tr_b16 a[240:241], v195 offset:8192
    v_fma_f32 v188, v188, v215, v246
    v_mfma_f32_16x16x32_bf16 v[28:31], a[224:227], v[0:3], 0
    s_waitcnt lgkmcnt(5)
    ds_read_b64_tr_b16 a[242:243], v195 offset:9216
    v_fma_f32 v189, v189, v215, v230
    v_mfma_f32_16x16x32_bf16 v[28:31], a[228:231], v[12:15], v[28:31]
    s_waitcnt lgkmcnt(4)
    ds_read_b64_tr_b16 a[244:245], v195 offset:10240
    v_lshlrev_b32 v247, 16, v231
    v_mfma_f32_16x16x32_bf16 v[28:31], a[232:235], v[48:51], v[28:31]
    s_waitcnt lgkmcnt(3)
    v_and_b32 v231, 0xffff0000, v231
    v_fma_f32 v190, v190, v215, v247
    v_mfma_f32_16x16x32_bf16 v[28:31], a[236:239], v[60:63], v[28:31]
    ds_read_b64_tr_b16 a[246:247], v195 offset:11264
    v_fma_f32 v191, v191, v215, v231
    v_mfma_f32_16x16x32_bf16 v[36:39], a[236:239], v[64:67], 0
    s_mul_i32 s78, s55, 12288
    ds_read_b64_tr_b16 a[248:249], v195 offset:12288
    v_cvt_pk_bf16_f32 v186, v188, v189
    v_mfma_f32_16x16x32_bf16 v[36:39], a[232:235], v[52:55], v[36:39]
    s_add_u32 s78, s78, 98304
    v_cvt_pk_bf16_f32 v187, v190, v191
    s_waitcnt vmcnt(5)
    v_lshlrev_b32 v246, 16, v232
    v_mfma_f32_16x16x32_bf16 v[36:39], a[228:231], v[16:19], v[36:39]
    s_add_u32 s78, s78, s58
    buffer_store_dwordx4 v[184:187], v212, s[68:71], s4 offen offset:2048 sc1
    s_nop 1
    s_mul_i32 s4, s55, 24576
    v_mfma_f32_16x16x32_bf16 v[36:39], a[224:227], v[4:7], v[36:39]
    s_add_u32 s4, s4, 12288
    ds_read_b64_tr_b16 a[250:251], v195 offset:13312
    v_and_b32 v232, 0xffff0000, v232
    v_mfma_f32_16x16x32_bf16 v[44:47], a[224:227], v[8:11], 0
    s_add_u32 s4, s4, s59
    ds_read_b64_tr_b16 a[252:253], v195 offset:14336
    s_waitcnt vmcnt(3)
    v_readfirstlane_b32 s79, v244
    s_nop 0
    s_cmp_lt_u32 s79, 9
    s_cbranch_scc1 L_rs11
L_rb11:
    v_fma_f32 v24, v24, v213, v246
    v_mfma_f32_16x16x32_bf16 v[44:47], a[228:231], v[20:23], v[44:47]
    buffer_load_dwordx4 v[196:199], v212, s[68:71], s78 offen offset:0 sc1
    v_fma_f32 v25, v25, v213, v232
    v_mfma_f32_16x16x32_bf16 v[44:47], a[232:235], v[56:59], v[44:47]
    ds_read_b64_tr_b16 a[254:255], v195 offset:15360
    v_lshlrev_b32 v247, 16, v233
    v_and_b32 v233, 0xffff0000, v233
    v_mfma_f32_16x16x32_bf16 v[44:47], a[236:239], v[68:71], v[44:47]
    s_waitcnt lgkmcnt(5)
    buffer_load_dwordx4 v[200:203], v212, s[68:71], s78 offen offset:1024 sc1
    v_fma_f32 v26, v26, v213, v247
    v_mfma_f32_16x16x32_bf16 v[44:47], a[240:243], v[104:107], v[44:47]
    s_waitcnt lgkmcnt(4)
    ds_read_b64_tr_b16 a[192:193], v194 offset:16384
    v_fma_f32 v27, v27, v213, v233
    v_mfma_f32_16x16x32_bf16 v[44:47], a[244:247], v[116:119], v[44:47]
    s_waitcnt lgkmcnt(3)
    buffer_load_dwordx4 v[204:207], v212, s[68:71], s78 offen offset:2048 sc1
    v_cvt_pk_bf16_f32 v24, v24, v25
    v_mfma_f32_16x16x32_bf16 v[44:47], a[248:251], v[152:155], v[44:47]
    s_waitcnt lgkmcnt(1)
    ds_read_b64_tr_b16 a[194:195], v194 offset:17408
    v_cvt_pk_bf16_f32 v25, v26, v27
    v_mfma_f32_16x16x32_bf16 v[44:47], a[252:255], v[164:167], v[44:47]
    ds_read_b64_tr_b16 a[196:197], v194 offset:18432
    v_lshlrev_b32 v246, 16, v236
    v_and_b32 v236, 0xffff0000, v236
    v_mfma_f32_16x16x32_bf16 v[36:39], a[252:255], v[160:163], v[36:39]
    buffer_load_dword v218, v217, s[72:75], 0 offen sc1
    v_fma_f32 v32, v32, v214, v246
    v_mfma_f32_16x16x32_bf16 v[36:39], a[248:251], v[148:151], v[36:39]
    ds_read_b64_tr_b16 a[198:199], v194 offset:19456
    v_fma_f32 v33, v33, v214, v236
    v_lshlrev_b32 v247, 16, v237
    v_mfma_f32_16x16x32_bf16 v[36:39], a[244:247], v[112:115], v[36:39]
    ds_read_b64_tr_b16 a[200:201], v194 offset:20480
    v_and_b32 v237, 0xffff0000, v237
    v_mfma_f32_16x16x32_bf16 v[36:39], a[240:243], v[100:103], v[36:39]
    ds_read_b64_tr_b16 a[202:203], v194 offset:21504
    v_fma_f32 v34, v34, v214, v247
    v_mfma_f32_16x16x32_bf16 v[28:31], a[240:243], v[96:99], v[28:31]
    ds_read_b64_tr_b16 a[204:205], v194 offset:22528
    v_fma_f32 v35, v35, v214, v237
    v_mfma_f32_16x16x32_bf16 v[28:31], a[244:247], v[108:111], v[28:31]
    ds_read_b64_tr_b16 a[206:207], v194 offset:23552
    v_cvt_pk_bf16_f32 v32, v32, v33
    v_cvt_pk_bf16_f32 v33, v34, v35
    v_mfma_f32_16x16x32_bf16 v[28:31], a[248:251], v[144:147], v[28:31]
    ds_read_b64_tr_b16 a[208:209], v194 offset:24576
    v_lshlrev_b32 v246, 16, v240
    v_mfma_f32_16x16x32_bf16 v[28:31], a[252:255], v[156:159], v[28:31]
    s_waitcnt lgkmcnt(7)
    ds_read_b64_tr_b16 a[210:211], v194 offset:25600
    v_and_b32 v240, 0xffff0000, v240
    v_mfma_f32_16x16x32_bf16 v[72:75], a[192:195], v[0:3], 0
    s_waitcnt lgkmcnt(6)
    v_fma_f32 v40, v40, v215, v246
    v_fma_f32 v41, v41, v215, v240
    v_mfma_f32_16x16x32_bf16 v[72:75], a[196:199], v[12:15], v[72:75]
    s_waitcnt lgkmcnt(4)
    ds_read_b64_tr_b16 a[212:213], v194 offset:26624
    v_lshlrev_b32 v247, 16, v241
    v_mfma_f32_16x16x32_bf16 v[72:75], a[200:203], v[48:51], v[72:75]
    s_waitcnt lgkmcnt(3)
    ds_read_b64_tr_b16 a[214:215], v194 offset:27648
    v_and_b32 v241, 0xffff0000, v241
    v_mfma_f32_16x16x32_bf16 v[72:75], a[204:207], v[60:63], v[72:75]
    ds_read_b64_tr_b16 a[216:217], v194 offset:28672
    v_fma_f32 v42, v42, v215, v247
    v_mfma_f32_16x16x32_bf16 v[80:83], a[204:207], v[64:67], 0
    v_fma_f32 v43, v43, v215, v241
    v_cvt_pk_bf16_f32 v40, v40, v41
    v_mfma_f32_16x16x32_bf16 v[80:83], a[200:203], v[52:55], v[80:83]
    ds_read_b64_tr_b16 a[218:219], v194 offset:29696
    v_cvt_pk_bf16_f32 v41, v42, v43
    v_mfma_f32_16x16x32_bf16 v[80:83], a[196:199], v[16:19], v[80:83]
    ds_read_b64_tr_b16 a[220:221], v194 offset:30720
    v_lshlrev_b32 v246, 16, v234
    v_mfma_f32_16x16x32_bf16 v[80:83], a[192:195], v[4:7], v[80:83]
L_pad10:
    s_cbranch_execz L_hopped1
    v_and_b32 v234, 0xffff0000, v234
    v_fma_f32 v28, v28, v213, v246
    v_mfma_f32_16x16x32_bf16 v[88:91], a[192:195], v[8:11], 0
    ds_read_b64_tr_b16 a[222:223], v194 offset:31744
    v_fma_f32 v29, v29, v213, v234
    v_mfma_f32_16x16x32_bf16 v[88:91], a[196:199], v[20:23], v[88:91]
    ds_read_b64_tr_b16 a[224:225], v195 offset:16384
    v_lshlrev_b32 v247, 16, v235
    v_mfma_f32_16x16x32_bf16 v[88:91], a[200:203], v[56:59], v[88:91]
    v_and_b32 v235, 0xffff0000, v235
    v_fma_f32 v30, v30, v213, v247
    v_mfma_f32_16x16x32_bf16 v[88:91], a[204:207], v[68:71], v[88:91]
    s_waitcnt lgkmcnt(6)
    ds_read_b64_tr_b16 a[226:227], v195 offset:17408
    v_fma_f32 v31, v31, v213, v235
    v_mfma_f32_16x16x32_bf16 v[88:91], a[208:211], v[104:107], v[88:91]
    s_waitcnt lgkmcnt(6)
    ds_read_b64_tr_b16 a[228:229], v195 offset:18432
    v_cvt_pk_bf16_f32 v26, v28, v29
    v_mfma_f32_16x16x32_bf16 v[88:91], a[212:215], v[116:119], v[88:91]
    s_waitcnt lgkmcnt(5)
    v_cvt_pk_bf16_f32 v27, v30, v31
    v_lshlrev_b32 v246, 16, v238
    v_mfma_f32_16x16x32_bf16 v[88:91], a[216:219], v[152:155], v[88:91]
    s_waitcnt lgkmcnt(3)
    buffer_store_dwordx4 v[24:27], v212, s[68:71], s4 offen offset:0 sc1
    v_and_b32 v238, 0xffff0000, v238
    v_mfma_f32_16x16x32_bf16 v[88:91], a[220:223], v[164:167], v[88:91]
    ds_read_b64_tr_b16 a[230:231], v195 offset:19456
    v_fma_f32 v36, v36, v214, v246
    v_mfma_f32_16x16x32_bf16 v[80:83], a[220:223], v[160:163], v[80:83]
    ds_read_b64_tr_b16 a[232:233], v195 offset:20480
    v_fma_f32 v37, v37, v214, v238
    v_mfma_f32_16x16x32_bf16 v[80:83], a[216:219], v[148:151], v[80:83]
    ds_read_b64_tr_b16 a[234:235], v195 offset:21504
    v_lshlrev_b32 v247, 16, v239
    v_mfma_f32_16x16x32_bf16 v[80:83], a[212:215], v[112:115], v[80:83]
    ds_read_b64_tr_b16 a[236:237], v195 offset:22528
    v_and_b32 v239, 0xffff0000, v239
    v_mfma_f32_16x16x32_bf16 v[80:83], a[208:211], v[100:103], v[80:83]
    ds_read_b64_tr_b16 a[238:239], v195 offset:23552
    v_fma_f32 v38, v38, v214, v247
    v_fma_f32 v39, v39, v214, v239
    v_mfma_f32_16x16x32_bf16 v[72:75], a[208:211], v[96:99], v[72:75]
    v_cvt_pk_bf16_f32 v34, v36, v37
    v_cvt_pk_bf16_f32 v35, v38, v39
    v_mfma_f32_16x16x32_bf16 v[72:75], a[212:215], v[108:111], v[72:75]
    buffer_store_dwordx4 v[32:35], v212, s[68:71], s4 offen offset:1024 sc1
    v_lshlrev_b32 v246, 16, v242
    v_mfma_f32_16x16x32_bf16 v[72:75], a[216:219], v[144:147], v[72:75]
    ds_read_b64_tr_b16 a[240:241], v195 offset:24576
    v_and_b32 v242, 0xffff0000, v242
    v_mfma_f32_16x16x32_bf16 v[72:75], a[220:223], v[156:159], v[72:75]
    s_waitcnt lgkmcnt(6)
    ds_read_b64_tr_b16 a[242:243], v195 offset:25600
    v_fma_f32 v44, v44, v215, v246
    v_mfma_f32_16x16x32_bf16 v[76:79], a[224:227], v[0:3], 0
    s_waitcnt lgkmcnt(6)
    ds_read_b64_tr_b16 a[244:245], v195 offset:26624
    v_fma_f32 v45, v45, v215, v242
    v_mfma_f32_16x16x32_bf16 v[76:79], a[228:231], v[12:15], v[76:79]
    s_waitcnt lgkmcnt(5)
    ds_read_b64_tr_b16 a[246:247], v195 offset:27648
    v_lshlrev_b32 v247, 16, v243
    v_mfma_f32_16x16x32_bf16 v[76:79], a[232:235], v[48:51], v[76:79]
    s_waitcnt lgkmcnt(4)
    v_and_b32 v243, 0xffff0000, v243
    v_fma_f32 v46, v46, v215, v247
    v_mfma_f32_16x16x32_bf16 v[76:79], a[236:239], v[60:63], v[76:79]
    ds_read_b64_tr_b16 a[248:249], v195 offset:28672
    v_fma_f32 v47, v47, v215, v243
    v_mfma_f32_16x16x32_bf16 v[84:87], a[236:239], v[64:67], 0
    ds_read_b64_tr_b16 a[250:251], v195 offset:29696
    v_cvt_pk_bf16_f32 v42, v44, v45
    v_mfma_f32_16x16x32_bf16 v[84:87], a[232:235], v[52:55], v[84:87]
    v_cvt_pk_bf16_f32 v43, v46, v47
    s_waitcnt vmcnt(5)
    v_lshlrev_b32 v246, 16, v196
    v_mfma_f32_16x16x32_bf16 v[84:87], a[228:231], v[16:19], v[84:87]
    buffer_store_dwordx4 v[40:43], v212, s[68:71], s4 offen offset:2048 sc1
    s_nop 1
    s_mul_i32 s4, s55, 12288
    v_mfma_f32_16x16x32_bf16 v[84:87], a[224:227], v[4:7], v[84:87]
    s_add_u32 s4, s4, 98304
    ds_read_b64_tr_b16 a[252:253], v195 offset:30720
    v_and_b32 v196, 0xffff0000, v196
    v_mfma_f32_16x16x32_bf16 v[92:95], a[224:227], v[8:11], 0
    s_add_u32 s4, s4, s59
    ds_read_b64_tr_b16 a[254:255], v195 offset:31744
    v_fma_f32 v72, v72, v213, v246
    v_mfma_f32_16x16x32_bf16 v[92:95], a[228:231], v[20:23], v[92:95]
    v_fma_f32 v73, v73, v213, v196
    v_lshlrev_b32 v247, 16, v197
    v_mfma_f32_16x16x32_bf16 v[92:95], a[232:235], v[56:59], v[92:95]
    v_and_b32 v197, 0xffff0000, v197
    v_fma_f32 v74, v74, v213, v247
    v_mfma_f32_16x16x32_bf16 v[92:95], a[236:239], v[68:71], v[92:95]
    s_waitcnt lgkmcnt(4)
    v_fma_f32 v75, v75, v213, v197
    v_cvt_pk_bf16_f32 v72, v72, v73
    v_mfma_f32_16x16x32_bf16 v[92:95], a[240:243], v[104:107], v[92:95]
    v_cvt_pk_bf16_f32 v73, v74, v75
    s_waitcnt vmcnt(5)
    v_lshlrev_b32 v246, 16, v200
    v_mfma_f32_16x16x32_bf16 v[92:95], a[244:247], v[116:119], v[92:95]
    s_waitcnt lgkmcnt(2)
    v_and_b32 v200, 0xffff0000, v200
    v_fma_f32 v80, v80, v214, v246
    v_mfma_f32_16x16x32_bf16 v[92:95], a[248:251], v[152:155], v[92:95]
    s_waitcnt lgkmcnt(0)
    v_fma_f32 v81, v81, v214, v200
    v_lshlrev_b32 v247, 16, v201
    v_mfma_f32_16x16x32_bf16 v[92:95], a[252:255], v[164:167], v[92:95]
    v_and_b32 v201, 0xffff0000, v201
    v_fma_f32 v82, v82, v214, v247
    v_mfma_f32_16x16x32_bf16 v[84:87], a[252:255], v[160:163], v[84:87]
    v_mfma_f32_16x16x32_bf16 v[84:87], a[248:251], v[148:151], v[84:87]
    v_fma_f32 v83, v83, v214, v201
    v_cvt_pk_bf16_f32 v80, v80, v81
    v_mfma_f32_16x16x32_bf16 v[84:87], a[244:247], v[112:115], v[84:87]
    v_cvt_pk_bf16_f32 v81, v82, v83
    v_mfma_f32_16x16x32_bf16 v[84:87], a[240:243], v[100:103], v[84:87]
    s_waitcnt vmcnt(4)
    v_lshlrev_b32 v246, 16, v204
    v_and_b32 v204, 0xffff0000, v204
    v_mfma_f32_16x16x32_bf16 v[76:79], a[240:243], v[96:99], v[76:79]
    v_mfma_f32_16x16x32_bf16 v[76:79], a[244:247], v[108:111], v[76:79]
    v_fma_f32 v88, v88, v215, v246
    v_fma_f32 v89, v89, v215, v204
    v_mfma_f32_16x16x32_bf16 v[76:79], a[248:251], v[144:147], v[76:79]
    v_lshlrev_b32 v247, 16, v205
    v_and_b32 v205, 0xffff0000, v205
    v_mfma_f32_16x16x32_bf16 v[76:79], a[252:255], v[156:159], v[76:79]
    v_fma_f32 v90, v90, v215, v247
    v_fma_f32 v91, v91, v215, v205
    v_cvt_pk_bf16_f32 v88, v88, v89
    v_cvt_pk_bf16_f32 v89, v90, v91
    v_lshlrev_b32 v246, 16, v198
    v_and_b32 v198, 0xffff0000, v198
    s_nop 1
    v_fma_f32 v76, v76, v213, v246
    v_fma_f32 v77, v77, v213, v198
    v_lshlrev_b32 v247, 16, v199
    v_and_b32 v199, 0xffff0000, v199
    v_fma_f32 v78, v78, v213, v247
    v_fma_f32 v79, v79, v213, v199
    v_cvt_pk_bf16_f32 v74, v76, v77
    v_cvt_pk_bf16_f32 v75, v78, v79
    buffer_store_dwordx4 v[72:75], v212, s[68:71], s4 offen offset:0 sc1
    v_lshlrev_b32 v246, 16, v202
    v_and_b32 v202, 0xffff0000, v202
    v_fma_f32 v84, v84, v214, v246
    v_fma_f32 v85, v85, v214, v202
    v_lshlrev_b32 v247, 16, v203
    v_and_b32 v203, 0xffff0000, v203
    v_fma_f32 v86, v86, v214, v247
    v_fma_f32 v87, v87, v214, v203
    v_cvt_pk_bf16_f32 v82, v84, v85
    v_cvt_pk_bf16_f32 v83, v86, v87
    buffer_store_dwordx4 v[80:83], v212, s[68:71], s4 offen offset:1024 sc1
    v_lshlrev_b32 v246, 16, v206
    v_and_b32 v206, 0xffff0000, v206
    v_fma_f32 v92, v92, v215, v246
    v_fma_f32 v93, v93, v215, v206
    v_lshlrev_b32 v247, 16, v207
    v_and_b32 v207, 0xffff0000, v207
    v_fma_f32 v94, v94, v215, v247
    v_fma_f32 v95, v95, v215, v207
    v_cvt_pk_bf16_f32 v90, v92, v93
    v_cvt_pk_bf16_f32 v91, v94, v95
    buffer_store_dwordx4 v[88:91], v212, s[68:71], s4 offen offset:2048 sc1
L_join:
    v_mov_b32 v245, 2
    s_cmp_lt_u32 s66, 24
    s_cbranch_scc1 L_direct
    v_mul_u32_u24 v231, 1792, v250
    v_lshl_add_u32 v231, v249, 4, v231
    v_add_u32 v233, s62, v231
    v_mul_u32_u24 v229, 272, v249
    v_lshl_add_u32 v229, v250, 4, v229
    s_lshl_b32 s92, s32, 1
    v_add_u32 v229, s92, v229
    v_mul_u32_u24 v230, 272, v250
    v_lshl_add_u32 v230, v249, 4, v230
    v_add_u32 v230, s92, v230
    v_and_b32 v238, 1, v249
    v_lshlrev_b32 v238, 4, v238
    v_mov_b32 v239, 0x3f80
    v_lshlrev_b32 v238, v238, v239
    v_lshrrev_b32 v237, 1, v249
    v_cmp_eq_u32 vcc, 0, v237
    s_nop 1
    v_cndmask_b32 v220, 0, v238, vcc
    v_cmp_eq_u32 vcc, 1, v237
    s_nop 1
    v_cndmask_b32 v221, 0, v238, vcc
    v_cmp_eq_u32 vcc, 4, v237
    s_nop 1
    v_cndmask_b32 v222, 0, v238, vcc
    v_cmp_eq_u32 vcc, 5, v237
    s_nop 1
    v_cndmask_b32 v223, 0, v238, vcc
    v_cmp_eq_u32 vcc, 2, v237
    s_nop 1
    v_cndmask_b32 v224, 0, v238, vcc
    v_cmp_eq_u32 vcc, 3, v237
    s_nop 1
    v_cndmask_b32 v225, 0, v238, vcc
    v_cmp_eq_u32 vcc, 6, v237
    s_nop 1
    v_cndmask_b32 v226, 0, v238, vcc
    v_cmp_eq_u32 vcc, 7, v237
    s_nop 1
    v_cndmask_b32 v227, 0, v238, vcc
    s_waitcnt vmcnt(0)
    s_barrier
    buffer_store_dword v245, v209, s[72:75], s30 offen sc1
    s_cmp_ge_u32 s66, 60
    s_cbranch_scc1 L_done
L_poll:
    buffer_load_dword v218, v217, s[72:75], 0 offen sc1
    s_waitcnt vmcnt(0)
    v_cmp_gt_u32 vcc, 2, v218
    s_nop 1
    s_cbranch_vccz L_go
    s_sleep 2
    s_sub_u32 s67, s67, 1
    s_cbranch_scc0 L_poll
    s_endpgm
L_go:
    buffer_load_dwordx4 a[0:3], v248, s[68:71], s88 offen offset:0 sc1
    buffer_load_dwordx4 a[4:7], v248, s[68:71], s88 offen offset:256 sc1
    buffer_load_dwordx4 a[8:11], v248, s[68:71], s88 offen offset:512 sc1
    buffer_load_dwordx4 a[12:15], v248, s[68:71], s88 offen offset:768 sc1
    buffer_load_dwordx4 a[16:19], v248, s[68:71], s89 offen offset:0 sc1
    buffer_load_dwordx4 a[20:23], v248, s[68:71], s89 offen offset:256 sc1
    buffer_load_dwordx4 a[24:27], v248, s[68:71], s89 offen offset:512 sc1
    buffer_load_dwordx4 a[28:31], v248, s[68:71], s89 offen offset:768 sc1
    buffer_load_dwordx4 a[32:35], v248, s[68:71], s90 offen offset:0 sc1
    buffer_load_dwordx4 a[36:39], v248, s[68:71], s90 offen offset:256 sc1
    buffer_load_dwordx4 a[40:43], v248, s[68:71], s90 offen offset:512 sc1
    buffer_load_dwordx4 a[44:47], v248, s[68:71], s90 offen offset:768 sc1
    buffer_load_dwordx4 a[48:51], v248, s[68:71], s91 offen offset:0 sc1
    buffer_load_dwordx4 a[52:55], v248, s[68:71], s91 offen offset:256 sc1
    buffer_load_dwordx4 a[56:59], v248, s[68:71], s91 offen offset:512 sc1
    buffer_load_dwordx4 a[60:63], v248, s[68:71], s91 offen offset:768 sc1
    s_waitcnt vmcnt(12)
    v_mfma_f32_16x16x32_bf16 v[0:3], v[220:223], a[0:3], 0
    v_mfma_f32_16x16x32_bf16 v[4:7], v[220:223], a[4:7], 0
    v_mfma_f32_16x16x32_bf16 v[0:3], v[224:227], a[8:11], v[0:3]
    v_mfma_f32_16x16x32_bf16 v[4:7], v[224:227], a[12:15], v[4:7]
    s_waitcnt vmcnt(8)
    v_mfma_f32_16x16x32_bf16 v[8:11], v[220:223], a[16:19], 0
    v_mfma_f32_16x16x32_bf16 v[12:15], v[220:223], a[20:23], 0
    v_mfma_f32_16x16x32_bf16 v[8:11], v[224:227], a[24:27], v[8:11]
    v_mfma_f32_16x16x32_bf16 v[12:15], v[224:227], a[28:31], v[12:15]
    s_nop 1
    v_cvt_pk_bf16_f32 v0, v0, v1
    v_cvt_pk_bf16_f32 v1, v2, v3
    v_cvt_pk_bf16_f32 v2, v4, v5
    v_cvt_pk_bf16_f32 v3, v6, v7
    ds_write_b128 v229, v[0:3] offset:0
    s_waitcnt vmcnt(4)
    v_mfma_f32_16x16x32_bf16 v[16:19], v[220:223], a[32:35], 0
    v_mfma_f32_16x16x32_bf16 v[20:23], v[220:223], a[36:39], 0
    v_mfma_f32_16x16x32_bf16 v[16:19], v[224:227], a[40:43], v[16:19]
    v_mfma_f32_16x16x32_bf16 v[20:23], v[224:227], a[44:47], v[20:23]
    v_cvt_pk_bf16_f32 v8, v8, v9
    v_cvt_pk_bf16_f32 v9, v10, v11
    v_cvt_pk_bf16_f32 v10, v12, v13
    v_cvt_pk_bf16_f32 v11, v14, v15
    ds_write_b128 v229, v[8:11] offset:64
    s_waitcnt vmcnt(0)
    v_mfma_f32_16x16x32_bf16 v[24:27], v[220:223], a[48:51], 0
    v_mfma_f32_16x16x32_bf16 v[28:31], v[220:223], a[52:55], 0
    v_mfma_f32_16x16x32_bf16 v[24:27], v[224:227], a[56:59], v[24:27]
    v_mfma_f32_16x16x32_bf16 v[28:31], v[224:227], a[60:63], v[28:31]
    v_cvt_pk_bf16_f32 v16, v16, v17
    v_cvt_pk_bf16_f32 v17, v18, v19
    v_cvt_pk_bf16_f32 v18, v20, v21
    v_cvt_pk_bf16_f32 v19, v22, v23
    ds_write_b128 v229, v[16:19] offset:128
    s_nop 1
    v_cvt_pk_bf16_f32 v24, v24, v25
    v_cvt_pk_bf16_f32 v25, v26, v27
    v_cvt_pk_bf16_f32 v26, v28, v29
    v_cvt_pk_bf16_f32 v27, v30, v31
    ds_write_b128 v229, v[24:27] offset:192
    ds_read_b128 v[32:35], v230 offset:0
    ds_read_b128 v[36:39], v230 offset:1088
    ds_read_b128 v[40:43], v230 offset:2176
    ds_read_b128 v[44:47], v230 offset:3264
    s_mov_b32 s92, 0
    s_waitcnt lgkmcnt(3)
    buffer_store_dwordx4 v[32:35], v233, s[84:87], s92 offen nt
    s_nop 1
    s_mov_b32 s92, 7168
    s_waitcnt lgkmcnt(2)
    buffer_store_dwordx4 v[36:39], v233, s[84:87], s92 offen nt
    s_nop 1
    s_mov_b32 s92, 14336
    s_waitcnt lgkmcnt(1)
    buffer_store_dwordx4 v[40:43], v233, s[84:87], s92 offen nt
    s_nop 1
    s_mov_b32 s92, 21504
    s_waitcnt lgkmcnt(0)
    buffer_store_dwordx4 v[44:47], v233, s[84:87], s92 offen nt
L_done:
L_end:
    s_endpgm
L_direct:
    v_mul_u32_u24 v231, 1792, v249
    v_lshl_add_u32 v231, v250, 4, v231
    v_and_b32 v238, 1, v249
    v_lshlrev_b32 v238, 4, v238
    v_mov_b32 v239, 0x3f80
    v_lshlrev_b32 v238, v238, v239
    v_lshrrev_b32 v237, 1, v249
    v_cmp_eq_u32 vcc, 0, v237
    s_nop 1
    v_cndmask_b32 v220, 0, v238, vcc
    v_cmp_eq_u32 vcc, 1, v237
    s_nop 1
    v_cndmask_b32 v221, 0, v238, vcc
    v_cmp_eq_u32 vcc, 4, v237
    s_nop 1
    v_cndmask_b32 v222, 0, v238, vcc
    v_cmp_eq_u32 vcc, 5, v237
    s_nop 1
    v_cndmask_b32 v223, 0, v238, vcc
    v_cmp_eq_u32 vcc, 2, v237
    s_nop 1
    v_cndmask_b32 v224, 0, v238, vcc
    v_cmp_eq_u32 vcc, 3, v237
    s_nop 1
    v_cndmask_b32 v225, 0, v238, vcc
    v_cmp_eq_u32 vcc, 6, v237
    s_nop 1
    v_cndmask_b32 v226, 0, v238, vcc
    v_cmp_eq_u32 vcc, 7, v237
    s_nop 1
    v_cndmask_b32 v227, 0, v238, vcc
    s_waitcnt vmcnt(0)
    s_barrier
    buffer_store_dword v245, v209, s[72:75], s30 offen sc1
    v_cmp_gt_u32 vcc, 1, v218
    s_nop 1
    s_cbranch_vccnz L_dpoll
L_dgo:
    buffer_load_dwordx4 a[0:3], v248, s[68:71], s88 offen offset:0 sc1
    buffer_load_dwordx4 a[4:7], v248, s[68:71], s88 offen offset:256 sc1
    buffer_load_dwordx4 a[8:11], v248, s[68:71], s88 offen offset:512 sc1
    buffer_load_dwordx4 a[12:15], v248, s[68:71], s88 offen offset:768 sc1
    buffer_load_dwordx4 a[16:19], v248, s[68:71], s89 offen offset:0 sc1
    buffer_load_dwordx4 a[20:23], v248, s[68:71], s89 offen offset:256 sc1
    buffer_load_dwordx4 a[24:27], v248, s[68:71], s89 offen offset:512 sc1
    buffer_load_dwordx4 a[28:31], v248, s[68:71], s89 offen offset:768 sc1
    buffer_load_dwordx4 a[32:35], v248, s[68:71], s90 offen offset:0 sc1
    buffer_load_dwordx4 a[36:39], v248, s[68:71], s90 offen offset:256 sc1
    buffer_load_dwordx4 a[40:43], v248, s[68:71], s90 offen offset:512 sc1
    buffer_load_dwordx4 a[44:47], v248, s[68:71], s90 offen offset:768 sc1
    buffer_load_dwordx4 a[48:51], v248, s[68:71], s91 offen offset:0 sc1
    buffer_load_dwordx4 a[52:55], v248, s[68:71], s91 offen offset:256 sc1
    buffer_load_dwordx4 a[56:59], v248, s[68:71], s91 offen offset:512 sc1
    buffer_load_dwordx4 a[60:63], v248, s[68:71], s91 offen offset:768 sc1
    s_waitcnt vmcnt(12)
    v_mfma_f32_16x16x32_bf16 v[0:3], v[220:223], a[0:3], 0
    v_mfma_f32_16x16x32_bf16 v[4:7], v[220:223], a[4:7], 0
    v_mfma_f32_16x16x32_bf16 v[0:3], v[224:227], a[8:11], v[0:3]
    v_mfma_f32_16x16x32_bf16 v[4:7], v[224:227], a[12:15], v[4:7]
    s_waitcnt vmcnt(8)
    v_mfma_f32_16x16x32_bf16 v[0:3], v[220:223], a[16:19], v[0:3]
    v_mfma_f32_16x16x32_bf16 v[4:7], v[220:223], a[20:23], v[4:7]
    v_mfma_f32_16x16x32_bf16 v[0:3], v[224:227], a[24:27], v[0:3]
    v_mfma_f32_16x16x32_bf16 v[4:7], v[224:227], a[28:31], v[4:7]
    s_waitcnt vmcnt(4)
    v_mfma_f32_16x16x32_bf16 v[0:3], v[220:223], a[32:35], v[0:3]
    v_mfma_f32_16x16x32_bf16 v[4:7], v[220:223], a[36:39], v[4:7]
    v_mfma_f32_16x16x32_bf16 v[0:3], v[224:227], a[40:43], v[0:3]
    v_mfma_f32_16x16x32_bf16 v[4:7], v[224:227], a[44:47], v[4:7]
    s_waitcnt vmcnt(0)
    v_mfma_f32_16x16x32_bf16 v[0:3], v[220:223], a[48:51], v[0:3]
    v_mfma_f32_16x16x32_bf16 v[4:7], v[220:223], a[52:55], v[4:7]
    v_mfma_f32_16x16x32_bf16 v[0:3], v[224:227], a[56:59], v[0:3]
    v_mfma_f32_16x16x32_bf16 v[4:7], v[224:227], a[60:63], v[4:7]
    s_nop 6
    v_cvt_pk_bf16_f32 v0, v0, v1
    v_cvt_pk_bf16_f32 v1, v2, v3
    v_cvt_pk_bf16_f32 v2, v4, v5
    v_cvt_pk_bf16_f32 v3, v6, v7
    buffer_store_dwordx4 v[0:3], v231, s[84:87], s62 offen nt
    s_branch L_done
L_dpoll:
    buffer_load_dword v218, v217, s[72:75], 0 offen sc1
    s_waitcnt vmcnt(0)
    v_cmp_gt_u32 vcc, 1, v218
    s_nop 1
    s_cbranch_vccz L_dgo
    s_sleep 2
    s_sub_u32 s67, s67, 1
    s_cbranch_scc0 L_dpoll
    s_endpgm
L_dbg:
    s_sleep 2
    buffer_load_dword v239, off, s[80:83], 0 sc1
    s_waitcnt vmcnt(0)
    v_readfirstlane_b32 s79, v239
    s_nop 1
    s_and_b32 s79, s79, 15
    s_cbranch_scc0 L_dbgok
    s_sub_u32 s67, s67, 1
    s_cbranch_scc0 L_dbg
    s_endpgm
L_rs3:
    s_sleep 2
    buffer_load_dword v244, off, s[72:75], s60 sc1
    s_waitcnt vmcnt(0)
    v_readfirstlane_b32 s79, v244
    s_nop 1
    s_cmp_lt_u32 s79, 1
    s_cbranch_scc0 L_rb3
    s_sub_u32 s67, s67, 1
    s_cbranch_scc0 L_rs3
    s_endpgm
L_rs4:
    s_sleep 2
    buffer_load_dword v244, off, s[72:75], s60 sc1
    s_waitcnt vmcnt(0)
    v_readfirstlane_b32 s79, v244
    s_nop 1
    s_cmp_lt_u32 s79, 2
    s_cbranch_scc0 L_rb4
    s_sub_u32 s67, s67, 1
    s_cbranch_scc0 L_rs4
    s_endpgm
L_rs5:
    s_sleep 2
    buffer_load_dword v244, off, s[72:75], s60 sc1
    s_waitcnt vmcnt(0)
    v_readfirstlane_b32 s79, v244
    s_nop 1
    s_cmp_lt_u32 s79, 3
    s_cbranch_scc0 L_rb5
    s_sub_u32 s67, s67, 1
    s_cbranch_scc0 L_rs5
    s_endpgm
L_rs6:
    s_sleep 2
    buffer_load_dword v244, off, s[72:75], s61 sc1
    s_waitcnt vmcnt(0)
    v_readfirstlane_b32 s79, v244
    s_nop 1
    s_cmp_lt_u32 s79, 4
    s_cbranch_scc0 L_rb6
    s_sub_u32 s67, s67, 1
    s_cbranch_scc0 L_rs6
    s_endpgm
L_rs7:
    s_sleep 2
    buffer_load_dword v244, off, s[72:75], s61 sc1
    s_waitcnt vmcnt(0)
    v_readfirstlane_b32 s79, v244
    s_nop 1
    s_cmp_lt_u32 s79, 5
    s_cbranch_scc0 L_rb7
    s_sub_u32 s67, s67, 1
    s_cbranch_scc0 L_rs7
    s_endpgm
L_rs8:
    s_sleep 2
    buffer_load_dword v244, off, s[72:75], s61 sc1
    s_waitcnt vmcnt(0)
    v_readfirstlane_b32 s79, v244
    s_nop 1
    s_cmp_lt_u32 s79, 6
    s_cbranch_scc0 L_rb8
    s_sub_u32 s67, s67, 1
    s_cbranch_scc0 L_rs8
    s_endpgm
L_rs9:
    s_sleep 2
    buffer_load_dword v244, off, s[72:75], s60 sc1
    s_waitcnt vmcnt(0)
    v_readfirstlane_b32 s79, v244
    s_nop 1
    s_cmp_lt_u32 s79, 7
    s_cbranch_scc0 L_rb9
    s_sub_u32 s67, s67, 1
    s_cbranch_scc0 L_rs9
    s_endpgm
L_rs10:
    s_sleep 2
    buffer_load_dword v244, off, s[72:75], s60 sc1
    s_waitcnt vmcnt(0)
    v_readfirstlane_b32 s79, v244
    s_nop 1
    s_cmp_lt_u32 s79, 8
    s_cbranch_scc0 L_rb10
    s_sub_u32 s67, s67, 1
    s_cbranch_scc0 L_rs10
    s_endpgm
L_rs11:
    s_sleep 2
    buffer_load_dword v244, off, s[72:75], s60 sc1
    s_waitcnt vmcnt(0)
    v_readfirstlane_b32 s79, v244
    s_nop 1
    s_cmp_lt_u32 s79, 9
    s_cbranch_scc0 L_rb11
    s_sub_u32 s67, s67, 1
    s_cbranch_scc0 L_rs11
    s_endpgm
L_last:
L_far:
    v_accvgpr_read_b32 v227, a43
    v_cvt_pk_bf16_f32 v16, v220, v221
    v_mfma_f32_16x16x32_bf16 a[168:171], a[244:247], v[132:135], a[168:171]
    ds_read_b64_tr_b16 a[194:195], v194 offset:1024
    v_cvt_pk_bf16_f32 v17, v222, v223
    v_mfma_f32_16x16x32_bf16 a[172:175], a[244:247], v[136:139], a[172:175]
    ds_read_b64_tr_b16 a[196:197], v195 offset:0
    v_mov_b32 v216, 1
    v_mfma_f32_16x16x32_bf16 a[172:175], a[240:243], v[124:127], a[172:175]
    v_lshrrev_b32 v217, 7, v208
    v_cvt_pk_bf16_f32 v18, v224, v225
    v_mfma_f32_16x16x32_bf16 a[176:179], a[240:243], v[128:131], a[176:179]
    ds_read_b64_tr_b16 a[198:199], v195 offset:1024
    v_cvt_pk_bf16_f32 v19, v226, v227
    v_mfma_f32_16x16x32_bf16 a[176:179], a[244:247], v[140:143], a[176:179]
    ds_read_b64_tr_b16 a[200:201], v194 offset:16384
    v_and_b32 v217, 480, v217
    v_mfma_f32_16x16x32_bf16 a[188:191], a[248:251], v[128:131], a[188:191]
    s_mul_i32 s35, s52, 64
    s_add_u32 s35, s35, 512
    s_add_u32 s36, s35, 13312
    v_mfma_f32_16x16x32_bf16 a[188:191], a[252:255], v[140:143], a[188:191]
    s_mul_i32 s92, s53, 64
    ds_read_b64_tr_b16 a[202:203], v194 offset:17408
    s_add_u32 s92, s92, 512
    v_mfma_f32_16x16x32_bf16 a[184:187], a[252:255], v[136:139], a[184:187]
    s_add_u32 s93, s92, 13312
    ds_read_b64_tr_b16 a[204:205], v195 offset:16384
    v_accvgpr_read_b32 v228, a32
    v_mfma_f32_16x16x32_bf16 a[184:187], a[248:251], v[124:127], a[184:187]
    s_add_u32 m0, s32, 65536
    ds_read_b64_tr_b16 a[206:207], v195 offset:17408
    v_accvgpr_read_b32 v229, a33
    v_mfma_f32_16x16x32_bf16 a[180:183], a[248:251], v[120:123], a[180:183]
    buffer_load_dwordx4 v210, s[24:27], s35 offen offset:0 lds
    v_accvgpr_read_b32 v230, a34
    v_mfma_f32_16x16x32_bf16 a[180:183], a[252:255], v[132:135], a[180:183]
    s_waitcnt lgkmcnt(6)
    ds_read_b64_tr_b16 a[208:209], v194 offset:2048
    v_accvgpr_read_b32 v231, a35
    v_mfma_f32_16x16x32_bf16 v[24:27], a[192:195], v[0:3], 0
    s_waitcnt lgkmcnt(5)
    ds_read_b64_tr_b16 a[210:211], v194 offset:3072
    s_add_u32 m0, s32, 49152
    v_mfma_f32_16x16x32_bf16 v[28:31], a[196:199], v[0:3], 0
    buffer_load_dwordx4 v210, s[24:27], s92 offen offset:0 lds
    v_accvgpr_read_b32 v232, a44
    v_mfma_f32_16x16x32_bf16 v[36:39], a[196:199], v[4:7], 0
    s_add_u32 m0, s32, 65536
    ds_read_b64_tr_b16 a[212:213], v195 offset:2048
    v_accvgpr_read_b32 v233, a45
    v_mfma_f32_16x16x32_bf16 v[32:35], a[192:195], v[4:7], 0
    ds_read_b64_tr_b16 a[214:215], v195 offset:3072
    v_accvgpr_read_b32 v234, a46
    v_mfma_f32_16x16x32_bf16 v[40:43], a[192:195], v[8:11], 0
    ds_read_b64_tr_b16 a[216:217], v194 offset:18432
    v_accvgpr_read_b32 v235, a47
    v_mfma_f32_16x16x32_bf16 v[44:47], a[196:199], v[8:11], 0
    s_waitcnt lgkmcnt(7)
    buffer_load_dwordx4 v211, s[24:27], s35 offen offset:2048 lds
    s_add_u32 m0, s32, 49152
    v_mfma_f32_16x16x32_bf16 v[88:91], a[200:203], v[8:11], 0
    s_waitcnt lgkmcnt(5)
    ds_read_b64_tr_b16 a[218:219], v194 offset:19456
    v_cvt_pk_bf16_f32 v20, v228, v229
    v_mfma_f32_16x16x32_bf16 v[92:95], a[204:207], v[8:11], 0
    ds_read_b64_tr_b16 a[220:221], v195 offset:18432
    v_cvt_pk_bf16_f32 v21, v230, v231
    v_mfma_f32_16x16x32_bf16 v[84:87], a[204:207], v[4:7], 0
    buffer_load_dwordx4 v211, s[24:27], s92 offen offset:2048 lds
    s_add_u32 m0, s32, 65536
    v_mfma_f32_16x16x32_bf16 v[80:83], a[200:203], v[4:7], 0
    ds_read_b64_tr_b16 a[222:223], v195 offset:19456
    v_cvt_pk_bf16_f32 v22, v232, v233
    v_mfma_f32_16x16x32_bf16 v[72:75], a[200:203], v[0:3], 0
    ds_read_b64_tr_b16 a[224:225], v194 offset:4096
    buffer_load_dwordx4 v210, s[24:27], s36 offen offset:1024 lds
    v_mfma_f32_16x16x32_bf16 v[76:79], a[204:207], v[0:3], 0
    s_waitcnt lgkmcnt(7)
    ds_read_b64_tr_b16 a[226:227], v194 offset:5120
    s_add_u32 m0, s32, 49152
    v_mfma_f32_16x16x32_bf16 v[24:27], a[208:211], v[12:15], v[24:27]
    s_waitcnt lgkmcnt(6)
    buffer_load_dwordx4 v210, s[24:27], s93 offen offset:1024 lds
    v_cvt_pk_bf16_f32 v23, v234, v235
    v_mfma_f32_16x16x32_bf16 v[28:31], a[212:215], v[12:15], v[28:31]
    s_add_u32 m0, s32, 65536
    ds_read_b64_tr_b16 a[228:229], v195 offset:4096
    v_accvgpr_read_b32 v220, a48
    v_mfma_f32_16x16x32_bf16 v[36:39], a[212:215], v[16:19], v[36:39]
    ds_read_b64_tr_b16 a[230:231], v195 offset:5120
    v_accvgpr_read_b32 v221, a49
    v_mfma_f32_16x16x32_bf16 v[32:35], a[208:211], v[16:19], v[32:35]
    buffer_load_dwordx4 v211, s[24:27], s36 offen offset:3072 lds
    s_add_u32 m0, s32, 49152
    v_mfma_f32_16x16x32_bf16 v[40:43], a[208:211], v[20:23], v[40:43]
    ds_read_b64_tr_b16 a[232:233], v194 offset:20480
    v_accvgpr_read_b32 v222, a50
    v_mfma_f32_16x16x32_bf16 v[44:47], a[212:215], v[20:23], v[44:47]
    s_waitcnt lgkmcnt(6)
    ds_read_b64_tr_b16 a[234:235], v194 offset:21504
    v_accvgpr_read_b32 v223, a51
    v_mfma_f32_16x16x32_bf16 v[88:91], a[216:219], v[20:23], v[88:91]
    s_waitcnt lgkmcnt(6)
    ds_read_b64_tr_b16 a[236:237], v195 offset:20480
    buffer_load_dwordx4 v211, s[24:27], s93 offen offset:3072 lds
    v_mfma_f32_16x16x32_bf16 v[92:95], a[220:223], v[20:23], v[92:95]
    s_mul_i32 s35, s53, 128
    s_add_u32 s35, s35, 0
    v_accvgpr_read_b32 v224, a60
    v_mfma_f32_16x16x32_bf16 v[84:87], a[220:223], v[16:19], v[84:87]
    s_add_u32 s36, s35, 13312
    ds_read_b64_tr_b16 a[238:239], v195 offset:21504
    v_accvgpr_read_b32 v225, a61
    v_mfma_f32_16x16x32_bf16 v[80:83], a[216:219], v[16:19], v[80:83]
    s_mul_i32 s92, s53, 128
    ds_read_b64_tr_b16 a[240:241], v194 offset:6144
    v_accvgpr_read_b32 v226, a62
    v_mfma_f32_16x16x32_bf16 v[72:75], a[216:219], v[12:15], v[72:75]
    s_add_u32 s92, s92, 64
    v_accvgpr_read_b32 v227, a63
    v_cvt_pk_bf16_f32 v48, v220, v221
    v_mfma_f32_16x16x32_bf16 v[76:79], a[220:223], v[12:15], v[76:79]
    s_add_u32 s93, s92, 13312
    ds_read_b64_tr_b16 a[242:243], v194 offset:7168
    v_cvt_pk_bf16_f32 v49, v222, v223
    v_cvt_pk_bf16_f32 v50, v224, v225
    v_cvt_pk_bf16_f32 v51, v226, v227
    s_waitcnt lgkmcnt(7)
    s_nop 0
    v_mfma_f32_16x16x32_bf16 v[24:27], a[224:227], v[48:51], v[24:27]
    s_waitcnt lgkmcnt(6)
    ds_read_b64_tr_b16 a[244:245], v195 offset:6144
    v_accvgpr_read_b32 v228, a52
    v_mfma_f32_16x16x32_bf16 v[28:31], a[228:231], v[48:51], v[28:31]
    s_add_u32 m0, s32, 81920
    ds_read_b64_tr_b16 a[246:247], v195 offset:7168
    v_accvgpr_read_b32 v229, a53
    v_accvgpr_read_b32 v230, a54
    v_accvgpr_read_b32 v231, a55
    v_accvgpr_read_b32 v232, a64
    v_accvgpr_read_b32 v233, a65
    v_accvgpr_read_b32 v234, a66
    v_accvgpr_read_b32 v235, a67
    v_cvt_pk_bf16_f32 v52, v228, v229
    v_cvt_pk_bf16_f32 v53, v230, v231
    v_cvt_pk_bf16_f32 v54, v232, v233
    v_cvt_pk_bf16_f32 v55, v234, v235
    s_nop 1
    v_mfma_f32_16x16x32_bf16 v[36:39], a[228:231], v[52:55], v[36:39]
    buffer_load_dwordx4 v210, s[24:27], s35 offen offset:0 lds
    v_accvgpr_read_b32 v220, a56
    v_mfma_f32_16x16x32_bf16 v[32:35], a[224:227], v[52:55], v[32:35]
    s_add_u32 m0, s32, 32768
    ds_read_b64_tr_b16 a[248:249], v194 offset:22528
    v_accvgpr_read_b32 v221, a57
    v_accvgpr_read_b32 v222, a58
    v_accvgpr_read_b32 v223, a59
    v_accvgpr_read_b32 v224, a68
    v_accvgpr_read_b32 v225, a69
    v_accvgpr_read_b32 v226, a70
    v_accvgpr_read_b32 v227, a71
    v_cvt_pk_bf16_f32 v56, v220, v221
    v_cvt_pk_bf16_f32 v57, v222, v223
    v_cvt_pk_bf16_f32 v58, v224, v225
    v_cvt_pk_bf16_f32 v59, v226, v227
    s_nop 1
    v_mfma_f32_16x16x32_bf16 v[40:43], a[224:227], v[56:59], v[40:43]
    ds_read_b64_tr_b16 a[250:251], v194 offset:23552
    v_accvgpr_read_b32 v228, a72
    v_mfma_f32_16x16x32_bf16 v[44:47], a[228:231], v[56:59], v[44:47]
    s_waitcnt lgkmcnt(7)
    buffer_load_dwordx4 v210, s[24:27], s92 offen offset:0 lds
    v_accvgpr_read_b32 v229, a73
    v_mfma_f32_16x16x32_bf16 v[88:91], a[232:235], v[56:59], v[88:91]
    s_waitcnt lgkmcnt(6)
    ds_read_b64_tr_b16 a[252:253], v195 offset:22528
    s_add_u32 m0, s32, 81920
    v_mfma_f32_16x16x32_bf16 v[92:95], a[236:239], v[56:59], v[92:95]
    ds_read_b64_tr_b16 a[254:255], v195 offset:23552
    v_accvgpr_read_b32 v230, a74
    v_mfma_f32_16x16x32_bf16 v[84:87], a[236:239], v[52:55], v[84:87]
    ds_read_b64_tr_b16 a[192:193], v194 offset:8192
    buffer_load_dwordx4 v211, s[24:27], s35 offen offset:2048 lds
    v_mfma_f32_16x16x32_bf16 v[80:83], a[232:235], v[52:55], v[80:83]
    s_add_u32 m0, s32, 32768
    s_nop 0
    buffer_load_dwordx4 v211, s[24:27], s92 offen offset:2048 lds
    v_accvgpr_read_b32 v231, a75
    v_mfma_f32_16x16x32_bf16 v[72:75], a[232:235], v[48:51], v[72:75]
    s_add_u32 m0, s32, 81920
    ds_read_b64_tr_b16 a[194:195], v194 offset:9216
    v_accvgpr_read_b32 v232, a84
    v_mfma_f32_16x16x32_bf16 v[76:79], a[236:239], v[48:51], v[76:79]
    ds_read_b64_tr_b16 a[196:197], v195 offset:8192
    v_accvgpr_read_b32 v233, a85
    v_accvgpr_read_b32 v234, a86
    v_accvgpr_read_b32 v235, a87
    v_cvt_pk_bf16_f32 v60, v228, v229
    v_cvt_pk_bf16_f32 v61, v230, v231
    v_cvt_pk_bf16_f32 v62, v232, v233
    v_cvt_pk_bf16_f32 v63, v234, v235
    s_waitcnt lgkmcnt(7)
    s_nop 0
    v_mfma_f32_16x16x32_bf16 v[24:27], a[240:243], v[60:63], v[24:27]
    buffer_load_dwordx4 v210, s[24:27], s36 offen offset:1024 lds
    v_accvgpr_read_b32 v220, a76
    v_mfma_f32_16x16x32_bf16 v[28:31], a[244:247], v[60:63], v[28:31]
    s_add_u32 m0, s32, 32768
    ds_read_b64_tr_b16 a[198:199], v195 offset:9216
    v_accvgpr_read_b32 v221, a77
    v_accvgpr_read_b32 v222, a78
    v_accvgpr_read_b32 v223, a79
    v_accvgpr_read_b32 v224, a88
    v_accvgpr_read_b32 v225, a89
    v_accvgpr_read_b32 v226, a90
    v_accvgpr_read_b32 v227, a91
    v_cvt_pk_bf16_f32 v64, v220, v221
    v_cvt_pk_bf16_f32 v65, v222, v223
    v_cvt_pk_bf16_f32 v66, v224, v225
    v_cvt_pk_bf16_f32 v67, v226, v227
    s_nop 1
    v_mfma_f32_16x16x32_bf16 v[36:39], a[244:247], v[64:67], v[36:39]
    ds_read_b64_tr_b16 a[200:201], v194 offset:24576
    v_accvgpr_read_b32 v228, a80
    v_mfma_f32_16x16x32_bf16 v[32:35], a[240:243], v[64:67], v[32:35]
    buffer_load_dwordx4 v210, s[24:27], s93 offen offset:1024 lds
    v_accvgpr_read_b32 v229, a81
    v_accvgpr_read_b32 v230, a82
    v_accvgpr_read_b32 v231, a83
    v_accvgpr_read_b32 v232, a92
    v_accvgpr_read_b32 v233, a93
    v_accvgpr_read_b32 v234, a94
    v_accvgpr_read_b32 v235, a95
    v_cvt_pk_bf16_f32 v68, v228, v229
    v_cvt_pk_bf16_f32 v69, v230, v231
    v_cvt_pk_bf16_f32 v70, v232, v233
    v_cvt_pk_bf16_f32 v71, v234, v235
    s_nop 1
    v_mfma_f32_16x16x32_bf16 v[40:43], a[240:243], v[68:71], v[40:43]
    s_add_u32 m0, s32, 81920
    ds_read_b64_tr_b16 a[202:203], v194 offset:25600
    v_accvgpr_read_b32 v220, a96
    v_mfma_f32_16x16x32_bf16 v[44:47], a[244:247], v[68:71], v[44:47]
    s_waitcnt lgkmcnt(6)
    ds_read_b64_tr_b16 a[204:205], v195 offset:24576
    v_accvgpr_read_b32 v221, a97
    v_mfma_f32_16x16x32_bf16 v[88:91], a[248:251], v[68:71], v[88:91]
    ds_read_b64_tr_b16 a[206:207], v195 offset:25600
    buffer_load_dwordx4 v211, s[24:27], s36 offen offset:3072 lds
    v_mfma_f32_16x16x32_bf16 v[92:95], a[252:255], v[68:71], v[92:95]
    s_add_u32 m0, s32, 32768
    s_nop 0
    buffer_load_dwordx4 v211, s[24:27], s93 offen offset:3072 lds
    v_accvgpr_read_b32 v222, a98
    v_mfma_f32_16x16x32_bf16 v[84:87], a[252:255], v[64:67], v[84:87]
    ds_read_b64_tr_b16 a[208:209], v194 offset:10240
    v_accvgpr_read_b32 v223, a99
    v_mfma_f32_16x16x32_bf16 v[80:83], a[248:251], v[64:67], v[80:83]
    ds_read_b64_tr_b16 a[210:211], v194 offset:11264
    v_accvgpr_read_b32 v224, a108
    v_mfma_f32_16x16x32_bf16 v[72:75], a[248:251], v[60:63], v[72:75]
    buffer_load_dword v192, v254, s[68:71], s45 offen
    s_add_u32 s45, s45, 4608
    v_mfma_f32_16x16x32_bf16 v[76:79], a[252:255], v[60:63], v[76:79]
    ds_read_b64_tr_b16 a[212:213], v195 offset:10240
    v_accvgpr_read_b32 v225, a109
    v_accvgpr_read_b32 v226, a110
    v_accvgpr_read_b32 v227, a111
    v_cvt_pk_bf16_f32 v96, v220, v221
    v_cvt_pk_bf16_f32 v97, v222, v223
    v_cvt_pk_bf16_f32 v98, v224, v225
    v_cvt_pk_bf16_f32 v99, v226, v227
    s_waitcnt lgkmcnt(7)
    s_nop 0
    v_mfma_f32_16x16x32_bf16 v[24:27], a[192:195], v[96:99], v[24:27]
    ds_read_b64_tr_b16 a[214:215], v195 offset:11264
    v_accvgpr_read_b32 v228, a100
    v_mfma_f32_16x16x32_bf16 v[28:31], a[196:199], v[96:99], v[28:31]
    ds_read_b64_tr_b16 a[216:217], v194 offset:26624
    buffer_load_dword v193, v254, s[68:71], s45 offen
    v_accvgpr_read_b32 v229, a101
    v_accvgpr_read_b32 v230, a102
    v_accvgpr_read_b32 v231, a103
    v_accvgpr_read_b32 v232, a112
    v_accvgpr_read_b32 v233, a113
    v_accvgpr_read_b32 v234, a114
    v_accvgpr_read_b32 v235, a115
    v_cvt_pk_bf16_f32 v100, v228, v229
    v_cvt_pk_bf16_f32 v101, v230, v231
    v_cvt_pk_bf16_f32 v102, v232, v233
    v_cvt_pk_bf16_f32 v103, v234, v235
    s_nop 1
    v_mfma_f32_16x16x32_bf16 v[36:39], a[196:199], v[100:103], v[36:39]
    s_add_u32 s45, s45, 4608
    v_accvgpr_read_b32 v220, a104
    v_accvgpr_read_b32 v221, a105
    v_mfma_f32_16x16x32_bf16 v[32:35], a[192:195], v[100:103], v[32:35]
    ds_read_b64_tr_b16 a[218:219], v194 offset:27648
    v_accvgpr_read_b32 v222, a106
    v_accvgpr_read_b32 v223, a107
    v_accvgpr_read_b32 v224, a116
    v_accvgpr_read_b32 v225, a117
    v_accvgpr_read_b32 v226, a118
    v_accvgpr_read_b32 v227, a119
    v_cvt_pk_bf16_f32 v104, v220, v221
    v_cvt_pk_bf16_f32 v105, v222, v223
    v_cvt_pk_bf16_f32 v106, v224, v225
    v_cvt_pk_bf16_f32 v107, v226, v227
    s_nop 1
    v_mfma_f32_16x16x32_bf16 v[40:43], a[192:195], v[104:107], v[40:43]
    ds_read_b64_tr_b16 a[220:221], v195 offset:26624
    v_accvgpr_read_b32 v228, a120
    v_mfma_f32_16x16x32_bf16 v[44:47], a[196:199], v[104:107], v[44:47]
    s_waitcnt lgkmcnt(7)
    v_accvgpr_read_b32 v229, a121
    v_accvgpr_read_b32 v230, a122
    v_mfma_f32_16x16x32_bf16 v[88:91], a[200:203], v[104:107], v[88:91]
    ds_read_b64_tr_b16 a[222:223], v195 offset:27648
    v_accvgpr_read_b32 v231, a123
    v_mfma_f32_16x16x32_bf16 v[92:95], a[204:207], v[104:107], v[92:95]
    ds_read_b64_tr_b16 a[224:225], v194 offset:12288
    v_accvgpr_read_b32 v232, a132
    v_mfma_f32_16x16x32_bf16 v[84:87], a[204:207], v[100:103], v[84:87]
    ds_read_b64_tr_b16 a[226:227], v194 offset:13312
    v_accvgpr_read_b32 v233, a133
    v_mfma_f32_16x16x32_bf16 v[80:83], a[200:203], v[100:103], v[80:83]
    v_accvgpr_read_b32 v234, a134
    v_accvgpr_read_b32 v235, a135
    v_mfma_f32_16x16x32_bf16 v[72:75], a[200:203], v[96:99], v[72:75]
    ds_read_b64_tr_b16 a[228:229], v195 offset:12288
    v_cvt_pk_bf16_f32 v108, v228, v229
    v_mfma_f32_16x16x32_bf16 v[76:79], a[204:207], v[96:99], v[76:79]
    ds_read_b64_tr_b16 a[230:231], v195 offset:13312
    v_cvt_pk_bf16_f32 v109, v230, v231
    v_cvt_pk_bf16_f32 v110, v232, v233
    v_cvt_pk_bf16_f32 v111, v234, v235
    s_waitcnt lgkmcnt(7)
    s_nop 0
    v_mfma_f32_16x16x32_bf16 v[24:27], a[208:211], v[108:111], v[24:27]
    v_accvgpr_read_b32 v220, a124
    v_accvgpr_read_b32 v221, a125
    v_mfma_f32_16x16x32_bf16 v[28:31], a[212:215], v[108:111], v[28:31]
    ds_read_b64_tr_b16 a[232:233], v194 offset:28672
    v_accvgpr_read_b32 v222, a126
    v_accvgpr_read_b32 v223, a127
    v_accvgpr_read_b32 v224, a136
    v_accvgpr_read_b32 v225, a137
    v_accvgpr_read_b32 v226, a138
    v_accvgpr_read_b32 v227, a139
    v_cvt_pk_bf16_f32 v112, v220, v221
    v_cvt_pk_bf16_f32 v113, v222, v223
    v_cvt_pk_bf16_f32 v114, v224, v225
    v_cvt_pk_bf16_f32 v115, v226, v227
    s_nop 1
    v_mfma_f32_16x16x32_bf16 v[36:39], a[212:215], v[112:115], v[36:39]
    ds_read_b64_tr_b16 a[234:235], v194 offset:29696
    v_accvgpr_read_b32 v228, a128
    v_mfma_f32_16x16x32_bf16 v[32:35], a[208:211], v[112:115], v[32:35]
    ds_read_b64_tr_b16 a[236:237], v195 offset:28672
    v_accvgpr_read_b32 v229, a129
    v_accvgpr_read_b32 v230, a130
    v_accvgpr_read_b32 v231, a131
    v_accvgpr_read_b32 v232, a140
    v_accvgpr_read_b32 v233, a141
    v_accvgpr_read_b32 v234, a142
    v_accvgpr_read_b32 v235, a143
    v_cvt_pk_bf16_f32 v116, v228, v229
    v_cvt_pk_bf16_f32 v117, v230, v231
    v_cvt_pk_bf16_f32 v118, v232, v233
    v_cvt_pk_bf16_f32 v119, v234, v235
    s_nop 1
    v_mfma_f32_16x16x32_bf16 v[40:43], a[208:211], v[116:119], v[40:43]
    v_accvgpr_read_b32 v220, a144
    v_accvgpr_read_b32 v221, a145
    v_mfma_f32_16x16x32_bf16 v[44:47], a[212:215], v[116:119], v[44:47]
    s_waitcnt lgkmcnt(6)
    ds_read_b64_tr_b16 a[238:239], v195 offset:29696
    v_accvgpr_read_b32 v222, a146
    v_mfma_f32_16x16x32_bf16 v[88:91], a[216:219], v[116:119], v[88:91]
    ds_read_b64_tr_b16 a[240:241], v194 offset:14336
    v_accvgpr_read_b32 v223, a147
    v_mfma_f32_16x16x32_bf16 v[92:95], a[220:223], v[116:119], v[92:95]
    v_accvgpr_read_b32 v224, a156
    v_accvgpr_read_b32 v225, a157
    v_mfma_f32_16x16x32_bf16 v[84:87], a[220:223], v[112:115], v[84:87]
    ds_read_b64_tr_b16 a[242:243], v194 offset:15360
    v_accvgpr_read_b32 v226, a158
    v_mfma_f32_16x16x32_bf16 v[80:83], a[216:219], v[112:115], v[80:83]
    ds_read_b64_tr_b16 a[244:245], v195 offset:14336
    v_accvgpr_read_b32 v227, a159
    v_mfma_f32_16x16x32_bf16 v[72:75], a[216:219], v[108:111], v[72:75]
    ds_read_b64_tr_b16 a[246:247], v195 offset:15360
    v_cvt_pk_bf16_f32 v144, v220, v221
    v_mfma_f32_16x16x32_bf16 v[76:79], a[220:223], v[108:111], v[76:79]
    v_cvt_pk_bf16_f32 v145, v222, v223
    v_cvt_pk_bf16_f32 v146, v224, v225
    v_cvt_pk_bf16_f32 v147, v226, v227
    s_waitcnt lgkmcnt(7)
    s_nop 0
    v_mfma_f32_16x16x32_bf16 v[24:27], a[224:227], v[144:147], v[24:27]
    ds_read_b64_tr_b16 a[248:249], v194 offset:30720
    v_accvgpr_read_b32 v228, a148
    v_mfma_f32_16x16x32_bf16 v[28:31], a[228:231], v[144:147], v[28:31]
    ds_read_b64_tr_b16 a[250:251], v194 offset:31744
    v_accvgpr_read_b32 v229, a149
    v_accvgpr_read_b32 v230, a150
    v_accvgpr_read_b32 v231, a151
    v_accvgpr_read_b32 v232, a160
    v_accvgpr_read_b32 v233, a161
    v_accvgpr_read_b32 v234, a162
    v_accvgpr_read_b32 v235, a163
    v_cvt_pk_bf16_f32 v148, v228, v229
    v_cvt_pk_bf16_f32 v149, v230, v231
    v_cvt_pk_bf16_f32 v150, v232, v233
    v_cvt_pk_bf16_f32 v151, v234, v235
    s_nop 1
    v_mfma_f32_16x16x32_bf16 v[36:39], a[228:231], v[148:151], v[36:39]
    v_accvgpr_read_b32 v220, a152
    v_accvgpr_read_b32 v221, a153
    v_mfma_f32_16x16x32_bf16 v[32:35], a[224:227], v[148:151], v[32:35]
    ds_read_b64_tr_b16 a[252:253], v195 offset:30720
    v_accvgpr_read_b32 v222, a154
    v_accvgpr_read_b32 v223, a155
    v_accvgpr_read_b32 v224, a164
    v_accvgpr_read_b32 v225, a165
    v_accvgpr_read_b32 v226, a166
    v_accvgpr_read_b32 v227, a167
    v_cvt_pk_bf16_f32 v152, v220, v221
    v_cvt_pk_bf16_f32 v153, v222, v223
    v_cvt_pk_bf16_f32 v154, v224, v225
    v_cvt_pk_bf16_f32 v155, v226, v227
    s_nop 1
    v_mfma_f32_16x16x32_bf16 v[40:43], a[224:227], v[152:155], v[40:43]
    ds_read_b64_tr_b16 a[254:255], v195 offset:31744
    v_accvgpr_read_b32 v228, a168
    v_mfma_f32_16x16x32_bf16 v[44:47], a[228:231], v[152:155], v[44:47]
    s_waitcnt lgkmcnt(7)
    v_add_u32 v194, 0xfffe0000, v194
    v_accvgpr_read_b32 v229, a169
    v_mfma_f32_16x16x32_bf16 v[88:91], a[232:235], v[152:155], v[88:91]
    v_accvgpr_read_b32 v230, a170
    v_accvgpr_read_b32 v231, a171
    v_mfma_f32_16x16x32_bf16 v[92:95], a[236:239], v[152:155], v[92:95]
    v_accvgpr_read_b32 v232, a180
    v_accvgpr_read_b32 v233, a181
    v_mfma_f32_16x16x32_bf16 v[84:87], a[236:239], v[148:151], v[84:87]
    v_add_u32 v195, 0xfffe0000, v195
    v_accvgpr_read_b32 v234, a182
    v_mfma_f32_16x16x32_bf16 v[80:83], a[232:235], v[148:151], v[80:83]
    v_accvgpr_read_b32 v235, a183
    v_cvt_pk_bf16_f32 v156, v228, v229
    v_mfma_f32_16x16x32_bf16 v[72:75], a[232:235], v[144:147], v[72:75]
    v_cvt_pk_bf16_f32 v157, v230, v231
    v_cvt_pk_bf16_f32 v158, v232, v233
    v_mfma_f32_16x16x32_bf16 v[76:79], a[236:239], v[144:147], v[76:79]
    s_waitcnt vmcnt(18) lgkmcnt(0)
    s_barrier
    ds_read_b64_tr_b16 a[192:193], v194 offset:0
    v_cvt_pk_bf16_f32 v159, v234, v235
    s_nop 1
    v_mfma_f32_16x16x32_bf16 v[24:27], a[240:243], v[156:159], v[24:27]
    v_bfe_u32 v249, v208, 12, 4
    v_accvgpr_read_b32 v220, a172
    v_mfma_f32_16x16x32_bf16 v[28:31], a[244:247], v[156:159], v[28:31]
    ds_read_b64_tr_b16 a[194:195], v194 offset:1024
    v_accvgpr_read_b32 v221, a173
    v_accvgpr_read_b32 v222, a174
    v_accvgpr_read_b32 v223, a175
    v_accvgpr_read_b32 v224, a184
    v_accvgpr_read_b32 v225, a185
    v_accvgpr_read_b32 v226, a186
    v_accvgpr_read_b32 v227, a187
    v_cvt_pk_bf16_f32 v160, v220, v221
    v_cvt_pk_bf16_f32 v161, v222, v223
    v_cvt_pk_bf16_f32 v162, v224, v225
    v_cvt_pk_bf16_f32 v163, v226, v227
    s_nop 1
    v_mfma_f32_16x16x32_bf16 v[36:39], a[244:247], v[160:163], v[36:39]
    ds_read_b64_tr_b16 a[196:197], v194 offset:2048
    v_lshrrev_b32 v250, 16, v208
    v_mfma_f32_16x16x32_bf16 v[32:35], a[240:243], v[160:163], v[32:35]
    v_mul_lo_u32 v248, s47, v250
    v_accvgpr_read_b32 v228, a176
    v_accvgpr_read_b32 v229, a177
    v_accvgpr_read_b32 v230, a178
    v_accvgpr_read_b32 v231, a179
    v_accvgpr_read_b32 v232, a188
    v_accvgpr_read_b32 v233, a189
    v_accvgpr_read_b32 v234, a190
    v_accvgpr_read_b32 v235, a191
    v_cvt_pk_bf16_f32 v164, v228, v229
    v_cvt_pk_bf16_f32 v165, v230, v231
    v_cvt_pk_bf16_f32 v166, v232, v233
    v_cvt_pk_bf16_f32 v167, v234, v235
    s_nop 1
    v_mfma_f32_16x16x32_bf16 v[40:43], a[240:243], v[164:167], v[40:43]
    ds_read_b64_tr_b16 a[198:199], v194 offset:3072
    v_lshl_add_u32 v248, v249, 4, v248
    v_mfma_f32_16x16x32_bf16 v[44:47], a[244:247], v[164:167], v[44:47]
    ds_read_b64_tr_b16 a[200:201], v194 offset:4096
    v_add_u32 v248, s46, v248
    v_mfma_f32_16x16x32_bf16 v[88:91], a[248:251], v[164:167], v[88:91]
    v_mfma_f32_16x16x32_bf16 v[92:95], a[252:255], v[164:167], v[92:95]
    ds_read_b64_tr_b16 a[202:203], v194 offset:5120
    v_mfma_f32_16x16x32_bf16 v[84:87], a[252:255], v[160:163], v[84:87]
    ds_read_b64_tr_b16 a[204:205], v194 offset:6144
    v_mfma_f32_16x16x32_bf16 v[80:83], a[248:251], v[160:163], v[80:83]
    ds_read_b64_tr_b16 a[206:207], v194 offset:7168
    v_mfma_f32_16x16x32_bf16 v[72:75], a[248:251], v[156:159], v[72:75]
    v_mfma_f32_16x16x32_bf16 v[76:79], a[252:255], v[156:159], v[76:79]
    s_waitcnt lgkmcnt(6)
    ds_read_b64_tr_b16 a[208:209], v194 offset:8192
    v_mul_f32 v24, v213, v24
    v_mfma_f32_16x16x32_bf16 v[120:123], a[192:195], v[0:3], 0
    s_waitcnt lgkmcnt(5)
    ds_read_b64_tr_b16 a[210:211], v194 offset:9216
    v_mul_f32 v25, v213, v25
    v_mfma_f32_16x16x32_bf16 v[120:123], a[196:199], v[12:15], v[120:123]
    s_waitcnt lgkmcnt(4)
    v_mfma_f32_16x16x32_bf16 v[120:123], a[200:203], v[48:51], v[120:123]
    s_waitcnt lgkmcnt(2)
    ds_read_b64_tr_b16 a[212:213], v194 offset:10240
    v_mul_f32 v26, v213, v26
    v_mfma_f32_16x16x32_bf16 v[120:123], a[204:207], v[60:63], v[120:123]
    s_add_u32 s4, s63, 0
    ds_read_b64_tr_b16 a[214:215], v194 offset:11264
    v_mul_f32 v27, v213, v27
    v_mfma_f32_16x16x32_bf16 v[128:131], a[204:207], v[64:67], 0
    ds_read_b64_tr_b16 a[216:217], v194 offset:12288
    v_cvt_pk_bf16_f32 v24, v24, v25
    v_mfma_f32_16x16x32_bf16 v[128:131], a[200:203], v[52:55], v[128:131]
    v_mfma_f32_16x16x32_bf16 v[128:131], a[196:199], v[16:19], v[128:131]
    ds_read_b64_tr_b16 a[218:219], v194 offset:13312
    v_cvt_pk_bf16_f32 v25, v26, v27
    v_mfma_f32_16x16x32_bf16 v[128:131], a[192:195], v[4:7], v[128:131]
    ds_read_b64_tr_b16 a[220:221], v194 offset:14336
    v_mul_f32 v32, v214, v32
    v_mfma_f32_16x16x32_bf16 v[136:139], a[192:195], v[8:11], 0
    v_mul_f32 v33, v214, v33
    v_mul_f32 v34, v214, v34
    v_mfma_f32_16x16x32_bf16 v[136:139], a[196:199], v[20:23], v[136:139]
    ds_read_b64_tr_b16 a[222:223], v194 offset:15360
    v_mul_f32 v35, v214, v35
    v_mfma_f32_16x16x32_bf16 v[136:139], a[200:203], v[56:59], v[136:139]
    ds_read_b64_tr_b16 a[224:225], v195 offset:0
    v_cvt_pk_bf16_f32 v32, v32, v33
    v_mfma_f32_16x16x32_bf16 v[136:139], a[204:207], v[68:71], v[136:139]
    s_waitcnt lgkmcnt(7)
    ds_read_b64_tr_b16 a[226:227], v195 offset:1024
    v_cvt_pk_bf16_f32 v33, v34, v35
    v_mfma_f32_16x16x32_bf16 v[136:139], a[208:211], v[104:107], v[136:139]
    s_waitcnt lgkmcnt(6)
    v_mul_f32 v40, v215, v40
    v_mul_f32 v41, v215, v41
    v_mfma_f32_16x16x32_bf16 v[136:139], a[212:215], v[116:119], v[136:139]
    s_waitcnt lgkmcnt(4)
    ds_read_b64_tr_b16 a[228:229], v195 offset:2048
    v_mul_f32 v42, v215, v42
    v_mfma_f32_16x16x32_bf16 v[136:139], a[216:219], v[152:155], v[136:139]
    s_waitcnt lgkmcnt(3)
    ds_read_b64_tr_b16 a[230:231], v195 offset:3072
    v_mul_f32 v43, v215, v43
    v_mfma_f32_16x16x32_bf16 v[136:139], a[220:223], v[164:167], v[136:139]
    v_cvt_pk_bf16_f32 v40, v40, v41
    v_cvt_pk_bf16_f32 v41, v42, v43
    v_mfma_f32_16x16x32_bf16 v[128:131], a[220:223], v[160:163], v[128:131]
    ds_read_b64_tr_b16 a[232:233], v195 offset:4096
    v_mul_f32 v28, v213, v28
    v_mfma_f32_16x16x32_bf16 v[128:131], a[216:219], v[148:151], v[128:131]
    ds_read_b64_tr_b16 a[234:235], v195 offset:5120
    v_mul_f32 v29, v213, v29
    v_mfma_f32_16x16x32_bf16 v[128:131], a[212:215], v[112:115], v[128:131]
    ds_read_b64_tr_b16 a[236:237], v195 offset:6144
    v_mul_f32 v30, v213, v30
    v_mfma_f32_16x16x32_bf16 v[128:131], a[208:211], v[100:103], v[128:131]
    v_mul_f32 v31, v213, v31
    v_cvt_pk_bf16_f32 v26, v28, v29
    v_mfma_f32_16x16x32_bf16 v[120:123], a[208:211], v[96:99], v[120:123]
    ds_read_b64_tr_b16 a[238:239], v195 offset:7168
    v_cvt_pk_bf16_f32 v27, v30, v31
    v_mfma_f32_16x16x32_bf16 v[120:123], a[212:215], v[108:111], v[120:123]
    buffer_store_dwordx4 v[24:27], v212, s[68:71], s4 offen offset:0 sc1
    v_mul_f32 v36, v214, v36
    v_mfma_f32_16x16x32_bf16 v[120:123], a[216:219], v[144:147], v[120:123]
    ds_read_b64_tr_b16 a[240:241], v195 offset:8192
    v_mul_f32 v37, v214, v37
    v_mfma_f32_16x16x32_bf16 v[120:123], a[220:223], v[156:159], v[120:123]
    s_waitcnt lgkmcnt(6)
    ds_read_b64_tr_b16 a[242:243], v195 offset:9216
    v_mul_f32 v38, v214, v38
    v_mfma_f32_16x16x32_bf16 v[124:127], a[224:227], v[0:3], 0
    s_waitcnt lgkmcnt(6)
    ds_read_b64_tr_b16 a[244:245], v195 offset:10240
    v_mul_f32 v39, v214, v39
    v_mfma_f32_16x16x32_bf16 v[124:127], a[228:231], v[12:15], v[124:127]
    s_waitcnt lgkmcnt(5)
    ds_read_b64_tr_b16 a[246:247], v195 offset:11264
    v_cvt_pk_bf16_f32 v34, v36, v37
    v_mfma_f32_16x16x32_bf16 v[124:127], a[232:235], v[48:51], v[124:127]
    s_waitcnt lgkmcnt(4)
    v_cvt_pk_bf16_f32 v35, v38, v39
    v_mul_f32 v44, v215, v44
    v_mfma_f32_16x16x32_bf16 v[124:127], a[236:239], v[60:63], v[124:127]
    buffer_store_dwordx4 v[32:35], v212, s[68:71], s4 offen offset:1024 sc1
    v_mul_f32 v45, v215, v45
    v_mfma_f32_16x16x32_bf16 v[132:135], a[236:239], v[64:67], 0
    ds_read_b64_tr_b16 a[248:249], v195 offset:12288
    v_mul_f32 v46, v215, v46
    v_mfma_f32_16x16x32_bf16 v[132:135], a[232:235], v[52:55], v[132:135]
    ds_read_b64_tr_b16 a[250:251], v195 offset:13312
    v_mul_f32 v47, v215, v47
    v_mfma_f32_16x16x32_bf16 v[132:135], a[228:231], v[16:19], v[132:135]
    ds_read_b64_tr_b16 a[252:253], v195 offset:14336
    v_cvt_pk_bf16_f32 v42, v44, v45
    v_mfma_f32_16x16x32_bf16 v[132:135], a[224:227], v[4:7], v[132:135]
    ds_read_b64_tr_b16 a[254:255], v195 offset:15360
    v_cvt_pk_bf16_f32 v43, v46, v47
    v_mfma_f32_16x16x32_bf16 v[140:143], a[224:227], v[8:11], 0
    buffer_store_dwordx4 v[40:43], v212, s[68:71], s4 offen offset:2048 sc1
    s_nop 1
    s_add_u32 s4, s63, 12288
    v_mfma_f32_16x16x32_bf16 v[140:143], a[228:231], v[20:23], v[140:143]
    ds_read_b64_tr_b16 a[192:193], v194 offset:16384
    v_mul_f32 v72, v213, v72
    v_mfma_f32_16x16x32_bf16 v[140:143], a[232:235], v[56:59], v[140:143]
    ds_read_b64_tr_b16 a[194:195], v194 offset:17408
    v_mul_f32 v73, v213, v73
    v_mfma_f32_16x16x32_bf16 v[140:143], a[236:239], v[68:71], v[140:143]
    s_waitcnt lgkmcnt(6)
    ds_read_b64_tr_b16 a[196:197], v194 offset:18432
    v_mul_f32 v74, v213, v74
    v_mfma_f32_16x16x32_bf16 v[140:143], a[240:243], v[104:107], v[140:143]
    v_mul_f32 v75, v213, v75
    v_cvt_pk_bf16_f32 v72, v72, v73
    v_mfma_f32_16x16x32_bf16 v[140:143], a[244:247], v[116:119], v[140:143]
    s_waitcnt lgkmcnt(5)
    ds_read_b64_tr_b16 a[198:199], v194 offset:19456
    v_cvt_pk_bf16_f32 v73, v74, v75
    v_mfma_f32_16x16x32_bf16 v[140:143], a[248:251], v[152:155], v[140:143]
    s_waitcnt lgkmcnt(4)
    ds_read_b64_tr_b16 a[200:201], v194 offset:20480
    v_mul_f32 v80, v214, v80
    v_mfma_f32_16x16x32_bf16 v[140:143], a[252:255], v[164:167], v[140:143]
    v_mul_f32 v81, v214, v81
    v_mul_f32 v82, v214, v82
    v_mfma_f32_16x16x32_bf16 v[132:135], a[252:255], v[160:163], v[132:135]
    ds_read_b64_tr_b16 a[202:203], v194 offset:21504
    v_mul_f32 v83, v214, v83
    v_mfma_f32_16x16x32_bf16 v[132:135], a[248:251], v[148:151], v[132:135]
    ds_read_b64_tr_b16 a[204:205], v194 offset:22528
    v_cvt_pk_bf16_f32 v80, v80, v81
    v_mfma_f32_16x16x32_bf16 v[132:135], a[244:247], v[112:115], v[132:135]
    ds_read_b64_tr_b16 a[206:207], v194 offset:23552
    v_cvt_pk_bf16_f32 v81, v82, v83
    v_mfma_f32_16x16x32_bf16 v[132:135], a[240:243], v[100:103], v[132:135]
    v_mul_f32 v88, v215, v88
    v_mul_f32 v89, v215, v89
    v_mfma_f32_16x16x32_bf16 v[124:127], a[240:243], v[96:99], v[124:127]
    ds_read_b64_tr_b16 a[208:209], v194 offset:24576
    v_mul_f32 v90, v215, v90
    v_mfma_f32_16x16x32_bf16 v[124:127], a[244:247], v[108:111], v[124:127]
    ds_read_b64_tr_b16 a[210:211], v194 offset:25600
    v_mul_f32 v91, v215, v91
    v_mfma_f32_16x16x32_bf16 v[124:127], a[248:251], v[144:147], v[124:127]
    v_cvt_pk_bf16_f32 v88, v88, v89
    v_cvt_pk_bf16_f32 v89, v90, v91
    v_mfma_f32_16x16x32_bf16 v[124:127], a[252:255], v[156:159], v[124:127]
    s_waitcnt lgkmcnt(6)
    ds_read_b64_tr_b16 a[212:213], v194 offset:26624
    v_mul_f32 v76, v213, v76
    v_mfma_f32_16x16x32_bf16 v[168:171], a[192:195], v[0:3], 0
    ds_read_b64_tr_b16 a[214:215], v194 offset:27648
    v_mul_f32 v77, v213, v77
    v_mfma_f32_16x16x32_bf16 v[168:171], a[196:199], v[12:15], v[168:171]
    s_waitcnt lgkmcnt(6)
    ds_read_b64_tr_b16 a[216:217], v194 offset:28672
    v_mul_f32 v78, v213, v78
    v_mfma_f32_16x16x32_bf16 v[168:171], a[200:203], v[48:51], v[168:171]
    s_waitcnt lgkmcnt(5)
    v_mul_f32 v79, v213, v79
    v_cvt_pk_bf16_f32 v74, v76, v77
    v_mfma_f32_16x16x32_bf16 v[168:171], a[204:207], v[60:63], v[168:171]
    ds_read_b64_tr_b16 a[218:219], v194 offset:29696
    v_cvt_pk_bf16_f32 v75, v78, v79
    v_mfma_f32_16x16x32_bf16 v[176:179], a[204:207], v[64:67], 0
    buffer_store_dwordx4 v[72:75], v212, s[68:71], s4 offen offset:0 sc1
    v_mul_f32 v84, v214, v84
    v_mfma_f32_16x16x32_bf16 v[176:179], a[200:203], v[52:55], v[176:179]
    ds_read_b64_tr_b16 a[220:221], v194 offset:30720
    v_mul_f32 v85, v214, v85
    v_mfma_f32_16x16x32_bf16 v[176:179], a[196:199], v[16:19], v[176:179]
    ds_read_b64_tr_b16 a[222:223], v194 offset:31744
    v_mul_f32 v86, v214, v86
    v_mul_f32 v87, v214, v87
    v_mfma_f32_16x16x32_bf16 v[176:179], a[192:195], v[4:7], v[176:179]
    ds_read_b64_tr_b16 a[224:225], v195 offset:16384
    v_cvt_pk_bf16_f32 v82, v84, v85
    v_mfma_f32_16x16x32_bf16 v[184:187], a[192:195], v[8:11], 0
    ds_read_b64_tr_b16 a[226:227], v195 offset:17408
    v_cvt_pk_bf16_f32 v83, v86, v87
    v_mfma_f32_16x16x32_bf16 v[184:187], a[196:199], v[20:23], v[184:187]
    buffer_store_dwordx4 v[80:83], v212, s[68:71], s4 offen offset:1024 sc1
    v_mul_f32 v92, v215, v92
    v_mfma_f32_16x16x32_bf16 v[184:187], a[200:203], v[56:59], v[184:187]
    ds_read_b64_tr_b16 a[228:229], v195 offset:18432
    v_mul_f32 v93, v215, v93
    v_mul_f32 v94, v215, v94
    v_mfma_f32_16x16x32_bf16 v[184:187], a[204:207], v[68:71], v[184:187]
    s_waitcnt lgkmcnt(6)
    ds_read_b64_tr_b16 a[230:231], v195 offset:19456
    v_mul_f32 v95, v215, v95
    v_mfma_f32_16x16x32_bf16 v[184:187], a[208:211], v[104:107], v[184:187]
    v_cvt_pk_bf16_f32 v90, v92, v93
    v_cvt_pk_bf16_f32 v91, v94, v95
    v_mfma_f32_16x16x32_bf16 v[184:187], a[212:215], v[116:119], v[184:187]
    s_waitcnt lgkmcnt(6)
    buffer_store_dwordx4 v[88:91], v212, s[68:71], s4 offen offset:2048 sc1
    s_nop 1
    s_mul_i32 s4, s52, 24576
    v_mul_f32 v120, v213, v120
    v_mfma_f32_16x16x32_bf16 v[184:187], a[216:219], v[152:155], v[184:187]
    s_waitcnt lgkmcnt(4)
    ds_read_b64_tr_b16 a[232:233], v195 offset:20480
    s_add_u32 s4, s4, 0
    v_mul_f32 v121, v213, v121
    v_mfma_f32_16x16x32_bf16 v[184:187], a[220:223], v[164:167], v[184:187]
    s_add_u32 s4, s4, s56
    ds_read_b64_tr_b16 a[234:235], v195 offset:21504
    v_mul_f32 v122, v213, v122
    v_mfma_f32_16x16x32_bf16 v[176:179], a[220:223], v[160:163], v[176:179]
    ds_read_b64_tr_b16 a[236:237], v195 offset:22528
    v_mul_f32 v123, v213, v123
    v_mfma_f32_16x16x32_bf16 v[176:179], a[216:219], v[148:151], v[176:179]
    ds_read_b64_tr_b16 a[238:239], v195 offset:23552
    v_cvt_pk_bf16_f32 v120, v120, v121
    v_cvt_pk_bf16_f32 v121, v122, v123
    v_mfma_f32_16x16x32_bf16 v[176:179], a[212:215], v[112:115], v[176:179]
    ds_read_b64_tr_b16 a[240:241], v195 offset:24576
    v_mul_f32 v128, v214, v128
    v_mfma_f32_16x16x32_bf16 v[176:179], a[208:211], v[100:103], v[176:179]
    v_mul_f32 v129, v214, v129
    v_mul_f32 v130, v214, v130
    v_mfma_f32_16x16x32_bf16 v[168:171], a[208:211], v[96:99], v[168:171]
    ds_read_b64_tr_b16 a[242:243], v195 offset:25600
    v_mul_f32 v131, v214, v131
    v_mfma_f32_16x16x32_bf16 v[168:171], a[212:215], v[108:111], v[168:171]
    ds_read_b64_tr_b16 a[244:245], v195 offset:26624
    v_cvt_pk_bf16_f32 v128, v128, v129
    v_mfma_f32_16x16x32_bf16 v[168:171], a[216:219], v[144:147], v[168:171]
    ds_read_b64_tr_b16 a[246:247], v195 offset:27648
    v_cvt_pk_bf16_f32 v129, v130, v131
    v_mfma_f32_16x16x32_bf16 v[168:171], a[220:223], v[156:159], v[168:171]
    s_waitcnt lgkmcnt(8)
    v_mul_f32 v136, v215, v136
    v_mul_f32 v137, v215, v137
    v_mfma_f32_16x16x32_bf16 v[172:175], a[224:227], v[0:3], 0
    ds_read_b64_tr_b16 a[248:249], v195 offset:28672
    v_mul_f32 v138, v215, v138
    v_mfma_f32_16x16x32_bf16 v[172:175], a[228:231], v[12:15], v[172:175]
    s_waitcnt lgkmcnt(7)
    ds_read_b64_tr_b16 a[250:251], v195 offset:29696
    v_mul_f32 v139, v215, v139
    v_mfma_f32_16x16x32_bf16 v[172:175], a[232:235], v[48:51], v[172:175]
    s_waitcnt lgkmcnt(6)
    v_cvt_pk_bf16_f32 v136, v136, v137
    v_cvt_pk_bf16_f32 v137, v138, v139
    v_mfma_f32_16x16x32_bf16 v[172:175], a[236:239], v[60:63], v[172:175]
    ds_read_b64_tr_b16 a[252:253], v195 offset:30720
    v_mul_f32 v124, v213, v124
    v_mfma_f32_16x16x32_bf16 v[180:183], a[236:239], v[64:67], 0
    ds_read_b64_tr_b16 a[254:255], v195 offset:31744
    v_mul_f32 v125, v213, v125
    v_mfma_f32_16x16x32_bf16 v[180:183], a[232:235], v[52:55], v[180:183]
    v_add_u32 v194, 0x10000, v194
    v_mul_f32 v126, v213, v126
    v_mfma_f32_16x16x32_bf16 v[180:183], a[228:231], v[16:19], v[180:183]
    v_mul_f32 v127, v213, v127
    v_cvt_pk_bf16_f32 v122, v124, v125
    v_mfma_f32_16x16x32_bf16 v[180:183], a[224:227], v[4:7], v[180:183]
    v_cvt_pk_bf16_f32 v123, v126, v127
    v_mul_f32 v132, v214, v132
    v_mfma_f32_16x16x32_bf16 v[188:191], a[224:227], v[8:11], 0
    buffer_store_dwordx4 v[120:123], v212, s[68:71], s4 offen offset:0 sc1
    v_add_u32 v195, 0x10000, v195
    v_mfma_f32_16x16x32_bf16 v[188:191], a[228:231], v[20:23], v[188:191]
    v_mul_f32 v133, v214, v133
    v_mul_f32 v134, v214, v134
    v_mfma_f32_16x16x32_bf16 v[188:191], a[232:235], v[56:59], v[188:191]
    v_mul_f32 v135, v214, v135
    v_cvt_pk_bf16_f32 v130, v132, v133
    v_mfma_f32_16x16x32_bf16 v[188:191], a[236:239], v[68:71], v[188:191]
    s_waitcnt lgkmcnt(2)
    s_waitcnt vmcnt(10) lgkmcnt(0)
    s_barrier
    ds_read_b64_tr_b16 a[192:193], v194 offset:0
    v_cvt_pk_bf16_f32 v131, v134, v135
    v_mfma_f32_16x16x32_bf16 v[188:191], a[240:243], v[104:107], v[188:191]
    s_mul_i32 s35, s54, 128
    buffer_store_dwordx4 v[128:131], v212, s[68:71], s4 offen offset:1024 sc1
    v_mul_f32 v140, v215, v140
    v_mfma_f32_16x16x32_bf16 v[188:191], a[244:247], v[116:119], v[188:191]
    ds_read_b64_tr_b16 a[194:195], v194 offset:1024
    v_mul_f32 v141, v215, v141
    v_mfma_f32_16x16x32_bf16 v[188:191], a[248:251], v[152:155], v[188:191]
    ds_read_b64_tr_b16 a[196:197], v194 offset:2048
    v_mul_f32 v142, v215, v142
    v_mfma_f32_16x16x32_bf16 v[188:191], a[252:255], v[164:167], v[188:191]
    s_add_u32 s35, s35, 0
    v_mul_f32 v143, v215, v143
    v_cvt_pk_bf16_f32 v138, v140, v141
    v_mfma_f32_16x16x32_bf16 v[180:183], a[252:255], v[160:163], v[180:183]
    ds_read_b64_tr_b16 a[198:199], v194 offset:3072
    v_cvt_pk_bf16_f32 v139, v142, v143
    v_mfma_f32_16x16x32_bf16 v[180:183], a[248:251], v[148:151], v[180:183]
    s_add_u32 s36, s35, 13312
    buffer_store_dwordx4 v[136:139], v212, s[68:71], s4 offen offset:2048 sc1
    s_nop 1
    s_mul_i32 s4, s52, 24576
    v_mul_f32 v168, v213, v168
    v_mfma_f32_16x16x32_bf16 v[180:183], a[244:247], v[112:115], v[180:183]
    s_add_u32 s4, s4, 12288
    ds_read_b64_tr_b16 a[200:201], v194 offset:4096
    v_mul_f32 v169, v213, v169
    v_mfma_f32_16x16x32_bf16 v[180:183], a[240:243], v[100:103], v[180:183]
    s_add_u32 s4, s4, s56
    ds_read_b64_tr_b16 a[202:203], v194 offset:5120
    v_mul_f32 v170, v213, v170
    v_mfma_f32_16x16x32_bf16 v[172:175], a[240:243], v[96:99], v[172:175]
    s_mul_i32 s92, s54, 128
    ds_read_b64_tr_b16 a[204:205], v194 offset:6144
    v_mul_f32 v171, v213, v171
    v_mfma_f32_16x16x32_bf16 v[172:175], a[244:247], v[108:111], v[172:175]
    s_add_u32 s92, s92, 64
    ds_read_b64_tr_b16 a[206:207], v194 offset:7168
    v_cvt_pk_bf16_f32 v168, v168, v169
    v_cvt_pk_bf16_f32 v169, v170, v171
    v_mfma_f32_16x16x32_bf16 v[172:175], a[248:251], v[144:147], v[172:175]
    v_mul_f32 v176, v214, v176
    v_mul_f32 v177, v214, v177
    v_mfma_f32_16x16x32_bf16 v[172:175], a[252:255], v[156:159], v[172:175]
    s_waitcnt lgkmcnt(6)
    ds_read_b64_tr_b16 a[208:209], v194 offset:8192
    v_mul_f32 v178, v214, v178
    v_mfma_f32_16x16x32_bf16 v[24:27], a[192:195], v[0:3], 0
    s_waitcnt lgkmcnt(5)
    ds_read_b64_tr_b16 a[210:211], v194 offset:9216
    v_mul_f32 v179, v214, v179
    v_mfma_f32_16x16x32_bf16 v[24:27], a[196:199], v[12:15], v[24:27]
    s_waitcnt lgkmcnt(4)
    s_add_u32 s93, s92, 13312
    v_cvt_pk_bf16_f32 v176, v176, v177
    v_mfma_f32_16x16x32_bf16 v[24:27], a[200:203], v[48:51], v[24:27]
    s_waitcnt lgkmcnt(2)
    ds_read_b64_tr_b16 a[212:213], v194 offset:10240
    v_cvt_pk_bf16_f32 v177, v178, v179
    v_mfma_f32_16x16x32_bf16 v[24:27], a[204:207], v[60:63], v[24:27]
    s_add_u32 m0, s32, 98304
    ds_read_b64_tr_b16 a[214:215], v194 offset:11264
    v_mul_f32 v184, v215, v184
    v_mfma_f32_16x16x32_bf16 v[32:35], a[204:207], v[64:67], 0
    ds_read_b64_tr_b16 a[216:217], v194 offset:12288
    v_mul_f32 v185, v215, v185
    v_mul_f32 v186, v215, v186
    v_mfma_f32_16x16x32_bf16 v[32:35], a[200:203], v[52:55], v[32:35]
    buffer_load_dwordx4 v210, s[24:27], s35 offen offset:0 lds
    v_mul_f32 v187, v215, v187
    v_mfma_f32_16x16x32_bf16 v[32:35], a[196:199], v[16:19], v[32:35]
    s_add_u32 m0, s32, 114688
    ds_read_b64_tr_b16 a[218:219], v194 offset:13312
    v_cvt_pk_bf16_f32 v184, v184, v185
    v_mfma_f32_16x16x32_bf16 v[32:35], a[192:195], v[4:7], v[32:35]
    ds_read_b64_tr_b16 a[220:221], v194 offset:14336
    v_cvt_pk_bf16_f32 v185, v186, v187
    v_mul_f32 v172, v213, v172
    v_mfma_f32_16x16x32_bf16 v[40:43], a[192:195], v[8:11], 0
    buffer_load_dwordx4 v210, s[24:27], s92 offen offset:0 lds
    v_mul_f32 v173, v213, v173
    v_mfma_f32_16x16x32_bf16 v[40:43], a[196:199], v[20:23], v[40:43]
    s_add_u32 m0, s32, 98304
    ds_read_b64_tr_b16 a[222:223], v194 offset:15360
    v_mul_f32 v174, v213, v174
    v_mfma_f32_16x16x32_bf16 v[40:43], a[200:203], v[56:59], v[40:43]
    ds_read_b64_tr_b16 a[224:225], v195 offset:0
    v_mul_f32 v175, v213, v175
    v_mfma_f32_16x16x32_bf16 v[40:43], a[204:207], v[68:71], v[40:43]
    s_waitcnt lgkmcnt(7)
    ds_read_b64_tr_b16 a[226:227], v195 offset:1024
    v_cvt_pk_bf16_f32 v170, v172, v173
    v_cvt_pk_bf16_f32 v171, v174, v175
    v_mfma_f32_16x16x32_bf16 v[40:43], a[208:211], v[104:107], v[40:43]
    s_waitcnt lgkmcnt(6)
    buffer_store_dwordx4 v[168:171], v212, s[68:71], s4 offen offset:0 sc1
    v_mul_f32 v180, v214, v180
    v_mfma_f32_16x16x32_bf16 v[40:43], a[212:215], v[116:119], v[40:43]
    s_waitcnt lgkmcnt(4)
    ds_read_b64_tr_b16 a[228:229], v195 offset:2048
    v_mul_f32 v181, v214, v181
    v_mfma_f32_16x16x32_bf16 v[40:43], a[216:219], v[152:155], v[40:43]
    s_waitcnt lgkmcnt(3)
    ds_read_b64_tr_b16 a[230:231], v195 offset:3072
    buffer_load_dwordx4 v211, s[24:27], s35 offen offset:2048 lds
    v_mul_f32 v182, v214, v182
    v_mfma_f32_16x16x32_bf16 v[40:43], a[220:223], v[164:167], v[40:43]
    s_add_u32 m0, s32, 114688
    s_nop 0
    buffer_load_dwordx4 v211, s[24:27], s92 offen offset:2048 lds
    v_mul_f32 v183, v214, v183
    v_cvt_pk_bf16_f32 v178, v180, v181
    v_mfma_f32_16x16x32_bf16 v[32:35], a[220:223], v[160:163], v[32:35]
    ds_read_b64_tr_b16 a[232:233], v195 offset:4096
    v_cvt_pk_bf16_f32 v179, v182, v183
    v_mfma_f32_16x16x32_bf16 v[32:35], a[216:219], v[148:151], v[32:35]
    s_add_u32 m0, s32, 98304
    buffer_store_dwordx4 v[176:179], v212, s[68:71], s4 offen offset:1024 sc1
    v_mul_f32 v188, v215, v188
    v_mfma_f32_16x16x32_bf16 v[32:35], a[212:215], v[112:115], v[32:35]
    ds_read_b64_tr_b16 a[234:235], v195 offset:5120
    v_mul_f32 v189, v215, v189
    v_mul_f32 v190, v215, v190
    v_mfma_f32_16x16x32_bf16 v[32:35], a[208:211], v[100:103], v[32:35]
    ds_read_b64_tr_b16 a[236:237], v195 offset:6144
    v_mul_f32 v191, v215, v191
    v_mfma_f32_16x16x32_bf16 v[24:27], a[208:211], v[96:99], v[24:27]
    ds_read_b64_tr_b16 a[238:239], v195 offset:7168
    v_cvt_pk_bf16_f32 v186, v188, v189
    v_mfma_f32_16x16x32_bf16 v[24:27], a[212:215], v[108:111], v[24:27]
    ds_read_b64_tr_b16 a[240:241], v195 offset:8192
    v_cvt_pk_bf16_f32 v187, v190, v191
    v_mfma_f32_16x16x32_bf16 v[24:27], a[216:219], v[144:147], v[24:27]
    buffer_store_dwordx4 v[184:187], v212, s[68:71], s4 offen offset:2048 sc1
    buffer_load_dwordx4 v210, s[24:27], s36 offen offset:1024 lds
    v_mfma_f32_16x16x32_bf16 v[24:27], a[220:223], v[156:159], v[24:27]
    s_waitcnt lgkmcnt(6)
    ds_read_b64_tr_b16 a[242:243], v195 offset:9216
    v_mov_b32 v245, 1
    v_mfma_f32_16x16x32_bf16 v[28:31], a[224:227], v[0:3], 0
    s_waitcnt lgkmcnt(6)
    ds_read_b64_tr_b16 a[244:245], v195 offset:10240
    s_add_u32 m0, s32, 114688
    v_mfma_f32_16x16x32_bf16 v[28:31], a[228:231], v[12:15], v[28:31]
    s_waitcnt lgkmcnt(5)
    ds_read_b64_tr_b16 a[246:247], v195 offset:11264
    v_mfma_f32_16x16x32_bf16 v[28:31], a[232:235], v[48:51], v[28:31]
    s_waitcnt lgkmcnt(4)
    buffer_load_dwordx4 v210, s[24:27], s93 offen offset:1024 lds
    v_mfma_f32_16x16x32_bf16 v[28:31], a[236:239], v[60:63], v[28:31]
    s_waitcnt vmcnt(9)
    buffer_store_dword v245, v208, s[72:75], s28 offen sc1
    s_add_u32 m0, s32, 98304
    v_mfma_f32_16x16x32_bf16 v[36:39], a[236:239], v[64:67], 0
    ds_read_b64_tr_b16 a[248:249], v195 offset:12288
    v_mfma_f32_16x16x32_bf16 v[36:39], a[232:235], v[52:55], v[36:39]
    ds_read_b64_tr_b16 a[250:251], v195 offset:13312
    v_mfma_f32_16x16x32_bf16 v[36:39], a[228:231], v[16:19], v[36:39]
    ds_read_b64_tr_b16 a[252:253], v195 offset:14336
    buffer_load_dwordx4 v211, s[24:27], s36 offen offset:3072 lds
    v_mfma_f32_16x16x32_bf16 v[36:39], a[224:227], v[4:7], v[36:39]
    s_add_u32 m0, s32, 114688
    ds_read_b64_tr_b16 a[254:255], v195 offset:15360
    v_mfma_f32_16x16x32_bf16 v[44:47], a[224:227], v[8:11], 0
    ds_read_b64_tr_b16 a[192:193], v194 offset:16384
    v_mfma_f32_16x16x32_bf16 v[44:47], a[228:231], v[20:23], v[44:47]
    buffer_load_dwordx4 v211, s[24:27], s93 offen offset:3072 lds
    v_mul_f32 v24, v213, v24
    v_mfma_f32_16x16x32_bf16 v[44:47], a[232:235], v[56:59], v[44:47]
    s_mul_i32 s35, s54, 64
    ds_read_b64_tr_b16 a[194:195], v194 offset:17408
    v_mul_f32 v25, v213, v25
    v_mfma_f32_16x16x32_bf16 v[44:47], a[236:239], v[68:71], v[44:47]
    s_waitcnt lgkmcnt(6)
    ds_read_b64_tr_b16 a[196:197], v194 offset:18432
    v_mul_f32 v26, v213, v26
    v_mfma_f32_16x16x32_bf16 v[44:47], a[240:243], v[104:107], v[44:47]
    s_add_u32 s35, s35, 512
    v_mfma_f32_16x16x32_bf16 v[44:47], a[244:247], v[116:119], v[44:47]
    s_waitcnt lgkmcnt(5)
    ds_read_b64_tr_b16 a[198:199], v194 offset:19456
    v_mul_f32 v27, v213, v27
    v_mfma_f32_16x16x32_bf16 v[44:47], a[248:251], v[152:155], v[44:47]
    s_waitcnt lgkmcnt(4)
    ds_read_b64_tr_b16 a[200:201], v194 offset:20480
    s_mul_i32 s4, s52, 12288
    v_mfma_f32_16x16x32_bf16 v[44:47], a[252:255], v[164:167], v[44:47]
    s_add_u32 s36, s35, 13312
    v_mfma_f32_16x16x32_bf16 v[36:39], a[252:255], v[160:163], v[36:39]
    s_add_u32 s4, s4, 98304
    ds_read_b64_tr_b16 a[202:203], v194 offset:21504
    v_cvt_pk_bf16_f32 v24, v24, v25
    v_mfma_f32_16x16x32_bf16 v[36:39], a[248:251], v[148:151], v[36:39]
    s_mul_i32 s92, s55, 64
    buffer_load_dword v244, off, s[72:75], s60 sc1
    s_add_u32 s4, s4, s56
    v_mfma_f32_16x16x32_bf16 v[36:39], a[244:247], v[112:115], v[36:39]
    s_add_u32 s92, s92, 512
    ds_read_b64_tr_b16 a[204:205], v194 offset:22528
    v_cvt_pk_bf16_f32 v25, v26, v27
    v_mfma_f32_16x16x32_bf16 v[36:39], a[240:243], v[100:103], v[36:39]
    s_add_u32 s93, s92, 13312
    ds_read_b64_tr_b16 a[206:207], v194 offset:23552
    v_mul_f32 v32, v214, v32
    v_mfma_f32_16x16x32_bf16 v[28:31], a[240:243], v[96:99], v[28:31]
    ds_read_b64_tr_b16 a[208:209], v194 offset:24576
    v_mul_f32 v33, v214, v33
    v_mfma_f32_16x16x32_bf16 v[28:31], a[244:247], v[108:111], v[28:31]
    s_add_u32 m0, s32, 131072
    ds_read_b64_tr_b16 a[210:211], v194 offset:25600
    v_mul_f32 v34, v214, v34
    v_mfma_f32_16x16x32_bf16 v[28:31], a[248:251], v[144:147], v[28:31]
    v_mul_f32 v35, v214, v35
    v_cvt_pk_bf16_f32 v32, v32, v33
    v_mfma_f32_16x16x32_bf16 v[28:31], a[252:255], v[156:159], v[28:31]
    s_waitcnt lgkmcnt(6)
    ds_read_b64_tr_b16 a[212:213], v194 offset:26624
    v_cvt_pk_bf16_f32 v33, v34, v35
    v_mfma_f32_16x16x32_bf16 v[72:75], a[192:195], v[0:3], 0
    ds_read_b64_tr_b16 a[214:215], v194 offset:27648
    v_mul_f32 v40, v215, v40
    v_mfma_f32_16x16x32_bf16 v[72:75], a[196:199], v[12:15], v[72:75]
    s_waitcnt lgkmcnt(6)
    ds_read_b64_tr_b16 a[216:217], v194 offset:28672
    v_mul_f32 v41, v215, v41
    v_mfma_f32_16x16x32_bf16 v[72:75], a[200:203], v[48:51], v[72:75]
    s_waitcnt lgkmcnt(5)
    buffer_load_dwordx4 v210, s[24:27], s35 offen offset:0 lds
    v_mul_f32 v42, v215, v42
    v_mfma_f32_16x16x32_bf16 v[72:75], a[204:207], v[60:63], v[72:75]
    s_add_u32 m0, s32, 16384
    ds_read_b64_tr_b16 a[218:219], v194 offset:29696
    v_mov_b32 v245, 2
    v_mul_f32 v43, v215, v43
    v_mfma_f32_16x16x32_bf16 v[80:83], a[204:207], v[64:67], 0
    s_mul_i32 s78, s53, 24576
    ds_read_b64_tr_b16 a[220:221], v194 offset:30720
    v_cvt_pk_bf16_f32 v40, v40, v41
    v_mfma_f32_16x16x32_bf16 v[80:83], a[200:203], v[52:55], v[80:83]
    s_add_u32 s78, s78, 0
    buffer_load_dwordx4 v210, s[24:27], s92 offen offset:0 lds
    v_cvt_pk_bf16_f32 v41, v42, v43
    v_mul_f32 v28, v213, v28
    v_mfma_f32_16x16x32_bf16 v[80:83], a[196:199], v[16:19], v[80:83]
    s_add_u32 m0, s32, 131072
    ds_read_b64_tr_b16 a[222:223], v194 offset:31744
    v_mul_f32 v29, v213, v29
    v_mfma_f32_16x16x32_bf16 v[80:83], a[192:195], v[4:7], v[80:83]
    s_add_u32 s78, s78, s56
    ds_read_b64_tr_b16 a[224:225], v195 offset:16384
    v_mul_f32 v30, v213, v30
    v_mfma_f32_16x16x32_bf16 v[88:91], a[192:195], v[8:11], 0
    s_waitcnt vmcnt(8)
    buffer_store_dword v245, v208, s[72:75], s28 offen sc1
    v_mul_f32 v31, v213, v31
    v_mfma_f32_16x16x32_bf16 v[88:91], a[196:199], v[20:23], v[88:91]
    ds_read_b64_tr_b16 a[226:227], v195 offset:17408
    v_cvt_pk_bf16_f32 v26, v28, v29
    v_cvt_pk_bf16_f32 v27, v30, v31
    v_mfma_f32_16x16x32_bf16 v[88:91], a[200:203], v[56:59], v[88:91]
    buffer_store_dwordx4 v[24:27], v212, s[68:71], s4 offen offset:0 sc1
    buffer_load_dwordx4 v211, s[24:27], s35 offen offset:2048 lds
    v_mul_f32 v36, v214, v36
    v_mfma_f32_16x16x32_bf16 v[88:91], a[204:207], v[68:71], v[88:91]
    s_waitcnt lgkmcnt(5)
    ds_read_b64_tr_b16 a[228:229], v195 offset:18432
    s_waitcnt vmcnt(5)
    v_readfirstlane_b32 s79, v244
    s_nop 0
    s_cmp_lt_u32 s79, 1
    s_cbranch_scc1 L_fs3
L_fb3:
    s_add_u32 m0, s32, 16384
    v_mul_f32 v37, v214, v37
    v_mfma_f32_16x16x32_bf16 v[88:91], a[208:211], v[104:107], v[88:91]
    buffer_load_dwordx4 v[220:223], v212, s[68:71], s78 offen offset:0 sc1
    v_mul_f32 v38, v214, v38
    v_mul_f32 v39, v214, v39
    v_mfma_f32_16x16x32_bf16 v[88:91], a[212:215], v[116:119], v[88:91]
    s_waitcnt lgkmcnt(5)
    buffer_load_dwordx4 v[224:227], v212, s[68:71], s78 offen offset:1024 sc1
    v_cvt_pk_bf16_f32 v34, v36, v37
    v_mfma_f32_16x16x32_bf16 v[88:91], a[216:219], v[152:155], v[88:91]
    s_waitcnt lgkmcnt(3)
    buffer_load_dwordx4 v[228:231], v212, s[68:71], s78 offen offset:2048 sc1
    buffer_load_dwordx4 v211, s[24:27], s92 offen offset:2048 lds
    v_cvt_pk_bf16_f32 v35, v38, v39
    v_mfma_f32_16x16x32_bf16 v[88:91], a[220:223], v[164:167], v[88:91]
    s_add_u32 m0, s32, 131072
    buffer_store_dwordx4 v[32:35], v212, s[68:71], s4 offen offset:1024 sc1
    ds_read_b64_tr_b16 a[230:231], v195 offset:19456
    v_mul_f32 v44, v215, v44
    v_mfma_f32_16x16x32_bf16 v[80:83], a[220:223], v[160:163], v[80:83]
    ds_read_b64_tr_b16 a[232:233], v195 offset:20480
    v_mul_f32 v45, v215, v45
    v_mul_f32 v46, v215, v46
    v_mfma_f32_16x16x32_bf16 v[80:83], a[216:219], v[148:151], v[80:83]
    ds_read_b64_tr_b16 a[234:235], v195 offset:21504
    v_mul_f32 v47, v215, v47
    v_mfma_f32_16x16x32_bf16 v[80:83], a[212:215], v[112:115], v[80:83]
    ds_read_b64_tr_b16 a[236:237], v195 offset:22528
    buffer_load_dwordx4 v210, s[24:27], s36 offen offset:1024 lds
    v_cvt_pk_bf16_f32 v42, v44, v45
    v_mfma_f32_16x16x32_bf16 v[80:83], a[208:211], v[100:103], v[80:83]
    s_add_u32 m0, s32, 16384
    ds_read_b64_tr_b16 a[238:239], v195 offset:23552
    v_cvt_pk_bf16_f32 v43, v46, v47
    v_mfma_f32_16x16x32_bf16 v[72:75], a[208:211], v[96:99], v[72:75]
    buffer_store_dwordx4 v[40:43], v212, s[68:71], s4 offen offset:2048 sc1
    v_mfma_f32_16x16x32_bf16 v[72:75], a[212:215], v[108:111], v[72:75]
    ds_read_b64_tr_b16 a[240:241], v195 offset:24576
    v_mfma_f32_16x16x32_bf16 v[72:75], a[216:219], v[144:147], v[72:75]
    ds_read_b64_tr_b16 a[242:243], v195 offset:25600
    buffer_load_dwordx4 v210, s[24:27], s93 offen offset:1024 lds
    v_mfma_f32_16x16x32_bf16 v[72:75], a[220:223], v[156:159], v[72:75]
    s_waitcnt lgkmcnt(7)
    ds_read_b64_tr_b16 a[244:245], v195 offset:26624
    s_add_u32 m0, s32, 131072
    v_mfma_f32_16x16x32_bf16 v[76:79], a[224:227], v[0:3], 0
    s_waitcnt lgkmcnt(7)
    ds_read_b64_tr_b16 a[246:247], v195 offset:27648
    v_mfma_f32_16x16x32_bf16 v[76:79], a[228:231], v[12:15], v[76:79]
    s_waitcnt lgkmcnt(6)
    ds_read_b64_tr_b16 a[248:249], v195 offset:28672
    v_mfma_f32_16x16x32_bf16 v[76:79], a[232:235], v[48:51], v[76:79]
    s_waitcnt lgkmcnt(5)
    ds_read_b64_tr_b16 a[250:251], v195 offset:29696
    buffer_load_dwordx4 v211, s[24:27], s36 offen offset:3072 lds
    v_mfma_f32_16x16x32_bf16 v[76:79], a[236:239], v[60:63], v[76:79]
    s_add_u32 m0, s32, 16384
    buffer_load_dword v244, off, s[72:75], s60 sc1
    s_waitcnt vmcnt(9)
    v_lshlrev_b32 v246, 16, v220
    v_mfma_f32_16x16x32_bf16 v[84:87], a[236:239], v[64:67], 0
    s_mul_i32 s4, s53, 24576
    ds_read_b64_tr_b16 a[252:253], v195 offset:30720
    v_and_b32 v220, 0xffff0000, v220
    v_mfma_f32_16x16x32_bf16 v[84:87], a[232:235], v[52:55], v[84:87]
    s_add_u32 s4, s4, 0
    ds_read_b64_tr_b16 a[254:255], v195 offset:31744
    v_add_u32 v194, 0xffff8000, v194
    v_mfma_f32_16x16x32_bf16 v[84:87], a[228:231], v[16:19], v[84:87]
    s_add_u32 s4, s4, s57
    buffer_load_dwordx4 v211, s[24:27], s93 offen offset:3072 lds
    v_fma_f32 v72, v72, v213, v246
    v_mfma_f32_16x16x32_bf16 v[84:87], a[224:227], v[4:7], v[84:87]
    v_fma_f32 v73, v73, v213, v220
    v_lshlrev_b32 v247, 16, v221
    v_mfma_f32_16x16x32_bf16 v[92:95], a[224:227], v[8:11], 0
    v_add_u32 v195, 0xffff8000, v195
    v_and_b32 v221, 0xffff0000, v221
    v_mfma_f32_16x16x32_bf16 v[92:95], a[228:231], v[20:23], v[92:95]
    v_fma_f32 v74, v74, v213, v247
    v_fma_f32 v75, v75, v213, v221
    v_mfma_f32_16x16x32_bf16 v[92:95], a[232:235], v[56:59], v[92:95]
    v_cvt_pk_bf16_f32 v72, v72, v73
    v_cvt_pk_bf16_f32 v73, v74, v75
    v_mfma_f32_16x16x32_bf16 v[92:95], a[236:239], v[68:71], v[92:95]
    s_waitcnt lgkmcnt(3)
    s_waitcnt lgkmcnt(0)
    s_barrier
    ds_read_b64_tr_b16 a[192:193], v194 offset:0
    s_waitcnt vmcnt(9)
    v_lshlrev_b32 v246, 16, v224
    v_mfma_f32_16x16x32_bf16 v[92:95], a[240:243], v[104:107], v[92:95]
    s_mul_i32 s35, s55, 128
    v_and_b32 v224, 0xffff0000, v224
    v_fma_f32 v80, v80, v214, v246
    v_mfma_f32_16x16x32_bf16 v[92:95], a[244:247], v[116:119], v[92:95]
    ds_read_b64_tr_b16 a[194:195], v194 offset:1024
    v_fma_f32 v81, v81, v214, v224
    v_mfma_f32_16x16x32_bf16 v[92:95], a[248:251], v[152:155], v[92:95]
    ds_read_b64_tr_b16 a[196:197], v194 offset:2048
    v_lshlrev_b32 v247, 16, v225
    v_mfma_f32_16x16x32_bf16 v[92:95], a[252:255], v[164:167], v[92:95]
    v_and_b32 v225, 0xffff0000, v225
    v_fma_f32 v82, v82, v214, v247
    v_mfma_f32_16x16x32_bf16 v[84:87], a[252:255], v[160:163], v[84:87]
    ds_read_b64_tr_b16 a[198:199], v194 offset:3072
    v_fma_f32 v83, v83, v214, v225
    v_mfma_f32_16x16x32_bf16 v[84:87], a[248:251], v[148:151], v[84:87]
    s_add_u32 s35, s35, 0
    ds_read_b64_tr_b16 a[200:201], v194 offset:4096
    v_cvt_pk_bf16_f32 v80, v80, v81
    v_mfma_f32_16x16x32_bf16 v[84:87], a[244:247], v[112:115], v[84:87]
    s_mul_i32 s78, s53, 24576
    v_cvt_pk_bf16_f32 v81, v82, v83
    v_mfma_f32_16x16x32_bf16 v[84:87], a[240:243], v[100:103], v[84:87]
    s_add_u32 s78, s78, 12288
    ds_read_b64_tr_b16 a[202:203], v194 offset:5120
    s_waitcnt vmcnt(8)
    v_lshlrev_b32 v246, 16, v228
    v_mfma_f32_16x16x32_bf16 v[76:79], a[240:243], v[96:99], v[76:79]
    s_add_u32 s78, s78, s56
    ds_read_b64_tr_b16 a[204:205], v194 offset:6144
    v_and_b32 v228, 0xffff0000, v228
    v_mfma_f32_16x16x32_bf16 v[76:79], a[244:247], v[108:111], v[76:79]
    s_add_u32 s36, s35, 13312
    ds_read_b64_tr_b16 a[206:207], v194 offset:7168
    s_waitcnt vmcnt(1)
    v_readfirstlane_b32 s79, v244
    s_nop 0
    s_cmp_lt_u32 s79, 2
    s_cbranch_scc1 L_fs4
L_fb4:
    v_fma_f32 v88, v88, v215, v246
    v_mfma_f32_16x16x32_bf16 v[76:79], a[248:251], v[144:147], v[76:79]
    buffer_load_dwordx4 v[232:235], v212, s[68:71], s78 offen offset:0 sc1
    v_fma_f32 v89, v89, v215, v228
    v_mfma_f32_16x16x32_bf16 v[76:79], a[252:255], v[156:159], v[76:79]
    s_waitcnt lgkmcnt(6)
    ds_read_b64_tr_b16 a[208:209], v194 offset:8192
    v_lshlrev_b32 v247, 16, v229
    v_mfma_f32_16x16x32_bf16 v[120:123], a[192:195], v[0:3], 0
    s_waitcnt lgkmcnt(5)
    buffer_load_dwordx4 v[236:239], v212, s[68:71], s78 offen offset:1024 sc1
    v_and_b32 v229, 0xffff0000, v229
    v_mfma_f32_16x16x32_bf16 v[120:123], a[196:199], v[12:15], v[120:123]
    s_waitcnt lgkmcnt(3)
    ds_read_b64_tr_b16 a[210:211], v194 offset:9216
    v_mov_b32 v245, 3
    v_mfma_f32_16x16x32_bf16 v[120:123], a[200:203], v[48:51], v[120:123]
    s_waitcnt lgkmcnt(2)
    buffer_load_dwordx4 v[240:243], v212, s[68:71], s78 offen offset:2048 sc1
    v_fma_f32 v90, v90, v215, v247
    v_mfma_f32_16x16x32_bf16 v[120:123], a[204:207], v[60:63], v[120:123]
    s_mul_i32 s92, s55, 128
    ds_read_b64_tr_b16 a[212:213], v194 offset:10240
    v_fma_f32 v91, v91, v215, v229
    v_mfma_f32_16x16x32_bf16 v[128:131], a[204:207], v[64:67], 0
    ds_read_b64_tr_b16 a[214:215], v194 offset:11264
    v_cvt_pk_bf16_f32 v88, v88, v89
    v_mfma_f32_16x16x32_bf16 v[128:131], a[200:203], v[52:55], v[128:131]
    s_add_u32 s92, s92, 64
    ds_read_b64_tr_b16 a[216:217], v194 offset:12288
    v_cvt_pk_bf16_f32 v89, v90, v91
    v_mfma_f32_16x16x32_bf16 v[128:131], a[196:199], v[16:19], v[128:131]
    buffer_store_dword v245, v208, s[72:75], s28 offen sc1
    v_lshlrev_b32 v246, 16, v222
    v_mfma_f32_16x16x32_bf16 v[128:131], a[192:195], v[4:7], v[128:131]
    ds_read_b64_tr_b16 a[218:219], v194 offset:13312
    v_and_b32 v222, 0xffff0000, v222
    v_mfma_f32_16x16x32_bf16 v[136:139], a[192:195], v[8:11], 0
    ds_read_b64_tr_b16 a[220:221], v194 offset:14336
    v_fma_f32 v76, v76, v213, v246
    v_fma_f32 v77, v77, v213, v222
    v_mfma_f32_16x16x32_bf16 v[136:139], a[196:199], v[20:23], v[136:139]
    s_add_u32 s93, s92, 13312
    ds_read_b64_tr_b16 a[222:223], v194 offset:15360
    v_lshlrev_b32 v247, 16, v223
    v_mfma_f32_16x16x32_bf16 v[136:139], a[200:203], v[56:59], v[136:139]
    ds_read_b64_tr_b16 a[224:225], v195 offset:0
    v_and_b32 v223, 0xffff0000, v223
    v_mfma_f32_16x16x32_bf16 v[136:139], a[204:207], v[68:71], v[136:139]
    s_waitcnt lgkmcnt(7)
    ds_read_b64_tr_b16 a[226:227], v195 offset:1024
    v_fma_f32 v78, v78, v213, v247
    v_fma_f32 v79, v79, v213, v223
    v_mfma_f32_16x16x32_bf16 v[136:139], a[208:211], v[104:107], v[136:139]
    s_waitcnt lgkmcnt(6)
    v_cvt_pk_bf16_f32 v74, v76, v77
    v_cvt_pk_bf16_f32 v75, v78, v79
    v_mfma_f32_16x16x32_bf16 v[136:139], a[212:215], v[116:119], v[136:139]
    s_waitcnt lgkmcnt(4)
    buffer_store_dwordx4 v[72:75], v212, s[68:71], s4 offen offset:0 sc1
    v_lshlrev_b32 v246, 16, v226
    v_mfma_f32_16x16x32_bf16 v[136:139], a[216:219], v[152:155], v[136:139]
    s_waitcnt lgkmcnt(2)
    ds_read_b64_tr_b16 a[228:229], v195 offset:2048
    v_and_b32 v226, 0xffff0000, v226
    v_mfma_f32_16x16x32_bf16 v[136:139], a[220:223], v[164:167], v[136:139]
    s_add_u32 m0, s32, 147456
    ds_read_b64_tr_b16 a[230:231], v195 offset:3072
    v_fma_f32 v84, v84, v214, v246
    v_mfma_f32_16x16x32_bf16 v[128:131], a[220:223], v[160:163], v[128:131]
    ds_read_b64_tr_b16 a[232:233], v195 offset:4096
    v_fma_f32 v85, v85, v214, v226
    v_mfma_f32_16x16x32_bf16 v[128:131], a[216:219], v[148:151], v[128:131]
    ds_read_b64_tr_b16 a[234:235], v195 offset:5120
    v_lshlrev_b32 v247, 16, v227
    v_mfma_f32_16x16x32_bf16 v[128:131], a[212:215], v[112:115], v[128:131]
    ds_read_b64_tr_b16 a[236:237], v195 offset:6144
    v_and_b32 v227, 0xffff0000, v227
    v_mfma_f32_16x16x32_bf16 v[128:131], a[208:211], v[100:103], v[128:131]
    buffer_load_dwordx4 v210, s[24:27], s35 offen offset:0 lds
    v_fma_f32 v86, v86, v214, v247
    v_fma_f32 v87, v87, v214, v227
    v_mfma_f32_16x16x32_bf16 v[120:123], a[208:211], v[96:99], v[120:123]
    ds_read_b64_tr_b16 a[238:239], v195 offset:7168
    v_cvt_pk_bf16_f32 v82, v84, v85
    v_mfma_f32_16x16x32_bf16 v[120:123], a[212:215], v[108:111], v[120:123]
    s_add_u32 m0, s32, 0
    ds_read_b64_tr_b16 a[240:241], v195 offset:8192
    v_cvt_pk_bf16_f32 v83, v86, v87
    v_mfma_f32_16x16x32_bf16 v[120:123], a[216:219], v[144:147], v[120:123]
    buffer_store_dwordx4 v[80:83], v212, s[68:71], s4 offen offset:1024 sc1
    v_lshlrev_b32 v246, 16, v230
    v_and_b32 v230, 0xffff0000, v230
    v_mfma_f32_16x16x32_bf16 v[120:123], a[220:223], v[156:159], v[120:123]
    s_waitcnt lgkmcnt(7)
    ds_read_b64_tr_b16 a[242:243], v195 offset:9216
    v_fma_f32 v92, v92, v215, v246
    v_mfma_f32_16x16x32_bf16 v[124:127], a[224:227], v[0:3], 0
    s_waitcnt lgkmcnt(6)
    ds_read_b64_tr_b16 a[244:245], v195 offset:10240
    v_fma_f32 v93, v93, v215, v230
    v_mfma_f32_16x16x32_bf16 v[124:127], a[228:231], v[12:15], v[124:127]
    s_waitcnt lgkmcnt(5)
    ds_read_b64_tr_b16 a[246:247], v195 offset:11264
    v_lshlrev_b32 v247, 16, v231
    v_mfma_f32_16x16x32_bf16 v[124:127], a[232:235], v[48:51], v[124:127]
    s_waitcnt lgkmcnt(4)
    buffer_load_dwordx4 v210, s[24:27], s92 offen offset:0 lds
    v_and_b32 v231, 0xffff0000, v231
    v_fma_f32 v94, v94, v215, v247
    v_mfma_f32_16x16x32_bf16 v[124:127], a[236:239], v[60:63], v[124:127]
    buffer_load_dword v244, off, s[72:75], s60 sc1
    v_fma_f32 v95, v95, v215, v231
    v_mfma_f32_16x16x32_bf16 v[132:135], a[236:239], v[64:67], 0
    ds_read_b64_tr_b16 a[248:249], v195 offset:12288
    v_cvt_pk_bf16_f32 v90, v92, v93
    v_mfma_f32_16x16x32_bf16 v[132:135], a[232:235], v[52:55], v[132:135]
    s_add_u32 m0, s32, 147456
    ds_read_b64_tr_b16 a[250:251], v195 offset:13312
    v_cvt_pk_bf16_f32 v91, v94, v95
    v_mfma_f32_16x16x32_bf16 v[132:135], a[228:231], v[16:19], v[132:135]
    s_waitcnt vmcnt(8)
    buffer_store_dwordx4 v[88:91], v212, s[68:71], s4 offen offset:2048 sc1
    s_nop 1
    s_mul_i32 s4, s53, 24576
    v_lshlrev_b32 v246, 16, v232
    v_mfma_f32_16x16x32_bf16 v[132:135], a[224:227], v[4:7], v[132:135]
    s_add_u32 s4, s4, 12288
    ds_read_b64_tr_b16 a[252:253], v195 offset:14336
    v_and_b32 v232, 0xffff0000, v232
    v_mfma_f32_16x16x32_bf16 v[140:143], a[224:227], v[8:11], 0
    s_add_u32 s4, s4, s57
    ds_read_b64_tr_b16 a[254:255], v195 offset:15360
    v_fma_f32 v120, v120, v213, v246
    v_mfma_f32_16x16x32_bf16 v[140:143], a[228:231], v[20:23], v[140:143]
    ds_read_b64_tr_b16 a[192:193], v194 offset:16384
    v_fma_f32 v121, v121, v213, v232
    v_mfma_f32_16x16x32_bf16 v[140:143], a[232:235], v[56:59], v[140:143]
    ds_read_b64_tr_b16 a[194:195], v194 offset:17408
    v_lshlrev_b32 v247, 16, v233
    v_and_b32 v233, 0xffff0000, v233
    v_mfma_f32_16x16x32_bf16 v[140:143], a[236:239], v[68:71], v[140:143]
    s_waitcnt lgkmcnt(6)
    ds_read_b64_tr_b16 a[196:197], v194 offset:18432
    v_fma_f32 v122, v122, v213, v247
    v_mfma_f32_16x16x32_bf16 v[140:143], a[240:243], v[104:107], v[140:143]
    buffer_load_dwordx4 v211, s[24:27], s35 offen offset:2048 lds
    v_fma_f32 v123, v123, v213, v233
    v_mfma_f32_16x16x32_bf16 v[140:143], a[244:247], v[116:119], v[140:143]
    s_waitcnt lgkmcnt(5)
    ds_read_b64_tr_b16 a[198:199], v194 offset:19456
    v_cvt_pk_bf16_f32 v120, v120, v121
    v_mfma_f32_16x16x32_bf16 v[140:143], a[248:251], v[152:155], v[140:143]
    s_waitcnt lgkmcnt(4)
    ds_read_b64_tr_b16 a[200:201], v194 offset:20480
    v_cvt_pk_bf16_f32 v121, v122, v123
    v_mfma_f32_16x16x32_bf16 v[140:143], a[252:255], v[164:167], v[140:143]
    s_waitcnt vmcnt(9)
    s_add_u32 m0, s32, 0
    v_lshlrev_b32 v246, 16, v236
    v_and_b32 v236, 0xffff0000, v236
    v_mfma_f32_16x16x32_bf16 v[132:135], a[252:255], v[160:163], v[132:135]
    ds_read_b64_tr_b16 a[202:203], v194 offset:21504
    v_fma_f32 v128, v128, v214, v246
    v_mfma_f32_16x16x32_bf16 v[132:135], a[248:251], v[148:151], v[132:135]
    s_mul_i32 s78, s53, 12288
    ds_read_b64_tr_b16 a[204:205], v194 offset:22528
    v_mov_b32 v245, 4
    v_fma_f32 v129, v129, v214, v236
    v_mfma_f32_16x16x32_bf16 v[132:135], a[244:247], v[112:115], v[132:135]
    s_add_u32 s78, s78, 98304
    ds_read_b64_tr_b16 a[206:207], v194 offset:23552
    v_lshlrev_b32 v247, 16, v237
    v_and_b32 v237, 0xffff0000, v237
    v_mfma_f32_16x16x32_bf16 v[132:135], a[240:243], v[100:103], v[132:135]
    s_add_u32 s78, s78, s56
    buffer_load_dwordx4 v211, s[24:27], s92 offen offset:2048 lds
    v_fma_f32 v130, v130, v214, v247
    v_mfma_f32_16x16x32_bf16 v[124:127], a[240:243], v[96:99], v[124:127]
    ds_read_b64_tr_b16 a[208:209], v194 offset:24576
    v_fma_f32 v131, v131, v214, v237
    v_mfma_f32_16x16x32_bf16 v[124:127], a[244:247], v[108:111], v[124:127]
    s_add_u32 m0, s32, 147456
    ds_read_b64_tr_b16 a[210:211], v194 offset:25600
    s_waitcnt vmcnt(3)
    v_readfirstlane_b32 s79, v244
    s_nop 0
    s_cmp_lt_u32 s79, 3
    s_cbranch_scc1 L_fs5
L_fb5:
    v_cvt_pk_bf16_f32 v128, v128, v129
    v_cvt_pk_bf16_f32 v129, v130, v131
    v_mfma_f32_16x16x32_bf16 v[124:127], a[248:251], v[144:147], v[124:127]
    s_waitcnt vmcnt(2)
    buffer_store_dword v245, v208, s[72:75], s28 offen sc1
    v_lshlrev_b32 v246, 16, v240
    v_mfma_f32_16x16x32_bf16 v[124:127], a[252:255], v[156:159], v[124:127]
    s_waitcnt lgkmcnt(6)
    buffer_load_dwordx4 v[196:199], v212, s[68:71], s78 offen offset:0 sc1
    v_and_b32 v240, 0xffff0000, v240
    v_mfma_f32_16x16x32_bf16 v[168:171], a[192:195], v[0:3], 0
    buffer_load_dwordx4 v[200:203], v212, s[68:71], s78 offen offset:1024 sc1
    v_fma_f32 v136, v136, v215, v246
    v_mfma_f32_16x16x32_bf16 v[168:171], a[196:199], v[12:15], v[168:171]
    s_waitcnt lgkmcnt(4)
    ds_read_b64_tr_b16 a[212:213], v194 offset:26624
    v_fma_f32 v137, v137, v215, v240
    v_lshlrev_b32 v247, 16, v241
    v_mfma_f32_16x16x32_bf16 v[168:171], a[200:203], v[48:51], v[168:171]
    s_waitcnt lgkmcnt(3)
    buffer_load_dwordx4 v[204:207], v212, s[68:71], s78 offen offset:2048 sc1
    v_and_b32 v241, 0xffff0000, v241
    v_mfma_f32_16x16x32_bf16 v[168:171], a[204:207], v[60:63], v[168:171]
    ds_read_b64_tr_b16 a[214:215], v194 offset:27648
    v_fma_f32 v138, v138, v215, v247
    v_mfma_f32_16x16x32_bf16 v[176:179], a[204:207], v[64:67], 0
    ds_read_b64_tr_b16 a[216:217], v194 offset:28672
    buffer_load_dwordx4 v210, s[24:27], s36 offen offset:1024 lds
    v_fma_f32 v139, v139, v215, v241
    v_mfma_f32_16x16x32_bf16 v[176:179], a[200:203], v[52:55], v[176:179]
    s_add_u32 m0, s32, 0
    ds_read_b64_tr_b16 a[218:219], v194 offset:29696
    v_cvt_pk_bf16_f32 v136, v136, v137
    v_cvt_pk_bf16_f32 v137, v138, v139
    v_mfma_f32_16x16x32_bf16 v[176:179], a[196:199], v[16:19], v[176:179]
    ds_read_b64_tr_b16 a[220:221], v194 offset:30720
    v_lshlrev_b32 v246, 16, v234
    v_mfma_f32_16x16x32_bf16 v[176:179], a[192:195], v[4:7], v[176:179]
    ds_read_b64_tr_b16 a[222:223], v194 offset:31744
    v_and_b32 v234, 0xffff0000, v234
    v_mfma_f32_16x16x32_bf16 v[184:187], a[192:195], v[8:11], 0
    ds_read_b64_tr_b16 a[224:225], v195 offset:16384
    v_fma_f32 v124, v124, v213, v246
    v_fma_f32 v125, v125, v213, v234
    v_mfma_f32_16x16x32_bf16 v[184:187], a[196:199], v[20:23], v[184:187]
    ds_read_b64_tr_b16 a[226:227], v195 offset:17408
    v_lshlrev_b32 v247, 16, v235
    v_mfma_f32_16x16x32_bf16 v[184:187], a[200:203], v[56:59], v[184:187]
    ds_read_b64_tr_b16 a[228:229], v195 offset:18432
    v_and_b32 v235, 0xffff0000, v235
    v_mfma_f32_16x16x32_bf16 v[184:187], a[204:207], v[68:71], v[184:187]
    s_waitcnt lgkmcnt(8)
    ds_read_b64_tr_b16 a[230:231], v195 offset:19456
    v_fma_f32 v126, v126, v213, v247
    v_fma_f32 v127, v127, v213, v235
    v_mfma_f32_16x16x32_bf16 v[184:187], a[208:211], v[104:107], v[184:187]
    s_waitcnt lgkmcnt(8)
    buffer_load_dwordx4 v210, s[24:27], s93 offen offset:1024 lds
    v_cvt_pk_bf16_f32 v122, v124, v125
    v_mfma_f32_16x16x32_bf16 v[184:187], a[212:215], v[116:119], v[184:187]
    s_waitcnt lgkmcnt(6)
    ds_read_b64_tr_b16 a[232:233], v195 offset:20480
    v_cvt_pk_bf16_f32 v123, v126, v127
    v_mfma_f32_16x16x32_bf16 v[184:187], a[216:219], v[152:155], v[184:187]
    s_waitcnt lgkmcnt(5)
    buffer_store_dwordx4 v[120:123], v212, s[68:71], s4 offen offset:0 sc1
    v_lshlrev_b32 v246, 16, v238
    v_mfma_f32_16x16x32_bf16 v[184:187], a[220:223], v[164:167], v[184:187]
    s_add_u32 m0, s32, 147456
    ds_read_b64_tr_b16 a[234:235], v195 offset:21504
    v_and_b32 v238, 0xffff0000, v238
    v_fma_f32 v132, v132, v214, v246
    v_mfma_f32_16x16x32_bf16 v[176:179], a[220:223], v[160:163], v[176:179]
    ds_read_b64_tr_b16 a[236:237], v195 offset:22528
    v_fma_f32 v133, v133, v214, v238
    v_mfma_f32_16x16x32_bf16 v[176:179], a[216:219], v[148:151], v[176:179]
    ds_read_b64_tr_b16 a[238:239], v195 offset:23552
    v_lshlrev_b32 v247, 16, v239
    v_mfma_f32_16x16x32_bf16 v[176:179], a[212:215], v[112:115], v[176:179]
    ds_read_b64_tr_b16 a[240:241], v195 offset:24576
    v_and_b32 v239, 0xffff0000, v239
    v_mfma_f32_16x16x32_bf16 v[176:179], a[208:211], v[100:103], v[176:179]
    buffer_load_dwordx4 v211, s[24:27], s36 offen offset:3072 lds
    v_fma_f32 v134, v134, v214, v247
    v_fma_f32 v135, v135, v214, v239
    v_mfma_f32_16x16x32_bf16 v[168:171], a[208:211], v[96:99], v[168:171]
    ds_read_b64_tr_b16 a[242:243], v195 offset:25600
    v_cvt_pk_bf16_f32 v130, v132, v133
    v_mfma_f32_16x16x32_bf16 v[168:171], a[212:215], v[108:111], v[168:171]
    s_add_u32 m0, s32, 0
    ds_read_b64_tr_b16 a[244:245], v195 offset:26624
    v_cvt_pk_bf16_f32 v131, v134, v135
    v_mfma_f32_16x16x32_bf16 v[168:171], a[216:219], v[144:147], v[168:171]
    buffer_store_dwordx4 v[128:131], v212, s[68:71], s4 offen offset:1024 sc1
    v_lshlrev_b32 v246, 16, v242
    v_and_b32 v242, 0xffff0000, v242
    v_mfma_f32_16x16x32_bf16 v[168:171], a[220:223], v[156:159], v[168:171]
    s_waitcnt lgkmcnt(6)
    ds_read_b64_tr_b16 a[246:247], v195 offset:27648
    v_fma_f32 v140, v140, v215, v246
    v_mfma_f32_16x16x32_bf16 v[172:175], a[224:227], v[0:3], 0
    ds_read_b64_tr_b16 a[248:249], v195 offset:28672
    v_fma_f32 v141, v141, v215, v242
    v_mfma_f32_16x16x32_bf16 v[172:175], a[228:231], v[12:15], v[172:175]
    s_waitcnt lgkmcnt(7)
    ds_read_b64_tr_b16 a[250:251], v195 offset:29696
    v_lshlrev_b32 v247, 16, v243
    v_mfma_f32_16x16x32_bf16 v[172:175], a[232:235], v[48:51], v[172:175]
    s_waitcnt lgkmcnt(6)
    buffer_load_dwordx4 v211, s[24:27], s93 offen offset:3072 lds
    v_and_b32 v243, 0xffff0000, v243
    v_fma_f32 v142, v142, v215, v247
    v_mfma_f32_16x16x32_bf16 v[172:175], a[236:239], v[60:63], v[172:175]
    buffer_load_dword v244, off, s[72:75], s61 sc1
    v_fma_f32 v143, v143, v215, v243
    v_mfma_f32_16x16x32_bf16 v[180:183], a[236:239], v[64:67], 0
    ds_read_b64_tr_b16 a[252:253], v195 offset:30720
    v_cvt_pk_bf16_f32 v138, v140, v141
    v_mfma_f32_16x16x32_bf16 v[180:183], a[232:235], v[52:55], v[180:183]
    ds_read_b64_tr_b16 a[254:255], v195 offset:31744
    v_add_u32 v194, 0x10000, v194
    v_cvt_pk_bf16_f32 v139, v142, v143
    v_mfma_f32_16x16x32_bf16 v[180:183], a[228:231], v[16:19], v[180:183]
    s_waitcnt vmcnt(9)
    buffer_store_dwordx4 v[136:139], v212, s[68:71], s4 offen offset:2048 sc1
    s_nop 1
    s_mul_i32 s4, s53, 12288
    v_lshlrev_b32 v246, 16, v196
    v_mfma_f32_16x16x32_bf16 v[180:183], a[224:227], v[4:7], v[180:183]
    s_add_u32 s4, s4, 98304
    v_and_b32 v196, 0xffff0000, v196
    v_fma_f32 v168, v168, v213, v246
    v_mfma_f32_16x16x32_bf16 v[188:191], a[224:227], v[8:11], 0
    s_add_u32 s4, s4, s57
    v_add_u32 v195, 0x10000, v195
    v_fma_f32 v169, v169, v213, v196
    v_mfma_f32_16x16x32_bf16 v[188:191], a[228:231], v[20:23], v[188:191]
    v_lshlrev_b32 v247, 16, v197
    v_and_b32 v197, 0xffff0000, v197
    v_mfma_f32_16x16x32_bf16 v[188:191], a[232:235], v[56:59], v[188:191]
    v_fma_f32 v170, v170, v213, v247
    v_fma_f32 v171, v171, v213, v197
    v_mfma_f32_16x16x32_bf16 v[188:191], a[236:239], v[68:71], v[188:191]
    s_waitcnt lgkmcnt(2)
    s_waitcnt lgkmcnt(0)
    s_barrier
    ds_read_b64_tr_b16 a[192:193], v194 offset:0
    v_cvt_pk_bf16_f32 v168, v168, v169
    v_mfma_f32_16x16x32_bf16 v[188:191], a[240:243], v[104:107], v[188:191]
    buffer_store_dword v216, v209, s[72:75], s30 offen sc1
    v_cvt_pk_bf16_f32 v169, v170, v171
    v_mfma_f32_16x16x32_bf16 v[188:191], a[244:247], v[116:119], v[188:191]
    s_waitcnt vmcnt(10)
    ds_read_b64_tr_b16 a[194:195], v194 offset:1024
    v_lshlrev_b32 v246, 16, v200
    v_mfma_f32_16x16x32_bf16 v[188:191], a[248:251], v[152:155], v[188:191]
    ds_read_b64_tr_b16 a[196:197], v194 offset:2048
    v_and_b32 v200, 0xffff0000, v200
    v_mfma_f32_16x16x32_bf16 v[188:191], a[252:255], v[164:167], v[188:191]
    v_fma_f32 v176, v176, v214, v246
    v_fma_f32 v177, v177, v214, v200
    v_mfma_f32_16x16x32_bf16 v[180:183], a[252:255], v[160:163], v[180:183]
    ds_read_b64_tr_b16 a[198:199], v194 offset:3072
    v_lshlrev_b32 v247, 16, v201
    v_mfma_f32_16x16x32_bf16 v[180:183], a[248:251], v[148:151], v[180:183]
    s_mul_i32 s78, s54, 24576
    ds_read_b64_tr_b16 a[200:201], v194 offset:4096
    v_mov_b32 v245, 5
    v_mfma_f32_16x16x32_bf16 v[180:183], a[244:247], v[112:115], v[180:183]
    s_add_u32 s78, s78, 0
    v_and_b32 v201, 0xffff0000, v201
    v_fma_f32 v178, v178, v214, v247
    v_mfma_f32_16x16x32_bf16 v[180:183], a[240:243], v[100:103], v[180:183]
    s_add_u32 s78, s78, s57
    ds_read_b64_tr_b16 a[202:203], v194 offset:5120
    v_fma_f32 v179, v179, v214, v201
    v_mfma_f32_16x16x32_bf16 v[172:175], a[240:243], v[96:99], v[172:175]
    ds_read_b64_tr_b16 a[204:205], v194 offset:6144
    v_cvt_pk_bf16_f32 v176, v176, v177
    v_mfma_f32_16x16x32_bf16 v[172:175], a[244:247], v[108:111], v[172:175]
    s_waitcnt vmcnt(2)
    v_readfirstlane_b32 s79, v244
    s_nop 0
    s_cmp_lt_u32 s79, 4
    s_cbranch_scc1 L_fs6
L_fb6:
    ds_read_b64_tr_b16 a[206:207], v194 offset:7168
    v_cvt_pk_bf16_f32 v177, v178, v179
    v_mfma_f32_16x16x32_bf16 v[172:175], a[248:251], v[144:147], v[172:175]
    s_waitcnt vmcnt(1)
    buffer_store_dword v245, v208, s[72:75], s28 offen sc1
    v_lshlrev_b32 v246, 16, v204
    v_mfma_f32_16x16x32_bf16 v[172:175], a[252:255], v[156:159], v[172:175]
    s_waitcnt lgkmcnt(6)
    buffer_load_dwordx4 v[220:223], v212, s[68:71], s78 offen offset:0 sc1
    v_and_b32 v204, 0xffff0000, v204
    v_mfma_f32_16x16x32_bf16 v[24:27], a[192:195], v[0:3], 0
    s_waitcnt lgkmcnt(4)
    buffer_load_dwordx4 v[224:227], v212, s[68:71], s78 offen offset:1024 sc1
    v_fma_f32 v184, v184, v215, v246
    v_mfma_f32_16x16x32_bf16 v[24:27], a[196:199], v[12:15], v[24:27]
    s_waitcnt lgkmcnt(2)
    ds_read_b64_tr_b16 a[208:209], v194 offset:8192
    v_fma_f32 v185, v185, v215, v204
    v_lshlrev_b32 v247, 16, v205
    v_mfma_f32_16x16x32_bf16 v[24:27], a[200:203], v[48:51], v[24:27]
    s_waitcnt lgkmcnt(1)
    buffer_load_dwordx4 v[228:231], v212, s[68:71], s78 offen offset:2048 sc1
    v_and_b32 v205, 0xffff0000, v205
    v_mfma_f32_16x16x32_bf16 v[24:27], a[204:207], v[60:63], v[24:27]
    ds_read_b64_tr_b16 a[210:211], v194 offset:9216
    v_fma_f32 v186, v186, v215, v247
    v_mfma_f32_16x16x32_bf16 v[32:35], a[204:207], v[64:67], 0
    ds_read_b64_tr_b16 a[212:213], v194 offset:10240
    v_fma_f32 v187, v187, v215, v205
    v_cvt_pk_bf16_f32 v184, v184, v185
    v_mfma_f32_16x16x32_bf16 v[32:35], a[200:203], v[52:55], v[32:35]
    ds_read_b64_tr_b16 a[214:215], v194 offset:11264
    v_cvt_pk_bf16_f32 v185, v186, v187
    v_mfma_f32_16x16x32_bf16 v[32:35], a[196:199], v[16:19], v[32:35]
    ds_read_b64_tr_b16 a[216:217], v194 offset:12288
    v_lshlrev_b32 v246, 16, v198
    v_mfma_f32_16x16x32_bf16 v[32:35], a[192:195], v[4:7], v[32:35]
    ds_read_b64_tr_b16 a[218:219], v194 offset:13312
    v_and_b32 v198, 0xffff0000, v198
    v_mfma_f32_16x16x32_bf16 v[40:43], a[192:195], v[8:11], 0
    ds_read_b64_tr_b16 a[220:221], v194 offset:14336
    v_fma_f32 v172, v172, v213, v246
    v_fma_f32 v173, v173, v213, v198
    v_mfma_f32_16x16x32_bf16 v[40:43], a[196:199], v[20:23], v[40:43]
    ds_read_b64_tr_b16 a[222:223], v194 offset:15360
    v_lshlrev_b32 v247, 16, v199
    v_mfma_f32_16x16x32_bf16 v[40:43], a[200:203], v[56:59], v[40:43]
    ds_read_b64_tr_b16 a[224:225], v195 offset:0
    v_and_b32 v199, 0xffff0000, v199
    v_mfma_f32_16x16x32_bf16 v[40:43], a[204:207], v[68:71], v[40:43]
    s_waitcnt lgkmcnt(7)
    ds_read_b64_tr_b16 a[226:227], v195 offset:1024
    v_fma_f32 v174, v174, v213, v247
    v_fma_f32 v175, v175, v213, v199
    v_mfma_f32_16x16x32_bf16 v[40:43], a[208:211], v[104:107], v[40:43]
    s_waitcnt lgkmcnt(6)
    v_cvt_pk_bf16_f32 v170, v172, v173
    v_cvt_pk_bf16_f32 v171, v174, v175
    v_mfma_f32_16x16x32_bf16 v[40:43], a[212:215], v[116:119], v[40:43]
    s_waitcnt lgkmcnt(4)
    buffer_store_dwordx4 v[168:171], v212, s[68:71], s4 offen offset:0 sc1
    v_lshlrev_b32 v246, 16, v202
    v_mfma_f32_16x16x32_bf16 v[40:43], a[216:219], v[152:155], v[40:43]
    s_waitcnt lgkmcnt(2)
    ds_read_b64_tr_b16 a[228:229], v195 offset:2048
    v_and_b32 v202, 0xffff0000, v202
    v_mfma_f32_16x16x32_bf16 v[40:43], a[220:223], v[164:167], v[40:43]
    ds_read_b64_tr_b16 a[230:231], v195 offset:3072
    v_fma_f32 v180, v180, v214, v246
    v_mfma_f32_16x16x32_bf16 v[32:35], a[220:223], v[160:163], v[32:35]
    ds_read_b64_tr_b16 a[232:233], v195 offset:4096
    v_fma_f32 v181, v181, v214, v202
    v_mfma_f32_16x16x32_bf16 v[32:35], a[216:219], v[148:151], v[32:35]
    ds_read_b64_tr_b16 a[234:235], v195 offset:5120
    v_lshlrev_b32 v247, 16, v203
    v_mfma_f32_16x16x32_bf16 v[32:35], a[212:215], v[112:115], v[32:35]
    ds_read_b64_tr_b16 a[236:237], v195 offset:6144
    v_and_b32 v203, 0xffff0000, v203
    v_mfma_f32_16x16x32_bf16 v[32:35], a[208:211], v[100:103], v[32:35]
    v_fma_f32 v182, v182, v214, v247
    v_fma_f32 v183, v183, v214, v203
    v_mfma_f32_16x16x32_bf16 v[24:27], a[208:211], v[96:99], v[24:27]
    ds_read_b64_tr_b16 a[238:239], v195 offset:7168
    v_cvt_pk_bf16_f32 v178, v180, v181
    v_mfma_f32_16x16x32_bf16 v[24:27], a[212:215], v[108:111], v[24:27]
    ds_read_b64_tr_b16 a[240:241], v195 offset:8192
    v_cvt_pk_bf16_f32 v179, v182, v183
    v_mfma_f32_16x16x32_bf16 v[24:27], a[216:219], v[144:147], v[24:27]
    buffer_store_dwordx4 v[176:179], v212, s[68:71], s4 offen offset:1024 sc1
    v_lshlrev_b32 v246, 16, v206
    v_and_b32 v206, 0xffff0000, v206
    v_mfma_f32_16x16x32_bf16 v[24:27], a[220:223], v[156:159], v[24:27]
    s_waitcnt lgkmcnt(7)
    ds_read_b64_tr_b16 a[242:243], v195 offset:9216
    v_fma_f32 v188, v188, v215, v246
    v_mfma_f32_16x16x32_bf16 v[28:31], a[224:227], v[0:3], 0
    s_waitcnt lgkmcnt(6)
    ds_read_b64_tr_b16 a[244:245], v195 offset:10240
    v_fma_f32 v189, v189, v215, v206
    v_mfma_f32_16x16x32_bf16 v[28:31], a[228:231], v[12:15], v[28:31]
    s_waitcnt lgkmcnt(5)
    ds_read_b64_tr_b16 a[246:247], v195 offset:11264
    v_lshlrev_b32 v247, 16, v207
    v_mfma_f32_16x16x32_bf16 v[28:31], a[232:235], v[48:51], v[28:31]
    s_waitcnt lgkmcnt(4)
    v_and_b32 v207, 0xffff0000, v207
    v_fma_f32 v190, v190, v215, v247
    v_mfma_f32_16x16x32_bf16 v[28:31], a[236:239], v[60:63], v[28:31]
    buffer_load_dword v244, off, s[72:75], s61 sc1
    v_fma_f32 v191, v191, v215, v207
    v_mfma_f32_16x16x32_bf16 v[36:39], a[236:239], v[64:67], 0
    ds_read_b64_tr_b16 a[248:249], v195 offset:12288
    v_cvt_pk_bf16_f32 v186, v188, v189
    v_mfma_f32_16x16x32_bf16 v[36:39], a[232:235], v[52:55], v[36:39]
    ds_read_b64_tr_b16 a[250:251], v195 offset:13312
    v_cvt_pk_bf16_f32 v187, v190, v191
    v_mfma_f32_16x16x32_bf16 v[36:39], a[228:231], v[16:19], v[36:39]
    s_waitcnt vmcnt(5)
    buffer_store_dwordx4 v[184:187], v212, s[68:71], s4 offen offset:2048 sc1
    s_nop 1
    s_mul_i32 s4, s54, 24576
    v_lshlrev_b32 v246, 16, v220
    v_mfma_f32_16x16x32_bf16 v[36:39], a[224:227], v[4:7], v[36:39]
    s_add_u32 s4, s4, 0
    ds_read_b64_tr_b16 a[252:253], v195 offset:14336
    v_and_b32 v220, 0xffff0000, v220
    v_mfma_f32_16x16x32_bf16 v[44:47], a[224:227], v[8:11], 0
    s_add_u32 s4, s4, s58
    ds_read_b64_tr_b16 a[254:255], v195 offset:15360
    v_fma_f32 v24, v24, v213, v246
    v_mfma_f32_16x16x32_bf16 v[44:47], a[228:231], v[20:23], v[44:47]
    ds_read_b64_tr_b16 a[192:193], v194 offset:16384
    v_fma_f32 v25, v25, v213, v220
    v_mfma_f32_16x16x32_bf16 v[44:47], a[232:235], v[56:59], v[44:47]
    ds_read_b64_tr_b16 a[194:195], v194 offset:17408
    v_lshlrev_b32 v247, 16, v221
    v_and_b32 v221, 0xffff0000, v221
    v_mfma_f32_16x16x32_bf16 v[44:47], a[236:239], v[68:71], v[44:47]
    s_waitcnt lgkmcnt(6)
    ds_read_b64_tr_b16 a[196:197], v194 offset:18432
    v_fma_f32 v26, v26, v213, v247
    v_mfma_f32_16x16x32_bf16 v[44:47], a[240:243], v[104:107], v[44:47]
    v_fma_f32 v27, v27, v213, v221
    v_cvt_pk_bf16_f32 v24, v24, v25
    v_mfma_f32_16x16x32_bf16 v[44:47], a[244:247], v[116:119], v[44:47]
    s_waitcnt lgkmcnt(5)
    ds_read_b64_tr_b16 a[198:199], v194 offset:19456
    v_cvt_pk_bf16_f32 v25, v26, v27
    v_mfma_f32_16x16x32_bf16 v[44:47], a[248:251], v[152:155], v[44:47]
    s_waitcnt lgkmcnt(4)
    ds_read_b64_tr_b16 a[200:201], v194 offset:20480
    v_mov_b32 v245, 6
    v_mfma_f32_16x16x32_bf16 v[44:47], a[252:255], v[164:167], v[44:47]
    s_waitcnt vmcnt(5)
    v_lshlrev_b32 v246, 16, v224
    v_and_b32 v224, 0xffff0000, v224
    v_mfma_f32_16x16x32_bf16 v[36:39], a[252:255], v[160:163], v[36:39]
    ds_read_b64_tr_b16 a[202:203], v194 offset:21504
    v_fma_f32 v32, v32, v214, v246
    v_mfma_f32_16x16x32_bf16 v[36:39], a[248:251], v[148:151], v[36:39]
    s_mul_i32 s78, s54, 24576
    ds_read_b64_tr_b16 a[204:205], v194 offset:22528
    v_fma_f32 v33, v33, v214, v224
    v_lshlrev_b32 v247, 16, v225
    v_mfma_f32_16x16x32_bf16 v[36:39], a[244:247], v[112:115], v[36:39]
    s_add_u32 s78, s78, 12288
    ds_read_b64_tr_b16 a[206:207], v194 offset:23552
    v_and_b32 v225, 0xffff0000, v225
    v_mfma_f32_16x16x32_bf16 v[36:39], a[240:243], v[100:103], v[36:39]
    s_add_u32 s78, s78, s57
    v_fma_f32 v34, v34, v214, v247
    v_fma_f32 v35, v35, v214, v225
    v_mfma_f32_16x16x32_bf16 v[28:31], a[240:243], v[96:99], v[28:31]
    ds_read_b64_tr_b16 a[208:209], v194 offset:24576
    v_cvt_pk_bf16_f32 v32, v32, v33
    v_mfma_f32_16x16x32_bf16 v[28:31], a[244:247], v[108:111], v[28:31]
    s_waitcnt vmcnt(1)
    v_readfirstlane_b32 s79, v244
    s_nop 0
    s_cmp_lt_u32 s79, 5
    s_cbranch_scc1 L_fs7
L_fb7:
    ds_read_b64_tr_b16 a[210:211], v194 offset:25600
    v_cvt_pk_bf16_f32 v33, v34, v35
    v_mfma_f32_16x16x32_bf16 v[28:31], a[248:251], v[144:147], v[28:31]
    s_waitcnt vmcnt(0)
    buffer_store_dword v245, v208, s[72:75], s28 offen sc1
    v_lshlrev_b32 v246, 16, v228
    v_mfma_f32_16x16x32_bf16 v[28:31], a[252:255], v[156:159], v[28:31]
    s_waitcnt lgkmcnt(6)
    buffer_load_dwordx4 v[232:235], v212, s[68:71], s78 offen offset:0 sc1
    v_and_b32 v228, 0xffff0000, v228
    v_mfma_f32_16x16x32_bf16 v[72:75], a[192:195], v[0:3], 0
    buffer_load_dwordx4 v[236:239], v212, s[68:71], s78 offen offset:1024 sc1
    v_fma_f32 v40, v40, v215, v246
    v_mfma_f32_16x16x32_bf16 v[72:75], a[196:199], v[12:15], v[72:75]
    s_waitcnt lgkmcnt(4)
    ds_read_b64_tr_b16 a[212:213], v194 offset:26624
    v_fma_f32 v41, v41, v215, v228
    v_lshlrev_b32 v247, 16, v229
    v_mfma_f32_16x16x32_bf16 v[72:75], a[200:203], v[48:51], v[72:75]
    s_waitcnt lgkmcnt(3)
    buffer_load_dwordx4 v[240:243], v212, s[68:71], s78 offen offset:2048 sc1
    v_and_b32 v229, 0xffff0000, v229
    v_mfma_f32_16x16x32_bf16 v[72:75], a[204:207], v[60:63], v[72:75]
    ds_read_b64_tr_b16 a[214:215], v194 offset:27648
    v_fma_f32 v42, v42, v215, v247
    v_mfma_f32_16x16x32_bf16 v[80:83], a[204:207], v[64:67], 0
    ds_read_b64_tr_b16 a[216:217], v194 offset:28672
    v_fma_f32 v43, v43, v215, v229
    v_cvt_pk_bf16_f32 v40, v40, v41
    v_mfma_f32_16x16x32_bf16 v[80:83], a[200:203], v[52:55], v[80:83]
    ds_read_b64_tr_b16 a[218:219], v194 offset:29696
    v_cvt_pk_bf16_f32 v41, v42, v43
    v_mfma_f32_16x16x32_bf16 v[80:83], a[196:199], v[16:19], v[80:83]
    ds_read_b64_tr_b16 a[220:221], v194 offset:30720
    v_lshlrev_b32 v246, 16, v222
    v_mfma_f32_16x16x32_bf16 v[80:83], a[192:195], v[4:7], v[80:83]
    ds_read_b64_tr_b16 a[222:223], v194 offset:31744
    v_and_b32 v222, 0xffff0000, v222
    v_mfma_f32_16x16x32_bf16 v[88:91], a[192:195], v[8:11], 0
    ds_read_b64_tr_b16 a[224:225], v195 offset:16384
    v_fma_f32 v28, v28, v213, v246
    v_fma_f32 v29, v29, v213, v222
    v_mfma_f32_16x16x32_bf16 v[88:91], a[196:199], v[20:23], v[88:91]
    ds_read_b64_tr_b16 a[226:227], v195 offset:17408
    v_lshlrev_b32 v247, 16, v223
    v_mfma_f32_16x16x32_bf16 v[88:91], a[200:203], v[56:59], v[88:91]
    ds_read_b64_tr_b16 a[228:229], v195 offset:18432
    v_and_b32 v223, 0xffff0000, v223
    v_mfma_f32_16x16x32_bf16 v[88:91], a[204:207], v[68:71], v[88:91]
    s_waitcnt lgkmcnt(8)
    ds_read_b64_tr_b16 a[230:231], v195 offset:19456
    v_fma_f32 v30, v30, v213, v247
    v_fma_f32 v31, v31, v213, v223
    v_mfma_f32_16x16x32_bf16 v[88:91], a[208:211], v[104:107], v[88:91]
    s_waitcnt lgkmcnt(8)
    v_cvt_pk_bf16_f32 v26, v28, v29
    v_cvt_pk_bf16_f32 v27, v30, v31
    v_mfma_f32_16x16x32_bf16 v[88:91], a[212:215], v[116:119], v[88:91]
    s_waitcnt lgkmcnt(6)
    buffer_store_dwordx4 v[24:27], v212, s[68:71], s4 offen offset:0 sc1
    v_lshlrev_b32 v246, 16, v226
    v_mfma_f32_16x16x32_bf16 v[88:91], a[216:219], v[152:155], v[88:91]
    s_waitcnt lgkmcnt(4)
    ds_read_b64_tr_b16 a[232:233], v195 offset:20480
    v_and_b32 v226, 0xffff0000, v226
    v_mfma_f32_16x16x32_bf16 v[88:91], a[220:223], v[164:167], v[88:91]
    ds_read_b64_tr_b16 a[234:235], v195 offset:21504
    v_fma_f32 v36, v36, v214, v246
    v_mfma_f32_16x16x32_bf16 v[80:83], a[220:223], v[160:163], v[80:83]
    ds_read_b64_tr_b16 a[236:237], v195 offset:22528
    v_fma_f32 v37, v37, v214, v226
    v_mfma_f32_16x16x32_bf16 v[80:83], a[216:219], v[148:151], v[80:83]
    ds_read_b64_tr_b16 a[238:239], v195 offset:23552
    v_lshlrev_b32 v247, 16, v227
    v_mfma_f32_16x16x32_bf16 v[80:83], a[212:215], v[112:115], v[80:83]
    ds_read_b64_tr_b16 a[240:241], v195 offset:24576
    v_and_b32 v227, 0xffff0000, v227
    v_mfma_f32_16x16x32_bf16 v[80:83], a[208:211], v[100:103], v[80:83]
    v_fma_f32 v38, v38, v214, v247
    v_fma_f32 v39, v39, v214, v227
    v_mfma_f32_16x16x32_bf16 v[72:75], a[208:211], v[96:99], v[72:75]
    ds_read_b64_tr_b16 a[242:243], v195 offset:25600
    v_cvt_pk_bf16_f32 v34, v36, v37
    v_mfma_f32_16x16x32_bf16 v[72:75], a[212:215], v[108:111], v[72:75]
    ds_read_b64_tr_b16 a[244:245], v195 offset:26624
    v_cvt_pk_bf16_f32 v35, v38, v39
    v_mfma_f32_16x16x32_bf16 v[72:75], a[216:219], v[144:147], v[72:75]
    buffer_store_dwordx4 v[32:35], v212, s[68:71], s4 offen offset:1024 sc1
    v_lshlrev_b32 v246, 16, v230
    v_and_b32 v230, 0xffff0000, v230
    v_mfma_f32_16x16x32_bf16 v[72:75], a[220:223], v[156:159], v[72:75]
    s_waitcnt lgkmcnt(7)
    ds_read_b64_tr_b16 a[246:247], v195 offset:27648
    v_fma_f32 v44, v44, v215, v246
    v_mfma_f32_16x16x32_bf16 v[76:79], a[224:227], v[0:3], 0
    ds_read_b64_tr_b16 a[248:249], v195 offset:28672
    v_fma_f32 v45, v45, v215, v230
    v_mfma_f32_16x16x32_bf16 v[76:79], a[228:231], v[12:15], v[76:79]
    s_waitcnt lgkmcnt(7)
    ds_read_b64_tr_b16 a[250:251], v195 offset:29696
    v_lshlrev_b32 v247, 16, v231
    v_mfma_f32_16x16x32_bf16 v[76:79], a[232:235], v[48:51], v[76:79]
    s_waitcnt lgkmcnt(6)
    v_and_b32 v231, 0xffff0000, v231
    v_fma_f32 v46, v46, v215, v247
    v_mfma_f32_16x16x32_bf16 v[76:79], a[236:239], v[60:63], v[76:79]
    buffer_load_dword v244, off, s[72:75], s61 sc1
    v_fma_f32 v47, v47, v215, v231
    v_mfma_f32_16x16x32_bf16 v[84:87], a[236:239], v[64:67], 0
    ds_read_b64_tr_b16 a[252:253], v195 offset:30720
    v_cvt_pk_bf16_f32 v42, v44, v45
    v_mfma_f32_16x16x32_bf16 v[84:87], a[232:235], v[52:55], v[84:87]
    ds_read_b64_tr_b16 a[254:255], v195 offset:31744
    v_add_u32 v194, 0x8000, v194
    v_cvt_pk_bf16_f32 v43, v46, v47
    v_mfma_f32_16x16x32_bf16 v[84:87], a[228:231], v[16:19], v[84:87]
    s_waitcnt vmcnt(5)
    buffer_store_dwordx4 v[40:43], v212, s[68:71], s4 offen offset:2048 sc1
    s_nop 1
    s_mul_i32 s4, s54, 24576
    v_lshlrev_b32 v246, 16, v232
    v_mfma_f32_16x16x32_bf16 v[84:87], a[224:227], v[4:7], v[84:87]
    s_add_u32 s4, s4, 12288
    v_and_b32 v232, 0xffff0000, v232
    v_fma_f32 v72, v72, v213, v246
    v_mfma_f32_16x16x32_bf16 v[92:95], a[224:227], v[8:11], 0
    s_add_u32 s4, s4, s58
    v_add_u32 v195, 0x8000, v195
    v_fma_f32 v73, v73, v213, v232
    v_mfma_f32_16x16x32_bf16 v[92:95], a[228:231], v[20:23], v[92:95]
    v_lshlrev_b32 v247, 16, v233
    v_and_b32 v233, 0xffff0000, v233
    v_mfma_f32_16x16x32_bf16 v[92:95], a[232:235], v[56:59], v[92:95]
    v_fma_f32 v74, v74, v213, v247
    v_fma_f32 v75, v75, v213, v233
    v_mfma_f32_16x16x32_bf16 v[92:95], a[236:239], v[68:71], v[92:95]
    s_waitcnt lgkmcnt(2)
    s_waitcnt lgkmcnt(0)
    s_barrier
    ds_read_b64_tr_b16 a[192:193], v194 offset:0
    v_cvt_pk_bf16_f32 v72, v72, v73
    v_mfma_f32_16x16x32_bf16 v[92:95], a[240:243], v[104:107], v[92:95]
    v_cvt_pk_bf16_f32 v73, v74, v75
    s_waitcnt vmcnt(5)
    v_lshlrev_b32 v246, 16, v236
    v_mfma_f32_16x16x32_bf16 v[92:95], a[244:247], v[116:119], v[92:95]
    ds_read_b64_tr_b16 a[194:195], v194 offset:1024
    v_and_b32 v236, 0xffff0000, v236
    v_mfma_f32_16x16x32_bf16 v[92:95], a[248:251], v[152:155], v[92:95]
    ds_read_b64_tr_b16 a[196:197], v194 offset:2048
    v_fma_f32 v80, v80, v214, v246
    v_mfma_f32_16x16x32_bf16 v[92:95], a[252:255], v[164:167], v[92:95]
    v_fma_f32 v81, v81, v214, v236
    v_lshlrev_b32 v247, 16, v237
    v_mfma_f32_16x16x32_bf16 v[84:87], a[252:255], v[160:163], v[84:87]
    ds_read_b64_tr_b16 a[198:199], v194 offset:3072
    v_and_b32 v237, 0xffff0000, v237
    v_mfma_f32_16x16x32_bf16 v[84:87], a[248:251], v[148:151], v[84:87]
    s_mul_i32 s78, s54, 12288
    ds_read_b64_tr_b16 a[200:201], v194 offset:4096
    v_mov_b32 v245, 7
    v_mfma_f32_16x16x32_bf16 v[84:87], a[244:247], v[112:115], v[84:87]
    s_add_u32 s78, s78, 98304
    v_fma_f32 v82, v82, v214, v247
    v_fma_f32 v83, v83, v214, v237
    v_mfma_f32_16x16x32_bf16 v[84:87], a[240:243], v[100:103], v[84:87]
    s_add_u32 s78, s78, s57
    ds_read_b64_tr_b16 a[202:203], v194 offset:5120
    v_cvt_pk_bf16_f32 v80, v80, v81
    v_mfma_f32_16x16x32_bf16 v[76:79], a[240:243], v[96:99], v[76:79]
    ds_read_b64_tr_b16 a[204:205], v194 offset:6144
    v_cvt_pk_bf16_f32 v81, v82, v83
    v_mfma_f32_16x16x32_bf16 v[76:79], a[244:247], v[108:111], v[76:79]
    s_waitcnt vmcnt(4)
    s_waitcnt vmcnt(1)
    v_readfirstlane_b32 s79, v244
    s_nop 0
    s_cmp_lt_u32 s79, 6
    s_cbranch_scc1 L_fs8
L_fb8:
    v_lshlrev_b32 v246, 16, v240
    v_and_b32 v240, 0xffff0000, v240
    v_mfma_f32_16x16x32_bf16 v[76:79], a[248:251], v[144:147], v[76:79]
    s_waitcnt vmcnt(0)
    buffer_store_dword v245, v208, s[72:75], s28 offen sc1
    v_fma_f32 v88, v88, v215, v246
    v_mfma_f32_16x16x32_bf16 v[76:79], a[252:255], v[156:159], v[76:79]
    s_waitcnt lgkmcnt(5)
    buffer_load_dwordx4 v[196:199], v212, s[68:71], s78 offen offset:0 sc1
    v_fma_f32 v89, v89, v215, v240
    v_mfma_f32_16x16x32_bf16 v[120:123], a[192:195], v[0:3], 0
    s_waitcnt lgkmcnt(3)
    buffer_load_dwordx4 v[200:203], v212, s[68:71], s78 offen offset:1024 sc1
    v_lshlrev_b32 v247, 16, v241
    v_mfma_f32_16x16x32_bf16 v[120:123], a[196:199], v[12:15], v[120:123]
    s_waitcnt lgkmcnt(1)
    ds_read_b64_tr_b16 a[206:207], v194 offset:7168
    v_and_b32 v241, 0xffff0000, v241
    v_mfma_f32_16x16x32_bf16 v[120:123], a[200:203], v[48:51], v[120:123]
    s_waitcnt lgkmcnt(0)
    buffer_load_dwordx4 v[204:207], v212, s[68:71], s78 offen offset:2048 sc1
    ds_read_b64_tr_b16 a[208:209], v194 offset:8192
    v_mfma_f32_16x16x32_bf16 v[120:123], a[204:207], v[60:63], v[120:123]
    ds_read_b64_tr_b16 a[210:211], v194 offset:9216
    v_fma_f32 v90, v90, v215, v247
    v_mfma_f32_16x16x32_bf16 v[128:131], a[204:207], v[64:67], 0
    ds_read_b64_tr_b16 a[212:213], v194 offset:10240
    v_fma_f32 v91, v91, v215, v241
    v_cvt_pk_bf16_f32 v88, v88, v89
    v_mfma_f32_16x16x32_bf16 v[128:131], a[200:203], v[52:55], v[128:131]
    ds_read_b64_tr_b16 a[214:215], v194 offset:11264
    v_cvt_pk_bf16_f32 v89, v90, v91
    v_mfma_f32_16x16x32_bf16 v[128:131], a[196:199], v[16:19], v[128:131]
    ds_read_b64_tr_b16 a[216:217], v194 offset:12288
    v_lshlrev_b32 v246, 16, v234
    v_mfma_f32_16x16x32_bf16 v[128:131], a[192:195], v[4:7], v[128:131]
    ds_read_b64_tr_b16 a[218:219], v194 offset:13312
    v_and_b32 v234, 0xffff0000, v234
    v_mfma_f32_16x16x32_bf16 v[136:139], a[192:195], v[8:11], 0
    ds_read_b64_tr_b16 a[220:221], v194 offset:14336
    v_fma_f32 v76, v76, v213, v246
    v_fma_f32 v77, v77, v213, v234
    v_mfma_f32_16x16x32_bf16 v[136:139], a[196:199], v[20:23], v[136:139]
    ds_read_b64_tr_b16 a[222:223], v194 offset:15360
    v_lshlrev_b32 v247, 16, v235
    v_mfma_f32_16x16x32_bf16 v[136:139], a[200:203], v[56:59], v[136:139]
    v_and_b32 v235, 0xffff0000, v235
    v_fma_f32 v78, v78, v213, v247
    v_mfma_f32_16x16x32_bf16 v[136:139], a[204:207], v[68:71], v[136:139]
    s_waitcnt lgkmcnt(6)
    ds_read_b64_tr_b16 a[224:225], v195 offset:0
    v_fma_f32 v79, v79, v213, v235
    v_mfma_f32_16x16x32_bf16 v[136:139], a[208:211], v[104:107], v[136:139]
    s_waitcnt lgkmcnt(5)
    ds_read_b64_tr_b16 a[226:227], v195 offset:1024
    v_cvt_pk_bf16_f32 v74, v76, v77
    v_mfma_f32_16x16x32_bf16 v[136:139], a[212:215], v[116:119], v[136:139]
    s_waitcnt lgkmcnt(4)
    v_cvt_pk_bf16_f32 v75, v78, v79
    v_lshlrev_b32 v246, 16, v238
    v_mfma_f32_16x16x32_bf16 v[136:139], a[216:219], v[152:155], v[136:139]
    s_waitcnt lgkmcnt(2)
    buffer_store_dwordx4 v[72:75], v212, s[68:71], s4 offen offset:0 sc1
    v_and_b32 v238, 0xffff0000, v238
    v_mfma_f32_16x16x32_bf16 v[136:139], a[220:223], v[164:167], v[136:139]
    ds_read_b64_tr_b16 a[228:229], v195 offset:2048
    v_fma_f32 v84, v84, v214, v246
    v_mfma_f32_16x16x32_bf16 v[128:131], a[220:223], v[160:163], v[128:131]
    ds_read_b64_tr_b16 a[230:231], v195 offset:3072
    v_fma_f32 v85, v85, v214, v238
    v_mfma_f32_16x16x32_bf16 v[128:131], a[216:219], v[148:151], v[128:131]
    ds_read_b64_tr_b16 a[232:233], v195 offset:4096
    v_lshlrev_b32 v247, 16, v239
    v_mfma_f32_16x16x32_bf16 v[128:131], a[212:215], v[112:115], v[128:131]
    ds_read_b64_tr_b16 a[234:235], v195 offset:5120
    v_and_b32 v239, 0xffff0000, v239
    v_mfma_f32_16x16x32_bf16 v[128:131], a[208:211], v[100:103], v[128:131]
    ds_read_b64_tr_b16 a[236:237], v195 offset:6144
    v_fma_f32 v86, v86, v214, v247
    v_fma_f32 v87, v87, v214, v239
    v_mfma_f32_16x16x32_bf16 v[120:123], a[208:211], v[96:99], v[120:123]
    v_cvt_pk_bf16_f32 v82, v84, v85
    v_cvt_pk_bf16_f32 v83, v86, v87
    v_mfma_f32_16x16x32_bf16 v[120:123], a[212:215], v[108:111], v[120:123]
    buffer_store_dwordx4 v[80:83], v212, s[68:71], s4 offen offset:1024 sc1
    v_lshlrev_b32 v246, 16, v242
    v_mfma_f32_16x16x32_bf16 v[120:123], a[216:219], v[144:147], v[120:123]
    ds_read_b64_tr_b16 a[238:239], v195 offset:7168
    v_and_b32 v242, 0xffff0000, v242
    v_mfma_f32_16x16x32_bf16 v[120:123], a[220:223], v[156:159], v[120:123]
    s_waitcnt lgkmcnt(6)
    ds_read_b64_tr_b16 a[240:241], v195 offset:8192
    v_fma_f32 v92, v92, v215, v246
    v_mfma_f32_16x16x32_bf16 v[124:127], a[224:227], v[0:3], 0
    s_waitcnt lgkmcnt(5)
    ds_read_b64_tr_b16 a[242:243], v195 offset:9216
    v_fma_f32 v93, v93, v215, v242
    v_mfma_f32_16x16x32_bf16 v[124:127], a[228:231], v[12:15], v[124:127]
    s_waitcnt lgkmcnt(4)
    ds_read_b64_tr_b16 a[244:245], v195 offset:10240
    v_lshlrev_b32 v247, 16, v243
    v_mfma_f32_16x16x32_bf16 v[124:127], a[232:235], v[48:51], v[124:127]
    s_waitcnt lgkmcnt(3)
    v_and_b32 v243, 0xffff0000, v243
    v_fma_f32 v94, v94, v215, v247
    v_mfma_f32_16x16x32_bf16 v[124:127], a[236:239], v[60:63], v[124:127]
    buffer_load_dword v244, off, s[72:75], s60 sc1
    v_fma_f32 v95, v95, v215, v243
    v_mfma_f32_16x16x32_bf16 v[132:135], a[236:239], v[64:67], 0
    ds_read_b64_tr_b16 a[246:247], v195 offset:11264
    v_cvt_pk_bf16_f32 v90, v92, v93
    v_mfma_f32_16x16x32_bf16 v[132:135], a[232:235], v[52:55], v[132:135]
    ds_read_b64_tr_b16 a[248:249], v195 offset:12288
    v_cvt_pk_bf16_f32 v91, v94, v95
    v_mfma_f32_16x16x32_bf16 v[132:135], a[228:231], v[16:19], v[132:135]
    s_waitcnt vmcnt(5)
    buffer_store_dwordx4 v[88:91], v212, s[68:71], s4 offen offset:2048 sc1
    s_nop 1
    s_mul_i32 s4, s54, 12288
    v_lshlrev_b32 v246, 16, v196
    v_mfma_f32_16x16x32_bf16 v[132:135], a[224:227], v[4:7], v[132:135]
    s_add_u32 s4, s4, 98304
    ds_read_b64_tr_b16 a[250:251], v195 offset:13312
    v_and_b32 v196, 0xffff0000, v196
    v_mfma_f32_16x16x32_bf16 v[140:143], a[224:227], v[8:11], 0
    s_add_u32 s4, s4, s58
    ds_read_b64_tr_b16 a[252:253], v195 offset:14336
    v_fma_f32 v120, v120, v213, v246
    v_mfma_f32_16x16x32_bf16 v[140:143], a[228:231], v[20:23], v[140:143]
    ds_read_b64_tr_b16 a[254:255], v195 offset:15360
    v_fma_f32 v121, v121, v213, v196
    v_mfma_f32_16x16x32_bf16 v[140:143], a[232:235], v[56:59], v[140:143]
    ds_read_b64_tr_b16 a[192:193], v194 offset:16384
    v_lshlrev_b32 v247, 16, v197
    v_and_b32 v197, 0xffff0000, v197
    v_mfma_f32_16x16x32_bf16 v[140:143], a[236:239], v[68:71], v[140:143]
    s_waitcnt lgkmcnt(6)
    ds_read_b64_tr_b16 a[194:195], v194 offset:17408
    v_fma_f32 v122, v122, v213, v247
    v_mfma_f32_16x16x32_bf16 v[140:143], a[240:243], v[104:107], v[140:143]
    s_waitcnt lgkmcnt(6)
    v_fma_f32 v123, v123, v213, v197
    v_cvt_pk_bf16_f32 v120, v120, v121
    v_mfma_f32_16x16x32_bf16 v[140:143], a[244:247], v[116:119], v[140:143]
    s_waitcnt lgkmcnt(4)
    ds_read_b64_tr_b16 a[196:197], v194 offset:18432
    v_cvt_pk_bf16_f32 v121, v122, v123
    v_mfma_f32_16x16x32_bf16 v[140:143], a[248:251], v[152:155], v[140:143]
    s_waitcnt lgkmcnt(3)
    ds_read_b64_tr_b16 a[198:199], v194 offset:19456
    v_mov_b32 v245, 8
    v_mfma_f32_16x16x32_bf16 v[140:143], a[252:255], v[164:167], v[140:143]
    s_waitcnt vmcnt(5)
    v_lshlrev_b32 v246, 16, v200
    v_and_b32 v200, 0xffff0000, v200
    v_mfma_f32_16x16x32_bf16 v[132:135], a[252:255], v[160:163], v[132:135]
    ds_read_b64_tr_b16 a[200:201], v194 offset:20480
    v_fma_f32 v128, v128, v214, v246
    v_mfma_f32_16x16x32_bf16 v[132:135], a[248:251], v[148:151], v[132:135]
    s_mul_i32 s78, s55, 24576
    ds_read_b64_tr_b16 a[202:203], v194 offset:21504
    v_fma_f32 v129, v129, v214, v200
    v_lshlrev_b32 v247, 16, v201
    v_mfma_f32_16x16x32_bf16 v[132:135], a[244:247], v[112:115], v[132:135]
    s_add_u32 s78, s78, 0
    v_and_b32 v201, 0xffff0000, v201
    v_fma_f32 v130, v130, v214, v247
    v_mfma_f32_16x16x32_bf16 v[132:135], a[240:243], v[100:103], v[132:135]
    s_add_u32 s78, s78, s58
    ds_read_b64_tr_b16 a[204:205], v194 offset:22528
    v_fma_f32 v131, v131, v214, v201
    v_mfma_f32_16x16x32_bf16 v[124:127], a[240:243], v[96:99], v[124:127]
    ds_read_b64_tr_b16 a[206:207], v194 offset:23552
    v_cvt_pk_bf16_f32 v128, v128, v129
    v_mfma_f32_16x16x32_bf16 v[124:127], a[244:247], v[108:111], v[124:127]
    s_waitcnt vmcnt(1)
    v_readfirstlane_b32 s79, v244
    s_nop 0
    s_cmp_lt_u32 s79, 7
    s_cbranch_scc1 L_fs9
L_fb9:
    v_cvt_pk_bf16_f32 v129, v130, v131
    v_lshlrev_b32 v246, 16, v204
    v_mfma_f32_16x16x32_bf16 v[124:127], a[248:251], v[144:147], v[124:127]
    s_waitcnt vmcnt(0)
    buffer_store_dword v245, v208, s[72:75], s28 offen sc1
    v_and_b32 v204, 0xffff0000, v204
    v_mfma_f32_16x16x32_bf16 v[124:127], a[252:255], v[156:159], v[124:127]
    s_waitcnt lgkmcnt(5)
    buffer_load_dwordx4 v[220:223], v212, s[68:71], s78 offen offset:0 sc1
    v_fma_f32 v136, v136, v215, v246
    v_mfma_f32_16x16x32_bf16 v[168:171], a[192:195], v[0:3], 0
    s_waitcnt lgkmcnt(4)
    buffer_load_dwordx4 v[224:227], v212, s[68:71], s78 offen offset:1024 sc1
    v_fma_f32 v137, v137, v215, v204
    v_mfma_f32_16x16x32_bf16 v[168:171], a[196:199], v[12:15], v[168:171]
    s_waitcnt lgkmcnt(2)
    ds_read_b64_tr_b16 a[208:209], v194 offset:24576
    v_lshlrev_b32 v247, 16, v205
    v_mfma_f32_16x16x32_bf16 v[168:171], a[200:203], v[48:51], v[168:171]
    s_waitcnt lgkmcnt(1)
    buffer_load_dwordx4 v[228:231], v212, s[68:71], s78 offen offset:2048 sc1
    ds_read_b64_tr_b16 a[210:211], v194 offset:25600
    v_and_b32 v205, 0xffff0000, v205
    v_mfma_f32_16x16x32_bf16 v[168:171], a[204:207], v[60:63], v[168:171]
    ds_read_b64_tr_b16 a[212:213], v194 offset:26624
    v_fma_f32 v138, v138, v215, v247
    v_mfma_f32_16x16x32_bf16 v[176:179], a[204:207], v[64:67], 0
    ds_read_b64_tr_b16 a[214:215], v194 offset:27648
    v_fma_f32 v139, v139, v215, v205
    v_cvt_pk_bf16_f32 v136, v136, v137
    v_mfma_f32_16x16x32_bf16 v[176:179], a[200:203], v[52:55], v[176:179]
    ds_read_b64_tr_b16 a[216:217], v194 offset:28672
    v_cvt_pk_bf16_f32 v137, v138, v139
    v_mfma_f32_16x16x32_bf16 v[176:179], a[196:199], v[16:19], v[176:179]
    ds_read_b64_tr_b16 a[218:219], v194 offset:29696
    v_lshlrev_b32 v246, 16, v198
    v_mfma_f32_16x16x32_bf16 v[176:179], a[192:195], v[4:7], v[176:179]
    ds_read_b64_tr_b16 a[220:221], v194 offset:30720
    v_and_b32 v198, 0xffff0000, v198
    v_mfma_f32_16x16x32_bf16 v[184:187], a[192:195], v[8:11], 0
    ds_read_b64_tr_b16 a[222:223], v194 offset:31744
    v_fma_f32 v124, v124, v213, v246
    v_fma_f32 v125, v125, v213, v198
    v_mfma_f32_16x16x32_bf16 v[184:187], a[196:199], v[20:23], v[184:187]
    ds_read_b64_tr_b16 a[224:225], v195 offset:16384
    v_lshlrev_b32 v247, 16, v199
    v_mfma_f32_16x16x32_bf16 v[184:187], a[200:203], v[56:59], v[184:187]
    v_and_b32 v199, 0xffff0000, v199
    v_fma_f32 v126, v126, v213, v247
    v_mfma_f32_16x16x32_bf16 v[184:187], a[204:207], v[68:71], v[184:187]
    s_waitcnt lgkmcnt(7)
    ds_read_b64_tr_b16 a[226:227], v195 offset:17408
    v_fma_f32 v127, v127, v213, v199
    v_mfma_f32_16x16x32_bf16 v[184:187], a[208:211], v[104:107], v[184:187]
    s_waitcnt lgkmcnt(6)
    ds_read_b64_tr_b16 a[228:229], v195 offset:18432
    v_cvt_pk_bf16_f32 v122, v124, v125
    v_mfma_f32_16x16x32_bf16 v[184:187], a[212:215], v[116:119], v[184:187]
    s_waitcnt lgkmcnt(5)
    v_cvt_pk_bf16_f32 v123, v126, v127
    v_lshlrev_b32 v246, 16, v202
    v_mfma_f32_16x16x32_bf16 v[184:187], a[216:219], v[152:155], v[184:187]
    s_waitcnt lgkmcnt(3)
    buffer_store_dwordx4 v[120:123], v212, s[68:71], s4 offen offset:0 sc1
    v_and_b32 v202, 0xffff0000, v202
    v_mfma_f32_16x16x32_bf16 v[184:187], a[220:223], v[164:167], v[184:187]
    ds_read_b64_tr_b16 a[230:231], v195 offset:19456
    v_fma_f32 v132, v132, v214, v246
    v_mfma_f32_16x16x32_bf16 v[176:179], a[220:223], v[160:163], v[176:179]
    ds_read_b64_tr_b16 a[232:233], v195 offset:20480
    v_fma_f32 v133, v133, v214, v202
    v_mfma_f32_16x16x32_bf16 v[176:179], a[216:219], v[148:151], v[176:179]
    ds_read_b64_tr_b16 a[234:235], v195 offset:21504
    v_lshlrev_b32 v247, 16, v203
    v_mfma_f32_16x16x32_bf16 v[176:179], a[212:215], v[112:115], v[176:179]
    ds_read_b64_tr_b16 a[236:237], v195 offset:22528
    v_and_b32 v203, 0xffff0000, v203
    v_mfma_f32_16x16x32_bf16 v[176:179], a[208:211], v[100:103], v[176:179]
    ds_read_b64_tr_b16 a[238:239], v195 offset:23552
    v_fma_f32 v134, v134, v214, v247
    v_fma_f32 v135, v135, v214, v203
    v_mfma_f32_16x16x32_bf16 v[168:171], a[208:211], v[96:99], v[168:171]
    v_cvt_pk_bf16_f32 v130, v132, v133
    v_cvt_pk_bf16_f32 v131, v134, v135
    v_mfma_f32_16x16x32_bf16 v[168:171], a[212:215], v[108:111], v[168:171]
    buffer_store_dwordx4 v[128:131], v212, s[68:71], s4 offen offset:1024 sc1
    v_lshlrev_b32 v246, 16, v206
    v_mfma_f32_16x16x32_bf16 v[168:171], a[216:219], v[144:147], v[168:171]
    ds_read_b64_tr_b16 a[240:241], v195 offset:24576
    v_and_b32 v206, 0xffff0000, v206
    v_mfma_f32_16x16x32_bf16 v[168:171], a[220:223], v[156:159], v[168:171]
    s_waitcnt lgkmcnt(6)
    ds_read_b64_tr_b16 a[242:243], v195 offset:25600
    v_fma_f32 v140, v140, v215, v246
    v_mfma_f32_16x16x32_bf16 v[172:175], a[224:227], v[0:3], 0
    s_waitcnt lgkmcnt(6)
    ds_read_b64_tr_b16 a[244:245], v195 offset:26624
    v_fma_f32 v141, v141, v215, v206
    v_mfma_f32_16x16x32_bf16 v[172:175], a[228:231], v[12:15], v[172:175]
    s_waitcnt lgkmcnt(5)
    ds_read_b64_tr_b16 a[246:247], v195 offset:27648
    v_lshlrev_b32 v247, 16, v207
    v_mfma_f32_16x16x32_bf16 v[172:175], a[232:235], v[48:51], v[172:175]
    s_waitcnt lgkmcnt(4)
    v_and_b32 v207, 0xffff0000, v207
    v_fma_f32 v142, v142, v215, v247
    v_mfma_f32_16x16x32_bf16 v[172:175], a[236:239], v[60:63], v[172:175]
    buffer_load_dword v244, off, s[72:75], s60 sc1
    v_fma_f32 v143, v143, v215, v207
    v_mfma_f32_16x16x32_bf16 v[180:183], a[236:239], v[64:67], 0
    ds_read_b64_tr_b16 a[248:249], v195 offset:28672
    v_cvt_pk_bf16_f32 v138, v140, v141
    v_mfma_f32_16x16x32_bf16 v[180:183], a[232:235], v[52:55], v[180:183]
    ds_read_b64_tr_b16 a[250:251], v195 offset:29696
    v_cvt_pk_bf16_f32 v139, v142, v143
    v_mfma_f32_16x16x32_bf16 v[180:183], a[228:231], v[16:19], v[180:183]
    s_waitcnt vmcnt(5)
    buffer_store_dwordx4 v[136:139], v212, s[68:71], s4 offen offset:2048 sc1
    s_nop 1
    s_mul_i32 s4, s55, 24576
    v_lshlrev_b32 v246, 16, v220
    v_mfma_f32_16x16x32_bf16 v[180:183], a[224:227], v[4:7], v[180:183]
    s_add_u32 s4, s4, 0
    ds_read_b64_tr_b16 a[252:253], v195 offset:30720
    v_and_b32 v220, 0xffff0000, v220
    v_mfma_f32_16x16x32_bf16 v[188:191], a[224:227], v[8:11], 0
    s_add_u32 s4, s4, s59
    ds_read_b64_tr_b16 a[254:255], v195 offset:31744
    v_add_u32 v194, 0xfffe0000, v194
    v_fma_f32 v168, v168, v213, v246
    v_mfma_f32_16x16x32_bf16 v[188:191], a[228:231], v[20:23], v[188:191]
    v_add_u32 v195, 0xfffe0000, v195
    v_fma_f32 v169, v169, v213, v220
    v_mfma_f32_16x16x32_bf16 v[188:191], a[232:235], v[56:59], v[188:191]
    v_lshlrev_b32 v247, 16, v221
    v_and_b32 v221, 0xffff0000, v221
    v_mfma_f32_16x16x32_bf16 v[188:191], a[236:239], v[68:71], v[188:191]
    s_waitcnt lgkmcnt(4)
    ds_read_b64_tr_b16 a[192:193], v194 offset:0
    v_fma_f32 v170, v170, v213, v247
    v_mfma_f32_16x16x32_bf16 v[188:191], a[240:243], v[104:107], v[188:191]
    v_fma_f32 v171, v171, v213, v221
    v_cvt_pk_bf16_f32 v168, v168, v169
    v_mfma_f32_16x16x32_bf16 v[188:191], a[244:247], v[116:119], v[188:191]
    s_waitcnt lgkmcnt(3)
    ds_read_b64_tr_b16 a[194:195], v194 offset:1024
    v_cvt_pk_bf16_f32 v169, v170, v171
    v_mfma_f32_16x16x32_bf16 v[188:191], a[248:251], v[152:155], v[188:191]
    s_waitcnt lgkmcnt(2)
    ds_read_b64_tr_b16 a[196:197], v194 offset:2048
    v_mov_b32 v245, 9
    v_mfma_f32_16x16x32_bf16 v[188:191], a[252:255], v[164:167], v[188:191]
    s_waitcnt vmcnt(5)
    v_lshlrev_b32 v246, 16, v224
    v_and_b32 v224, 0xffff0000, v224
    v_mfma_f32_16x16x32_bf16 v[180:183], a[252:255], v[160:163], v[180:183]
    ds_read_b64_tr_b16 a[198:199], v194 offset:3072
    v_fma_f32 v176, v176, v214, v246
    v_mfma_f32_16x16x32_bf16 v[180:183], a[248:251], v[148:151], v[180:183]
    s_mul_i32 s78, s55, 24576
    ds_read_b64_tr_b16 a[200:201], v194 offset:4096
    v_fma_f32 v177, v177, v214, v224
    v_lshlrev_b32 v247, 16, v225
    v_mfma_f32_16x16x32_bf16 v[180:183], a[244:247], v[112:115], v[180:183]
    s_add_u32 s78, s78, 12288
    v_and_b32 v225, 0xffff0000, v225
    v_fma_f32 v178, v178, v214, v247
    v_mfma_f32_16x16x32_bf16 v[180:183], a[240:243], v[100:103], v[180:183]
    s_add_u32 s78, s78, s58
    ds_read_b64_tr_b16 a[202:203], v194 offset:5120
    v_fma_f32 v179, v179, v214, v225
    v_mfma_f32_16x16x32_bf16 v[172:175], a[240:243], v[96:99], v[172:175]
    ds_read_b64_tr_b16 a[204:205], v194 offset:6144
    v_cvt_pk_bf16_f32 v176, v176, v177
    v_mfma_f32_16x16x32_bf16 v[172:175], a[244:247], v[108:111], v[172:175]
    s_waitcnt vmcnt(1)
    v_readfirstlane_b32 s79, v244
    s_nop 0
    s_cmp_lt_u32 s79, 8
    s_cbranch_scc1 L_fs10
L_fb10:
    v_cvt_pk_bf16_f32 v177, v178, v179
    v_lshlrev_b32 v246, 16, v228
    v_mfma_f32_16x16x32_bf16 v[172:175], a[248:251], v[144:147], v[172:175]
    s_waitcnt vmcnt(0)
    buffer_store_dword v245, v208, s[72:75], s28 offen sc1
    v_and_b32 v228, 0xffff0000, v228
    v_mfma_f32_16x16x32_bf16 v[172:175], a[252:255], v[156:159], v[172:175]
    s_waitcnt lgkmcnt(5)
    buffer_load_dwordx4 v[232:235], v212, s[68:71], s78 offen offset:0 sc1
    v_fma_f32 v184, v184, v215, v246
    v_mfma_f32_16x16x32_bf16 v[24:27], a[192:195], v[0:3], 0
    s_waitcnt lgkmcnt(3)
    buffer_load_dwordx4 v[236:239], v212, s[68:71], s78 offen offset:1024 sc1
    v_fma_f32 v185, v185, v215, v228
    v_mfma_f32_16x16x32_bf16 v[24:27], a[196:199], v[12:15], v[24:27]
    s_waitcnt lgkmcnt(1)
    ds_read_b64_tr_b16 a[206:207], v194 offset:7168
    v_lshlrev_b32 v247, 16, v229
    v_mfma_f32_16x16x32_bf16 v[24:27], a[200:203], v[48:51], v[24:27]
    s_waitcnt lgkmcnt(0)
    buffer_load_dwordx4 v[240:243], v212, s[68:71], s78 offen offset:2048 sc1
    ds_read_b64_tr_b16 a[208:209], v194 offset:8192
    v_and_b32 v229, 0xffff0000, v229
    v_mfma_f32_16x16x32_bf16 v[24:27], a[204:207], v[60:63], v[24:27]
    ds_read_b64_tr_b16 a[210:211], v194 offset:9216
    v_fma_f32 v186, v186, v215, v247
    v_mfma_f32_16x16x32_bf16 v[32:35], a[204:207], v[64:67], 0
    ds_read_b64_tr_b16 a[212:213], v194 offset:10240
    v_fma_f32 v187, v187, v215, v229
    v_cvt_pk_bf16_f32 v184, v184, v185
    v_mfma_f32_16x16x32_bf16 v[32:35], a[200:203], v[52:55], v[32:35]
    ds_read_b64_tr_b16 a[214:215], v194 offset:11264
    v_cvt_pk_bf16_f32 v185, v186, v187
    v_mfma_f32_16x16x32_bf16 v[32:35], a[196:199], v[16:19], v[32:35]
    ds_read_b64_tr_b16 a[216:217], v194 offset:12288
    v_lshlrev_b32 v246, 16, v222
    v_mfma_f32_16x16x32_bf16 v[32:35], a[192:195], v[4:7], v[32:35]
    ds_read_b64_tr_b16 a[218:219], v194 offset:13312
    v_and_b32 v222, 0xffff0000, v222
    v_mfma_f32_16x16x32_bf16 v[40:43], a[192:195], v[8:11], 0
    ds_read_b64_tr_b16 a[220:221], v194 offset:14336
    v_fma_f32 v172, v172, v213, v246
    v_fma_f32 v173, v173, v213, v222
    v_mfma_f32_16x16x32_bf16 v[40:43], a[196:199], v[20:23], v[40:43]
    ds_read_b64_tr_b16 a[222:223], v194 offset:15360
    v_lshlrev_b32 v247, 16, v223
    v_mfma_f32_16x16x32_bf16 v[40:43], a[200:203], v[56:59], v[40:43]
    v_and_b32 v223, 0xffff0000, v223
    v_fma_f32 v174, v174, v213, v247
    v_mfma_f32_16x16x32_bf16 v[40:43], a[204:207], v[68:71], v[40:43]
    s_waitcnt lgkmcnt(6)
    ds_read_b64_tr_b16 a[224:225], v195 offset:0
    v_fma_f32 v175, v175, v213, v223
    v_mfma_f32_16x16x32_bf16 v[40:43], a[208:211], v[104:107], v[40:43]
    s_waitcnt lgkmcnt(5)
    ds_read_b64_tr_b16 a[226:227], v195 offset:1024
    v_cvt_pk_bf16_f32 v170, v172, v173
    v_mfma_f32_16x16x32_bf16 v[40:43], a[212:215], v[116:119], v[40:43]
    s_waitcnt lgkmcnt(4)
    v_cvt_pk_bf16_f32 v171, v174, v175
    v_lshlrev_b32 v246, 16, v226
    v_mfma_f32_16x16x32_bf16 v[40:43], a[216:219], v[152:155], v[40:43]
    s_waitcnt lgkmcnt(2)
    buffer_load_dword v244, off, s[72:75], s60 sc1
    buffer_store_dwordx4 v[168:171], v212, s[68:71], s4 offen offset:0 sc1
    v_mfma_f32_16x16x32_bf16 v[40:43], a[220:223], v[164:167], v[40:43]
    ds_read_b64_tr_b16 a[228:229], v195 offset:2048
    v_and_b32 v226, 0xffff0000, v226
    v_fma_f32 v180, v180, v214, v246
    v_mfma_f32_16x16x32_bf16 v[32:35], a[220:223], v[160:163], v[32:35]
    ds_read_b64_tr_b16 a[230:231], v195 offset:3072
    v_fma_f32 v181, v181, v214, v226
    v_mfma_f32_16x16x32_bf16 v[32:35], a[216:219], v[148:151], v[32:35]
    ds_read_b64_tr_b16 a[232:233], v195 offset:4096
    v_lshlrev_b32 v247, 16, v227
    v_mfma_f32_16x16x32_bf16 v[32:35], a[212:215], v[112:115], v[32:35]
    ds_read_b64_tr_b16 a[234:235], v195 offset:5120
    v_and_b32 v227, 0xffff0000, v227
    v_mfma_f32_16x16x32_bf16 v[32:35], a[208:211], v[100:103], v[32:35]
    ds_read_b64_tr_b16 a[236:237], v195 offset:6144
    v_fma_f32 v182, v182, v214, v247
    v_fma_f32 v183, v183, v214, v227
    v_mfma_f32_16x16x32_bf16 v[24:27], a[208:211], v[96:99], v[24:27]
    v_cvt_pk_bf16_f32 v178, v180, v181
    v_cvt_pk_bf16_f32 v179, v182, v183
    v_mfma_f32_16x16x32_bf16 v[24:27], a[212:215], v[108:111], v[24:27]
    buffer_store_dwordx4 v[176:179], v212, s[68:71], s4 offen offset:1024 sc1
    v_lshlrev_b32 v246, 16, v230
    v_mfma_f32_16x16x32_bf16 v[24:27], a[216:219], v[144:147], v[24:27]
    ds_read_b64_tr_b16 a[238:239], v195 offset:7168
    v_and_b32 v230, 0xffff0000, v230
    v_mfma_f32_16x16x32_bf16 v[24:27], a[220:223], v[156:159], v[24:27]
    s_waitcnt lgkmcnt(6)
    ds_read_b64_tr_b16 a[240:241], v195 offset:8192
    v_fma_f32 v188, v188, v215, v246
    v_mfma_f32_16x16x32_bf16 v[28:31], a[224:227], v[0:3], 0
    s_waitcnt lgkmcnt(5)
    ds_read_b64_tr_b16 a[242:243], v195 offset:9216
    v_fma_f32 v189, v189, v215, v230
    v_mfma_f32_16x16x32_bf16 v[28:31], a[228:231], v[12:15], v[28:31]
    s_waitcnt lgkmcnt(4)
    ds_read_b64_tr_b16 a[244:245], v195 offset:10240
    v_lshlrev_b32 v247, 16, v231
    v_mfma_f32_16x16x32_bf16 v[28:31], a[232:235], v[48:51], v[28:31]
    s_waitcnt lgkmcnt(3)
    v_and_b32 v231, 0xffff0000, v231
    v_fma_f32 v190, v190, v215, v247
    v_mfma_f32_16x16x32_bf16 v[28:31], a[236:239], v[60:63], v[28:31]
    ds_read_b64_tr_b16 a[246:247], v195 offset:11264
    v_fma_f32 v191, v191, v215, v231
    v_mfma_f32_16x16x32_bf16 v[36:39], a[236:239], v[64:67], 0
    s_mul_i32 s78, s55, 12288
    ds_read_b64_tr_b16 a[248:249], v195 offset:12288
    v_cvt_pk_bf16_f32 v186, v188, v189
    v_mfma_f32_16x16x32_bf16 v[36:39], a[232:235], v[52:55], v[36:39]
    s_add_u32 s78, s78, 98304
    v_cvt_pk_bf16_f32 v187, v190, v191
    s_waitcnt vmcnt(5)
    v_lshlrev_b32 v246, 16, v232
    v_mfma_f32_16x16x32_bf16 v[36:39], a[228:231], v[16:19], v[36:39]
    s_add_u32 s78, s78, s58
    buffer_store_dwordx4 v[184:187], v212, s[68:71], s4 offen offset:2048 sc1
    s_nop 1
    s_mul_i32 s4, s55, 24576
    v_mfma_f32_16x16x32_bf16 v[36:39], a[224:227], v[4:7], v[36:39]
    s_add_u32 s4, s4, 12288
    ds_read_b64_tr_b16 a[250:251], v195 offset:13312
    v_and_b32 v232, 0xffff0000, v232
    v_mfma_f32_16x16x32_bf16 v[44:47], a[224:227], v[8:11], 0
    s_add_u32 s4, s4, s59
    ds_read_b64_tr_b16 a[252:253], v195 offset:14336
    s_waitcnt vmcnt(3)
    v_readfirstlane_b32 s79, v244
    s_nop 0
    s_cmp_lt_u32 s79, 9
    s_cbranch_scc1 L_fs11
L_fb11:
    v_fma_f32 v24, v24, v213, v246
    v_mfma_f32_16x16x32_bf16 v[44:47], a[228:231], v[20:23], v[44:47]
    buffer_load_dwordx4 v[196:199], v212, s[68:71], s78 offen offset:0 sc1
    v_fma_f32 v25, v25, v213, v232
    v_mfma_f32_16x16x32_bf16 v[44:47], a[232:235], v[56:59], v[44:47]
    ds_read_b64_tr_b16 a[254:255], v195 offset:15360
    v_lshlrev_b32 v247, 16, v233
    v_and_b32 v233, 0xffff0000, v233
    v_mfma_f32_16x16x32_bf16 v[44:47], a[236:239], v[68:71], v[44:47]
    s_waitcnt lgkmcnt(5)
    buffer_load_dwordx4 v[200:203], v212, s[68:71], s78 offen offset:1024 sc1
    v_fma_f32 v26, v26, v213, v247
    v_mfma_f32_16x16x32_bf16 v[44:47], a[240:243], v[104:107], v[44:47]
    s_waitcnt lgkmcnt(4)
    ds_read_b64_tr_b16 a[192:193], v194 offset:16384
    v_fma_f32 v27, v27, v213, v233
    v_mfma_f32_16x16x32_bf16 v[44:47], a[244:247], v[116:119], v[44:47]
    s_waitcnt lgkmcnt(3)
    buffer_load_dwordx4 v[204:207], v212, s[68:71], s78 offen offset:2048 sc1
    v_cvt_pk_bf16_f32 v24, v24, v25
    v_mfma_f32_16x16x32_bf16 v[44:47], a[248:251], v[152:155], v[44:47]
    s_waitcnt lgkmcnt(1)
    ds_read_b64_tr_b16 a[194:195], v194 offset:17408
    v_cvt_pk_bf16_f32 v25, v26, v27
    v_mfma_f32_16x16x32_bf16 v[44:47], a[252:255], v[164:167], v[44:47]
    ds_read_b64_tr_b16 a[196:197], v194 offset:18432
    v_lshlrev_b32 v246, 16, v236
    v_and_b32 v236, 0xffff0000, v236
    v_mfma_f32_16x16x32_bf16 v[36:39], a[252:255], v[160:163], v[36:39]
    buffer_load_dword v218, v217, s[72:75], 0 offen sc1
    v_fma_f32 v32, v32, v214, v246
    v_mfma_f32_16x16x32_bf16 v[36:39], a[248:251], v[148:151], v[36:39]
    ds_read_b64_tr_b16 a[198:199], v194 offset:19456
    v_fma_f32 v33, v33, v214, v236
    v_lshlrev_b32 v247, 16, v237
    v_mfma_f32_16x16x32_bf16 v[36:39], a[244:247], v[112:115], v[36:39]
    ds_read_b64_tr_b16 a[200:201], v194 offset:20480
    v_and_b32 v237, 0xffff0000, v237
    v_mfma_f32_16x16x32_bf16 v[36:39], a[240:243], v[100:103], v[36:39]
    ds_read_b64_tr_b16 a[202:203], v194 offset:21504
    v_fma_f32 v34, v34, v214, v247
    v_mfma_f32_16x16x32_bf16 v[28:31], a[240:243], v[96:99], v[28:31]
    ds_read_b64_tr_b16 a[204:205], v194 offset:22528
    v_fma_f32 v35, v35, v214, v237
    v_mfma_f32_16x16x32_bf16 v[28:31], a[244:247], v[108:111], v[28:31]
    ds_read_b64_tr_b16 a[206:207], v194 offset:23552
    v_cvt_pk_bf16_f32 v32, v32, v33
    v_cvt_pk_bf16_f32 v33, v34, v35
    v_mfma_f32_16x16x32_bf16 v[28:31], a[248:251], v[144:147], v[28:31]
    ds_read_b64_tr_b16 a[208:209], v194 offset:24576
    v_lshlrev_b32 v246, 16, v240
    v_mfma_f32_16x16x32_bf16 v[28:31], a[252:255], v[156:159], v[28:31]
    s_waitcnt lgkmcnt(7)
    ds_read_b64_tr_b16 a[210:211], v194 offset:25600
    v_and_b32 v240, 0xffff0000, v240
    v_mfma_f32_16x16x32_bf16 v[72:75], a[192:195], v[0:3], 0
    s_waitcnt lgkmcnt(6)
    v_fma_f32 v40, v40, v215, v246
    v_fma_f32 v41, v41, v215, v240
    v_mfma_f32_16x16x32_bf16 v[72:75], a[196:199], v[12:15], v[72:75]
    s_waitcnt lgkmcnt(4)
    ds_read_b64_tr_b16 a[212:213], v194 offset:26624
    v_lshlrev_b32 v247, 16, v241
    v_mfma_f32_16x16x32_bf16 v[72:75], a[200:203], v[48:51], v[72:75]
    s_waitcnt lgkmcnt(3)
    ds_read_b64_tr_b16 a[214:215], v194 offset:27648
    v_and_b32 v241, 0xffff0000, v241
    v_mfma_f32_16x16x32_bf16 v[72:75], a[204:207], v[60:63], v[72:75]
    ds_read_b64_tr_b16 a[216:217], v194 offset:28672
    v_fma_f32 v42, v42, v215, v247
    v_mfma_f32_16x16x32_bf16 v[80:83], a[204:207], v[64:67], 0
    v_fma_f32 v43, v43, v215, v241
    v_cvt_pk_bf16_f32 v40, v40, v41
    v_mfma_f32_16x16x32_bf16 v[80:83], a[200:203], v[52:55], v[80:83]
    ds_read_b64_tr_b16 a[218:219], v194 offset:29696
    v_cvt_pk_bf16_f32 v41, v42, v43
    v_mfma_f32_16x16x32_bf16 v[80:83], a[196:199], v[16:19], v[80:83]
    ds_read_b64_tr_b16 a[220:221], v194 offset:30720
    v_lshlrev_b32 v246, 16, v234
    v_mfma_f32_16x16x32_bf16 v[80:83], a[192:195], v[4:7], v[80:83]
    v_and_b32 v234, 0xffff0000, v234
    v_fma_f32 v28, v28, v213, v246
    v_mfma_f32_16x16x32_bf16 v[88:91], a[192:195], v[8:11], 0
    ds_read_b64_tr_b16 a[222:223], v194 offset:31744
    v_fma_f32 v29, v29, v213, v234
    v_mfma_f32_16x16x32_bf16 v[88:91], a[196:199], v[20:23], v[88:91]
    ds_read_b64_tr_b16 a[224:225], v195 offset:16384
    v_lshlrev_b32 v247, 16, v235
    v_mfma_f32_16x16x32_bf16 v[88:91], a[200:203], v[56:59], v[88:91]
    v_and_b32 v235, 0xffff0000, v235
    v_fma_f32 v30, v30, v213, v247
    v_mfma_f32_16x16x32_bf16 v[88:91], a[204:207], v[68:71], v[88:91]
    s_waitcnt lgkmcnt(6)
    ds_read_b64_tr_b16 a[226:227], v195 offset:17408
    v_fma_f32 v31, v31, v213, v235
    v_mfma_f32_16x16x32_bf16 v[88:91], a[208:211], v[104:107], v[88:91]
    s_waitcnt lgkmcnt(6)
    ds_read_b64_tr_b16 a[228:229], v195 offset:18432
    v_cvt_pk_bf16_f32 v26, v28, v29
    v_mfma_f32_16x16x32_bf16 v[88:91], a[212:215], v[116:119], v[88:91]
    s_waitcnt lgkmcnt(5)
    v_cvt_pk_bf16_f32 v27, v30, v31
    v_lshlrev_b32 v246, 16, v238
    v_mfma_f32_16x16x32_bf16 v[88:91], a[216:219], v[152:155], v[88:91]
    s_waitcnt lgkmcnt(3)
    buffer_store_dwordx4 v[24:27], v212, s[68:71], s4 offen offset:0 sc1
    v_and_b32 v238, 0xffff0000, v238
    v_mfma_f32_16x16x32_bf16 v[88:91], a[220:223], v[164:167], v[88:91]
    ds_read_b64_tr_b16 a[230:231], v195 offset:19456
    v_fma_f32 v36, v36, v214, v246
    v_mfma_f32_16x16x32_bf16 v[80:83], a[220:223], v[160:163], v[80:83]
    ds_read_b64_tr_b16 a[232:233], v195 offset:20480
    v_fma_f32 v37, v37, v214, v238
    v_mfma_f32_16x16x32_bf16 v[80:83], a[216:219], v[148:151], v[80:83]
    ds_read_b64_tr_b16 a[234:235], v195 offset:21504
    v_lshlrev_b32 v247, 16, v239
    v_mfma_f32_16x16x32_bf16 v[80:83], a[212:215], v[112:115], v[80:83]
    ds_read_b64_tr_b16 a[236:237], v195 offset:22528
    v_and_b32 v239, 0xffff0000, v239
    v_mfma_f32_16x16x32_bf16 v[80:83], a[208:211], v[100:103], v[80:83]
    ds_read_b64_tr_b16 a[238:239], v195 offset:23552
    v_fma_f32 v38, v38, v214, v247
    v_fma_f32 v39, v39, v214, v239
    v_mfma_f32_16x16x32_bf16 v[72:75], a[208:211], v[96:99], v[72:75]
    v_cvt_pk_bf16_f32 v34, v36, v37
    v_cvt_pk_bf16_f32 v35, v38, v39
    v_mfma_f32_16x16x32_bf16 v[72:75], a[212:215], v[108:111], v[72:75]
    buffer_store_dwordx4 v[32:35], v212, s[68:71], s4 offen offset:1024 sc1
    v_lshlrev_b32 v246, 16, v242
    v_mfma_f32_16x16x32_bf16 v[72:75], a[216:219], v[144:147], v[72:75]
    ds_read_b64_tr_b16 a[240:241], v195 offset:24576
    v_and_b32 v242, 0xffff0000, v242
    v_mfma_f32_16x16x32_bf16 v[72:75], a[220:223], v[156:159], v[72:75]
    s_waitcnt lgkmcnt(6)
    ds_read_b64_tr_b16 a[242:243], v195 offset:25600
    v_fma_f32 v44, v44, v215, v246
    v_mfma_f32_16x16x32_bf16 v[76:79], a[224:227], v[0:3], 0
    s_waitcnt lgkmcnt(6)
    ds_read_b64_tr_b16 a[244:245], v195 offset:26624
    v_fma_f32 v45, v45, v215, v242
    v_mfma_f32_16x16x32_bf16 v[76:79], a[228:231], v[12:15], v[76:79]
    s_waitcnt lgkmcnt(5)
    ds_read_b64_tr_b16 a[246:247], v195 offset:27648
    v_lshlrev_b32 v247, 16, v243
    v_mfma_f32_16x16x32_bf16 v[76:79], a[232:235], v[48:51], v[76:79]
    s_waitcnt lgkmcnt(4)
    v_and_b32 v243, 0xffff0000, v243
    v_fma_f32 v46, v46, v215, v247
    v_mfma_f32_16x16x32_bf16 v[76:79], a[236:239], v[60:63], v[76:79]
    ds_read_b64_tr_b16 a[248:249], v195 offset:28672
    v_fma_f32 v47, v47, v215, v243
    v_mfma_f32_16x16x32_bf16 v[84:87], a[236:239], v[64:67], 0
    ds_read_b64_tr_b16 a[250:251], v195 offset:29696
    v_cvt_pk_bf16_f32 v42, v44, v45
    v_mfma_f32_16x16x32_bf16 v[84:87], a[232:235], v[52:55], v[84:87]
    v_cvt_pk_bf16_f32 v43, v46, v47
    s_waitcnt vmcnt(5)
    v_lshlrev_b32 v246, 16, v196
    v_mfma_f32_16x16x32_bf16 v[84:87], a[228:231], v[16:19], v[84:87]
    buffer_store_dwordx4 v[40:43], v212, s[68:71], s4 offen offset:2048 sc1
    s_nop 1
    s_mul_i32 s4, s55, 12288
    v_mfma_f32_16x16x32_bf16 v[84:87], a[224:227], v[4:7], v[84:87]
    s_add_u32 s4, s4, 98304
    ds_read_b64_tr_b16 a[252:253], v195 offset:30720
    v_and_b32 v196, 0xffff0000, v196
    v_mfma_f32_16x16x32_bf16 v[92:95], a[224:227], v[8:11], 0
    s_add_u32 s4, s4, s59
    ds_read_b64_tr_b16 a[254:255], v195 offset:31744
    v_fma_f32 v72, v72, v213, v246
    v_mfma_f32_16x16x32_bf16 v[92:95], a[228:231], v[20:23], v[92:95]
    v_fma_f32 v73, v73, v213, v196
    v_lshlrev_b32 v247, 16, v197
    v_mfma_f32_16x16x32_bf16 v[92:95], a[232:235], v[56:59], v[92:95]
    v_and_b32 v197, 0xffff0000, v197
    v_fma_f32 v74, v74, v213, v247
    v_mfma_f32_16x16x32_bf16 v[92:95], a[236:239], v[68:71], v[92:95]
    s_waitcnt lgkmcnt(4)
    v_fma_f32 v75, v75, v213, v197
    v_cvt_pk_bf16_f32 v72, v72, v73
    v_mfma_f32_16x16x32_bf16 v[92:95], a[240:243], v[104:107], v[92:95]
    v_cvt_pk_bf16_f32 v73, v74, v75
    s_waitcnt vmcnt(5)
    v_lshlrev_b32 v246, 16, v200
    v_mfma_f32_16x16x32_bf16 v[92:95], a[244:247], v[116:119], v[92:95]
    s_waitcnt lgkmcnt(2)
    v_and_b32 v200, 0xffff0000, v200
    v_fma_f32 v80, v80, v214, v246
    v_mfma_f32_16x16x32_bf16 v[92:95], a[248:251], v[152:155], v[92:95]
    s_waitcnt lgkmcnt(0)
    v_fma_f32 v81, v81, v214, v200
    v_lshlrev_b32 v247, 16, v201
    v_mfma_f32_16x16x32_bf16 v[92:95], a[252:255], v[164:167], v[92:95]
    v_and_b32 v201, 0xffff0000, v201
    v_fma_f32 v82, v82, v214, v247
    v_mfma_f32_16x16x32_bf16 v[84:87], a[252:255], v[160:163], v[84:87]
    v_mfma_f32_16x16x32_bf16 v[84:87], a[248:251], v[148:151], v[84:87]
    v_fma_f32 v83, v83, v214, v201
    v_cvt_pk_bf16_f32 v80, v80, v81
    v_mfma_f32_16x16x32_bf16 v[84:87], a[244:247], v[112:115], v[84:87]
    v_cvt_pk_bf16_f32 v81, v82, v83
    v_mfma_f32_16x16x32_bf16 v[84:87], a[240:243], v[100:103], v[84:87]
    s_waitcnt vmcnt(4)
    v_lshlrev_b32 v246, 16, v204
    v_and_b32 v204, 0xffff0000, v204
    v_mfma_f32_16x16x32_bf16 v[76:79], a[240:243], v[96:99], v[76:79]
    v_mfma_f32_16x16x32_bf16 v[76:79], a[244:247], v[108:111], v[76:79]
    v_fma_f32 v88, v88, v215, v246
    v_fma_f32 v89, v89, v215, v204
    v_mfma_f32_16x16x32_bf16 v[76:79], a[248:251], v[144:147], v[76:79]
    v_lshlrev_b32 v247, 16, v205
    v_and_b32 v205, 0xffff0000, v205
    v_mfma_f32_16x16x32_bf16 v[76:79], a[252:255], v[156:159], v[76:79]
    v_fma_f32 v90, v90, v215, v247
    v_fma_f32 v91, v91, v215, v205
    v_cvt_pk_bf16_f32 v88, v88, v89
    v_cvt_pk_bf16_f32 v89, v90, v91
    v_lshlrev_b32 v246, 16, v198
    v_and_b32 v198, 0xffff0000, v198
    s_nop 1
    v_fma_f32 v76, v76, v213, v246
    v_fma_f32 v77, v77, v213, v198
    v_lshlrev_b32 v247, 16, v199
    v_and_b32 v199, 0xffff0000, v199
    v_fma_f32 v78, v78, v213, v247
    v_fma_f32 v79, v79, v213, v199
    v_cvt_pk_bf16_f32 v74, v76, v77
    v_cvt_pk_bf16_f32 v75, v78, v79
    buffer_store_dwordx4 v[72:75], v212, s[68:71], s4 offen offset:0 sc1
    v_lshlrev_b32 v246, 16, v202
    v_and_b32 v202, 0xffff0000, v202
    v_fma_f32 v84, v84, v214, v246
    v_fma_f32 v85, v85, v214, v202
    v_lshlrev_b32 v247, 16, v203
    v_and_b32 v203, 0xffff0000, v203
    v_fma_f32 v86, v86, v214, v247
    v_fma_f32 v87, v87, v214, v203
    v_cvt_pk_bf16_f32 v82, v84, v85
    v_cvt_pk_bf16_f32 v83, v86, v87
    buffer_store_dwordx4 v[80:83], v212, s[68:71], s4 offen offset:1024 sc1
    v_lshlrev_b32 v246, 16, v206
    v_and_b32 v206, 0xffff0000, v206
    v_fma_f32 v92, v92, v215, v246
    v_fma_f32 v93, v93, v215, v206
    v_lshlrev_b32 v247, 16, v207
    v_and_b32 v207, 0xffff0000, v207
    v_fma_f32 v94, v94, v215, v247
    v_fma_f32 v95, v95, v215, v207
    v_cvt_pk_bf16_f32 v90, v92, v93
    v_cvt_pk_bf16_f32 v91, v94, v95
    buffer_store_dwordx4 v[88:91], v212, s[68:71], s4 offen offset:2048 sc1
    s_branch L_join
L_fs3:
    s_sleep 2
    buffer_load_dword v244, off, s[72:75], s60 sc1
    s_waitcnt vmcnt(0)
    v_readfirstlane_b32 s79, v244
    s_nop 1
    s_cmp_lt_u32 s79, 1
    s_cbranch_scc0 L_fb3
    s_sub_u32 s67, s67, 1
    s_cbranch_scc0 L_fs3
    s_endpgm
L_fs4:
    s_sleep 2
    buffer_load_dword v244, off, s[72:75], s60 sc1
    s_waitcnt vmcnt(0)
    v_readfirstlane_b32 s79, v244
    s_nop 1
    s_cmp_lt_u32 s79, 2
    s_cbranch_scc0 L_fb4
    s_sub_u32 s67, s67, 1
    s_cbranch_scc0 L_fs4
    s_endpgm
L_fs5:
    s_sleep 2
    buffer_load_dword v244, off, s[72:75], s60 sc1
    s_waitcnt vmcnt(0)
    v_readfirstlane_b32 s79, v244
    s_nop 1
    s_cmp_lt_u32 s79, 3
    s_cbranch_scc0 L_fb5
    s_sub_u32 s67, s67, 1
    s_cbranch_scc0 L_fs5
    s_endpgm
L_fs6:
    s_sleep 2
    buffer_load_dword v244, off, s[72:75], s61 sc1
    s_waitcnt vmcnt(0)
    v_readfirstlane_b32 s79, v244
    s_nop 1
    s_cmp_lt_u32 s79, 4
    s_cbranch_scc0 L_fb6
    s_sub_u32 s67, s67, 1
    s_cbranch_scc0 L_fs6
    s_endpgm
L_fs7:
    s_sleep 2
    buffer_load_dword v244, off, s[72:75], s61 sc1
    s_waitcnt vmcnt(0)
    v_readfirstlane_b32 s79, v244
    s_nop 1
    s_cmp_lt_u32 s79, 5
    s_cbranch_scc0 L_fb7
    s_sub_u32 s67, s67, 1
    s_cbranch_scc0 L_fs7
    s_endpgm
L_fs8:
    s_sleep 2
    buffer_load_dword v244, off, s[72:75], s61 sc1
    s_waitcnt vmcnt(0)
    v_readfirstlane_b32 s79, v244
    s_nop 1
    s_cmp_lt_u32 s79, 6
    s_cbranch_scc0 L_fb8
    s_sub_u32 s67, s67, 1
    s_cbranch_scc0 L_fs8
    s_endpgm
L_fs9:
    s_sleep 2
    buffer_load_dword v244, off, s[72:75], s60 sc1
    s_waitcnt vmcnt(0)
    v_readfirstlane_b32 s79, v244
    s_nop 1
    s_cmp_lt_u32 s79, 7
    s_cbranch_scc0 L_fb9
    s_sub_u32 s67, s67, 1
    s_cbranch_scc0 L_fs9
    s_endpgm
L_fs10:
    s_sleep 2
    buffer_load_dword v244, off, s[72:75], s60 sc1
    s_waitcnt vmcnt(0)
    v_readfirstlane_b32 s79, v244
    s_nop 1
    s_cmp_lt_u32 s79, 8
    s_cbranch_scc0 L_fb10
    s_sub_u32 s67, s67, 1
    s_cbranch_scc0 L_fs10
    s_endpgm
L_fs11:
    s_sleep 2
    buffer_load_dword v244, off, s[72:75], s60 sc1
    s_waitcnt vmcnt(0)
    v_readfirstlane_b32 s79, v244
    s_nop 1
    s_cmp_lt_u32 s79, 9
    s_cbranch_scc0 L_fb11
    s_sub_u32 s67, s67, 1
    s_cbranch_scc0 L_fs11
    s_endpgm
L_slow0:
    s_call_b64 s[6:7], L_rescale0
    s_branch L_back0
L_slow1:
    s_call_b64 s[6:7], L_rescale0
    s_branch L_back1
L_slow2:
    s_call_b64 s[6:7], L_rescale0
    s_branch L_back2
L_slow3:
    s_call_b64 s[6:7], L_rescale0
    s_branch L_back3
L_rescale0:
    s_nop 15
    v_max_f32 v233, v24, v25
    v_max_f32 v234, v28, v29
    v_max_f32 v235, v32, v33
    v_max3_f32 v233, v233, v26, v27
    v_max3_f32 v234, v234, v30, v31
    v_max3_f32 v235, v235, v34, v35
    v_max3_f32 v233, v233, v36, v37
    v_max3_f32 v234, v234, v40, v41
    v_max3_f32 v235, v235, v44, v45
    v_max3_f32 v233, v233, v38, v39
    v_max3_f32 v234, v234, v42, v43
    v_max3_f32 v235, v235, v46, v47
    v_max3_f32 v233, v233, v72, v73
    v_max3_f32 v234, v234, v76, v77
    v_max3_f32 v235, v235, v80, v81
    v_max3_f32 v233, v233, v74, v75
    v_max3_f32 v234, v234, v78, v79
    v_max3_f32 v235, v235, v82, v83
    v_max3_f32 v233, v233, v84, v85
    v_max3_f32 v234, v234, v88, v89
    v_max3_f32 v235, v235, v92, v93
    v_max3_f32 v233, v233, v86, v87
    v_max3_f32 v234, v234, v90, v91
    v_max3_f32 v235, v235, v94, v95
    v_mov_b32 v236, v233
    v_mov_b32 v237, v234
    v_mov_b32 v238, v235
    v_permlane16_swap_b32 v233, v236
    v_permlane16_swap_b32 v234, v237
    v_permlane16_swap_b32 v235, v238
    v_max_f32 v233, v233, v236
    v_max_f32 v234, v234, v237
    v_max_f32 v235, v235, v238
    v_mov_b32 v236, v233
    v_mov_b32 v237, v234
    v_mov_b32 v238, v235
    v_permlane32_swap_b32 v233, v236
    v_permlane32_swap_b32 v234, v237
    v_permlane32_swap_b32 v235, v238
    v_max_f32 v233, v233, v236
    v_max_f32 v234, v234, v237
    v_max_f32 v235, v235, v238
    v_add_f32 v233, 0x42100000, v233
    v_add_f32 v234, 0x42100000, v234
    v_add_f32 v235, 0x42100000, v235
    v_max_f32 v233, 0, v233
    v_max_f32 v234, 0, v234
    v_max_f32 v235, 0, v235
    v_sub_f32 v240, v240, v233
    v_sub_f32 v241, v241, v233
    v_sub_f32 v242, v242, v233
    v_sub_f32 v243, v243, v233
    v_sub_f32 v24, v24, v233
    v_sub_f32 v25, v25, v233
    v_sub_f32 v26, v26, v233
    v_sub_f32 v27, v27, v233
    v_sub_f32 v36, v36, v233
    v_sub_f32 v37, v37, v233
    v_sub_f32 v38, v38, v233
    v_sub_f32 v39, v39, v233
    v_sub_f32 v72, v72, v233
    v_sub_f32 v73, v73, v233
    v_sub_f32 v74, v74, v233
    v_sub_f32 v75, v75, v233
    v_sub_f32 v84, v84, v233
    v_sub_f32 v85, v85, v233
    v_sub_f32 v86, v86, v233
    v_sub_f32 v87, v87, v233
    v_sub_f32 v244, v244, v234
    v_sub_f32 v245, v245, v234
    v_sub_f32 v246, v246, v234
    v_sub_f32 v247, v247, v234
    v_sub_f32 v28, v28, v234
    v_sub_f32 v29, v29, v234
    v_sub_f32 v30, v30, v234
    v_sub_f32 v31, v31, v234
    v_sub_f32 v40, v40, v234
    v_sub_f32 v41, v41, v234
    v_sub_f32 v42, v42, v234
    v_sub_f32 v43, v43, v234
    v_sub_f32 v76, v76, v234
    v_sub_f32 v77, v77, v234
    v_sub_f32 v78, v78, v234
    v_sub_f32 v79, v79, v234
    v_sub_f32 v88, v88, v234
    v_sub_f32 v89, v89, v234
    v_sub_f32 v90, v90, v234
    v_sub_f32 v91, v91, v234
    v_sub_f32 v248, v248, v235
    v_sub_f32 v249, v249, v235
    v_sub_f32 v250, v250, v235
    v_sub_f32 v251, v251, v235
    v_sub_f32 v32, v32, v235
    v_sub_f32 v33, v33, v235
    v_sub_f32 v34, v34, v235
    v_sub_f32 v35, v35, v235
    v_sub_f32 v44, v44, v235
    v_sub_f32 v45, v45, v235
    v_sub_f32 v46, v46, v235
    v_sub_f32 v47, v47, v235
    v_sub_f32 v80, v80, v235
    v_sub_f32 v81, v81, v235
    v_sub_f32 v82, v82, v235
    v_sub_f32 v83, v83, v235
    v_sub_f32 v92, v92, v235
    v_sub_f32 v93, v93, v235
    v_sub_f32 v94, v94, v235
    v_sub_f32 v95, v95, v235
    v_exp_f32_e64 v233, -v233
    v_exp_f32_e64 v234, -v234
    v_exp_f32_e64 v235, -v235
    v_mul_f32 v168, v168, v233
    v_mul_f32 v172, v172, v234
    v_mul_f32 v176, v176, v235
    v_accvgpr_read_b32 v220, a0
    v_accvgpr_read_b32 v221, a1
    v_accvgpr_read_b32 v222, a2
    v_accvgpr_read_b32 v223, a3
    v_mul_f32 v220, v220, v233
    v_mul_f32 v221, v221, v233
    v_mul_f32 v222, v222, v233
    v_mul_f32 v223, v223, v233
    v_accvgpr_write_b32 a0, v220
    v_accvgpr_write_b32 a1, v221
    v_accvgpr_write_b32 a2, v222
    v_accvgpr_write_b32 a3, v223
    v_accvgpr_read_b32 v220, a4
    v_accvgpr_read_b32 v221, a5
    v_accvgpr_read_b32 v222, a6
    v_accvgpr_read_b32 v223, a7
    v_mul_f32 v220, v220, v234
    v_mul_f32 v221, v221, v234
    v_mul_f32 v222, v222, v234
    v_mul_f32 v223, v223, v234
    v_accvgpr_write_b32 a4, v220
    v_accvgpr_write_b32 a5, v221
    v_accvgpr_write_b32 a6, v222
    v_accvgpr_write_b32 a7, v223
    v_accvgpr_read_b32 v220, a8
    v_accvgpr_read_b32 v221, a9
    v_accvgpr_read_b32 v222, a10
    v_accvgpr_read_b32 v223, a11
    v_mul_f32 v220, v220, v235
    v_mul_f32 v221, v221, v235
    v_mul_f32 v222, v222, v235
    v_mul_f32 v223, v223, v235
    v_accvgpr_write_b32 a8, v220
    v_accvgpr_write_b32 a9, v221
    v_accvgpr_write_b32 a10, v222
    v_accvgpr_write_b32 a11, v223
    v_accvgpr_read_b32 v220, a12
    v_accvgpr_read_b32 v221, a13
    v_accvgpr_read_b32 v222, a14
    v_accvgpr_read_b32 v223, a15
    v_mul_f32 v220, v220, v233
    v_mul_f32 v221, v221, v233
    v_mul_f32 v222, v222, v233
    v_mul_f32 v223, v223, v233
    v_accvgpr_write_b32 a12, v220
    v_accvgpr_write_b32 a13, v221
    v_accvgpr_write_b32 a14, v222
    v_accvgpr_write_b32 a15, v223
    v_accvgpr_read_b32 v220, a16
    v_accvgpr_read_b32 v221, a17
    v_accvgpr_read_b32 v222, a18
    v_accvgpr_read_b32 v223, a19
    v_mul_f32 v220, v220, v234
    v_mul_f32 v221, v221, v234
    v_mul_f32 v222, v222, v234
    v_mul_f32 v223, v223, v234
    v_accvgpr_write_b32 a16, v220
    v_accvgpr_write_b32 a17, v221
    v_accvgpr_write_b32 a18, v222
    v_accvgpr_write_b32 a19, v223
    v_accvgpr_read_b32 v220, a20
    v_accvgpr_read_b32 v221, a21
    v_accvgpr_read_b32 v222, a22
    v_accvgpr_read_b32 v223, a23
    v_mul_f32 v220, v220, v235
    v_mul_f32 v221, v221, v235
    v_mul_f32 v222, v222, v235
    v_mul_f32 v223, v223, v235
    v_accvgpr_write_b32 a20, v220
    v_accvgpr_write_b32 a21, v221
    v_accvgpr_write_b32 a22, v222
    v_accvgpr_write_b32 a23, v223
    v_accvgpr_read_b32 v220, a24
    v_accvgpr_read_b32 v221, a25
    v_accvgpr_read_b32 v222, a26
    v_accvgpr_read_b32 v223, a27
    v_mul_f32 v220, v220, v233
    v_mul_f32 v221, v221, v233
    v_mul_f32 v222, v222, v233
    v_mul_f32 v223, v223, v233
    v_accvgpr_write_b32 a24, v220
    v_accvgpr_write_b32 a25, v221
    v_accvgpr_write_b32 a26, v222
    v_accvgpr_write_b32 a27, v223
    v_accvgpr_read_b32 v220, a28
    v_accvgpr_read_b32 v221, a29
    v_accvgpr_read_b32 v222, a30
    v_accvgpr_read_b32 v223, a31
    v_mul_f32 v220, v220, v234
    v_mul_f32 v221, v221, v234
    v_mul_f32 v222, v222, v234
    v_mul_f32 v223, v223, v234
    v_accvgpr_write_b32 a28, v220
    v_accvgpr_write_b32 a29, v221
    v_accvgpr_write_b32 a30, v222
    v_accvgpr_write_b32 a31, v223
    v_accvgpr_read_b32 v220, a32
    v_accvgpr_read_b32 v221, a33
    v_accvgpr_read_b32 v222, a34
    v_accvgpr_read_b32 v223, a35
    v_mul_f32 v220, v220, v235
    v_mul_f32 v221, v221, v235
    v_mul_f32 v222, v222, v235
    v_mul_f32 v223, v223, v235
    v_accvgpr_write_b32 a32, v220
    v_accvgpr_write_b32 a33, v221
    v_accvgpr_write_b32 a34, v222
    v_accvgpr_write_b32 a35, v223
    v_accvgpr_read_b32 v220, a36
    v_accvgpr_read_b32 v221, a37
    v_accvgpr_read_b32 v222, a38
    v_accvgpr_read_b32 v223, a39
    v_mul_f32 v220, v220, v233
    v_mul_f32 v221, v221, v233
    v_mul_f32 v222, v222, v233
    v_mul_f32 v223, v223, v233
    v_accvgpr_write_b32 a36, v220
    v_accvgpr_write_b32 a37, v221
    v_accvgpr_write_b32 a38, v222
    v_accvgpr_write_b32 a39, v223
    v_accvgpr_read_b32 v220, a40
    v_accvgpr_read_b32 v221, a41
    v_accvgpr_read_b32 v222, a42
    v_accvgpr_read_b32 v223, a43
    v_mul_f32 v220, v220, v234
    v_mul_f32 v221, v221, v234
    v_mul_f32 v222, v222, v234
    v_mul_f32 v223, v223, v234
    v_accvgpr_write_b32 a40, v220
    v_accvgpr_write_b32 a41, v221
    v_accvgpr_write_b32 a42, v222
    v_accvgpr_write_b32 a43, v223
    v_accvgpr_read_b32 v220, a44
    v_accvgpr_read_b32 v221, a45
    v_accvgpr_read_b32 v222, a46
    v_accvgpr_read_b32 v223, a47
    v_mul_f32 v220, v220, v235
    v_mul_f32 v221, v221, v235
    v_mul_f32 v222, v222, v235
    v_mul_f32 v223, v223, v235
    v_accvgpr_write_b32 a44, v220
    v_accvgpr_write_b32 a45, v221
    v_accvgpr_write_b32 a46, v222
    v_accvgpr_write_b32 a47, v223
    v_accvgpr_read_b32 v220, a48
    v_accvgpr_read_b32 v221, a49
    v_accvgpr_read_b32 v222, a50
    v_accvgpr_read_b32 v223, a51
    v_mul_f32 v220, v220, v233
    v_mul_f32 v221, v221, v233
    v_mul_f32 v222, v222, v233
    v_mul_f32 v223, v223, v233
    v_accvgpr_write_b32 a48, v220
    v_accvgpr_write_b32 a49, v221
    v_accvgpr_write_b32 a50, v222
    v_accvgpr_write_b32 a51, v223
    v_accvgpr_read_b32 v220, a52
    v_accvgpr_read_b32 v221, a53
    v_accvgpr_read_b32 v222, a54
    v_accvgpr_read_b32 v223, a55
    v_mul_f32 v220, v220, v234
    v_mul_f32 v221, v221, v234
    v_mul_f32 v222, v222, v234
    v_mul_f32 v223, v223, v234
    v_accvgpr_write_b32 a52, v220
    v_accvgpr_write_b32 a53, v221
    v_accvgpr_write_b32 a54, v222
    v_accvgpr_write_b32 a55, v223
    v_accvgpr_read_b32 v220, a56
    v_accvgpr_read_b32 v221, a57
    v_accvgpr_read_b32 v222, a58
    v_accvgpr_read_b32 v223, a59
    v_mul_f32 v220, v220, v235
    v_mul_f32 v221, v221, v235
    v_mul_f32 v222, v222, v235
    v_mul_f32 v223, v223, v235
    v_accvgpr_write_b32 a56, v220
    v_accvgpr_write_b32 a57, v221
    v_accvgpr_write_b32 a58, v222
    v_accvgpr_write_b32 a59, v223
    v_accvgpr_read_b32 v220, a60
    v_accvgpr_read_b32 v221, a61
    v_accvgpr_read_b32 v222, a62
    v_accvgpr_read_b32 v223, a63
    v_mul_f32 v220, v220, v233
    v_mul_f32 v221, v221, v233
    v_mul_f32 v222, v222, v233
    v_mul_f32 v223, v223, v233
    v_accvgpr_write_b32 a60, v220
    v_accvgpr_write_b32 a61, v221
    v_accvgpr_write_b32 a62, v222
    v_accvgpr_write_b32 a63, v223
    v_accvgpr_read_b32 v220, a64
    v_accvgpr_read_b32 v221, a65
    v_accvgpr_read_b32 v222, a66
    v_accvgpr_read_b32 v223, a67
    v_mul_f32 v220, v220, v234
    v_mul_f32 v221, v221, v234
    v_mul_f32 v222, v222, v234
    v_mul_f32 v223, v223, v234
    v_accvgpr_write_b32 a64, v220
    v_accvgpr_write_b32 a65, v221
    v_accvgpr_write_b32 a66, v222
    v_accvgpr_write_b32 a67, v223
    v_accvgpr_read_b32 v220, a68
    v_accvgpr_read_b32 v221, a69
    v_accvgpr_read_b32 v222, a70
    v_accvgpr_read_b32 v223, a71
    v_mul_f32 v220, v220, v235
    v_mul_f32 v221, v221, v235
    v_mul_f32 v222, v222, v235
    v_mul_f32 v223, v223, v235
    v_accvgpr_write_b32 a68, v220
    v_accvgpr_write_b32 a69, v221
    v_accvgpr_write_b32 a70, v222
    v_accvgpr_write_b32 a71, v223
    v_accvgpr_read_b32 v220, a72
    v_accvgpr_read_b32 v221, a73
    v_accvgpr_read_b32 v222, a74
    v_accvgpr_read_b32 v223, a75
    v_mul_f32 v220, v220, v233
    v_mul_f32 v221, v221, v233
    v_mul_f32 v222, v222, v233
    v_mul_f32 v223, v223, v233
    v_accvgpr_write_b32 a72, v220
    v_accvgpr_write_b32 a73, v221
    v_accvgpr_write_b32 a74, v222
    v_accvgpr_write_b32 a75, v223
    v_accvgpr_read_b32 v220, a76
    v_accvgpr_read_b32 v221, a77
    v_accvgpr_read_b32 v222, a78
    v_accvgpr_read_b32 v223, a79
    v_mul_f32 v220, v220, v234
    v_mul_f32 v221, v221, v234
    v_mul_f32 v222, v222, v234
    v_mul_f32 v223, v223, v234
    v_accvgpr_write_b32 a76, v220
    v_accvgpr_write_b32 a77, v221
    v_accvgpr_write_b32 a78, v222
    v_accvgpr_write_b32 a79, v223
    v_accvgpr_read_b32 v220, a80
    v_accvgpr_read_b32 v221, a81
    v_accvgpr_read_b32 v222, a82
    v_accvgpr_read_b32 v223, a83
    v_mul_f32 v220, v220, v235
    v_mul_f32 v221, v221, v235
    v_mul_f32 v222, v222, v235
    v_mul_f32 v223, v223, v235
    v_accvgpr_write_b32 a80, v220
    v_accvgpr_write_b32 a81, v221
    v_accvgpr_write_b32 a82, v222
    v_accvgpr_write_b32 a83, v223
    v_accvgpr_read_b32 v220, a84
    v_accvgpr_read_b32 v221, a85
    v_accvgpr_read_b32 v222, a86
    v_accvgpr_read_b32 v223, a87
    v_mul_f32 v220, v220, v233
    v_mul_f32 v221, v221, v233
    v_mul_f32 v222, v222, v233
    v_mul_f32 v223, v223, v233
    v_accvgpr_write_b32 a84, v220
    v_accvgpr_write_b32 a85, v221
    v_accvgpr_write_b32 a86, v222
    v_accvgpr_write_b32 a87, v223
    v_accvgpr_read_b32 v220, a88
    v_accvgpr_read_b32 v221, a89
    v_accvgpr_read_b32 v222, a90
    v_accvgpr_read_b32 v223, a91
    v_mul_f32 v220, v220, v234
    v_mul_f32 v221, v221, v234
    v_mul_f32 v222, v222, v234
    v_mul_f32 v223, v223, v234
    v_accvgpr_write_b32 a88, v220
    v_accvgpr_write_b32 a89, v221
    v_accvgpr_write_b32 a90, v222
    v_accvgpr_write_b32 a91, v223
    v_accvgpr_read_b32 v220, a92
    v_accvgpr_read_b32 v221, a93
    v_accvgpr_read_b32 v222, a94
    v_accvgpr_read_b32 v223, a95
    v_mul_f32 v220, v220, v235
    v_mul_f32 v221, v221, v235
    v_mul_f32 v222, v222, v235
    v_mul_f32 v223, v223, v235
    v_accvgpr_write_b32 a92, v220
    v_accvgpr_write_b32 a93, v221
    v_accvgpr_write_b32 a94, v222
    v_accvgpr_write_b32 a95, v223
    v_accvgpr_read_b32 v220, a96
    v_accvgpr_read_b32 v221, a97
    v_accvgpr_read_b32 v222, a98
    v_accvgpr_read_b32 v223, a99
    v_mul_f32 v220, v220, v233
    v_mul_f32 v221, v221, v233
    v_mul_f32 v222, v222, v233
    v_mul_f32 v223, v223, v233
    v_accvgpr_write_b32 a96, v220
    v_accvgpr_write_b32 a97, v221
    v_accvgpr_write_b32 a98, v222
    v_accvgpr_write_b32 a99, v223
    v_accvgpr_read_b32 v220, a100
    v_accvgpr_read_b32 v221, a101
    v_accvgpr_read_b32 v222, a102
    v_accvgpr_read_b32 v223, a103
    v_mul_f32 v220, v220, v234
    v_mul_f32 v221, v221, v234
    v_mul_f32 v222, v222, v234
    v_mul_f32 v223, v223, v234
    v_accvgpr_write_b32 a100, v220
    v_accvgpr_write_b32 a101, v221
    v_accvgpr_write_b32 a102, v222
    v_accvgpr_write_b32 a103, v223
    v_accvgpr_read_b32 v220, a104
    v_accvgpr_read_b32 v221, a105
    v_accvgpr_read_b32 v222, a106
    v_accvgpr_read_b32 v223, a107
    v_mul_f32 v220, v220, v235
    v_mul_f32 v221, v221, v235
    v_mul_f32 v222, v222, v235
    v_mul_f32 v223, v223, v235
    v_accvgpr_write_b32 a104, v220
    v_accvgpr_write_b32 a105, v221
    v_accvgpr_write_b32 a106, v222
    v_accvgpr_write_b32 a107, v223
    v_accvgpr_read_b32 v220, a108
    v_accvgpr_read_b32 v221, a109
    v_accvgpr_read_b32 v222, a110
    v_accvgpr_read_b32 v223, a111
    v_mul_f32 v220, v220, v233
    v_mul_f32 v221, v221, v233
    v_mul_f32 v222, v222, v233
    v_mul_f32 v223, v223, v233
    v_accvgpr_write_b32 a108, v220
    v_accvgpr_write_b32 a109, v221
    v_accvgpr_write_b32 a110, v222
    v_accvgpr_write_b32 a111, v223
    v_accvgpr_read_b32 v220, a112
    v_accvgpr_read_b32 v221, a113
    v_accvgpr_read_b32 v222, a114
    v_accvgpr_read_b32 v223, a115
    v_mul_f32 v220, v220, v234
    v_mul_f32 v221, v221, v234
    v_mul_f32 v222, v222, v234
    v_mul_f32 v223, v223, v234
    v_accvgpr_write_b32 a112, v220
    v_accvgpr_write_b32 a113, v221
    v_accvgpr_write_b32 a114, v222
    v_accvgpr_write_b32 a115, v223
    v_accvgpr_read_b32 v220, a116
    v_accvgpr_read_b32 v221, a117
    v_accvgpr_read_b32 v222, a118
    v_accvgpr_read_b32 v223, a119
    v_mul_f32 v220, v220, v235
    v_mul_f32 v221, v221, v235
    v_mul_f32 v222, v222, v235
    v_mul_f32 v223, v223, v235
    v_accvgpr_write_b32 a116, v220
    v_accvgpr_write_b32 a117, v221
    v_accvgpr_write_b32 a118, v222
    v_accvgpr_write_b32 a119, v223
    v_accvgpr_read_b32 v220, a120
    v_accvgpr_read_b32 v221, a121
    v_accvgpr_read_b32 v222, a122
    v_accvgpr_read_b32 v223, a123
    v_mul_f32 v220, v220, v233
    v_mul_f32 v221, v221, v233
    v_mul_f32 v222, v222, v233
    v_mul_f32 v223, v223, v233
    v_accvgpr_write_b32 a120, v220
    v_accvgpr_write_b32 a121, v221
    v_accvgpr_write_b32 a122, v222
    v_accvgpr_write_b32 a123, v223
    v_accvgpr_read_b32 v220, a124
    v_accvgpr_read_b32 v221, a125
    v_accvgpr_read_b32 v222, a126
    v_accvgpr_read_b32 v223, a127
    v_mul_f32 v220, v220, v234
    v_mul_f32 v221, v221, v234
    v_mul_f32 v222, v222, v234
    v_mul_f32 v223, v223, v234
    v_accvgpr_write_b32 a124, v220
    v_accvgpr_write_b32 a125, v221
    v_accvgpr_write_b32 a126, v222
    v_accvgpr_write_b32 a127, v223
    v_accvgpr_read_b32 v220, a128
    v_accvgpr_read_b32 v221, a129
    v_accvgpr_read_b32 v222, a130
    v_accvgpr_read_b32 v223, a131
    v_mul_f32 v220, v220, v235
    v_mul_f32 v221, v221, v235
    v_mul_f32 v222, v222, v235
    v_mul_f32 v223, v223, v235
    v_accvgpr_write_b32 a128, v220
    v_accvgpr_write_b32 a129, v221
    v_accvgpr_write_b32 a130, v222
    v_accvgpr_write_b32 a131, v223
    v_accvgpr_read_b32 v220, a132
    v_accvgpr_read_b32 v221, a133
    v_accvgpr_read_b32 v222, a134
    v_accvgpr_read_b32 v223, a135
    v_mul_f32 v220, v220, v233
    v_mul_f32 v221, v221, v233
    v_mul_f32 v222, v222, v233
    v_mul_f32 v223, v223, v233
    v_accvgpr_write_b32 a132, v220
    v_accvgpr_write_b32 a133, v221
    v_accvgpr_write_b32 a134, v222
    v_accvgpr_write_b32 a135, v223
    v_accvgpr_read_b32 v220, a136
    v_accvgpr_read_b32 v221, a137
    v_accvgpr_read_b32 v222, a138
    v_accvgpr_read_b32 v223, a139
    v_mul_f32 v220, v220, v234
    v_mul_f32 v221, v221, v234
    v_mul_f32 v222, v222, v234
    v_mul_f32 v223, v223, v234
    v_accvgpr_write_b32 a136, v220
    v_accvgpr_write_b32 a137, v221
    v_accvgpr_write_b32 a138, v222
    v_accvgpr_write_b32 a139, v223
    v_accvgpr_read_b32 v220, a140
    v_accvgpr_read_b32 v221, a141
    v_accvgpr_read_b32 v222, a142
    v_accvgpr_read_b32 v223, a143
    v_mul_f32 v220, v220, v235
    v_mul_f32 v221, v221, v235
    v_mul_f32 v222, v222, v235
    v_mul_f32 v223, v223, v235
    v_accvgpr_write_b32 a140, v220
    v_accvgpr_write_b32 a141, v221
    v_accvgpr_write_b32 a142, v222
    v_accvgpr_write_b32 a143, v223
    v_accvgpr_read_b32 v220, a144
    v_accvgpr_read_b32 v221, a145
    v_accvgpr_read_b32 v222, a146
    v_accvgpr_read_b32 v223, a147
    v_mul_f32 v220, v220, v233
    v_mul_f32 v221, v221, v233
    v_mul_f32 v222, v222, v233
    v_mul_f32 v223, v223, v233
    v_accvgpr_write_b32 a144, v220
    v_accvgpr_write_b32 a145, v221
    v_accvgpr_write_b32 a146, v222
    v_accvgpr_write_b32 a147, v223
    v_accvgpr_read_b32 v220, a148
    v_accvgpr_read_b32 v221, a149
    v_accvgpr_read_b32 v222, a150
    v_accvgpr_read_b32 v223, a151
    v_mul_f32 v220, v220, v234
    v_mul_f32 v221, v221, v234
    v_mul_f32 v222, v222, v234
    v_mul_f32 v223, v223, v234
    v_accvgpr_write_b32 a148, v220
    v_accvgpr_write_b32 a149, v221
    v_accvgpr_write_b32 a150, v222
    v_accvgpr_write_b32 a151, v223
    v_accvgpr_read_b32 v220, a152
    v_accvgpr_read_b32 v221, a153
    v_accvgpr_read_b32 v222, a154
    v_accvgpr_read_b32 v223, a155
    v_mul_f32 v220, v220, v235
    v_mul_f32 v221, v221, v235
    v_mul_f32 v222, v222, v235
    v_mul_f32 v223, v223, v235
    v_accvgpr_write_b32 a152, v220
    v_accvgpr_write_b32 a153, v221
    v_accvgpr_write_b32 a154, v222
    v_accvgpr_write_b32 a155, v223
    v_accvgpr_read_b32 v220, a156
    v_accvgpr_read_b32 v221, a157
    v_accvgpr_read_b32 v222, a158
    v_accvgpr_read_b32 v223, a159
    v_mul_f32 v220, v220, v233
    v_mul_f32 v221, v221, v233
    v_mul_f32 v222, v222, v233
    v_mul_f32 v223, v223, v233
    v_accvgpr_write_b32 a156, v220
    v_accvgpr_write_b32 a157, v221
    v_accvgpr_write_b32 a158, v222
    v_accvgpr_write_b32 a159, v223
    v_accvgpr_read_b32 v220, a160
    v_accvgpr_read_b32 v221, a161
    v_accvgpr_read_b32 v222, a162
    v_accvgpr_read_b32 v223, a163
    v_mul_f32 v220, v220, v234
    v_mul_f32 v221, v221, v234
    v_mul_f32 v222, v222, v234
    v_mul_f32 v223, v223, v234
    v_accvgpr_write_b32 a160, v220
    v_accvgpr_write_b32 a161, v221
    v_accvgpr_write_b32 a162, v222
    v_accvgpr_write_b32 a163, v223
    v_accvgpr_read_b32 v220, a164
    v_accvgpr_read_b32 v221, a165
    v_accvgpr_read_b32 v222, a166
    v_accvgpr_read_b32 v223, a167
    v_mul_f32 v220, v220, v235
    v_mul_f32 v221, v221, v235
    v_mul_f32 v222, v222, v235
    v_mul_f32 v223, v223, v235
    v_accvgpr_write_b32 a164, v220
    v_accvgpr_write_b32 a165, v221
    v_accvgpr_write_b32 a166, v222
    v_accvgpr_write_b32 a167, v223
    v_accvgpr_read_b32 v220, a168
    v_accvgpr_read_b32 v221, a169
    v_accvgpr_read_b32 v222, a170
    v_accvgpr_read_b32 v223, a171
    v_mul_f32 v220, v220, v233
    v_mul_f32 v221, v221, v233
    v_mul_f32 v222, v222, v233
    v_mul_f32 v223, v223, v233
    v_accvgpr_write_b32 a168, v220
    v_accvgpr_write_b32 a169, v221
    v_accvgpr_write_b32 a170, v222
    v_accvgpr_write_b32 a171, v223
    v_accvgpr_read_b32 v220, a172
    v_accvgpr_read_b32 v221, a173
    v_accvgpr_read_b32 v222, a174
    v_accvgpr_read_b32 v223, a175
    v_mul_f32 v220, v220, v234
    v_mul_f32 v221, v221, v234
    v_mul_f32 v222, v222, v234
    v_mul_f32 v223, v223, v234
    v_accvgpr_write_b32 a172, v220
    v_accvgpr_write_b32 a173, v221
    v_accvgpr_write_b32 a174, v222
    v_accvgpr_write_b32 a175, v223
    v_accvgpr_read_b32 v220, a176
    v_accvgpr_read_b32 v221, a177
    v_accvgpr_read_b32 v222, a178
    v_accvgpr_read_b32 v223, a179
    v_mul_f32 v220, v220, v235
    v_mul_f32 v221, v221, v235
    v_mul_f32 v222, v222, v235
    v_mul_f32 v223, v223, v235
    v_accvgpr_write_b32 a176, v220
    v_accvgpr_write_b32 a177, v221
    v_accvgpr_write_b32 a178, v222
    v_accvgpr_write_b32 a179, v223
    v_accvgpr_read_b32 v220, a180
    v_accvgpr_read_b32 v221, a181
    v_accvgpr_read_b32 v222, a182
    v_accvgpr_read_b32 v223, a183
    v_mul_f32 v220, v220, v233
    v_mul_f32 v221, v221, v233
    v_mul_f32 v222, v222, v233
    v_mul_f32 v223, v223, v233
    v_accvgpr_write_b32 a180, v220
    v_accvgpr_write_b32 a181, v221
    v_accvgpr_write_b32 a182, v222
    v_accvgpr_write_b32 a183, v223
    v_accvgpr_read_b32 v220, a184
    v_accvgpr_read_b32 v221, a185
    v_accvgpr_read_b32 v222, a186
    v_accvgpr_read_b32 v223, a187
    v_mul_f32 v220, v220, v234
    v_mul_f32 v221, v221, v234
    v_mul_f32 v222, v222, v234
    v_mul_f32 v223, v223, v234
    v_accvgpr_write_b32 a184, v220
    v_accvgpr_write_b32 a185, v221
    v_accvgpr_write_b32 a186, v222
    v_accvgpr_write_b32 a187, v223
    v_accvgpr_read_b32 v220, a188
    v_accvgpr_read_b32 v221, a189
    v_accvgpr_read_b32 v222, a190
    v_accvgpr_read_b32 v223, a191
    v_mul_f32 v220, v220, v235
    v_mul_f32 v221, v221, v235
    v_mul_f32 v222, v222, v235
    v_mul_f32 v223, v223, v235
    v_accvgpr_write_b32 a188, v220
    v_accvgpr_write_b32 a189, v221
    v_accvgpr_write_b32 a190, v222
    v_accvgpr_write_b32 a191, v223
    v_exp_f32 v220, v24
    v_exp_f32 v221, v25
    v_exp_f32 v222, v26
    v_exp_f32 v223, v27
    v_exp_f32 v224, v28
    v_cvt_pk_bf16_f32 v120, v220, v221
    v_cvt_pk_bf16_f32 v121, v222, v223
    v_exp_f32 v225, v29
    v_exp_f32 v226, v30
    v_or3_b32 v216, v120, v121, 0
    v_exp_f32 v227, v31
    v_exp_f32 v220, v32
    v_cvt_pk_bf16_f32 v124, v224, v225
    v_cvt_pk_bf16_f32 v125, v226, v227
    v_exp_f32 v221, v33
    v_exp_f32 v222, v34
    v_or3_b32 v216, v124, v125, v216
    v_exp_f32 v223, v35
    v_exp_f32 v224, v36
    v_cvt_pk_bf16_f32 v128, v220, v221
    v_cvt_pk_bf16_f32 v129, v222, v223
    v_exp_f32 v225, v37
    v_exp_f32 v226, v38
    v_or3_b32 v216, v128, v129, v216
    v_exp_f32 v227, v39
    v_exp_f32 v220, v40
    v_cvt_pk_bf16_f32 v122, v224, v225
    v_cvt_pk_bf16_f32 v123, v226, v227
    v_exp_f32 v221, v41
    v_exp_f32 v222, v42
    v_or3_b32 v216, v122, v123, v216
    v_exp_f32 v223, v43
    v_exp_f32 v224, v44
    v_cvt_pk_bf16_f32 v126, v220, v221
    v_cvt_pk_bf16_f32 v127, v222, v223
    v_exp_f32 v225, v45
    v_exp_f32 v226, v46
    v_or3_b32 v216, v126, v127, v216
    v_exp_f32 v227, v47
    v_exp_f32 v220, v72
    v_cvt_pk_bf16_f32 v130, v224, v225
    v_cvt_pk_bf16_f32 v131, v226, v227
    v_exp_f32 v221, v73
    v_exp_f32 v222, v74
    v_or3_b32 v216, v130, v131, v216
    v_exp_f32 v223, v75
    v_exp_f32 v224, v76
    v_cvt_pk_bf16_f32 v132, v220, v221
    v_cvt_pk_bf16_f32 v133, v222, v223
    v_exp_f32 v225, v77
    v_exp_f32 v226, v78
    v_or3_b32 v216, v132, v133, v216
    v_exp_f32 v227, v79
    v_exp_f32 v220, v80
    v_cvt_pk_bf16_f32 v136, v224, v225
    v_cvt_pk_bf16_f32 v137, v226, v227
    v_exp_f32 v221, v81
    v_exp_f32 v222, v82
    v_or3_b32 v216, v136, v137, v216
    v_exp_f32 v223, v83
    v_exp_f32 v224, v84
    v_cvt_pk_bf16_f32 v140, v220, v221
    v_cvt_pk_bf16_f32 v141, v222, v223
    v_exp_f32 v225, v85
    v_exp_f32 v226, v86
    v_or3_b32 v216, v140, v141, v216
    v_exp_f32 v227, v87
    v_exp_f32 v220, v88
    v_cvt_pk_bf16_f32 v134, v224, v225
    v_cvt_pk_bf16_f32 v135, v226, v227
    v_exp_f32 v221, v89
    v_exp_f32 v222, v90
    v_or3_b32 v216, v134, v135, v216
    v_exp_f32 v223, v91
    v_exp_f32 v224, v92
    v_cvt_pk_bf16_f32 v138, v220, v221
    v_cvt_pk_bf16_f32 v139, v222, v223
    v_exp_f32 v225, v93
    v_exp_f32 v226, v94
    v_or3_b32 v216, v138, v139, v216
    v_exp_f32 v227, v95
    v_cvt_pk_bf16_f32 v142, v224, v225
    v_cvt_pk_bf16_f32 v143, v226, v227
    v_or3_b32 v216, v142, v143, v216
    s_nop 3
    s_setpc_b64 s[6:7]
.section .rodata,"a"
.p2align 6
.amdhsa_kernel concat_heads__mha_block_cached__gqa_block_cached__near_ridge_kernel
  .amdhsa_next_free_vgpr 512
  .amdhsa_next_free_sgpr 102
  .amdhsa_accum_offset 256
  .amdhsa_group_segment_fixed_size 0
  .amdhsa_kernarg_size 104
  .amdhsa_user_sgpr_count 2
  .amdhsa_user_sgpr_kernarg_segment_ptr 1
  .amdhsa_system_sgpr_workgroup_id_x 1
.end_amdhsa_kernel
```
